```python
import torch

def _softmax(x, axis=-1):
    return torch.softmax(x, dim=axis)
def _gelu(x):
    return torch.nn.functional.gelu(x, approximate="tanh")
def _silu(x):
    return torch.nn.functional.silu(x)
def _sigmoid(x):
    return torch.sigmoid(x)
def _layernorm(x, axis=-1, eps=1e-5):
    m = x.mean(dim=axis, keepdim=True)
    v = x.var(dim=axis, keepdim=True, unbiased=False)
    return (x - m) / torch.sqrt(v + eps)
def _scatter_add(tgt, idx, src, axis=0):
    return tgt.clone().index_add_(axis, idx, src)
def _segment_sum(src, seg, n):
    out = torch.zeros((n,) + src.shape[1:], dtype=src.dtype)
    return out.index_add_(0, seg, src)
def _pad(x, pw):
    flat = tuple(v for pair in reversed(pw) for v in pair)
    return torch.nn.functional.pad(x, flat)

kernel_name = 'parallel_sum__compressed_kv_cla__glu_gated_reglu__prompt'

def setup_inputs():

    _w = (lambda a: (lambda t: t.to(torch.bfloat16) if t.is_floating_point() else t)(torch.as_tensor(a)))
    def _A_setup():
        B, H, Sq, Sk, D, M = 1, 32, 2048, 2048, 128, 512
        Dc = 4 * D
        return {
            "x": _w((lambda *s: torch.randn(*s, dtype=torch.bfloat16) * 0.05)(B, Sq, M)),
            "c_kv": _w((lambda *s: torch.randn(*s, dtype=torch.bfloat16) * 0.4)(B, Sk, Dc)),
            "w_q": _w((lambda *s: torch.randn(*s, dtype=torch.bfloat16) * 1.6)(M, H, D) * (M ** -0.5)),
            "w_uk": _w((lambda *s: torch.randn(*s, dtype=torch.bfloat16) * 1.6)(Dc, H, D) * (Dc ** -0.5)),
            "w_uv": _w((lambda *s: torch.randn(*s, dtype=torch.bfloat16) * 0.4)(Dc, H, D) * (Dc ** -0.5)),
            "w_o": _w((lambda *s: torch.randn(*s, dtype=torch.bfloat16) * 0.4)(H, D, M) * ((H * D) ** -0.5)),
        }
    _A_in = _A_setup()

    def _B_setup():
        B, S, D, F = 1, 2048, 512, 1376
        return {
            "x": _w((lambda *s: torch.randn(*s, dtype=torch.bfloat16) * 0.05)(B, S, D)),
            "W_gate": _w((lambda *s: torch.randn(*s, dtype=torch.bfloat16) * 0.2)(D, F) * (2.0 / D) ** 0.5),
            "W_up": _w((lambda *s: torch.randn(*s, dtype=torch.bfloat16) * 0.2)(D, F) * (2.0 / D) ** 0.5),
            "W_down": _w((lambda *s: torch.randn(*s, dtype=torch.bfloat16) * 0.2)(F, D) * (1.0 / F) ** 0.5),
        }
    _B_in = _B_setup()

    return {
        "A_x": _A_in["x"],
        "A_c_kv": _A_in["c_kv"],
        "A_w_q": _A_in["w_q"],
        "A_w_uk": _A_in["w_uk"],
        "A_w_uv": _A_in["w_uv"],
        "A_w_o": _A_in["w_o"],
        "B_x": _B_in["x"],
        "B_W_gate": _B_in["W_gate"],
        "B_W_up": _B_in["W_up"],
        "B_W_down": _B_in["W_down"],
    }

def reference(A_x, A_c_kv, A_w_q, A_w_uk, A_w_uv, A_w_o, B_x, B_W_gate, B_W_up, B_W_down):
    def _A_ref(x, c_kv, w_q, w_uk, w_uv, w_o):
        B, Sq, M = x.shape[0], x.shape[1], x.shape[2]
        Sk = c_kv.shape[1]
        H, D = w_q.shape[1], w_q.shape[2]
        q = torch.einsum("bqm,mhd->bhqd", x, w_q)
        k = torch.einsum("bkc,chd->bhkd", c_kv, w_uk)
        v = torch.einsum("bkc,chd->bhkd", c_kv, w_uv)
        scores = torch.einsum("bhqd,bhkd->bhqk", q, k) * (D ** -0.5)
        off = Sk - Sq
        qi = torch.arange(Sq)[:, None]
        kj = torch.arange(Sk)[None, :]
        cmask = kj <= (qi + off)
        scores = torch.where(cmask[None, None], scores, -1e9)
        p = _softmax(scores, axis=-1)
        ctx = torch.einsum("bhqk,bhkd->bhqd", p, v)
        return torch.einsum("bhqd,hdm->bqm", ctx, w_o)

    def _B_ref(x, W_gate, W_up, W_down):
        gate = torch.einsum("bsd,df->bsf", x, W_gate)
        up = torch.einsum("bsd,df->bsf", x, W_up)
        gate = gate * (lambda x, dt: x.to(dt))(gate > 0, gate.dtype)
        h = gate * up
        return torch.einsum("bsf,fd->bsd", h, W_down)

    x = A_x
    xn = _layernorm(x, axis=-1)
    return x + _A_ref(xn, A_c_kv, A_w_q, A_w_uk, A_w_uv, A_w_o) + _B_ref(xn, B_W_gate, B_W_up, B_W_down)
```

```asm
; @launch grid=(256,1,1) block=(512,1,1) lds=163840
.amdgcn_target "amdgcn-amd-amdhsa--gfx950"
.text
.globl parallel_sum__compressed_kv_cla__glu_gated_reglu__prompt_kernel
.p2align 8
.type parallel_sum__compressed_kv_cla__glu_gated_reglu__prompt_kernel,@function
parallel_sum__compressed_kv_cla__glu_gated_reglu__prompt_kernel:
    s_cmp_ge_u32 s2, 256
    s_cbranch_scc1 F_end
    s_load_dwordx4 s[4:7], s[0:1], 0
    s_load_dwordx4 s[8:11], s[0:1], 24
    s_load_dwordx2 s[12:13], s[0:1], 96
    s_load_dwordx2 s[14:15], s[0:1], 16
    s_load_dwordx4 s[96:99], s[0:1], 56
    v_lshrrev_b32 v1, 6, v0
    v_and_b32 v255, 63, v0
    s_and_b32 s54, s2, 7
    v_readfirstlane_b32 s50, v1
    s_lshr_b32 s49, s2, 3
    s_and_b32 s48, s49, 3
    s_lshl_b32 s54, s54, 2
    s_add_u32 s48, s48, s54
    s_lshr_b32 s49, s49, 2
    s_lshl_b32 s58, s50, 10
    s_lshl_b32 s59, s50, 11
    s_lshl_b32 s60, s50, 12
    v_lshlrev_b32 v254, 4, v255
    s_waitcnt lgkmcnt(0)
    s_mov_b32 s32, s4
    s_and_b32 s33, s5, 0xffff
    s_mov_b32 s34, 2097152
    s_mov_b32 s35, 0x20000
    s_mov_b32 s20, s6
    s_and_b32 s21, s7, 0xffff
    s_mov_b32 s22, 2097152
    s_mov_b32 s23, 0x20000
    s_mov_b32 s24, s8
    s_and_b32 s25, s9, 0xffff
    s_mov_b32 s26, 4194304
    s_mov_b32 s27, 0x20000
    s_mov_b32 s28, s10
    s_and_b32 s29, s11, 0xffff
    s_mov_b32 s30, 4194304
    s_mov_b32 s31, 0x20000
    s_mov_b32 s16, s12
    s_and_b32 s17, s13, 0xffff
    s_mov_b32 s18, 83886080
    s_mov_b32 s19, 0x20000
    s_mov_b32 s36, s14
    s_and_b32 s37, s15, 0xffff
    s_mov_b32 s38, 4194304
    s_mov_b32 s39, 0x20000
    s_mov_b32 s40, s96
    s_and_b32 s41, s97, 0xffff
    s_mov_b32 s42, 1409024
    s_mov_b32 s43, 0x20000
    s_mov_b32 s44, s98
    s_and_b32 s45, s99, 0xffff
    s_mov_b32 s46, 1409024
    s_mov_b32 s47, 0x20000
    s_mov_b32 s54, 58720256
    buffer_load_dword v251, off, s[16:19], s54 sc1
    v_lshrrev_b32 v1, 3, v255
    v_lshrrev_b32 v2, 4, v255
    v_and_b32 v3, 7, v255
    v_xor_b32 v2, v2, v3
    v_mov_b32 v3, s50
    v_lshl_add_u32 v1, v3, 6, v1
    v_lshlrev_b32 v1, 10, v1
    v_lshl_add_u32 v241, v2, 4, v1
    v_xor_b32 v2, 4, v2
    v_lshl_add_u32 v242, v2, 4, v1
    v_add_u32 v242, 7168, v242
    s_lshl_b32 s4, s49, 18
    s_lshl_b32 s5, s50, 13
    v_lshrrev_b32 v1, 4, v255
    s_bfe_u32 s54, s50, 0x10001
    s_lshl_b32 s54, s54, 2
    v_or_b32 v2, s54, v1
    v_lshlrev_b32 v2, 1, v2
    v_and_b32 v4, 15, v255
    v_xor_b32 v2, v2, v4
    v_lshl_add_u32 v1, v3, 2, v1
    v_lshlrev_b32 v1, 13, v1
    v_lshl_add_u32 v1, v2, 4, v1
    s_lshl_b32 s54, s48, 8
    v_add_u32 v243, s54, v1
    s_cmp_ge_u32 s50, 4
    s_cbranch_scc1 H_start
    s_mov_b32 s56, 0
    s_add_u32 m0, s58, 98304
    s_nop 0
    buffer_load_dwordx4 v243, s[24:27], s56 offen lds
    s_add_u32 m0, s58, 106496
    s_nop 0
    buffer_load_dwordx4 v243, s[28:31], s56 offen lds
    s_mov_b32 s56, 131072
    s_add_u32 m0, s58, 102400
    s_nop 0
    buffer_load_dwordx4 v243, s[24:27], s56 offen lds
    s_add_u32 m0, s58, 110592
    s_nop 0
    buffer_load_dwordx4 v243, s[28:31], s56 offen lds
    s_add_u32 m0, s5, 32768
    s_add_u32 s56, s4, 0
    buffer_load_dwordx4 v241, s[20:23], s56 offen offset:0 lds
    buffer_load_dwordx4 v242, s[20:23], s56 offen offset:1024 lds
    s_add_u32 s56, s4, 14336
    buffer_load_dwordx4 v241, s[20:23], s56 offen offset:2048 lds
    buffer_load_dwordx4 v242, s[20:23], s56 offen offset:3072 lds
    s_add_u32 m0, s5, 36864
    s_add_u32 s56, s4, 32768
    buffer_load_dwordx4 v241, s[20:23], s56 offen offset:0 lds
    buffer_load_dwordx4 v242, s[20:23], s56 offen offset:1024 lds
    s_add_u32 s56, s4, 47104
    buffer_load_dwordx4 v241, s[20:23], s56 offen offset:2048 lds
    buffer_load_dwordx4 v242, s[20:23], s56 offen offset:3072 lds
    s_mov_b32 s56, 262144
    s_add_u32 m0, s58, 114688
    s_nop 0
    buffer_load_dwordx4 v243, s[24:27], s56 offen lds
    s_add_u32 m0, s58, 122880
    s_nop 0
    buffer_load_dwordx4 v243, s[28:31], s56 offen lds
    s_mov_b32 s56, 393216
    s_add_u32 m0, s58, 118784
    s_nop 0
    buffer_load_dwordx4 v243, s[24:27], s56 offen lds
    s_add_u32 m0, s58, 126976
    s_nop 0
    buffer_load_dwordx4 v243, s[28:31], s56 offen lds
    v_and_b32 v40, 15, v255
    v_lshrrev_b32 v41, 1, v40
    v_lshrrev_b32 v42, 4, v255
    v_xor_b32 v41, v41, v42
    s_and_b32 s54, s50, 3
    s_lshl_b32 s54, s54, 13
    s_add_u32 s54, s54, 32768
    v_lshlrev_b32 v40, 7, v40
    v_add_u32 v40, s54, v40
    v_lshl_add_u32 v240, v41, 4, v40
    v_xor_b32 v41, 4, v41
    v_lshl_add_u32 v247, v41, 4, v40
    v_bfe_u32 v40, v255, 2, 2
    v_lshl_add_u32 v41, v42, 3, v40
    v_lshlrev_b32 v41, 8, v41
    v_and_b32 v43, 3, v255
    v_lshl_add_u32 v41, v43, 3, v41
    s_lshr_b32 s54, s50, 2
    s_lshl_b32 s54, s54, 13
    s_add_u32 s54, s54, 98304
    v_add_u32 v41, s54, v41
    v_and_b32 v42, 1, v42
    v_lshl_add_u32 v40, v42, 2, v40
    v_xor_b32 v56, 0, v40
    v_lshl_add_u32 v56, v56, 5, v41
    v_xor_b32 v57, 1, v40
    v_lshl_add_u32 v57, v57, 5, v41
    v_xor_b32 v58, 2, v40
    v_lshl_add_u32 v58, v58, 5, v41
    v_xor_b32 v59, 3, v40
    v_lshl_add_u32 v59, v59, 5, v41
    v_xor_b32 v60, 4, v40
    v_lshl_add_u32 v60, v60, 5, v41
    v_xor_b32 v61, 5, v40
    v_lshl_add_u32 v61, v61, 5, v41
    v_xor_b32 v62, 6, v40
    v_lshl_add_u32 v62, v62, 5, v41
    v_xor_b32 v63, 7, v40
    v_lshl_add_u32 v63, v63, 5, v41
    s_mov_b32 s56, 524288
    s_add_u32 m0, s58, 131072
    s_nop 0
    buffer_load_dwordx4 v243, s[24:27], s56 offen lds
    s_add_u32 m0, s58, 139264
    s_nop 0
    buffer_load_dwordx4 v243, s[28:31], s56 offen lds
    s_mov_b32 s56, 655360
    s_add_u32 m0, s58, 135168
    s_nop 0
    buffer_load_dwordx4 v243, s[24:27], s56 offen lds
    s_add_u32 m0, s58, 143360
    s_nop 0
    buffer_load_dwordx4 v243, s[28:31], s56 offen lds
    s_add_u32 m0, s5, 65536
    s_add_u32 s56, s4, 128
    buffer_load_dwordx4 v241, s[20:23], s56 offen offset:0 lds
    buffer_load_dwordx4 v242, s[20:23], s56 offen offset:1024 lds
    s_add_u32 s56, s4, 14464
    buffer_load_dwordx4 v241, s[20:23], s56 offen offset:2048 lds
    buffer_load_dwordx4 v242, s[20:23], s56 offen offset:3072 lds
    s_add_u32 m0, s5, 69632
    s_add_u32 s56, s4, 32896
    buffer_load_dwordx4 v241, s[20:23], s56 offen offset:0 lds
    buffer_load_dwordx4 v242, s[20:23], s56 offen offset:1024 lds
    s_add_u32 s56, s4, 47232
    buffer_load_dwordx4 v241, s[20:23], s56 offen offset:2048 lds
    buffer_load_dwordx4 v242, s[20:23], s56 offen offset:3072 lds
    s_waitcnt vmcnt(24)
    s_waitcnt vmcnt(16)
    s_barrier
    ds_read_b128 v[192:195], v240 offset:0
    ds_read_b64_tr_b16 v[224:225], v56 offset:0
    ds_read_b64_tr_b16 v[226:227], v56 offset:1024
    ds_read_b128 v[196:199], v240 offset:2048
    ds_read_b64_tr_b16 v[228:229], v57 offset:0
    ds_read_b64_tr_b16 v[230:231], v57 offset:1024
    ds_read_b128 v[200:203], v240 offset:4096
    ds_read_b64_tr_b16 v[232:233], v58 offset:0
    ds_read_b64_tr_b16 v[234:235], v58 offset:1024
    ds_read_b128 v[204:207], v240 offset:6144
    s_waitcnt lgkmcnt(7)
    v_mfma_f32_16x16x32_bf16 v[64:67], v[224:227], v[192:195], 0
    ds_read_b64_tr_b16 v[236:237], v59 offset:0
    s_mov_b32 s56, 786432
    s_add_u32 m0, s58, 147456
    s_waitcnt lgkmcnt(7)
    v_mfma_f32_16x16x32_bf16 v[72:75], v[224:227], v[196:199], 0
    ds_read_b64_tr_b16 v[238:239], v59 offset:1024
    s_nop 0
    buffer_load_dwordx4 v243, s[24:27], s56 offen lds
    s_waitcnt lgkmcnt(5)
    v_mfma_f32_16x16x32_bf16 v[80:83], v[224:227], v[200:203], 0
    s_add_u32 m0, s58, 155648
    s_nop 0
    s_waitcnt lgkmcnt(2)
    v_mfma_f32_16x16x32_bf16 v[88:91], v[224:227], v[204:207], 0
    buffer_load_dwordx4 v243, s[28:31], s56 offen lds
    v_mfma_f32_16x16x32_bf16 v[68:71], v[228:231], v[192:195], 0
    ds_read_b64_tr_b16 v[224:225], v60 offset:0
    s_mov_b32 s56, 917504
    s_add_u32 m0, s58, 151552
    v_mfma_f32_16x16x32_bf16 v[76:79], v[228:231], v[196:199], 0
    ds_read_b64_tr_b16 v[226:227], v60 offset:1024
    s_nop 0
    buffer_load_dwordx4 v243, s[24:27], s56 offen lds
    v_mfma_f32_16x16x32_bf16 v[84:87], v[228:231], v[200:203], 0
    s_add_u32 m0, s58, 159744
    s_nop 0
    v_mfma_f32_16x16x32_bf16 v[92:95], v[228:231], v[204:207], 0
    buffer_load_dwordx4 v243, s[28:31], s56 offen lds
    v_mfma_f32_16x16x32_bf16 v[96:99], v[232:235], v[192:195], 0
    ds_read_b64_tr_b16 v[228:229], v61 offset:0
    v_mfma_f32_16x16x32_bf16 v[104:107], v[232:235], v[196:199], 0
    ds_read_b64_tr_b16 v[230:231], v61 offset:1024
    v_mfma_f32_16x16x32_bf16 v[112:115], v[232:235], v[200:203], 0
    v_mfma_f32_16x16x32_bf16 v[120:123], v[232:235], v[204:207], 0
    s_waitcnt lgkmcnt(4)
    v_mfma_f32_16x16x32_bf16 v[100:103], v[236:239], v[192:195], 0
    ds_read_b64_tr_b16 v[232:233], v62 offset:0
    v_mfma_f32_16x16x32_bf16 v[108:111], v[236:239], v[196:199], 0
    ds_read_b64_tr_b16 v[234:235], v62 offset:1024
    v_mfma_f32_16x16x32_bf16 v[116:119], v[236:239], v[200:203], 0
    v_mfma_f32_16x16x32_bf16 v[124:127], v[236:239], v[204:207], 0
    s_waitcnt lgkmcnt(4)
    v_mfma_f32_16x16x32_bf16 v[128:131], v[224:227], v[192:195], 0
    ds_read_b64_tr_b16 v[236:237], v63 offset:0
    v_mfma_f32_16x16x32_bf16 v[136:139], v[224:227], v[196:199], 0
    ds_read_b64_tr_b16 v[238:239], v63 offset:1024
    v_mfma_f32_16x16x32_bf16 v[144:147], v[224:227], v[200:203], 0
    v_mfma_f32_16x16x32_bf16 v[152:155], v[224:227], v[204:207], 0
    s_waitcnt lgkmcnt(4)
    v_mfma_f32_16x16x32_bf16 v[132:135], v[228:231], v[192:195], 0
    s_waitcnt vmcnt(16)
    s_waitcnt lgkmcnt(0)
    s_barrier
    v_add_u32 v251, 1, v251
    s_nop 0
    v_readfirstlane_b32 s51, v251
    ds_read_b128 v[208:211], v247 offset:0
    s_mov_b32 s56, 1048576
    s_add_u32 m0, s58, 98304
    v_mfma_f32_16x16x32_bf16 v[140:143], v[228:231], v[196:199], 0
    ds_read_b64_tr_b16 v[224:225], v56 offset:16384
    s_nop 0
    buffer_load_dwordx4 v243, s[24:27], s56 offen lds
    v_mfma_f32_16x16x32_bf16 v[148:151], v[228:231], v[200:203], 0
    ds_read_b64_tr_b16 v[226:227], v56 offset:17408
    s_add_u32 m0, s58, 106496
    s_nop 0
    v_mfma_f32_16x16x32_bf16 v[156:159], v[228:231], v[204:207], 0
    ds_read_b128 v[212:215], v247 offset:2048
    buffer_load_dwordx4 v243, s[28:31], s56 offen lds
    v_mfma_f32_16x16x32_bf16 v[160:163], v[232:235], v[192:195], 0
    ds_read_b64_tr_b16 v[228:229], v57 offset:16384
    s_mov_b32 s56, 1179648
    s_add_u32 m0, s58, 102400
    v_mfma_f32_16x16x32_bf16 v[168:171], v[232:235], v[196:199], 0
    ds_read_b64_tr_b16 v[230:231], v57 offset:17408
    s_nop 0
    buffer_load_dwordx4 v243, s[24:27], s56 offen lds
    v_mfma_f32_16x16x32_bf16 v[176:179], v[232:235], v[200:203], 0
    ds_read_b128 v[216:219], v247 offset:4096
    s_add_u32 m0, s58, 110592
    s_nop 0
    v_mfma_f32_16x16x32_bf16 v[184:187], v[232:235], v[204:207], 0
    buffer_load_dwordx4 v243, s[28:31], s56 offen lds
    v_mfma_f32_16x16x32_bf16 v[164:167], v[236:239], v[192:195], 0
    ds_read_b64_tr_b16 v[232:233], v58 offset:16384
    s_add_u32 m0, s5, 0
    s_add_u32 s56, s4, 256
    v_mfma_f32_16x16x32_bf16 v[172:175], v[236:239], v[196:199], 0
    ds_read_b64_tr_b16 v[234:235], v58 offset:17408
    buffer_load_dwordx4 v241, s[20:23], s56 offen offset:0 lds
    v_mfma_f32_16x16x32_bf16 v[180:183], v[236:239], v[200:203], 0
    ds_read_b128 v[220:223], v247 offset:6144
    buffer_load_dwordx4 v242, s[20:23], s56 offen offset:1024 lds
    v_mfma_f32_16x16x32_bf16 v[188:191], v[236:239], v[204:207], 0
    s_add_u32 s56, s4, 14592
    buffer_load_dwordx4 v241, s[20:23], s56 offen offset:2048 lds
    s_waitcnt lgkmcnt(7)
    v_mfma_f32_16x16x32_bf16 v[64:67], v[224:227], v[208:211], v[64:67]
    ds_read_b64_tr_b16 v[236:237], v59 offset:16384
    buffer_load_dwordx4 v242, s[20:23], s56 offen offset:3072 lds
    s_waitcnt lgkmcnt(7)
    v_mfma_f32_16x16x32_bf16 v[72:75], v[224:227], v[212:215], v[72:75]
    ds_read_b64_tr_b16 v[238:239], v59 offset:17408
    s_add_u32 m0, s5, 4096
    s_add_u32 s56, s4, 33024
    s_waitcnt lgkmcnt(5)
    v_mfma_f32_16x16x32_bf16 v[80:83], v[224:227], v[216:219], v[80:83]
    buffer_load_dwordx4 v241, s[20:23], s56 offen offset:0 lds
    s_waitcnt lgkmcnt(2)
    v_mfma_f32_16x16x32_bf16 v[88:91], v[224:227], v[220:223], v[88:91]
    buffer_load_dwordx4 v242, s[20:23], s56 offen offset:1024 lds
    v_mfma_f32_16x16x32_bf16 v[68:71], v[228:231], v[208:211], v[68:71]
    ds_read_b64_tr_b16 v[224:225], v60 offset:16384
    s_add_u32 s56, s4, 47360
    buffer_load_dwordx4 v241, s[20:23], s56 offen offset:2048 lds
    v_mfma_f32_16x16x32_bf16 v[76:79], v[228:231], v[212:215], v[76:79]
    ds_read_b64_tr_b16 v[226:227], v60 offset:17408
    buffer_load_dwordx4 v242, s[20:23], s56 offen offset:3072 lds
    v_mfma_f32_16x16x32_bf16 v[84:87], v[228:231], v[216:219], v[84:87]
    s_lshl_b32 s54, s48, 6
    s_lshl_b32 s55, s49, 3
    v_mfma_f32_16x16x32_bf16 v[92:95], v[228:231], v[220:223], v[92:95]
    s_add_u32 s54, s54, s55
    s_and_b32 s55, s50, 3
    v_mfma_f32_16x16x32_bf16 v[96:99], v[232:235], v[208:211], v[96:99]
    ds_read_b64_tr_b16 v[228:229], v61 offset:16384
    s_lshl_b32 s55, s55, 1
    s_add_u32 s54, s54, s55
    v_mfma_f32_16x16x32_bf16 v[104:107], v[232:235], v[212:215], v[104:107]
    ds_read_b64_tr_b16 v[230:231], v61 offset:17408
    s_lshl_b32 s54, s54, 13
    s_add_u32 s6, s54, 2097152
    v_mfma_f32_16x16x32_bf16 v[112:115], v[232:235], v[216:219], v[112:115]
    s_add_u32 s7, s6, 4096
    s_add_u32 s8, s6, 8192
    v_mfma_f32_16x16x32_bf16 v[120:123], v[232:235], v[220:223], v[120:123]
    s_add_u32 s9, s6, 12288
    v_and_b32 v44, 15, v255
    s_waitcnt lgkmcnt(4)
    v_mfma_f32_16x16x32_bf16 v[100:103], v[236:239], v[208:211], v[100:103]
    ds_read_b64_tr_b16 v[232:233], v62 offset:16384
    v_lshlrev_b32 v44, 4, v44
    v_bfe_u32 v45, v255, 4, 1
    v_mfma_f32_16x16x32_bf16 v[108:111], v[236:239], v[212:215], v[108:111]
    ds_read_b64_tr_b16 v[234:235], v62 offset:17408
    v_lshl_add_u32 v46, v45, 9, v44
    v_lshrrev_b32 v47, 5, v255
    v_mfma_f32_16x16x32_bf16 v[116:119], v[236:239], v[216:219], v[116:119]
    v_lshl_add_u32 v244, v47, 10, v46
    v_mul_u32_u24 v45, 175104, v45
    v_mfma_f32_16x16x32_bf16 v[124:127], v[236:239], v[220:223], v[124:127]
    v_add_u32 v44, v44, v45
    v_lshl_add_u32 v253, v47, 8, v44
    s_waitcnt lgkmcnt(4)
    v_mfma_f32_16x16x32_bf16 v[128:131], v[224:227], v[208:211], v[128:131]
    ds_read_b64_tr_b16 v[236:237], v63 offset:16384
    s_lshl_b32 s54, s49, 2
    s_add_u32 s52, s54, s50
    v_mfma_f32_16x16x32_bf16 v[136:139], v[224:227], v[212:215], v[136:139]
    ds_read_b64_tr_b16 v[238:239], v63 offset:17408
    s_lshl_b32 s54, s49, 1
    s_sub_u32 s53, 32, s54
    v_mfma_f32_16x16x32_bf16 v[144:147], v[224:227], v[216:219], v[144:147]
    s_lshl_b32 s13, s52, 15
    s_mul_i32 s55, s52, 350208
    v_mfma_f32_16x16x32_bf16 v[152:155], v[224:227], v[220:223], v[152:155]
    s_add_u32 s55, s55, 35782656
    s_mul_i32 s96, s48, 96
    s_waitcnt lgkmcnt(4)
    v_mfma_f32_16x16x32_bf16 v[132:135], v[228:231], v[208:211], v[132:135]
    s_mul_i32 s54, s48, 1536
    s_add_u32 s99, s54, s55
    s_add_u32 s100, s99, 512
    s_add_u32 s101, s99, 1024
    s_waitcnt vmcnt(24)
    s_waitcnt vmcnt(16)
    s_waitcnt lgkmcnt(0)
    s_barrier
    v_add_u32 v240, 32768, v240
    v_add_u32 v247, 32768, v247
    s_getreg_b32 s15, hwreg(HW_REG_XCC_ID)
    s_lshl_b32 s15, s15, 28
    s_add_u32 s15, s15, s51
    ds_read_b128 v[192:195], v240 offset:0
    s_mov_b32 s56, 1310720
    s_add_u32 m0, s58, 114688
    v_mfma_f32_16x16x32_bf16 v[140:143], v[228:231], v[212:215], v[140:143]
    ds_read_b64_tr_b16 v[224:225], v56 offset:32768
    s_nop 0
    buffer_load_dwordx4 v243, s[24:27], s56 offen lds
    v_mfma_f32_16x16x32_bf16 v[148:151], v[228:231], v[216:219], v[148:151]
    ds_read_b64_tr_b16 v[226:227], v56 offset:33792
    s_add_u32 m0, s58, 122880
    s_nop 0
    v_mfma_f32_16x16x32_bf16 v[156:159], v[228:231], v[220:223], v[156:159]
    ds_read_b128 v[196:199], v240 offset:2048
    buffer_load_dwordx4 v243, s[28:31], s56 offen lds
    v_mfma_f32_16x16x32_bf16 v[160:163], v[232:235], v[208:211], v[160:163]
    ds_read_b64_tr_b16 v[228:229], v57 offset:32768
    s_mov_b32 s56, 1441792
    s_add_u32 m0, s58, 118784
    v_mfma_f32_16x16x32_bf16 v[168:171], v[232:235], v[212:215], v[168:171]
    ds_read_b64_tr_b16 v[230:231], v57 offset:33792
    s_nop 0
    buffer_load_dwordx4 v243, s[24:27], s56 offen lds
    v_mfma_f32_16x16x32_bf16 v[176:179], v[232:235], v[216:219], v[176:179]
    ds_read_b128 v[200:203], v240 offset:4096
    s_add_u32 m0, s58, 126976
    s_nop 0
    v_mfma_f32_16x16x32_bf16 v[184:187], v[232:235], v[220:223], v[184:187]
    buffer_load_dwordx4 v243, s[28:31], s56 offen lds
    v_mfma_f32_16x16x32_bf16 v[164:167], v[236:239], v[208:211], v[164:167]
    ds_read_b64_tr_b16 v[232:233], v58 offset:32768
    s_add_u32 m0, s5, 32768
    s_add_u32 s56, s4, 384
    v_mfma_f32_16x16x32_bf16 v[172:175], v[236:239], v[212:215], v[172:175]
    ds_read_b64_tr_b16 v[234:235], v58 offset:33792
    buffer_load_dwordx4 v241, s[20:23], s56 offen offset:0 lds
    v_mfma_f32_16x16x32_bf16 v[180:183], v[236:239], v[216:219], v[180:183]
    ds_read_b128 v[204:207], v240 offset:6144
    buffer_load_dwordx4 v242, s[20:23], s56 offen offset:1024 lds
    v_mfma_f32_16x16x32_bf16 v[188:191], v[236:239], v[220:223], v[188:191]
    s_add_u32 s56, s4, 14720
    buffer_load_dwordx4 v241, s[20:23], s56 offen offset:2048 lds
    s_waitcnt lgkmcnt(7)
    v_mfma_f32_16x16x32_bf16 v[64:67], v[224:227], v[192:195], v[64:67]
    ds_read_b64_tr_b16 v[236:237], v59 offset:32768
    buffer_load_dwordx4 v242, s[20:23], s56 offen offset:3072 lds
    s_waitcnt lgkmcnt(7)
    v_mfma_f32_16x16x32_bf16 v[72:75], v[224:227], v[196:199], v[72:75]
    ds_read_b64_tr_b16 v[238:239], v59 offset:33792
    s_add_u32 m0, s5, 36864
    s_add_u32 s56, s4, 33152
    s_waitcnt lgkmcnt(5)
    v_mfma_f32_16x16x32_bf16 v[80:83], v[224:227], v[200:203], v[80:83]
    buffer_load_dwordx4 v241, s[20:23], s56 offen offset:0 lds
    s_waitcnt lgkmcnt(2)
    v_mfma_f32_16x16x32_bf16 v[88:91], v[224:227], v[204:207], v[88:91]
    buffer_load_dwordx4 v242, s[20:23], s56 offen offset:1024 lds
    v_mfma_f32_16x16x32_bf16 v[68:71], v[228:231], v[192:195], v[68:71]
    ds_read_b64_tr_b16 v[224:225], v60 offset:32768
    s_add_u32 s56, s4, 47488
    buffer_load_dwordx4 v241, s[20:23], s56 offen offset:2048 lds
    v_mfma_f32_16x16x32_bf16 v[76:79], v[228:231], v[196:199], v[76:79]
    ds_read_b64_tr_b16 v[226:227], v60 offset:33792
    buffer_load_dwordx4 v242, s[20:23], s56 offen offset:3072 lds
    v_mfma_f32_16x16x32_bf16 v[84:87], v[228:231], v[200:203], v[84:87]
    v_mfma_f32_16x16x32_bf16 v[92:95], v[228:231], v[204:207], v[92:95]
    v_mfma_f32_16x16x32_bf16 v[96:99], v[232:235], v[192:195], v[96:99]
    ds_read_b64_tr_b16 v[228:229], v61 offset:32768
    v_mfma_f32_16x16x32_bf16 v[104:107], v[232:235], v[196:199], v[104:107]
    ds_read_b64_tr_b16 v[230:231], v61 offset:33792
    v_mfma_f32_16x16x32_bf16 v[112:115], v[232:235], v[200:203], v[112:115]
    v_mfma_f32_16x16x32_bf16 v[120:123], v[232:235], v[204:207], v[120:123]
    s_waitcnt lgkmcnt(4)
    v_mfma_f32_16x16x32_bf16 v[100:103], v[236:239], v[192:195], v[100:103]
    ds_read_b64_tr_b16 v[232:233], v62 offset:32768
    v_mfma_f32_16x16x32_bf16 v[108:111], v[236:239], v[196:199], v[108:111]
    ds_read_b64_tr_b16 v[234:235], v62 offset:33792
    v_mfma_f32_16x16x32_bf16 v[116:119], v[236:239], v[200:203], v[116:119]
    v_mfma_f32_16x16x32_bf16 v[124:127], v[236:239], v[204:207], v[124:127]
    s_waitcnt lgkmcnt(4)
    v_mfma_f32_16x16x32_bf16 v[128:131], v[224:227], v[192:195], v[128:131]
    ds_read_b64_tr_b16 v[236:237], v63 offset:32768
    v_mfma_f32_16x16x32_bf16 v[136:139], v[224:227], v[196:199], v[136:139]
    ds_read_b64_tr_b16 v[238:239], v63 offset:33792
    v_mfma_f32_16x16x32_bf16 v[144:147], v[224:227], v[200:203], v[144:147]
    v_mfma_f32_16x16x32_bf16 v[152:155], v[224:227], v[204:207], v[152:155]
    s_waitcnt lgkmcnt(4)
    v_mfma_f32_16x16x32_bf16 v[132:135], v[228:231], v[192:195], v[132:135]
    s_waitcnt vmcnt(24)
    s_waitcnt lgkmcnt(0)
    s_barrier
    s_cmp_lt_u32 s48, 28
    s_cselect_b32 s101, s101, 2146435072
    s_cmp_lt_u32 s48, 29
    s_cselect_b32 s99, s99, 2146435072
    s_cselect_b32 s100, s100, 2146435072
    v_lshrrev_b32 v44, 4, v255
    v_and_b32 v45, 15, v255
    v_lshlrev_b32 v46, 2, v44
    v_xor_b32 v45, v45, v46
    v_mov_b32 v46, s50
    v_lshl_add_u32 v44, v46, 4, v44
    v_lshlrev_b32 v44, 13, v44
    v_lshl_add_u32 v44, v45, 4, v44
    s_lshl_b32 s54, s48, 8
    v_add_u32 v245, s54, v44
    s_lshr_b32 s54, s50, 1
    s_mul_i32 s14, s54, 3072
    s_mul_i32 s55, s54, 88064
    v_add_u32 v44, 0, v255
    v_mul_u32_u24 v45, 171, v44
    v_lshrrev_b32 v45, 10, v45
    v_mul_u32_u24 v46, 6, v45
    v_sub_u32 v44, v44, v46
    v_mul_u32_u24 v45, 2752, v45
    v_lshl_add_u32 v44, v44, 4, v45
    v_add_u32 v44, s55, v44
    v_subrev_u32 v246, 0, v44
    v_add_u32 v44, 64, v255
    v_mul_u32_u24 v45, 171, v44
    v_lshrrev_b32 v45, 10, v45
    v_mul_u32_u24 v46, 6, v45
    v_sub_u32 v44, v44, v46
    v_mul_u32_u24 v45, 2752, v45
    v_lshl_add_u32 v44, v44, 4, v45
    v_add_u32 v44, s55, v44
    v_subrev_u32 v250, 1024, v44
    v_add_u32 v44, 128, v255
    v_mul_u32_u24 v45, 171, v44
    v_lshrrev_b32 v45, 10, v45
    v_mul_u32_u24 v46, 6, v45
    v_sub_u32 v44, v44, v46
    v_mul_u32_u24 v45, 2752, v45
    v_lshl_add_u32 v44, v44, 4, v45
    v_add_u32 v44, s55, v44
    v_subrev_u32 v252, 2048, v44
    s_and_b32 s54, s50, 1
    s_mul_i32 s55, s54, 6272
    s_add_u32 s14, s14, s55
    s_cmp_eq_u32 s54, 1
    s_cselect_b32 s40, s44, s40
    s_cselect_b32 s41, s45, s41
    s_cmp_lt_u32 s48, 29
    s_cselect_b32 s42, s42, 0
    ds_read_b128 v[208:211], v247 offset:0
    s_mov_b32 s56, 1572864
    s_add_u32 m0, s58, 131072
    v_mfma_f32_16x16x32_bf16 v[140:143], v[228:231], v[196:199], v[140:143]
    ds_read_b64_tr_b16 v[224:225], v56 offset:49152
    s_nop 0
    buffer_load_dwordx4 v243, s[24:27], s56 offen lds
    v_mfma_f32_16x16x32_bf16 v[148:151], v[228:231], v[200:203], v[148:151]
    ds_read_b64_tr_b16 v[226:227], v56 offset:50176
    s_add_u32 m0, s58, 139264
    s_nop 0
    v_mfma_f32_16x16x32_bf16 v[156:159], v[228:231], v[204:207], v[156:159]
    ds_read_b128 v[212:215], v247 offset:2048
    buffer_load_dwordx4 v243, s[28:31], s56 offen lds
    v_mfma_f32_16x16x32_bf16 v[160:163], v[232:235], v[192:195], v[160:163]
    ds_read_b64_tr_b16 v[228:229], v57 offset:49152
    s_mov_b32 s56, 1703936
    s_add_u32 m0, s58, 135168
    v_mfma_f32_16x16x32_bf16 v[168:171], v[232:235], v[196:199], v[168:171]
    ds_read_b64_tr_b16 v[230:231], v57 offset:50176
    s_nop 0
    buffer_load_dwordx4 v243, s[24:27], s56 offen lds
    v_mfma_f32_16x16x32_bf16 v[176:179], v[232:235], v[200:203], v[176:179]
    ds_read_b128 v[216:219], v247 offset:4096
    s_add_u32 m0, s58, 143360
    s_nop 0
    v_mfma_f32_16x16x32_bf16 v[184:187], v[232:235], v[204:207], v[184:187]
    buffer_load_dwordx4 v243, s[28:31], s56 offen lds
    v_mfma_f32_16x16x32_bf16 v[164:167], v[236:239], v[192:195], v[164:167]
    ds_read_b64_tr_b16 v[232:233], v58 offset:49152
    v_mfma_f32_16x16x32_bf16 v[172:175], v[236:239], v[196:199], v[172:175]
    ds_read_b64_tr_b16 v[234:235], v58 offset:50176
    v_mfma_f32_16x16x32_bf16 v[180:183], v[236:239], v[200:203], v[180:183]
    ds_read_b128 v[220:223], v247 offset:6144
    v_mfma_f32_16x16x32_bf16 v[188:191], v[236:239], v[204:207], v[188:191]
    s_waitcnt lgkmcnt(7)
    v_mfma_f32_16x16x32_bf16 v[64:67], v[224:227], v[208:211], v[64:67]
    ds_read_b64_tr_b16 v[236:237], v59 offset:49152
    s_waitcnt lgkmcnt(7)
    v_mfma_f32_16x16x32_bf16 v[72:75], v[224:227], v[212:215], v[72:75]
    ds_read_b64_tr_b16 v[238:239], v59 offset:50176
    s_waitcnt lgkmcnt(5)
    v_mfma_f32_16x16x32_bf16 v[80:83], v[224:227], v[216:219], v[80:83]
    s_waitcnt lgkmcnt(2)
    v_mfma_f32_16x16x32_bf16 v[88:91], v[224:227], v[220:223], v[88:91]
    v_mfma_f32_16x16x32_bf16 v[68:71], v[228:231], v[208:211], v[68:71]
    ds_read_b64_tr_b16 v[224:225], v60 offset:49152
    v_mfma_f32_16x16x32_bf16 v[76:79], v[228:231], v[212:215], v[76:79]
    ds_read_b64_tr_b16 v[226:227], v60 offset:50176
    v_mfma_f32_16x16x32_bf16 v[84:87], v[228:231], v[216:219], v[84:87]
    v_mfma_f32_16x16x32_bf16 v[92:95], v[228:231], v[220:223], v[92:95]
    v_mfma_f32_16x16x32_bf16 v[96:99], v[232:235], v[208:211], v[96:99]
    ds_read_b64_tr_b16 v[228:229], v61 offset:49152
    v_mfma_f32_16x16x32_bf16 v[104:107], v[232:235], v[212:215], v[104:107]
    ds_read_b64_tr_b16 v[230:231], v61 offset:50176
    v_mfma_f32_16x16x32_bf16 v[112:115], v[232:235], v[216:219], v[112:115]
    v_mfma_f32_16x16x32_bf16 v[120:123], v[232:235], v[220:223], v[120:123]
    s_waitcnt lgkmcnt(4)
    v_mfma_f32_16x16x32_bf16 v[100:103], v[236:239], v[208:211], v[100:103]
    ds_read_b64_tr_b16 v[232:233], v62 offset:49152
    v_mfma_f32_16x16x32_bf16 v[108:111], v[236:239], v[212:215], v[108:111]
    ds_read_b64_tr_b16 v[234:235], v62 offset:50176
    v_mfma_f32_16x16x32_bf16 v[116:119], v[236:239], v[216:219], v[116:119]
    v_mfma_f32_16x16x32_bf16 v[124:127], v[236:239], v[220:223], v[124:127]
    s_waitcnt lgkmcnt(4)
    v_mfma_f32_16x16x32_bf16 v[128:131], v[224:227], v[208:211], v[128:131]
    ds_read_b64_tr_b16 v[236:237], v63 offset:49152
    v_mfma_f32_16x16x32_bf16 v[136:139], v[224:227], v[212:215], v[136:139]
    ds_read_b64_tr_b16 v[238:239], v63 offset:50176
    v_mfma_f32_16x16x32_bf16 v[144:147], v[224:227], v[216:219], v[144:147]
    v_mfma_f32_16x16x32_bf16 v[152:155], v[224:227], v[220:223], v[152:155]
    s_waitcnt lgkmcnt(4)
    v_mfma_f32_16x16x32_bf16 v[132:135], v[228:231], v[208:211], v[132:135]
    s_waitcnt vmcnt(24)
    s_waitcnt vmcnt(16)
    s_waitcnt lgkmcnt(0)
    s_barrier
    v_add_u32 v240, 4294901760, v240
    v_add_u32 v247, 4294901760, v247
    ds_read_b128 v[192:195], v240 offset:0
    s_mov_b32 s56, 1835008
    s_add_u32 m0, s58, 147456
    v_mfma_f32_16x16x32_bf16 v[140:143], v[228:231], v[212:215], v[140:143]
    ds_read_b64_tr_b16 v[224:225], v56 offset:0
    s_nop 0
    buffer_load_dwordx4 v243, s[24:27], s56 offen lds
    v_mfma_f32_16x16x32_bf16 v[148:151], v[228:231], v[216:219], v[148:151]
    ds_read_b64_tr_b16 v[226:227], v56 offset:1024
    s_add_u32 m0, s58, 155648
    s_nop 0
    v_mfma_f32_16x16x32_bf16 v[156:159], v[228:231], v[220:223], v[156:159]
    ds_read_b128 v[196:199], v240 offset:2048
    buffer_load_dwordx4 v243, s[28:31], s56 offen lds
    v_mfma_f32_16x16x32_bf16 v[160:163], v[232:235], v[208:211], v[160:163]
    ds_read_b64_tr_b16 v[228:229], v57 offset:0
    s_mov_b32 s56, 1966080
    s_add_u32 m0, s58, 151552
    v_mfma_f32_16x16x32_bf16 v[168:171], v[232:235], v[212:215], v[168:171]
    ds_read_b64_tr_b16 v[230:231], v57 offset:1024
    s_nop 0
    buffer_load_dwordx4 v243, s[24:27], s56 offen lds
    v_mfma_f32_16x16x32_bf16 v[176:179], v[232:235], v[216:219], v[176:179]
    ds_read_b128 v[200:203], v240 offset:4096
    s_add_u32 m0, s58, 159744
    s_nop 0
    v_mfma_f32_16x16x32_bf16 v[184:187], v[232:235], v[220:223], v[184:187]
    buffer_load_dwordx4 v243, s[28:31], s56 offen lds
    v_mfma_f32_16x16x32_bf16 v[164:167], v[236:239], v[208:211], v[164:167]
    ds_read_b64_tr_b16 v[232:233], v58 offset:0
    s_add_u32 m0, s5, 65536
    s_add_u32 s56, s4, 512
    v_mfma_f32_16x16x32_bf16 v[172:175], v[236:239], v[212:215], v[172:175]
    ds_read_b64_tr_b16 v[234:235], v58 offset:1024
    buffer_load_dwordx4 v241, s[20:23], s56 offen offset:0 lds
    v_mfma_f32_16x16x32_bf16 v[180:183], v[236:239], v[216:219], v[180:183]
    ds_read_b128 v[204:207], v240 offset:6144
    buffer_load_dwordx4 v242, s[20:23], s56 offen offset:1024 lds
    v_mfma_f32_16x16x32_bf16 v[188:191], v[236:239], v[220:223], v[188:191]
    s_add_u32 s56, s4, 14848
    buffer_load_dwordx4 v241, s[20:23], s56 offen offset:2048 lds
    s_waitcnt lgkmcnt(7)
    v_mfma_f32_16x16x32_bf16 v[64:67], v[224:227], v[192:195], v[64:67]
    ds_read_b64_tr_b16 v[236:237], v59 offset:0
    buffer_load_dwordx4 v242, s[20:23], s56 offen offset:3072 lds
    s_waitcnt lgkmcnt(7)
    v_mfma_f32_16x16x32_bf16 v[72:75], v[224:227], v[196:199], v[72:75]
    ds_read_b64_tr_b16 v[238:239], v59 offset:1024
    s_add_u32 m0, s5, 69632
    s_add_u32 s56, s4, 33280
    s_waitcnt lgkmcnt(5)
    v_mfma_f32_16x16x32_bf16 v[80:83], v[224:227], v[200:203], v[80:83]
    buffer_load_dwordx4 v241, s[20:23], s56 offen offset:0 lds
    s_waitcnt lgkmcnt(2)
    v_mfma_f32_16x16x32_bf16 v[88:91], v[224:227], v[204:207], v[88:91]
    buffer_load_dwordx4 v242, s[20:23], s56 offen offset:1024 lds
    v_mfma_f32_16x16x32_bf16 v[68:71], v[228:231], v[192:195], v[68:71]
    ds_read_b64_tr_b16 v[224:225], v60 offset:0
    s_add_u32 s56, s4, 47616
    buffer_load_dwordx4 v241, s[20:23], s56 offen offset:2048 lds
    v_mfma_f32_16x16x32_bf16 v[76:79], v[228:231], v[196:199], v[76:79]
    ds_read_b64_tr_b16 v[226:227], v60 offset:1024
    buffer_load_dwordx4 v242, s[20:23], s56 offen offset:3072 lds
    v_mfma_f32_16x16x32_bf16 v[84:87], v[228:231], v[200:203], v[84:87]
    v_mfma_f32_16x16x32_bf16 v[92:95], v[228:231], v[204:207], v[92:95]
    v_mfma_f32_16x16x32_bf16 v[96:99], v[232:235], v[192:195], v[96:99]
    ds_read_b64_tr_b16 v[228:229], v61 offset:0
    v_mfma_f32_16x16x32_bf16 v[104:107], v[232:235], v[196:199], v[104:107]
    ds_read_b64_tr_b16 v[230:231], v61 offset:1024
    v_mfma_f32_16x16x32_bf16 v[112:115], v[232:235], v[200:203], v[112:115]
    v_mfma_f32_16x16x32_bf16 v[120:123], v[232:235], v[204:207], v[120:123]
    s_waitcnt lgkmcnt(4)
    v_mfma_f32_16x16x32_bf16 v[100:103], v[236:239], v[192:195], v[100:103]
    ds_read_b64_tr_b16 v[232:233], v62 offset:0
    v_mfma_f32_16x16x32_bf16 v[108:111], v[236:239], v[196:199], v[108:111]
    ds_read_b64_tr_b16 v[234:235], v62 offset:1024
    v_mfma_f32_16x16x32_bf16 v[116:119], v[236:239], v[200:203], v[116:119]
    v_mfma_f32_16x16x32_bf16 v[124:127], v[236:239], v[204:207], v[124:127]
    s_waitcnt lgkmcnt(4)
    v_mfma_f32_16x16x32_bf16 v[128:131], v[224:227], v[192:195], v[128:131]
    ds_read_b64_tr_b16 v[236:237], v63 offset:0
    v_mfma_f32_16x16x32_bf16 v[136:139], v[224:227], v[196:199], v[136:139]
    ds_read_b64_tr_b16 v[238:239], v63 offset:1024
    v_mfma_f32_16x16x32_bf16 v[144:147], v[224:227], v[200:203], v[144:147]
    v_mfma_f32_16x16x32_bf16 v[152:155], v[224:227], v[204:207], v[152:155]
    s_waitcnt lgkmcnt(4)
    v_mfma_f32_16x16x32_bf16 v[132:135], v[228:231], v[192:195], v[132:135]
    s_waitcnt vmcnt(24)
    s_waitcnt lgkmcnt(0)
    s_barrier
    ds_read_b128 v[208:211], v247 offset:0
    s_mov_b32 s56, 2097152
    s_add_u32 m0, s58, 98304
    v_mfma_f32_16x16x32_bf16 v[140:143], v[228:231], v[196:199], v[140:143]
    ds_read_b64_tr_b16 v[224:225], v56 offset:16384
    s_nop 0
    buffer_load_dwordx4 v243, s[24:27], s56 offen lds
    v_mfma_f32_16x16x32_bf16 v[148:151], v[228:231], v[200:203], v[148:151]
    ds_read_b64_tr_b16 v[226:227], v56 offset:17408
    s_add_u32 m0, s58, 106496
    s_nop 0
    v_mfma_f32_16x16x32_bf16 v[156:159], v[228:231], v[204:207], v[156:159]
    ds_read_b128 v[212:215], v247 offset:2048
    buffer_load_dwordx4 v243, s[28:31], s56 offen lds
    v_mfma_f32_16x16x32_bf16 v[160:163], v[232:235], v[192:195], v[160:163]
    ds_read_b64_tr_b16 v[228:229], v57 offset:16384
    s_mov_b32 s56, 2228224
    s_add_u32 m0, s58, 102400
    v_mfma_f32_16x16x32_bf16 v[168:171], v[232:235], v[196:199], v[168:171]
    ds_read_b64_tr_b16 v[230:231], v57 offset:17408
    s_nop 0
    buffer_load_dwordx4 v243, s[24:27], s56 offen lds
    v_mfma_f32_16x16x32_bf16 v[176:179], v[232:235], v[200:203], v[176:179]
    ds_read_b128 v[216:219], v247 offset:4096
    s_add_u32 m0, s58, 110592
    s_nop 0
    v_mfma_f32_16x16x32_bf16 v[184:187], v[232:235], v[204:207], v[184:187]
    buffer_load_dwordx4 v243, s[28:31], s56 offen lds
    v_mfma_f32_16x16x32_bf16 v[164:167], v[236:239], v[192:195], v[164:167]
    ds_read_b64_tr_b16 v[232:233], v58 offset:16384
    v_mfma_f32_16x16x32_bf16 v[172:175], v[236:239], v[196:199], v[172:175]
    ds_read_b64_tr_b16 v[234:235], v58 offset:17408
    v_mfma_f32_16x16x32_bf16 v[180:183], v[236:239], v[200:203], v[180:183]
    ds_read_b128 v[220:223], v247 offset:6144
    v_mfma_f32_16x16x32_bf16 v[188:191], v[236:239], v[204:207], v[188:191]
    s_waitcnt lgkmcnt(7)
    v_mfma_f32_16x16x32_bf16 v[64:67], v[224:227], v[208:211], v[64:67]
    ds_read_b64_tr_b16 v[236:237], v59 offset:16384
    s_waitcnt lgkmcnt(7)
    v_mfma_f32_16x16x32_bf16 v[72:75], v[224:227], v[212:215], v[72:75]
    ds_read_b64_tr_b16 v[238:239], v59 offset:17408
    s_waitcnt lgkmcnt(5)
    v_mfma_f32_16x16x32_bf16 v[80:83], v[224:227], v[216:219], v[80:83]
    s_waitcnt lgkmcnt(2)
    v_mfma_f32_16x16x32_bf16 v[88:91], v[224:227], v[220:223], v[88:91]
    v_mfma_f32_16x16x32_bf16 v[68:71], v[228:231], v[208:211], v[68:71]
    ds_read_b64_tr_b16 v[224:225], v60 offset:16384
    v_mfma_f32_16x16x32_bf16 v[76:79], v[228:231], v[212:215], v[76:79]
    ds_read_b64_tr_b16 v[226:227], v60 offset:17408
    v_mfma_f32_16x16x32_bf16 v[84:87], v[228:231], v[216:219], v[84:87]
    v_mfma_f32_16x16x32_bf16 v[92:95], v[228:231], v[220:223], v[92:95]
    v_mfma_f32_16x16x32_bf16 v[96:99], v[232:235], v[208:211], v[96:99]
    ds_read_b64_tr_b16 v[228:229], v61 offset:16384
    v_mfma_f32_16x16x32_bf16 v[104:107], v[232:235], v[212:215], v[104:107]
    ds_read_b64_tr_b16 v[230:231], v61 offset:17408
    v_mfma_f32_16x16x32_bf16 v[112:115], v[232:235], v[216:219], v[112:115]
    v_mfma_f32_16x16x32_bf16 v[120:123], v[232:235], v[220:223], v[120:123]
    s_waitcnt lgkmcnt(4)
    v_mfma_f32_16x16x32_bf16 v[100:103], v[236:239], v[208:211], v[100:103]
    ds_read_b64_tr_b16 v[232:233], v62 offset:16384
    v_mfma_f32_16x16x32_bf16 v[108:111], v[236:239], v[212:215], v[108:111]
    ds_read_b64_tr_b16 v[234:235], v62 offset:17408
    v_mfma_f32_16x16x32_bf16 v[116:119], v[236:239], v[216:219], v[116:119]
    v_mfma_f32_16x16x32_bf16 v[124:127], v[236:239], v[220:223], v[124:127]
    s_waitcnt lgkmcnt(4)
    v_mfma_f32_16x16x32_bf16 v[128:131], v[224:227], v[208:211], v[128:131]
    ds_read_b64_tr_b16 v[236:237], v63 offset:16384
    v_mfma_f32_16x16x32_bf16 v[136:139], v[224:227], v[212:215], v[136:139]
    ds_read_b64_tr_b16 v[238:239], v63 offset:17408
    v_mfma_f32_16x16x32_bf16 v[144:147], v[224:227], v[216:219], v[144:147]
    v_mfma_f32_16x16x32_bf16 v[152:155], v[224:227], v[220:223], v[152:155]
    s_waitcnt lgkmcnt(4)
    v_mfma_f32_16x16x32_bf16 v[132:135], v[228:231], v[208:211], v[132:135]
    s_waitcnt vmcnt(16)
    s_waitcnt lgkmcnt(0)
    s_barrier
    v_add_u32 v240, 32768, v240
    v_add_u32 v247, 32768, v247
    ds_read_b128 v[192:195], v240 offset:0
    s_mov_b32 s56, 2359296
    s_add_u32 m0, s58, 114688
    v_mfma_f32_16x16x32_bf16 v[140:143], v[228:231], v[212:215], v[140:143]
    ds_read_b64_tr_b16 v[224:225], v56 offset:32768
    s_nop 0
    buffer_load_dwordx4 v243, s[24:27], s56 offen lds
    v_mfma_f32_16x16x32_bf16 v[148:151], v[228:231], v[216:219], v[148:151]
    ds_read_b64_tr_b16 v[226:227], v56 offset:33792
    s_add_u32 m0, s58, 122880
    s_nop 0
    v_mfma_f32_16x16x32_bf16 v[156:159], v[228:231], v[220:223], v[156:159]
    ds_read_b128 v[196:199], v240 offset:2048
    buffer_load_dwordx4 v243, s[28:31], s56 offen lds
    v_mfma_f32_16x16x32_bf16 v[160:163], v[232:235], v[208:211], v[160:163]
    ds_read_b64_tr_b16 v[228:229], v57 offset:32768
    s_mov_b32 s56, 2490368
    s_add_u32 m0, s58, 118784
    v_mfma_f32_16x16x32_bf16 v[168:171], v[232:235], v[212:215], v[168:171]
    ds_read_b64_tr_b16 v[230:231], v57 offset:33792
    s_nop 0
    buffer_load_dwordx4 v243, s[24:27], s56 offen lds
    v_mfma_f32_16x16x32_bf16 v[176:179], v[232:235], v[216:219], v[176:179]
    ds_read_b128 v[200:203], v240 offset:4096
    s_add_u32 m0, s58, 126976
    s_nop 0
    v_mfma_f32_16x16x32_bf16 v[184:187], v[232:235], v[220:223], v[184:187]
    buffer_load_dwordx4 v243, s[28:31], s56 offen lds
    v_mfma_f32_16x16x32_bf16 v[164:167], v[236:239], v[208:211], v[164:167]
    ds_read_b64_tr_b16 v[232:233], v58 offset:32768
    s_add_u32 m0, s5, 0
    s_add_u32 s56, s4, 640
    v_mfma_f32_16x16x32_bf16 v[172:175], v[236:239], v[212:215], v[172:175]
    ds_read_b64_tr_b16 v[234:235], v58 offset:33792
    buffer_load_dwordx4 v241, s[20:23], s56 offen offset:0 lds
    v_mfma_f32_16x16x32_bf16 v[180:183], v[236:239], v[216:219], v[180:183]
    ds_read_b128 v[204:207], v240 offset:6144
    buffer_load_dwordx4 v242, s[20:23], s56 offen offset:1024 lds
    v_mfma_f32_16x16x32_bf16 v[188:191], v[236:239], v[220:223], v[188:191]
    s_add_u32 s56, s4, 14976
    buffer_load_dwordx4 v241, s[20:23], s56 offen offset:2048 lds
    s_waitcnt lgkmcnt(7)
    v_mfma_f32_16x16x32_bf16 v[64:67], v[224:227], v[192:195], v[64:67]
    ds_read_b64_tr_b16 v[236:237], v59 offset:32768
    buffer_load_dwordx4 v242, s[20:23], s56 offen offset:3072 lds
    s_waitcnt lgkmcnt(7)
    v_mfma_f32_16x16x32_bf16 v[72:75], v[224:227], v[196:199], v[72:75]
    ds_read_b64_tr_b16 v[238:239], v59 offset:33792
    s_add_u32 m0, s5, 4096
    s_add_u32 s56, s4, 33408
    s_waitcnt lgkmcnt(5)
    v_mfma_f32_16x16x32_bf16 v[80:83], v[224:227], v[200:203], v[80:83]
    buffer_load_dwordx4 v241, s[20:23], s56 offen offset:0 lds
    s_waitcnt lgkmcnt(2)
    v_mfma_f32_16x16x32_bf16 v[88:91], v[224:227], v[204:207], v[88:91]
    buffer_load_dwordx4 v242, s[20:23], s56 offen offset:1024 lds
    v_mfma_f32_16x16x32_bf16 v[68:71], v[228:231], v[192:195], v[68:71]
    ds_read_b64_tr_b16 v[224:225], v60 offset:32768
    s_add_u32 s56, s4, 47744
    buffer_load_dwordx4 v241, s[20:23], s56 offen offset:2048 lds
    v_mfma_f32_16x16x32_bf16 v[76:79], v[228:231], v[196:199], v[76:79]
    ds_read_b64_tr_b16 v[226:227], v60 offset:33792
    buffer_load_dwordx4 v242, s[20:23], s56 offen offset:3072 lds
    v_mfma_f32_16x16x32_bf16 v[84:87], v[228:231], v[200:203], v[84:87]
    v_mfma_f32_16x16x32_bf16 v[92:95], v[228:231], v[204:207], v[92:95]
    v_mfma_f32_16x16x32_bf16 v[96:99], v[232:235], v[192:195], v[96:99]
    ds_read_b64_tr_b16 v[228:229], v61 offset:32768
    v_mfma_f32_16x16x32_bf16 v[104:107], v[232:235], v[196:199], v[104:107]
    ds_read_b64_tr_b16 v[230:231], v61 offset:33792
    v_mfma_f32_16x16x32_bf16 v[112:115], v[232:235], v[200:203], v[112:115]
    v_mfma_f32_16x16x32_bf16 v[120:123], v[232:235], v[204:207], v[120:123]
    s_waitcnt lgkmcnt(4)
    v_mfma_f32_16x16x32_bf16 v[100:103], v[236:239], v[192:195], v[100:103]
    ds_read_b64_tr_b16 v[232:233], v62 offset:32768
    v_mfma_f32_16x16x32_bf16 v[108:111], v[236:239], v[196:199], v[108:111]
    ds_read_b64_tr_b16 v[234:235], v62 offset:33792
    v_mfma_f32_16x16x32_bf16 v[116:119], v[236:239], v[200:203], v[116:119]
    v_mfma_f32_16x16x32_bf16 v[124:127], v[236:239], v[204:207], v[124:127]
    s_waitcnt lgkmcnt(4)
    v_mfma_f32_16x16x32_bf16 v[128:131], v[224:227], v[192:195], v[128:131]
    ds_read_b64_tr_b16 v[236:237], v63 offset:32768
    v_mfma_f32_16x16x32_bf16 v[136:139], v[224:227], v[196:199], v[136:139]
    ds_read_b64_tr_b16 v[238:239], v63 offset:33792
    v_mfma_f32_16x16x32_bf16 v[144:147], v[224:227], v[200:203], v[144:147]
    v_mfma_f32_16x16x32_bf16 v[152:155], v[224:227], v[204:207], v[152:155]
    s_waitcnt lgkmcnt(4)
    v_mfma_f32_16x16x32_bf16 v[132:135], v[228:231], v[192:195], v[132:135]
    s_waitcnt vmcnt(24)
    s_waitcnt lgkmcnt(0)
    s_barrier
    ds_read_b128 v[208:211], v247 offset:0
    s_mov_b32 s56, 2621440
    s_add_u32 m0, s58, 131072
    v_mfma_f32_16x16x32_bf16 v[140:143], v[228:231], v[196:199], v[140:143]
    ds_read_b64_tr_b16 v[224:225], v56 offset:49152
    s_nop 0
    buffer_load_dwordx4 v243, s[24:27], s56 offen lds
    v_mfma_f32_16x16x32_bf16 v[148:151], v[228:231], v[200:203], v[148:151]
    ds_read_b64_tr_b16 v[226:227], v56 offset:50176
    s_add_u32 m0, s58, 139264
    s_nop 0
    v_mfma_f32_16x16x32_bf16 v[156:159], v[228:231], v[204:207], v[156:159]
    ds_read_b128 v[212:215], v247 offset:2048
    buffer_load_dwordx4 v243, s[28:31], s56 offen lds
    v_mfma_f32_16x16x32_bf16 v[160:163], v[232:235], v[192:195], v[160:163]
    ds_read_b64_tr_b16 v[228:229], v57 offset:49152
    s_mov_b32 s56, 2752512
    s_add_u32 m0, s58, 135168
    v_mfma_f32_16x16x32_bf16 v[168:171], v[232:235], v[196:199], v[168:171]
    ds_read_b64_tr_b16 v[230:231], v57 offset:50176
    s_nop 0
    buffer_load_dwordx4 v243, s[24:27], s56 offen lds
    v_mfma_f32_16x16x32_bf16 v[176:179], v[232:235], v[200:203], v[176:179]
    ds_read_b128 v[216:219], v247 offset:4096
    s_add_u32 m0, s58, 143360
    s_nop 0
    v_mfma_f32_16x16x32_bf16 v[184:187], v[232:235], v[204:207], v[184:187]
    buffer_load_dwordx4 v243, s[28:31], s56 offen lds
    v_mfma_f32_16x16x32_bf16 v[164:167], v[236:239], v[192:195], v[164:167]
    ds_read_b64_tr_b16 v[232:233], v58 offset:49152
    v_mfma_f32_16x16x32_bf16 v[172:175], v[236:239], v[196:199], v[172:175]
    ds_read_b64_tr_b16 v[234:235], v58 offset:50176
    v_mfma_f32_16x16x32_bf16 v[180:183], v[236:239], v[200:203], v[180:183]
    ds_read_b128 v[220:223], v247 offset:6144
    v_mfma_f32_16x16x32_bf16 v[188:191], v[236:239], v[204:207], v[188:191]
    s_waitcnt lgkmcnt(7)
    v_mfma_f32_16x16x32_bf16 v[64:67], v[224:227], v[208:211], v[64:67]
    ds_read_b64_tr_b16 v[236:237], v59 offset:49152
    s_waitcnt lgkmcnt(7)
    v_mfma_f32_16x16x32_bf16 v[72:75], v[224:227], v[212:215], v[72:75]
    ds_read_b64_tr_b16 v[238:239], v59 offset:50176
    s_waitcnt lgkmcnt(5)
    v_mfma_f32_16x16x32_bf16 v[80:83], v[224:227], v[216:219], v[80:83]
    s_waitcnt lgkmcnt(2)
    v_mfma_f32_16x16x32_bf16 v[88:91], v[224:227], v[220:223], v[88:91]
    v_mfma_f32_16x16x32_bf16 v[68:71], v[228:231], v[208:211], v[68:71]
    ds_read_b64_tr_b16 v[224:225], v60 offset:49152
    v_mfma_f32_16x16x32_bf16 v[76:79], v[228:231], v[212:215], v[76:79]
    ds_read_b64_tr_b16 v[226:227], v60 offset:50176
    v_mfma_f32_16x16x32_bf16 v[84:87], v[228:231], v[216:219], v[84:87]
    v_mfma_f32_16x16x32_bf16 v[92:95], v[228:231], v[220:223], v[92:95]
    v_mfma_f32_16x16x32_bf16 v[96:99], v[232:235], v[208:211], v[96:99]
    ds_read_b64_tr_b16 v[228:229], v61 offset:49152
    v_mfma_f32_16x16x32_bf16 v[104:107], v[232:235], v[212:215], v[104:107]
    ds_read_b64_tr_b16 v[230:231], v61 offset:50176
    v_mfma_f32_16x16x32_bf16 v[112:115], v[232:235], v[216:219], v[112:115]
    v_mfma_f32_16x16x32_bf16 v[120:123], v[232:235], v[220:223], v[120:123]
    s_waitcnt lgkmcnt(4)
    v_mfma_f32_16x16x32_bf16 v[100:103], v[236:239], v[208:211], v[100:103]
    ds_read_b64_tr_b16 v[232:233], v62 offset:49152
    v_mfma_f32_16x16x32_bf16 v[108:111], v[236:239], v[212:215], v[108:111]
    ds_read_b64_tr_b16 v[234:235], v62 offset:50176
    v_mfma_f32_16x16x32_bf16 v[116:119], v[236:239], v[216:219], v[116:119]
    v_mfma_f32_16x16x32_bf16 v[124:127], v[236:239], v[220:223], v[124:127]
    s_waitcnt lgkmcnt(4)
    v_mfma_f32_16x16x32_bf16 v[128:131], v[224:227], v[208:211], v[128:131]
    ds_read_b64_tr_b16 v[236:237], v63 offset:49152
    v_mfma_f32_16x16x32_bf16 v[136:139], v[224:227], v[212:215], v[136:139]
    ds_read_b64_tr_b16 v[238:239], v63 offset:50176
    v_mfma_f32_16x16x32_bf16 v[144:147], v[224:227], v[216:219], v[144:147]
    v_mfma_f32_16x16x32_bf16 v[152:155], v[224:227], v[220:223], v[152:155]
    s_waitcnt lgkmcnt(4)
    v_mfma_f32_16x16x32_bf16 v[132:135], v[228:231], v[208:211], v[132:135]
    s_waitcnt vmcnt(16)
    s_waitcnt lgkmcnt(0)
    s_barrier
    v_add_u32 v240, 32768, v240
    v_add_u32 v247, 32768, v247
    ds_read_b128 v[192:195], v240 offset:0
    s_mov_b32 s56, 2883584
    s_add_u32 m0, s58, 147456
    v_mfma_f32_16x16x32_bf16 v[140:143], v[228:231], v[212:215], v[140:143]
    ds_read_b64_tr_b16 v[224:225], v56 offset:0
    s_nop 0
    buffer_load_dwordx4 v243, s[24:27], s56 offen lds
    v_mfma_f32_16x16x32_bf16 v[148:151], v[228:231], v[216:219], v[148:151]
    ds_read_b64_tr_b16 v[226:227], v56 offset:1024
    s_add_u32 m0, s58, 155648
    s_nop 0
    v_mfma_f32_16x16x32_bf16 v[156:159], v[228:231], v[220:223], v[156:159]
    ds_read_b128 v[196:199], v240 offset:2048
    buffer_load_dwordx4 v243, s[28:31], s56 offen lds
    v_mfma_f32_16x16x32_bf16 v[160:163], v[232:235], v[208:211], v[160:163]
    ds_read_b64_tr_b16 v[228:229], v57 offset:0
    s_mov_b32 s56, 3014656
    s_add_u32 m0, s58, 151552
    v_mfma_f32_16x16x32_bf16 v[168:171], v[232:235], v[212:215], v[168:171]
    ds_read_b64_tr_b16 v[230:231], v57 offset:1024
    s_nop 0
    buffer_load_dwordx4 v243, s[24:27], s56 offen lds
    v_mfma_f32_16x16x32_bf16 v[176:179], v[232:235], v[216:219], v[176:179]
    ds_read_b128 v[200:203], v240 offset:4096
    s_add_u32 m0, s58, 159744
    s_nop 0
    v_mfma_f32_16x16x32_bf16 v[184:187], v[232:235], v[220:223], v[184:187]
    buffer_load_dwordx4 v243, s[28:31], s56 offen lds
    v_mfma_f32_16x16x32_bf16 v[164:167], v[236:239], v[208:211], v[164:167]
    ds_read_b64_tr_b16 v[232:233], v58 offset:0
    s_add_u32 m0, s5, 32768
    s_add_u32 s56, s4, 768
    v_mfma_f32_16x16x32_bf16 v[172:175], v[236:239], v[212:215], v[172:175]
    ds_read_b64_tr_b16 v[234:235], v58 offset:1024
    buffer_load_dwordx4 v241, s[20:23], s56 offen offset:0 lds
    v_mfma_f32_16x16x32_bf16 v[180:183], v[236:239], v[216:219], v[180:183]
    ds_read_b128 v[204:207], v240 offset:6144
    buffer_load_dwordx4 v242, s[20:23], s56 offen offset:1024 lds
    v_mfma_f32_16x16x32_bf16 v[188:191], v[236:239], v[220:223], v[188:191]
    s_add_u32 s56, s4, 15104
    buffer_load_dwordx4 v241, s[20:23], s56 offen offset:2048 lds
    s_waitcnt lgkmcnt(7)
    v_mfma_f32_16x16x32_bf16 v[64:67], v[224:227], v[192:195], v[64:67]
    ds_read_b64_tr_b16 v[236:237], v59 offset:0
    buffer_load_dwordx4 v242, s[20:23], s56 offen offset:3072 lds
    s_waitcnt lgkmcnt(7)
    v_mfma_f32_16x16x32_bf16 v[72:75], v[224:227], v[196:199], v[72:75]
    ds_read_b64_tr_b16 v[238:239], v59 offset:1024
    s_add_u32 m0, s5, 36864
    s_add_u32 s56, s4, 33536
    s_waitcnt lgkmcnt(5)
    v_mfma_f32_16x16x32_bf16 v[80:83], v[224:227], v[200:203], v[80:83]
    buffer_load_dwordx4 v241, s[20:23], s56 offen offset:0 lds
    s_waitcnt lgkmcnt(2)
    v_mfma_f32_16x16x32_bf16 v[88:91], v[224:227], v[204:207], v[88:91]
    buffer_load_dwordx4 v242, s[20:23], s56 offen offset:1024 lds
    v_mfma_f32_16x16x32_bf16 v[68:71], v[228:231], v[192:195], v[68:71]
    ds_read_b64_tr_b16 v[224:225], v60 offset:0
    s_add_u32 s56, s4, 47872
    buffer_load_dwordx4 v241, s[20:23], s56 offen offset:2048 lds
    v_mfma_f32_16x16x32_bf16 v[76:79], v[228:231], v[196:199], v[76:79]
    ds_read_b64_tr_b16 v[226:227], v60 offset:1024
    buffer_load_dwordx4 v242, s[20:23], s56 offen offset:3072 lds
    v_mfma_f32_16x16x32_bf16 v[84:87], v[228:231], v[200:203], v[84:87]
    v_mfma_f32_16x16x32_bf16 v[92:95], v[228:231], v[204:207], v[92:95]
    v_mfma_f32_16x16x32_bf16 v[96:99], v[232:235], v[192:195], v[96:99]
    ds_read_b64_tr_b16 v[228:229], v61 offset:0
    v_mfma_f32_16x16x32_bf16 v[104:107], v[232:235], v[196:199], v[104:107]
    ds_read_b64_tr_b16 v[230:231], v61 offset:1024
    v_mfma_f32_16x16x32_bf16 v[112:115], v[232:235], v[200:203], v[112:115]
    v_mfma_f32_16x16x32_bf16 v[120:123], v[232:235], v[204:207], v[120:123]
    s_waitcnt lgkmcnt(4)
    v_mfma_f32_16x16x32_bf16 v[100:103], v[236:239], v[192:195], v[100:103]
    ds_read_b64_tr_b16 v[232:233], v62 offset:0
    v_mfma_f32_16x16x32_bf16 v[108:111], v[236:239], v[196:199], v[108:111]
    ds_read_b64_tr_b16 v[234:235], v62 offset:1024
    v_mfma_f32_16x16x32_bf16 v[116:119], v[236:239], v[200:203], v[116:119]
    v_mfma_f32_16x16x32_bf16 v[124:127], v[236:239], v[204:207], v[124:127]
    s_waitcnt lgkmcnt(4)
    v_mfma_f32_16x16x32_bf16 v[128:131], v[224:227], v[192:195], v[128:131]
    ds_read_b64_tr_b16 v[236:237], v63 offset:0
    v_mfma_f32_16x16x32_bf16 v[136:139], v[224:227], v[196:199], v[136:139]
    ds_read_b64_tr_b16 v[238:239], v63 offset:1024
    v_mfma_f32_16x16x32_bf16 v[144:147], v[224:227], v[200:203], v[144:147]
    v_mfma_f32_16x16x32_bf16 v[152:155], v[224:227], v[204:207], v[152:155]
    s_waitcnt lgkmcnt(4)
    v_mfma_f32_16x16x32_bf16 v[132:135], v[228:231], v[192:195], v[132:135]
    s_waitcnt vmcnt(24)
    s_waitcnt lgkmcnt(0)
    s_barrier
    v_and_b32 v52, 7, v255
    v_lshlrev_b32 v52, 2, v52
    s_lshl_b32 s54, s48, 5
    s_add_u32 s54, s54, 58785792
    buffer_load_dword v53, v52, s[16:19], s54 offen sc1
    ds_read_b128 v[208:211], v247 offset:0
    s_mov_b32 s56, 3145728
    s_add_u32 m0, s58, 98304
    v_mfma_f32_16x16x32_bf16 v[140:143], v[228:231], v[196:199], v[140:143]
    ds_read_b64_tr_b16 v[224:225], v56 offset:16384
    s_nop 0
    buffer_load_dwordx4 v243, s[24:27], s56 offen lds
    v_mfma_f32_16x16x32_bf16 v[148:151], v[228:231], v[200:203], v[148:151]
    ds_read_b64_tr_b16 v[226:227], v56 offset:17408
    s_add_u32 m0, s58, 106496
    s_nop 0
    v_mfma_f32_16x16x32_bf16 v[156:159], v[228:231], v[204:207], v[156:159]
    ds_read_b128 v[212:215], v247 offset:2048
    buffer_load_dwordx4 v243, s[28:31], s56 offen lds
    v_mfma_f32_16x16x32_bf16 v[160:163], v[232:235], v[192:195], v[160:163]
    ds_read_b64_tr_b16 v[228:229], v57 offset:16384
    s_mov_b32 s56, 3276800
    s_add_u32 m0, s58, 102400
    v_mfma_f32_16x16x32_bf16 v[168:171], v[232:235], v[196:199], v[168:171]
    ds_read_b64_tr_b16 v[230:231], v57 offset:17408
    s_nop 0
    buffer_load_dwordx4 v243, s[24:27], s56 offen lds
    v_mfma_f32_16x16x32_bf16 v[176:179], v[232:235], v[200:203], v[176:179]
    ds_read_b128 v[216:219], v247 offset:4096
    s_add_u32 m0, s58, 110592
    s_nop 0
    v_mfma_f32_16x16x32_bf16 v[184:187], v[232:235], v[204:207], v[184:187]
    buffer_load_dwordx4 v243, s[28:31], s56 offen lds
    v_mfma_f32_16x16x32_bf16 v[164:167], v[236:239], v[192:195], v[164:167]
    ds_read_b64_tr_b16 v[232:233], v58 offset:16384
    v_mfma_f32_16x16x32_bf16 v[172:175], v[236:239], v[196:199], v[172:175]
    ds_read_b64_tr_b16 v[234:235], v58 offset:17408
    v_mfma_f32_16x16x32_bf16 v[180:183], v[236:239], v[200:203], v[180:183]
    ds_read_b128 v[220:223], v247 offset:6144
    v_mfma_f32_16x16x32_bf16 v[188:191], v[236:239], v[204:207], v[188:191]
    s_waitcnt lgkmcnt(7)
    v_mfma_f32_16x16x32_bf16 v[64:67], v[224:227], v[208:211], v[64:67]
    ds_read_b64_tr_b16 v[236:237], v59 offset:16384
    s_waitcnt lgkmcnt(7)
    v_mfma_f32_16x16x32_bf16 v[72:75], v[224:227], v[212:215], v[72:75]
    ds_read_b64_tr_b16 v[238:239], v59 offset:17408
    s_waitcnt lgkmcnt(5)
    v_mfma_f32_16x16x32_bf16 v[80:83], v[224:227], v[216:219], v[80:83]
    s_waitcnt lgkmcnt(2)
    v_mfma_f32_16x16x32_bf16 v[88:91], v[224:227], v[220:223], v[88:91]
    v_mfma_f32_16x16x32_bf16 v[68:71], v[228:231], v[208:211], v[68:71]
    ds_read_b64_tr_b16 v[224:225], v60 offset:16384
    v_mfma_f32_16x16x32_bf16 v[76:79], v[228:231], v[212:215], v[76:79]
    ds_read_b64_tr_b16 v[226:227], v60 offset:17408
    v_mfma_f32_16x16x32_bf16 v[84:87], v[228:231], v[216:219], v[84:87]
    v_mfma_f32_16x16x32_bf16 v[92:95], v[228:231], v[220:223], v[92:95]
    v_mfma_f32_16x16x32_bf16 v[96:99], v[232:235], v[208:211], v[96:99]
    ds_read_b64_tr_b16 v[228:229], v61 offset:16384
    v_mfma_f32_16x16x32_bf16 v[104:107], v[232:235], v[212:215], v[104:107]
    ds_read_b64_tr_b16 v[230:231], v61 offset:17408
    v_mfma_f32_16x16x32_bf16 v[112:115], v[232:235], v[216:219], v[112:115]
    v_mfma_f32_16x16x32_bf16 v[120:123], v[232:235], v[220:223], v[120:123]
    s_waitcnt lgkmcnt(4)
    v_mfma_f32_16x16x32_bf16 v[100:103], v[236:239], v[208:211], v[100:103]
    ds_read_b64_tr_b16 v[232:233], v62 offset:16384
    v_mfma_f32_16x16x32_bf16 v[108:111], v[236:239], v[212:215], v[108:111]
    ds_read_b64_tr_b16 v[234:235], v62 offset:17408
    v_mfma_f32_16x16x32_bf16 v[116:119], v[236:239], v[216:219], v[116:119]
    v_mfma_f32_16x16x32_bf16 v[124:127], v[236:239], v[220:223], v[124:127]
    s_waitcnt lgkmcnt(4)
    v_mfma_f32_16x16x32_bf16 v[128:131], v[224:227], v[208:211], v[128:131]
    ds_read_b64_tr_b16 v[236:237], v63 offset:16384
    v_mfma_f32_16x16x32_bf16 v[136:139], v[224:227], v[212:215], v[136:139]
    ds_read_b64_tr_b16 v[238:239], v63 offset:17408
    v_mfma_f32_16x16x32_bf16 v[144:147], v[224:227], v[216:219], v[144:147]
    v_mfma_f32_16x16x32_bf16 v[152:155], v[224:227], v[220:223], v[152:155]
    s_waitcnt lgkmcnt(4)
    v_mfma_f32_16x16x32_bf16 v[132:135], v[228:231], v[208:211], v[132:135]
    s_waitcnt vmcnt(17)
    s_waitcnt lgkmcnt(0)
    s_barrier
    v_add_u32 v240, 4294901760, v240
    v_add_u32 v247, 4294901760, v247
    ds_read_b128 v[192:195], v240 offset:0
    s_mov_b32 s56, 3407872
    s_add_u32 m0, s58, 114688
    v_mfma_f32_16x16x32_bf16 v[140:143], v[228:231], v[212:215], v[140:143]
    ds_read_b64_tr_b16 v[224:225], v56 offset:32768
    s_nop 0
    buffer_load_dwordx4 v243, s[24:27], s56 offen lds
    v_mfma_f32_16x16x32_bf16 v[148:151], v[228:231], v[216:219], v[148:151]
    ds_read_b64_tr_b16 v[226:227], v56 offset:33792
    s_add_u32 m0, s58, 122880
    s_nop 0
    v_mfma_f32_16x16x32_bf16 v[156:159], v[228:231], v[220:223], v[156:159]
    ds_read_b128 v[196:199], v240 offset:2048
    buffer_load_dwordx4 v243, s[28:31], s56 offen lds
    v_mfma_f32_16x16x32_bf16 v[160:163], v[232:235], v[208:211], v[160:163]
    ds_read_b64_tr_b16 v[228:229], v57 offset:32768
    s_mov_b32 s56, 3538944
    s_add_u32 m0, s58, 118784
    v_mfma_f32_16x16x32_bf16 v[168:171], v[232:235], v[212:215], v[168:171]
    ds_read_b64_tr_b16 v[230:231], v57 offset:33792
    s_nop 0
    buffer_load_dwordx4 v243, s[24:27], s56 offen lds
    v_mfma_f32_16x16x32_bf16 v[176:179], v[232:235], v[216:219], v[176:179]
    ds_read_b128 v[200:203], v240 offset:4096
    s_add_u32 m0, s58, 126976
    s_nop 0
    v_mfma_f32_16x16x32_bf16 v[184:187], v[232:235], v[220:223], v[184:187]
    buffer_load_dwordx4 v243, s[28:31], s56 offen lds
    v_mfma_f32_16x16x32_bf16 v[164:167], v[236:239], v[208:211], v[164:167]
    ds_read_b64_tr_b16 v[232:233], v58 offset:32768
    s_add_u32 m0, s5, 65536
    s_add_u32 s56, s4, 896
    v_mfma_f32_16x16x32_bf16 v[172:175], v[236:239], v[212:215], v[172:175]
    ds_read_b64_tr_b16 v[234:235], v58 offset:33792
    buffer_load_dwordx4 v241, s[20:23], s56 offen offset:0 lds
    v_mfma_f32_16x16x32_bf16 v[180:183], v[236:239], v[216:219], v[180:183]
    ds_read_b128 v[204:207], v240 offset:6144
    buffer_load_dwordx4 v242, s[20:23], s56 offen offset:1024 lds
    v_mfma_f32_16x16x32_bf16 v[188:191], v[236:239], v[220:223], v[188:191]
    s_add_u32 s56, s4, 15232
    buffer_load_dwordx4 v241, s[20:23], s56 offen offset:2048 lds
    s_waitcnt lgkmcnt(7)
    v_mfma_f32_16x16x32_bf16 v[64:67], v[224:227], v[192:195], v[64:67]
    ds_read_b64_tr_b16 v[236:237], v59 offset:32768
    buffer_load_dwordx4 v242, s[20:23], s56 offen offset:3072 lds
    s_waitcnt lgkmcnt(7)
    v_mfma_f32_16x16x32_bf16 v[72:75], v[224:227], v[196:199], v[72:75]
    ds_read_b64_tr_b16 v[238:239], v59 offset:33792
    s_add_u32 m0, s5, 69632
    s_add_u32 s56, s4, 33664
    s_waitcnt lgkmcnt(5)
    v_mfma_f32_16x16x32_bf16 v[80:83], v[224:227], v[200:203], v[80:83]
    buffer_load_dwordx4 v241, s[20:23], s56 offen offset:0 lds
    s_waitcnt lgkmcnt(2)
    v_mfma_f32_16x16x32_bf16 v[88:91], v[224:227], v[204:207], v[88:91]
    buffer_load_dwordx4 v242, s[20:23], s56 offen offset:1024 lds
    v_mfma_f32_16x16x32_bf16 v[68:71], v[228:231], v[192:195], v[68:71]
    ds_read_b64_tr_b16 v[224:225], v60 offset:32768
    s_add_u32 s56, s4, 48000
    buffer_load_dwordx4 v241, s[20:23], s56 offen offset:2048 lds
    v_mfma_f32_16x16x32_bf16 v[76:79], v[228:231], v[196:199], v[76:79]
    ds_read_b64_tr_b16 v[226:227], v60 offset:33792
    buffer_load_dwordx4 v242, s[20:23], s56 offen offset:3072 lds
    v_mfma_f32_16x16x32_bf16 v[84:87], v[228:231], v[200:203], v[84:87]
    v_mfma_f32_16x16x32_bf16 v[92:95], v[228:231], v[204:207], v[92:95]
    v_mfma_f32_16x16x32_bf16 v[96:99], v[232:235], v[192:195], v[96:99]
    ds_read_b64_tr_b16 v[228:229], v61 offset:32768
    v_mfma_f32_16x16x32_bf16 v[104:107], v[232:235], v[196:199], v[104:107]
    ds_read_b64_tr_b16 v[230:231], v61 offset:33792
    v_mfma_f32_16x16x32_bf16 v[112:115], v[232:235], v[200:203], v[112:115]
    v_mfma_f32_16x16x32_bf16 v[120:123], v[232:235], v[204:207], v[120:123]
    s_waitcnt lgkmcnt(4)
    v_mfma_f32_16x16x32_bf16 v[100:103], v[236:239], v[192:195], v[100:103]
    ds_read_b64_tr_b16 v[232:233], v62 offset:32768
    v_mfma_f32_16x16x32_bf16 v[108:111], v[236:239], v[196:199], v[108:111]
    ds_read_b64_tr_b16 v[234:235], v62 offset:33792
    v_mfma_f32_16x16x32_bf16 v[116:119], v[236:239], v[200:203], v[116:119]
    v_mfma_f32_16x16x32_bf16 v[124:127], v[236:239], v[204:207], v[124:127]
    s_waitcnt lgkmcnt(4)
    v_mfma_f32_16x16x32_bf16 v[128:131], v[224:227], v[192:195], v[128:131]
    ds_read_b64_tr_b16 v[236:237], v63 offset:32768
    v_mfma_f32_16x16x32_bf16 v[136:139], v[224:227], v[196:199], v[136:139]
    ds_read_b64_tr_b16 v[238:239], v63 offset:33792
    v_mfma_f32_16x16x32_bf16 v[144:147], v[224:227], v[200:203], v[144:147]
    v_mfma_f32_16x16x32_bf16 v[152:155], v[224:227], v[204:207], v[152:155]
    s_waitcnt lgkmcnt(4)
    v_mfma_f32_16x16x32_bf16 v[132:135], v[228:231], v[192:195], v[132:135]
    s_waitcnt vmcnt(25)
    s_waitcnt lgkmcnt(0)
    s_barrier
    ds_read_b128 v[208:211], v247 offset:0
    s_mov_b32 s56, 3670016
    s_add_u32 m0, s58, 131072
    v_mfma_f32_16x16x32_bf16 v[140:143], v[228:231], v[196:199], v[140:143]
    ds_read_b64_tr_b16 v[224:225], v56 offset:49152
    s_nop 0
    buffer_load_dwordx4 v243, s[24:27], s56 offen lds
    v_mfma_f32_16x16x32_bf16 v[148:151], v[228:231], v[200:203], v[148:151]
    ds_read_b64_tr_b16 v[226:227], v56 offset:50176
    s_add_u32 m0, s58, 139264
    s_nop 0
    v_mfma_f32_16x16x32_bf16 v[156:159], v[228:231], v[204:207], v[156:159]
    ds_read_b128 v[212:215], v247 offset:2048
    buffer_load_dwordx4 v243, s[28:31], s56 offen lds
    v_mfma_f32_16x16x32_bf16 v[160:163], v[232:235], v[192:195], v[160:163]
    ds_read_b64_tr_b16 v[228:229], v57 offset:49152
    s_mov_b32 s56, 3801088
    s_add_u32 m0, s58, 135168
    v_mfma_f32_16x16x32_bf16 v[168:171], v[232:235], v[196:199], v[168:171]
    ds_read_b64_tr_b16 v[230:231], v57 offset:50176
    s_nop 0
    buffer_load_dwordx4 v243, s[24:27], s56 offen lds
    v_mfma_f32_16x16x32_bf16 v[176:179], v[232:235], v[200:203], v[176:179]
    ds_read_b128 v[216:219], v247 offset:4096
    s_add_u32 m0, s58, 143360
    s_nop 0
    v_mfma_f32_16x16x32_bf16 v[184:187], v[232:235], v[204:207], v[184:187]
    buffer_load_dwordx4 v243, s[28:31], s56 offen lds
    v_mfma_f32_16x16x32_bf16 v[164:167], v[236:239], v[192:195], v[164:167]
    ds_read_b64_tr_b16 v[232:233], v58 offset:49152
    v_mfma_f32_16x16x32_bf16 v[172:175], v[236:239], v[196:199], v[172:175]
    ds_read_b64_tr_b16 v[234:235], v58 offset:50176
    v_mfma_f32_16x16x32_bf16 v[180:183], v[236:239], v[200:203], v[180:183]
    ds_read_b128 v[220:223], v247 offset:6144
    v_mfma_f32_16x16x32_bf16 v[188:191], v[236:239], v[204:207], v[188:191]
    s_waitcnt lgkmcnt(7)
    v_mfma_f32_16x16x32_bf16 v[64:67], v[224:227], v[208:211], v[64:67]
    ds_read_b64_tr_b16 v[236:237], v59 offset:49152
    s_waitcnt lgkmcnt(7)
    v_mfma_f32_16x16x32_bf16 v[72:75], v[224:227], v[212:215], v[72:75]
    ds_read_b64_tr_b16 v[238:239], v59 offset:50176
    s_waitcnt lgkmcnt(5)
    v_mfma_f32_16x16x32_bf16 v[80:83], v[224:227], v[216:219], v[80:83]
    s_waitcnt lgkmcnt(2)
    v_mfma_f32_16x16x32_bf16 v[88:91], v[224:227], v[220:223], v[88:91]
    v_mfma_f32_16x16x32_bf16 v[68:71], v[228:231], v[208:211], v[68:71]
    ds_read_b64_tr_b16 v[224:225], v60 offset:49152
    v_mfma_f32_16x16x32_bf16 v[76:79], v[228:231], v[212:215], v[76:79]
    ds_read_b64_tr_b16 v[226:227], v60 offset:50176
    v_mfma_f32_16x16x32_bf16 v[84:87], v[228:231], v[216:219], v[84:87]
    v_mfma_f32_16x16x32_bf16 v[92:95], v[228:231], v[220:223], v[92:95]
    v_mfma_f32_16x16x32_bf16 v[96:99], v[232:235], v[208:211], v[96:99]
    ds_read_b64_tr_b16 v[228:229], v61 offset:49152
    v_mfma_f32_16x16x32_bf16 v[104:107], v[232:235], v[212:215], v[104:107]
    ds_read_b64_tr_b16 v[230:231], v61 offset:50176
    v_mfma_f32_16x16x32_bf16 v[112:115], v[232:235], v[216:219], v[112:115]
    v_mfma_f32_16x16x32_bf16 v[120:123], v[232:235], v[220:223], v[120:123]
    s_waitcnt lgkmcnt(4)
    v_mfma_f32_16x16x32_bf16 v[100:103], v[236:239], v[208:211], v[100:103]
    ds_read_b64_tr_b16 v[232:233], v62 offset:49152
    v_mfma_f32_16x16x32_bf16 v[108:111], v[236:239], v[212:215], v[108:111]
    ds_read_b64_tr_b16 v[234:235], v62 offset:50176
    v_mfma_f32_16x16x32_bf16 v[116:119], v[236:239], v[216:219], v[116:119]
    v_mfma_f32_16x16x32_bf16 v[124:127], v[236:239], v[220:223], v[124:127]
    s_waitcnt lgkmcnt(4)
    v_mfma_f32_16x16x32_bf16 v[128:131], v[224:227], v[208:211], v[128:131]
    ds_read_b64_tr_b16 v[236:237], v63 offset:49152
    v_mfma_f32_16x16x32_bf16 v[136:139], v[224:227], v[212:215], v[136:139]
    ds_read_b64_tr_b16 v[238:239], v63 offset:50176
    v_mfma_f32_16x16x32_bf16 v[144:147], v[224:227], v[216:219], v[144:147]
    v_mfma_f32_16x16x32_bf16 v[152:155], v[224:227], v[220:223], v[152:155]
    s_waitcnt lgkmcnt(4)
    v_mfma_f32_16x16x32_bf16 v[132:135], v[228:231], v[208:211], v[132:135]
    s_waitcnt vmcnt(16)
    s_waitcnt lgkmcnt(0)
    s_barrier
    v_add_u32 v240, 32768, v240
    v_add_u32 v247, 32768, v247
    ds_read_b128 v[192:195], v240 offset:0
    s_mov_b32 s56, 3932160
    s_add_u32 m0, s58, 147456
    v_mfma_f32_16x16x32_bf16 v[140:143], v[228:231], v[212:215], v[140:143]
    ds_read_b64_tr_b16 v[224:225], v56 offset:0
    s_nop 0
    buffer_load_dwordx4 v243, s[24:27], s56 offen lds
    v_mfma_f32_16x16x32_bf16 v[148:151], v[228:231], v[216:219], v[148:151]
    ds_read_b64_tr_b16 v[226:227], v56 offset:1024
    s_add_u32 m0, s58, 155648
    s_nop 0
    v_mfma_f32_16x16x32_bf16 v[156:159], v[228:231], v[220:223], v[156:159]
    ds_read_b128 v[196:199], v240 offset:2048
    buffer_load_dwordx4 v243, s[28:31], s56 offen lds
    v_mfma_f32_16x16x32_bf16 v[160:163], v[232:235], v[208:211], v[160:163]
    ds_read_b64_tr_b16 v[228:229], v57 offset:0
    s_mov_b32 s56, 4063232
    s_add_u32 m0, s58, 151552
    v_mfma_f32_16x16x32_bf16 v[168:171], v[232:235], v[212:215], v[168:171]
    ds_read_b64_tr_b16 v[230:231], v57 offset:1024
    s_nop 0
    buffer_load_dwordx4 v243, s[24:27], s56 offen lds
    v_mfma_f32_16x16x32_bf16 v[176:179], v[232:235], v[216:219], v[176:179]
    ds_read_b128 v[200:203], v240 offset:4096
    s_add_u32 m0, s58, 159744
    s_nop 0
    v_mfma_f32_16x16x32_bf16 v[184:187], v[232:235], v[220:223], v[184:187]
    buffer_load_dwordx4 v243, s[28:31], s56 offen lds
    v_mfma_f32_16x16x32_bf16 v[164:167], v[236:239], v[208:211], v[164:167]
    ds_read_b64_tr_b16 v[232:233], v58 offset:0
    s_add_u32 m0, s60, 0
    s_mov_b32 s56, 0
    v_mfma_f32_16x16x32_bf16 v[172:175], v[236:239], v[212:215], v[172:175]
    ds_read_b64_tr_b16 v[234:235], v58 offset:1024
    buffer_load_dwordx4 v245, s[36:39], s56 offen offset:0 lds
    v_mfma_f32_16x16x32_bf16 v[180:183], v[236:239], v[216:219], v[180:183]
    ds_read_b128 v[204:207], v240 offset:6144
    s_mov_b32 s56, 31744
    buffer_load_dwordx4 v245, s[36:39], s56 offen offset:1024 lds
    v_mfma_f32_16x16x32_bf16 v[188:191], v[236:239], v[220:223], v[188:191]
    s_mov_b32 s56, 63488
    buffer_load_dwordx4 v245, s[36:39], s56 offen offset:2048 lds
    s_waitcnt lgkmcnt(7)
    v_mfma_f32_16x16x32_bf16 v[64:67], v[224:227], v[192:195], v[64:67]
    ds_read_b64_tr_b16 v[236:237], v59 offset:0
    s_mov_b32 s56, 95232
    buffer_load_dwordx4 v245, s[36:39], s56 offen offset:3072 lds
    s_waitcnt lgkmcnt(7)
    v_mfma_f32_16x16x32_bf16 v[72:75], v[224:227], v[196:199], v[72:75]
    ds_read_b64_tr_b16 v[238:239], v59 offset:1024
    s_add_u32 m0, s14, 16384
    s_add_u32 s56, s96, 0
    s_waitcnt lgkmcnt(5)
    v_mfma_f32_16x16x32_bf16 v[80:83], v[224:227], v[200:203], v[80:83]
    buffer_load_dwordx4 v246, s[40:43], s56 offen offset:0 lds
    s_waitcnt lgkmcnt(2)
    v_mfma_f32_16x16x32_bf16 v[88:91], v[224:227], v[204:207], v[88:91]
    buffer_load_dwordx4 v250, s[40:43], s56 offen offset:1024 lds
    v_mfma_f32_16x16x32_bf16 v[68:71], v[228:231], v[192:195], v[68:71]
    ds_read_b64_tr_b16 v[224:225], v60 offset:0
    buffer_load_dwordx4 v252, s[40:43], s56 offen offset:2048 lds
    v_mfma_f32_16x16x32_bf16 v[76:79], v[228:231], v[196:199], v[76:79]
    ds_read_b64_tr_b16 v[226:227], v60 offset:1024
    v_mfma_f32_16x16x32_bf16 v[84:87], v[228:231], v[200:203], v[84:87]
    v_mfma_f32_16x16x32_bf16 v[92:95], v[228:231], v[204:207], v[92:95]
    v_mfma_f32_16x16x32_bf16 v[96:99], v[232:235], v[192:195], v[96:99]
    ds_read_b64_tr_b16 v[228:229], v61 offset:0
    v_mfma_f32_16x16x32_bf16 v[104:107], v[232:235], v[196:199], v[104:107]
    ds_read_b64_tr_b16 v[230:231], v61 offset:1024
    v_mfma_f32_16x16x32_bf16 v[112:115], v[232:235], v[200:203], v[112:115]
    v_mfma_f32_16x16x32_bf16 v[120:123], v[232:235], v[204:207], v[120:123]
    s_waitcnt lgkmcnt(4)
    v_mfma_f32_16x16x32_bf16 v[100:103], v[236:239], v[192:195], v[100:103]
    ds_read_b64_tr_b16 v[232:233], v62 offset:0
    v_mfma_f32_16x16x32_bf16 v[108:111], v[236:239], v[196:199], v[108:111]
    ds_read_b64_tr_b16 v[234:235], v62 offset:1024
    v_mfma_f32_16x16x32_bf16 v[116:119], v[236:239], v[200:203], v[116:119]
    v_mfma_f32_16x16x32_bf16 v[124:127], v[236:239], v[204:207], v[124:127]
    s_waitcnt lgkmcnt(4)
    v_mfma_f32_16x16x32_bf16 v[128:131], v[224:227], v[192:195], v[128:131]
    ds_read_b64_tr_b16 v[236:237], v63 offset:0
    v_mfma_f32_16x16x32_bf16 v[136:139], v[224:227], v[196:199], v[136:139]
    ds_read_b64_tr_b16 v[238:239], v63 offset:1024
    v_mfma_f32_16x16x32_bf16 v[144:147], v[224:227], v[200:203], v[144:147]
    v_mfma_f32_16x16x32_bf16 v[152:155], v[224:227], v[204:207], v[152:155]
    s_waitcnt lgkmcnt(4)
    v_mfma_f32_16x16x32_bf16 v[132:135], v[228:231], v[192:195], v[132:135]
    s_waitcnt vmcnt(23)
    s_waitcnt lgkmcnt(0)
    s_barrier
    ds_read_b128 v[208:211], v247 offset:0
    buffer_load_dwordx4 v[0:3], v254, s[16:19], s13 offen offset:0
    v_mfma_f32_16x16x32_bf16 v[140:143], v[228:231], v[196:199], v[140:143]
    ds_read_b64_tr_b16 v[224:225], v56 offset:16384
    buffer_load_dwordx4 v[4:7], v254, s[16:19], s13 offen offset:1024
    v_mfma_f32_16x16x32_bf16 v[148:151], v[228:231], v[200:203], v[148:151]
    ds_read_b64_tr_b16 v[226:227], v56 offset:17408
    buffer_load_dwordx4 v[8:11], v254, s[16:19], s13 offen offset:2048
    v_mfma_f32_16x16x32_bf16 v[156:159], v[228:231], v[204:207], v[156:159]
    ds_read_b128 v[212:215], v247 offset:2048
    buffer_load_dwordx4 v[12:15], v254, s[16:19], s13 offen offset:3072
    v_mfma_f32_16x16x32_bf16 v[160:163], v[232:235], v[192:195], v[160:163]
    ds_read_b64_tr_b16 v[228:229], v57 offset:16384
    s_add_u32 s13, s13, 4096
    v_mfma_f32_16x16x32_bf16 v[168:171], v[232:235], v[196:199], v[168:171]
    ds_read_b64_tr_b16 v[230:231], v57 offset:17408
    v_mfma_f32_16x16x32_bf16 v[176:179], v[232:235], v[200:203], v[176:179]
    ds_read_b128 v[216:219], v247 offset:4096
    v_mfma_f32_16x16x32_bf16 v[184:187], v[232:235], v[204:207], v[184:187]
    v_mfma_f32_16x16x32_bf16 v[164:167], v[236:239], v[192:195], v[164:167]
    ds_read_b64_tr_b16 v[232:233], v58 offset:16384
    v_mfma_f32_16x16x32_bf16 v[172:175], v[236:239], v[196:199], v[172:175]
    ds_read_b64_tr_b16 v[234:235], v58 offset:17408
    v_mfma_f32_16x16x32_bf16 v[180:183], v[236:239], v[200:203], v[180:183]
    ds_read_b128 v[220:223], v247 offset:6144
    v_mfma_f32_16x16x32_bf16 v[188:191], v[236:239], v[204:207], v[188:191]
    s_waitcnt lgkmcnt(7)
    v_mfma_f32_16x16x32_bf16 v[64:67], v[224:227], v[208:211], v[64:67]
    ds_read_b64_tr_b16 v[236:237], v59 offset:16384
    s_waitcnt lgkmcnt(7)
    v_mfma_f32_16x16x32_bf16 v[72:75], v[224:227], v[212:215], v[72:75]
    ds_read_b64_tr_b16 v[238:239], v59 offset:17408
    s_waitcnt lgkmcnt(5)
    v_mfma_f32_16x16x32_bf16 v[80:83], v[224:227], v[216:219], v[80:83]
    s_waitcnt lgkmcnt(2)
    v_mfma_f32_16x16x32_bf16 v[88:91], v[224:227], v[220:223], v[88:91]
    v_mfma_f32_16x16x32_bf16 v[68:71], v[228:231], v[208:211], v[68:71]
    ds_read_b64_tr_b16 v[224:225], v60 offset:16384
    v_mfma_f32_16x16x32_bf16 v[76:79], v[228:231], v[212:215], v[76:79]
    ds_read_b64_tr_b16 v[226:227], v60 offset:17408
    v_mfma_f32_16x16x32_bf16 v[84:87], v[228:231], v[216:219], v[84:87]
    v_mfma_f32_16x16x32_bf16 v[92:95], v[228:231], v[220:223], v[92:95]
    v_mfma_f32_16x16x32_bf16 v[96:99], v[232:235], v[208:211], v[96:99]
    ds_read_b64_tr_b16 v[228:229], v61 offset:16384
    v_mfma_f32_16x16x32_bf16 v[104:107], v[232:235], v[212:215], v[104:107]
    ds_read_b64_tr_b16 v[230:231], v61 offset:17408
    v_mfma_f32_16x16x32_bf16 v[112:115], v[232:235], v[216:219], v[112:115]
    v_mfma_f32_16x16x32_bf16 v[120:123], v[232:235], v[220:223], v[120:123]
    s_waitcnt lgkmcnt(4)
    v_mfma_f32_16x16x32_bf16 v[100:103], v[236:239], v[208:211], v[100:103]
    ds_read_b64_tr_b16 v[232:233], v62 offset:16384
    v_mfma_f32_16x16x32_bf16 v[108:111], v[236:239], v[212:215], v[108:111]
    ds_read_b64_tr_b16 v[234:235], v62 offset:17408
    v_mfma_f32_16x16x32_bf16 v[116:119], v[236:239], v[216:219], v[116:119]
    v_mfma_f32_16x16x32_bf16 v[124:127], v[236:239], v[220:223], v[124:127]
    s_waitcnt lgkmcnt(4)
    v_mfma_f32_16x16x32_bf16 v[128:131], v[224:227], v[208:211], v[128:131]
    ds_read_b64_tr_b16 v[236:237], v63 offset:16384
    v_mfma_f32_16x16x32_bf16 v[136:139], v[224:227], v[212:215], v[136:139]
    ds_read_b64_tr_b16 v[238:239], v63 offset:17408
    v_mfma_f32_16x16x32_bf16 v[144:147], v[224:227], v[216:219], v[144:147]
    v_mfma_f32_16x16x32_bf16 v[152:155], v[224:227], v[220:223], v[152:155]
    s_waitcnt lgkmcnt(4)
    v_mfma_f32_16x16x32_bf16 v[132:135], v[228:231], v[208:211], v[132:135]
    s_waitcnt vmcnt(15)
    s_waitcnt lgkmcnt(0)
    s_barrier
    v_add_u32 v240, 32768, v240
    v_add_u32 v247, 32768, v247
    v_cmp_ne_u32 vcc, s15, v53
    s_nop 1
    s_or_b32 s15, vcc_lo, vcc_hi
    ds_read_b128 v[192:195], v240 offset:0
    s_add_u32 m0, s60, 32768
    s_mov_b32 s56, 524288
    v_mfma_f32_16x16x32_bf16 v[140:143], v[228:231], v[212:215], v[140:143]
    ds_read_b64_tr_b16 v[224:225], v56 offset:32768
    buffer_load_dwordx4 v245, s[36:39], s56 offen offset:0 lds
    v_mfma_f32_16x16x32_bf16 v[148:151], v[228:231], v[216:219], v[148:151]
    ds_read_b64_tr_b16 v[226:227], v56 offset:33792
    s_mov_b32 s56, 556032
    buffer_load_dwordx4 v245, s[36:39], s56 offen offset:1024 lds
    v_mfma_f32_16x16x32_bf16 v[156:159], v[228:231], v[220:223], v[156:159]
    ds_read_b128 v[196:199], v240 offset:2048
    s_mov_b32 s56, 587776
    buffer_load_dwordx4 v245, s[36:39], s56 offen offset:2048 lds
    v_mfma_f32_16x16x32_bf16 v[160:163], v[232:235], v[208:211], v[160:163]
    ds_read_b64_tr_b16 v[228:229], v57 offset:32768
    s_mov_b32 s56, 619520
    buffer_load_dwordx4 v245, s[36:39], s56 offen offset:3072 lds
    v_mfma_f32_16x16x32_bf16 v[168:171], v[232:235], v[212:215], v[168:171]
    ds_read_b64_tr_b16 v[230:231], v57 offset:33792
    s_add_u32 m0, s14, 49152
    s_add_u32 s56, s96, 176128
    v_mfma_f32_16x16x32_bf16 v[176:179], v[232:235], v[216:219], v[176:179]
    ds_read_b128 v[200:203], v240 offset:4096
    buffer_load_dwordx4 v246, s[40:43], s56 offen offset:0 lds
    v_mfma_f32_16x16x32_bf16 v[184:187], v[232:235], v[220:223], v[184:187]
    buffer_load_dwordx4 v250, s[40:43], s56 offen offset:1024 lds
    v_mfma_f32_16x16x32_bf16 v[164:167], v[236:239], v[208:211], v[164:167]
    ds_read_b64_tr_b16 v[232:233], v58 offset:32768
    buffer_load_dwordx4 v252, s[40:43], s56 offen offset:2048 lds
    v_mfma_f32_16x16x32_bf16 v[172:175], v[236:239], v[212:215], v[172:175]
    ds_read_b64_tr_b16 v[234:235], v58 offset:33792
    buffer_load_dwordx4 v[16:19], v254, s[16:19], s13 offen offset:0
    v_mfma_f32_16x16x32_bf16 v[180:183], v[236:239], v[216:219], v[180:183]
    ds_read_b128 v[204:207], v240 offset:6144
    buffer_load_dwordx4 v[20:23], v254, s[16:19], s13 offen offset:1024
    v_mfma_f32_16x16x32_bf16 v[188:191], v[236:239], v[220:223], v[188:191]
    buffer_load_dwordx4 v[24:27], v254, s[16:19], s13 offen offset:2048
    s_waitcnt lgkmcnt(7)
    v_mfma_f32_16x16x32_bf16 v[64:67], v[224:227], v[192:195], v[64:67]
    ds_read_b64_tr_b16 v[236:237], v59 offset:32768
    buffer_load_dwordx4 v[28:31], v254, s[16:19], s13 offen offset:3072
    s_waitcnt lgkmcnt(7)
    v_mfma_f32_16x16x32_bf16 v[72:75], v[224:227], v[196:199], v[72:75]
    ds_read_b64_tr_b16 v[238:239], v59 offset:33792
    s_add_u32 s13, s13, 4096
    s_waitcnt lgkmcnt(5)
    v_mfma_f32_16x16x32_bf16 v[80:83], v[224:227], v[200:203], v[80:83]
    s_waitcnt lgkmcnt(2)
    v_mfma_f32_16x16x32_bf16 v[88:91], v[224:227], v[204:207], v[88:91]
    v_mfma_f32_16x16x32_bf16 v[68:71], v[228:231], v[192:195], v[68:71]
    ds_read_b64_tr_b16 v[224:225], v60 offset:32768
    v_mfma_f32_16x16x32_bf16 v[76:79], v[228:231], v[196:199], v[76:79]
    ds_read_b64_tr_b16 v[226:227], v60 offset:33792
    v_mfma_f32_16x16x32_bf16 v[84:87], v[228:231], v[200:203], v[84:87]
    v_mfma_f32_16x16x32_bf16 v[92:95], v[228:231], v[204:207], v[92:95]
    v_mfma_f32_16x16x32_bf16 v[96:99], v[232:235], v[192:195], v[96:99]
    ds_read_b64_tr_b16 v[228:229], v61 offset:32768
    v_mfma_f32_16x16x32_bf16 v[104:107], v[232:235], v[196:199], v[104:107]
    ds_read_b64_tr_b16 v[230:231], v61 offset:33792
    v_mfma_f32_16x16x32_bf16 v[112:115], v[232:235], v[200:203], v[112:115]
    v_mfma_f32_16x16x32_bf16 v[120:123], v[232:235], v[204:207], v[120:123]
    s_waitcnt lgkmcnt(4)
    v_mfma_f32_16x16x32_bf16 v[100:103], v[236:239], v[192:195], v[100:103]
    ds_read_b64_tr_b16 v[232:233], v62 offset:32768
    v_mfma_f32_16x16x32_bf16 v[108:111], v[236:239], v[196:199], v[108:111]
    ds_read_b64_tr_b16 v[234:235], v62 offset:33792
    v_mfma_f32_16x16x32_bf16 v[116:119], v[236:239], v[200:203], v[116:119]
    v_mfma_f32_16x16x32_bf16 v[124:127], v[236:239], v[204:207], v[124:127]
    s_waitcnt lgkmcnt(4)
    v_mfma_f32_16x16x32_bf16 v[128:131], v[224:227], v[192:195], v[128:131]
    ds_read_b64_tr_b16 v[236:237], v63 offset:32768
    v_mfma_f32_16x16x32_bf16 v[136:139], v[224:227], v[196:199], v[136:139]
    ds_read_b64_tr_b16 v[238:239], v63 offset:33792
    v_mfma_f32_16x16x32_bf16 v[144:147], v[224:227], v[200:203], v[144:147]
    v_mfma_f32_16x16x32_bf16 v[152:155], v[224:227], v[204:207], v[152:155]
    s_waitcnt lgkmcnt(4)
    v_mfma_f32_16x16x32_bf16 v[132:135], v[228:231], v[192:195], v[132:135]
    s_waitcnt vmcnt(22)
    s_waitcnt lgkmcnt(0)
    s_barrier
    ds_read_b128 v[208:211], v247 offset:0
    v_mfma_f32_16x16x32_bf16 v[140:143], v[228:231], v[196:199], v[140:143]
    ds_read_b64_tr_b16 v[224:225], v56 offset:49152
    v_mfma_f32_16x16x32_bf16 v[148:151], v[228:231], v[200:203], v[148:151]
    ds_read_b64_tr_b16 v[226:227], v56 offset:50176
    v_mfma_f32_16x16x32_bf16 v[156:159], v[228:231], v[204:207], v[156:159]
    ds_read_b128 v[212:215], v247 offset:2048
    v_mfma_f32_16x16x32_bf16 v[160:163], v[232:235], v[192:195], v[160:163]
    ds_read_b64_tr_b16 v[228:229], v57 offset:49152
    v_mfma_f32_16x16x32_bf16 v[168:171], v[232:235], v[196:199], v[168:171]
    ds_read_b64_tr_b16 v[230:231], v57 offset:50176
    v_mfma_f32_16x16x32_bf16 v[176:179], v[232:235], v[200:203], v[176:179]
    ds_read_b128 v[216:219], v247 offset:4096
    v_mfma_f32_16x16x32_bf16 v[184:187], v[232:235], v[204:207], v[184:187]
    v_mfma_f32_16x16x32_bf16 v[164:167], v[236:239], v[192:195], v[164:167]
    ds_read_b64_tr_b16 v[232:233], v58 offset:49152
    v_mfma_f32_16x16x32_bf16 v[172:175], v[236:239], v[196:199], v[172:175]
    ds_read_b64_tr_b16 v[234:235], v58 offset:50176
    v_mfma_f32_16x16x32_bf16 v[180:183], v[236:239], v[200:203], v[180:183]
    ds_read_b128 v[220:223], v247 offset:6144
    v_mfma_f32_16x16x32_bf16 v[188:191], v[236:239], v[204:207], v[188:191]
    s_waitcnt lgkmcnt(7)
    v_mfma_f32_16x16x32_bf16 v[64:67], v[224:227], v[208:211], v[64:67]
    ds_read_b64_tr_b16 v[236:237], v59 offset:49152
    s_waitcnt lgkmcnt(7)
    v_mfma_f32_16x16x32_bf16 v[72:75], v[224:227], v[212:215], v[72:75]
    ds_read_b64_tr_b16 v[238:239], v59 offset:50176
    s_waitcnt lgkmcnt(5)
    v_mfma_f32_16x16x32_bf16 v[80:83], v[224:227], v[216:219], v[80:83]
    s_waitcnt lgkmcnt(2)
    v_mfma_f32_16x16x32_bf16 v[88:91], v[224:227], v[220:223], v[88:91]
    v_mfma_f32_16x16x32_bf16 v[68:71], v[228:231], v[208:211], v[68:71]
    ds_read_b64_tr_b16 v[224:225], v60 offset:49152
    v_mfma_f32_16x16x32_bf16 v[76:79], v[228:231], v[212:215], v[76:79]
    ds_read_b64_tr_b16 v[226:227], v60 offset:50176
    v_mfma_f32_16x16x32_bf16 v[84:87], v[228:231], v[216:219], v[84:87]
    v_mfma_f32_16x16x32_bf16 v[92:95], v[228:231], v[220:223], v[92:95]
    v_mfma_f32_16x16x32_bf16 v[96:99], v[232:235], v[208:211], v[96:99]
    ds_read_b64_tr_b16 v[228:229], v61 offset:49152
    v_mfma_f32_16x16x32_bf16 v[104:107], v[232:235], v[212:215], v[104:107]
    ds_read_b64_tr_b16 v[230:231], v61 offset:50176
    v_mfma_f32_16x16x32_bf16 v[112:115], v[232:235], v[216:219], v[112:115]
    v_mfma_f32_16x16x32_bf16 v[120:123], v[232:235], v[220:223], v[120:123]
    s_waitcnt lgkmcnt(4)
    v_mfma_f32_16x16x32_bf16 v[100:103], v[236:239], v[208:211], v[100:103]
    ds_read_b64_tr_b16 v[232:233], v62 offset:49152
    v_cvt_pk_bf16_f32 v64, v64, v65
    v_cvt_pk_bf16_f32 v65, v66, v67
    v_cvt_pk_bf16_f32 v66, v68, v69
    v_mfma_f32_16x16x32_bf16 v[108:111], v[236:239], v[212:215], v[108:111]
    ds_read_b64_tr_b16 v[234:235], v62 offset:50176
    v_cvt_pk_bf16_f32 v67, v70, v71
    v_cvt_pk_bf16_f32 v68, v72, v73
    v_cvt_pk_bf16_f32 v69, v74, v75
    v_mfma_f32_16x16x32_bf16 v[116:119], v[236:239], v[216:219], v[116:119]
    v_cvt_pk_bf16_f32 v70, v76, v77
    v_cvt_pk_bf16_f32 v71, v78, v79
    v_cvt_pk_bf16_f32 v72, v80, v81
    v_mfma_f32_16x16x32_bf16 v[124:127], v[236:239], v[220:223], v[124:127]
    v_cvt_pk_bf16_f32 v73, v82, v83
    v_cvt_pk_bf16_f32 v74, v84, v85
    v_cvt_pk_bf16_f32 v75, v86, v87
    s_waitcnt lgkmcnt(4)
    v_mfma_f32_16x16x32_bf16 v[128:131], v[224:227], v[208:211], v[128:131]
    ds_read_b64_tr_b16 v[236:237], v63 offset:49152
    v_cvt_pk_bf16_f32 v76, v88, v89
    v_cvt_pk_bf16_f32 v77, v90, v91
    v_cvt_pk_bf16_f32 v78, v92, v93
    v_mfma_f32_16x16x32_bf16 v[136:139], v[224:227], v[212:215], v[136:139]
    ds_read_b64_tr_b16 v[238:239], v63 offset:50176
    v_cvt_pk_bf16_f32 v79, v94, v95
    v_mfma_f32_16x16x32_bf16 v[144:147], v[224:227], v[216:219], v[144:147]
    v_mfma_f32_16x16x32_bf16 v[152:155], v[224:227], v[220:223], v[152:155]
    s_waitcnt lgkmcnt(4)
    v_mfma_f32_16x16x32_bf16 v[132:135], v[228:231], v[208:211], v[132:135]
    v_cvt_pk_bf16_f32 v80, v96, v97
    v_cvt_pk_bf16_f32 v81, v98, v99
    v_cvt_pk_bf16_f32 v82, v100, v101
    v_mfma_f32_16x16x32_bf16 v[140:143], v[228:231], v[212:215], v[140:143]
    v_cvt_pk_bf16_f32 v83, v102, v103
    v_cvt_pk_bf16_f32 v84, v104, v105
    v_cvt_pk_bf16_f32 v85, v106, v107
    v_mfma_f32_16x16x32_bf16 v[148:151], v[228:231], v[216:219], v[148:151]
    v_cvt_pk_bf16_f32 v86, v108, v109
    v_cvt_pk_bf16_f32 v87, v110, v111
    v_cvt_pk_bf16_f32 v88, v112, v113
    v_mfma_f32_16x16x32_bf16 v[156:159], v[228:231], v[220:223], v[156:159]
    v_cvt_pk_bf16_f32 v89, v114, v115
    v_cvt_pk_bf16_f32 v90, v116, v117
    v_cvt_pk_bf16_f32 v91, v118, v119
    v_cvt_pk_bf16_f32 v92, v120, v121
    v_cvt_pk_bf16_f32 v93, v122, v123
    v_cvt_pk_bf16_f32 v94, v124, v125
    v_cvt_pk_bf16_f32 v95, v126, v127
    s_waitcnt vmcnt(15)
    s_waitcnt lgkmcnt(0)
    s_barrier
    v_bfe_u32 v48, v255, 2, 2
    v_and_b32 v49, 3, v255
    v_lshlrev_b32 v49, 3, v49
    v_add_u32 v49, 0, v49
    v_lshrrev_b32 v50, 5, v255
    v_lshl_add_u32 v50, v50, 3, v48
    v_mul_u32_u24 v51, 96, v50
    v_add_u32 v51, v51, v49
    v_lshl_add_u32 v49, v50, 8, v49
    v_bfe_u32 v50, v255, 4, 1
    v_lshl_add_u32 v49, v50, 5, v49
    v_xor_b32 v240, 0, v48
    v_lshl_add_u32 v240, v240, 6, v49
    v_xor_b32 v241, 1, v48
    v_lshl_add_u32 v241, v241, 6, v49
    v_xor_b32 v242, 2, v48
    v_lshl_add_u32 v242, v242, 6, v49
    v_xor_b32 v243, 3, v48
    v_lshl_add_u32 v243, v243, 6, v49
    v_mul_u32_u24 v48, 6272, v50
    v_add_u32 v247, v51, v48
    ds_read_b64_tr_b16 v[32:33], v240 offset:0
    ds_read_b64_tr_b16 v[34:35], v240 offset:1024
    ds_read_b64_tr_b16 v[36:37], v241 offset:0
    ds_read_b64_tr_b16 v[38:39], v241 offset:1024
    ds_read_b64_tr_b16 v[40:41], v242 offset:0
    ds_read_b64_tr_b16 v[42:43], v242 offset:1024
    ds_read_b64_tr_b16 v[44:45], v243 offset:0
    ds_read_b64_tr_b16 v[46:47], v243 offset:1024
    v_mfma_f32_16x16x32_bf16 v[160:163], v[232:235], v[208:211], v[160:163]
    s_add_u32 m0, s60, 65536
    s_mov_b32 s56, 1048576
    buffer_load_dwordx4 v245, s[36:39], s56 offen offset:0 lds
    v_mfma_f32_16x16x32_bf16 v[168:171], v[232:235], v[212:215], v[168:171]
    s_mov_b32 s56, 1080320
    buffer_load_dwordx4 v245, s[36:39], s56 offen offset:1024 lds
    v_mfma_f32_16x16x32_bf16 v[176:179], v[232:235], v[216:219], v[176:179]
    s_mov_b32 s56, 1112064
    buffer_load_dwordx4 v245, s[36:39], s56 offen offset:2048 lds
    v_mfma_f32_16x16x32_bf16 v[184:187], v[232:235], v[220:223], v[184:187]
    s_mov_b32 s56, 1143808
    buffer_load_dwordx4 v245, s[36:39], s56 offen offset:3072 lds
    v_mfma_f32_16x16x32_bf16 v[164:167], v[236:239], v[208:211], v[164:167]
    s_add_u32 m0, s14, 81920
    s_add_u32 s56, s96, 352256
    buffer_load_dwordx4 v246, s[40:43], s56 offen offset:0 lds
    v_mfma_f32_16x16x32_bf16 v[172:175], v[236:239], v[212:215], v[172:175]
    buffer_load_dwordx4 v250, s[40:43], s56 offen offset:1024 lds
    v_mfma_f32_16x16x32_bf16 v[180:183], v[236:239], v[216:219], v[180:183]
    buffer_load_dwordx4 v252, s[40:43], s56 offen offset:2048 lds
    v_mfma_f32_16x16x32_bf16 v[188:191], v[236:239], v[220:223], v[188:191]
    s_add_u32 m0, s60, 98304
    s_mov_b32 s56, 1572864
    buffer_load_dwordx4 v245, s[36:39], s56 offen offset:0 lds
    s_mov_b32 s56, 1604608
    buffer_load_dwordx4 v245, s[36:39], s56 offen offset:1024 lds
    s_mov_b32 s56, 1636352
    buffer_load_dwordx4 v245, s[36:39], s56 offen offset:2048 lds
    s_mov_b32 s56, 1668096
    buffer_load_dwordx4 v245, s[36:39], s56 offen offset:3072 lds
    s_add_u32 m0, s14, 114688
    s_add_u32 s56, s96, 528384
    buffer_load_dwordx4 v246, s[40:43], s56 offen offset:0 lds
    buffer_load_dwordx4 v250, s[40:43], s56 offen offset:1024 lds
    buffer_load_dwordx4 v252, s[40:43], s56 offen offset:2048 lds
    v_cvt_pk_bf16_f32 v96, v128, v129
    v_cvt_pk_bf16_f32 v97, v130, v131
    v_cvt_pk_bf16_f32 v98, v132, v133
    v_cvt_pk_bf16_f32 v99, v134, v135
    v_cvt_pk_bf16_f32 v100, v136, v137
    v_cvt_pk_bf16_f32 v101, v138, v139
    v_cvt_pk_bf16_f32 v102, v140, v141
    v_cvt_pk_bf16_f32 v103, v142, v143
    v_cvt_pk_bf16_f32 v104, v144, v145
    v_cvt_pk_bf16_f32 v105, v146, v147
    v_cvt_pk_bf16_f32 v106, v148, v149
    v_cvt_pk_bf16_f32 v107, v150, v151
    v_cvt_pk_bf16_f32 v108, v152, v153
    v_cvt_pk_bf16_f32 v109, v154, v155
    v_cvt_pk_bf16_f32 v110, v156, v157
    v_cvt_pk_bf16_f32 v111, v158, v159
    v_cvt_pk_bf16_f32 v112, v160, v161
    v_cvt_pk_bf16_f32 v113, v162, v163
    v_cvt_pk_bf16_f32 v114, v164, v165
    v_cvt_pk_bf16_f32 v115, v166, v167
    v_cvt_pk_bf16_f32 v116, v168, v169
    v_cvt_pk_bf16_f32 v117, v170, v171
    v_cvt_pk_bf16_f32 v118, v172, v173
    v_cvt_pk_bf16_f32 v119, v174, v175
    v_cvt_pk_bf16_f32 v120, v176, v177
    v_cvt_pk_bf16_f32 v121, v178, v179
    v_cvt_pk_bf16_f32 v122, v180, v181
    v_cvt_pk_bf16_f32 v123, v182, v183
    v_cvt_pk_bf16_f32 v124, v184, v185
    v_cvt_pk_bf16_f32 v125, v186, v187
    v_cvt_pk_bf16_f32 v126, v188, v189
    v_cvt_pk_bf16_f32 v127, v190, v191
    s_waitcnt vmcnt(28)
    s_waitcnt lgkmcnt(6)
    v_mfma_f32_32x32x16_bf16 v[128:143], v[32:35], v[0:3], 0
    ds_read_b64_tr_b16 v[48:49], v247 offset:16384
    ds_read_b64_tr_b16 v[50:51], v247 offset:16768
    s_waitcnt lgkmcnt(6)
    v_mfma_f32_32x32x16_bf16 v[144:159], v[36:39], v[0:3], 0
    ds_read_b64_tr_b16 v[52:53], v247 offset:16416
    ds_read_b64_tr_b16 v[54:55], v247 offset:16800
    s_waitcnt lgkmcnt(6)
    v_mfma_f32_32x32x16_bf16 v[160:175], v[40:43], v[0:3], 0
    ds_read_b64_tr_b16 v[56:57], v247 offset:16448
    ds_read_b64_tr_b16 v[58:59], v247 offset:16832
    s_cmp_lg_u32 s15, 0
    s_cbranch_scc1 L_kvs15a
    buffer_store_dwordx4 v[64:67], v244, s[16:19], s6 offen offset:0
    s_branch L_kvs15b
L_kvs15a:
    buffer_store_dwordx4 v[64:67], v244, s[16:19], s6 offen offset:0 sc1
L_kvs15b:
    s_waitcnt lgkmcnt(6)
    v_mfma_f32_32x32x16_bf16 v[176:191], v[44:47], v[0:3], 0
    ds_read_b64_tr_b16 v[60:61], v240 offset:4096
    ds_read_b64_tr_b16 v[62:63], v240 offset:5120
    s_waitcnt lgkmcnt(6)
    v_mfma_f32_32x32x16_bf16 v[192:207], v[48:51], v[0:3], 0
    ds_read_b64_tr_b16 v[32:33], v241 offset:4096
    ds_read_b64_tr_b16 v[34:35], v241 offset:5120
    s_waitcnt lgkmcnt(6)
    v_mfma_f32_32x32x16_bf16 v[208:223], v[52:55], v[0:3], 0
    ds_read_b64_tr_b16 v[36:37], v242 offset:4096
    ds_read_b64_tr_b16 v[38:39], v242 offset:5120
    s_waitcnt lgkmcnt(6)
    v_mfma_f32_32x32x16_bf16 v[224:239], v[56:59], v[0:3], 0
    ds_read_b64_tr_b16 v[40:41], v243 offset:4096
    ds_read_b64_tr_b16 v[42:43], v243 offset:5120
    buffer_load_dwordx4 v[0:3], v254, s[16:19], s13 offen offset:0
    s_waitcnt vmcnt(29)
    s_waitcnt lgkmcnt(6)
    v_mfma_f32_32x32x16_bf16 v[128:143], v[60:63], v[4:7], v[128:143]
    ds_read_b64_tr_b16 v[44:45], v247 offset:17920
    ds_read_b64_tr_b16 v[46:47], v247 offset:18304
    s_cmp_lg_u32 s15, 0
    s_cbranch_scc1 L_kvs14a
    buffer_store_dwordx4 v[68:71], v244, s[16:19], s6 offen offset:256
    s_branch L_kvs14b
L_kvs14a:
    buffer_store_dwordx4 v[68:71], v244, s[16:19], s6 offen offset:256 sc1
L_kvs14b:
    s_waitcnt lgkmcnt(6)
    v_mfma_f32_32x32x16_bf16 v[144:159], v[32:35], v[4:7], v[144:159]
    ds_read_b64_tr_b16 v[48:49], v247 offset:17952
    ds_read_b64_tr_b16 v[50:51], v247 offset:18336
    s_waitcnt lgkmcnt(6)
    v_mfma_f32_32x32x16_bf16 v[160:175], v[36:39], v[4:7], v[160:175]
    ds_read_b64_tr_b16 v[52:53], v247 offset:17984
    ds_read_b64_tr_b16 v[54:55], v247 offset:18368
    s_cmp_lg_u32 s15, 0
    s_cbranch_scc1 L_kvs13a
    buffer_store_dwordx4 v[72:75], v244, s[16:19], s8 offen offset:0
    s_branch L_kvs13b
L_kvs13a:
    buffer_store_dwordx4 v[72:75], v244, s[16:19], s8 offen offset:0 sc1
L_kvs13b:
    s_waitcnt lgkmcnt(6)
    v_mfma_f32_32x32x16_bf16 v[176:191], v[40:43], v[4:7], v[176:191]
    ds_read_b64_tr_b16 v[56:57], v240 offset:8192
    ds_read_b64_tr_b16 v[58:59], v240 offset:9216
    s_waitcnt lgkmcnt(6)
    v_mfma_f32_32x32x16_bf16 v[192:207], v[44:47], v[4:7], v[192:207]
    ds_read_b64_tr_b16 v[60:61], v241 offset:8192
    ds_read_b64_tr_b16 v[62:63], v241 offset:9216
    s_waitcnt lgkmcnt(6)
    v_mfma_f32_32x32x16_bf16 v[208:223], v[48:51], v[4:7], v[208:223]
    ds_read_b64_tr_b16 v[32:33], v242 offset:8192
    ds_read_b64_tr_b16 v[34:35], v242 offset:9216
    s_waitcnt lgkmcnt(6)
    v_mfma_f32_32x32x16_bf16 v[224:239], v[52:55], v[4:7], v[224:239]
    ds_read_b64_tr_b16 v[36:37], v243 offset:8192
    ds_read_b64_tr_b16 v[38:39], v243 offset:9216
    buffer_load_dwordx4 v[4:7], v254, s[16:19], s13 offen offset:1024
    s_waitcnt vmcnt(31)
    s_waitcnt lgkmcnt(6)
    v_mfma_f32_32x32x16_bf16 v[128:143], v[56:59], v[8:11], v[128:143]
    ds_read_b64_tr_b16 v[40:41], v247 offset:19456
    ds_read_b64_tr_b16 v[42:43], v247 offset:19840
    s_cmp_lg_u32 s15, 0
    s_cbranch_scc1 L_kvs12a
    buffer_store_dwordx4 v[76:79], v244, s[16:19], s8 offen offset:256
    s_branch L_kvs12b
L_kvs12a:
    buffer_store_dwordx4 v[76:79], v244, s[16:19], s8 offen offset:256 sc1
L_kvs12b:
    s_waitcnt lgkmcnt(6)
    v_mfma_f32_32x32x16_bf16 v[144:159], v[60:63], v[8:11], v[144:159]
    ds_read_b64_tr_b16 v[44:45], v247 offset:19488
    ds_read_b64_tr_b16 v[46:47], v247 offset:19872
    s_waitcnt lgkmcnt(6)
    v_mfma_f32_32x32x16_bf16 v[160:175], v[32:35], v[8:11], v[160:175]
    ds_read_b64_tr_b16 v[48:49], v247 offset:19520
    ds_read_b64_tr_b16 v[50:51], v247 offset:19904
    s_cmp_lg_u32 s15, 0
    s_cbranch_scc1 L_kvs11a
    buffer_store_dwordx4 v[80:83], v244, s[16:19], s6 offen offset:2048
    s_branch L_kvs11b
L_kvs11a:
    buffer_store_dwordx4 v[80:83], v244, s[16:19], s6 offen offset:2048 sc1
L_kvs11b:
    s_waitcnt lgkmcnt(6)
    v_mfma_f32_32x32x16_bf16 v[176:191], v[36:39], v[8:11], v[176:191]
    ds_read_b64_tr_b16 v[52:53], v240 offset:12288
    ds_read_b64_tr_b16 v[54:55], v240 offset:13312
    s_waitcnt lgkmcnt(6)
    v_mfma_f32_32x32x16_bf16 v[192:207], v[40:43], v[8:11], v[192:207]
    ds_read_b64_tr_b16 v[56:57], v241 offset:12288
    ds_read_b64_tr_b16 v[58:59], v241 offset:13312
    s_waitcnt lgkmcnt(6)
    v_mfma_f32_32x32x16_bf16 v[208:223], v[44:47], v[8:11], v[208:223]
    ds_read_b64_tr_b16 v[60:61], v242 offset:12288
    ds_read_b64_tr_b16 v[62:63], v242 offset:13312
    s_waitcnt lgkmcnt(6)
    v_mfma_f32_32x32x16_bf16 v[224:239], v[48:51], v[8:11], v[224:239]
    ds_read_b64_tr_b16 v[32:33], v243 offset:12288
    ds_read_b64_tr_b16 v[34:35], v243 offset:13312
    buffer_load_dwordx4 v[8:11], v254, s[16:19], s13 offen offset:2048
    s_waitcnt vmcnt(33)
    s_waitcnt lgkmcnt(6)
    v_mfma_f32_32x32x16_bf16 v[128:143], v[52:55], v[12:15], v[128:143]
    ds_read_b64_tr_b16 v[36:37], v247 offset:20992
    ds_read_b64_tr_b16 v[38:39], v247 offset:21376
    s_cmp_lg_u32 s15, 0
    s_cbranch_scc1 L_kvs10a
    buffer_store_dwordx4 v[84:87], v244, s[16:19], s6 offen offset:2304
    s_branch L_kvs10b
L_kvs10a:
    buffer_store_dwordx4 v[84:87], v244, s[16:19], s6 offen offset:2304 sc1
L_kvs10b:
    s_waitcnt lgkmcnt(6)
    v_mfma_f32_32x32x16_bf16 v[144:159], v[56:59], v[12:15], v[144:159]
    ds_read_b64_tr_b16 v[40:41], v247 offset:21024
    ds_read_b64_tr_b16 v[42:43], v247 offset:21408
    s_waitcnt lgkmcnt(6)
    v_mfma_f32_32x32x16_bf16 v[160:175], v[60:63], v[12:15], v[160:175]
    ds_read_b64_tr_b16 v[44:45], v247 offset:21056
    ds_read_b64_tr_b16 v[46:47], v247 offset:21440
    s_cmp_lg_u32 s15, 0
    s_cbranch_scc1 L_kvs9a
    buffer_store_dwordx4 v[88:91], v244, s[16:19], s8 offen offset:2048
    s_branch L_kvs9b
L_kvs9a:
    buffer_store_dwordx4 v[88:91], v244, s[16:19], s8 offen offset:2048 sc1
L_kvs9b:
    s_waitcnt lgkmcnt(6)
    v_mfma_f32_32x32x16_bf16 v[176:191], v[32:35], v[12:15], v[176:191]
    s_waitcnt vmcnt(28)
    s_barrier
    v_add_u32 v240, 32768, v240
    v_add_u32 v241, 32768, v241
    v_add_u32 v242, 32768, v242
    v_add_u32 v243, 32768, v243
    v_add_u32 v247, 32768, v247
    ds_read_b64_tr_b16 v[48:49], v240 offset:0
    ds_read_b64_tr_b16 v[50:51], v240 offset:1024
    s_add_u32 m0, s60, 131072
    s_mov_b32 s56, 2097152
    buffer_load_dwordx4 v245, s[36:39], s56 offen offset:0 lds
    s_waitcnt lgkmcnt(6)
    v_mfma_f32_32x32x16_bf16 v[192:207], v[36:39], v[12:15], v[192:207]
    ds_read_b64_tr_b16 v[52:53], v241 offset:0
    ds_read_b64_tr_b16 v[54:55], v241 offset:1024
    s_mov_b32 s56, 2128896
    buffer_load_dwordx4 v245, s[36:39], s56 offen offset:1024 lds
    s_waitcnt lgkmcnt(6)
    v_mfma_f32_32x32x16_bf16 v[208:223], v[40:43], v[12:15], v[208:223]
    ds_read_b64_tr_b16 v[56:57], v242 offset:0
    ds_read_b64_tr_b16 v[58:59], v242 offset:1024
    s_mov_b32 s56, 2160640
    buffer_load_dwordx4 v245, s[36:39], s56 offen offset:2048 lds
    s_waitcnt lgkmcnt(6)
    v_mfma_f32_32x32x16_bf16 v[224:239], v[44:47], v[12:15], v[224:239]
    ds_read_b64_tr_b16 v[60:61], v243 offset:0
    ds_read_b64_tr_b16 v[62:63], v243 offset:1024
    buffer_load_dwordx4 v[12:15], v254, s[16:19], s13 offen offset:3072
    s_add_u32 s13, s13, 4096
    s_mov_b32 s56, 2192384
    buffer_load_dwordx4 v245, s[36:39], s56 offen offset:3072 lds
    s_waitcnt vmcnt(32)
    s_waitcnt lgkmcnt(6)
    v_mfma_f32_32x32x16_bf16 v[128:143], v[48:51], v[16:19], v[128:143]
    ds_read_b64_tr_b16 v[32:33], v247 offset:16384
    ds_read_b64_tr_b16 v[34:35], v247 offset:16768
    s_cmp_lg_u32 s15, 0
    s_cbranch_scc1 L_kvs8a
    buffer_store_dwordx4 v[92:95], v244, s[16:19], s8 offen offset:2304
    s_branch L_kvs8b
L_kvs8a:
    buffer_store_dwordx4 v[92:95], v244, s[16:19], s8 offen offset:2304 sc1
L_kvs8b:
    s_add_u32 m0, s14, 147456
    s_add_u32 s56, s96, 704512
    buffer_load_dwordx4 v246, s[40:43], s56 offen offset:0 lds
    s_waitcnt lgkmcnt(6)
    v_mfma_f32_32x32x16_bf16 v[144:159], v[52:55], v[16:19], v[144:159]
    ds_read_b64_tr_b16 v[36:37], v247 offset:16416
    ds_read_b64_tr_b16 v[38:39], v247 offset:16800
    buffer_load_dwordx4 v250, s[40:43], s56 offen offset:1024 lds
    s_waitcnt lgkmcnt(6)
    v_mfma_f32_32x32x16_bf16 v[160:175], v[56:59], v[16:19], v[160:175]
    ds_read_b64_tr_b16 v[40:41], v247 offset:16448
    ds_read_b64_tr_b16 v[42:43], v247 offset:16832
    s_cmp_lg_u32 s15, 0
    s_cbranch_scc1 L_kvs7a
    buffer_store_dwordx4 v[96:99], v244, s[16:19], s7 offen offset:0
    s_branch L_kvs7b
L_kvs7a:
    buffer_store_dwordx4 v[96:99], v244, s[16:19], s7 offen offset:0 sc1
L_kvs7b:
    buffer_load_dwordx4 v252, s[40:43], s56 offen offset:2048 lds
    s_waitcnt lgkmcnt(6)
    v_mfma_f32_32x32x16_bf16 v[176:191], v[60:63], v[16:19], v[176:191]
    ds_read_b64_tr_b16 v[44:45], v240 offset:4096
    ds_read_b64_tr_b16 v[46:47], v240 offset:5120
    s_waitcnt lgkmcnt(6)
    v_mfma_f32_32x32x16_bf16 v[192:207], v[32:35], v[16:19], v[192:207]
    ds_read_b64_tr_b16 v[48:49], v241 offset:4096
    ds_read_b64_tr_b16 v[50:51], v241 offset:5120
    s_waitcnt lgkmcnt(6)
    v_mfma_f32_32x32x16_bf16 v[208:223], v[36:39], v[16:19], v[208:223]
    ds_read_b64_tr_b16 v[52:53], v242 offset:4096
    ds_read_b64_tr_b16 v[54:55], v242 offset:5120
    s_waitcnt lgkmcnt(6)
    v_mfma_f32_32x32x16_bf16 v[224:239], v[40:43], v[16:19], v[224:239]
    ds_read_b64_tr_b16 v[56:57], v243 offset:4096
    ds_read_b64_tr_b16 v[58:59], v243 offset:5120
    buffer_load_dwordx4 v[16:19], v254, s[16:19], s13 offen offset:0
    s_waitcnt vmcnt(37)
    s_waitcnt lgkmcnt(6)
    v_mfma_f32_32x32x16_bf16 v[128:143], v[44:47], v[20:23], v[128:143]
    ds_read_b64_tr_b16 v[60:61], v247 offset:17920
    ds_read_b64_tr_b16 v[62:63], v247 offset:18304
    s_cmp_lg_u32 s15, 0
    s_cbranch_scc1 L_kvs6a
    buffer_store_dwordx4 v[100:103], v244, s[16:19], s7 offen offset:256
    s_branch L_kvs6b
L_kvs6a:
    buffer_store_dwordx4 v[100:103], v244, s[16:19], s7 offen offset:256 sc1
L_kvs6b:
    s_waitcnt lgkmcnt(6)
    v_mfma_f32_32x32x16_bf16 v[144:159], v[48:51], v[20:23], v[144:159]
    ds_read_b64_tr_b16 v[32:33], v247 offset:17952
    ds_read_b64_tr_b16 v[34:35], v247 offset:18336
    s_waitcnt lgkmcnt(6)
    v_mfma_f32_32x32x16_bf16 v[160:175], v[52:55], v[20:23], v[160:175]
    ds_read_b64_tr_b16 v[36:37], v247 offset:17984
    ds_read_b64_tr_b16 v[38:39], v247 offset:18368
    s_cmp_lg_u32 s15, 0
    s_cbranch_scc1 L_kvs5a
    buffer_store_dwordx4 v[104:107], v244, s[16:19], s9 offen offset:0
    s_branch L_kvs5b
L_kvs5a:
    buffer_store_dwordx4 v[104:107], v244, s[16:19], s9 offen offset:0 sc1
L_kvs5b:
    s_waitcnt lgkmcnt(6)
    v_mfma_f32_32x32x16_bf16 v[176:191], v[56:59], v[20:23], v[176:191]
    ds_read_b64_tr_b16 v[40:41], v240 offset:8192
    ds_read_b64_tr_b16 v[42:43], v240 offset:9216
    s_waitcnt lgkmcnt(6)
    v_mfma_f32_32x32x16_bf16 v[192:207], v[60:63], v[20:23], v[192:207]
    ds_read_b64_tr_b16 v[44:45], v241 offset:8192
    ds_read_b64_tr_b16 v[46:47], v241 offset:9216
    s_waitcnt lgkmcnt(6)
    v_mfma_f32_32x32x16_bf16 v[208:223], v[32:35], v[20:23], v[208:223]
    ds_read_b64_tr_b16 v[48:49], v242 offset:8192
    ds_read_b64_tr_b16 v[50:51], v242 offset:9216
    s_waitcnt lgkmcnt(6)
    v_mfma_f32_32x32x16_bf16 v[224:239], v[36:39], v[20:23], v[224:239]
    ds_read_b64_tr_b16 v[52:53], v243 offset:8192
    ds_read_b64_tr_b16 v[54:55], v243 offset:9216
    buffer_load_dwordx4 v[20:23], v254, s[16:19], s13 offen offset:1024
    s_waitcnt vmcnt(39)
    s_waitcnt lgkmcnt(6)
    v_mfma_f32_32x32x16_bf16 v[128:143], v[40:43], v[24:27], v[128:143]
    ds_read_b64_tr_b16 v[56:57], v247 offset:19456
    ds_read_b64_tr_b16 v[58:59], v247 offset:19840
    s_cmp_lg_u32 s15, 0
    s_cbranch_scc1 L_kvs4a
    buffer_store_dwordx4 v[108:111], v244, s[16:19], s9 offen offset:256
    s_branch L_kvs4b
L_kvs4a:
    buffer_store_dwordx4 v[108:111], v244, s[16:19], s9 offen offset:256 sc1
L_kvs4b:
    s_waitcnt lgkmcnt(6)
    v_mfma_f32_32x32x16_bf16 v[144:159], v[44:47], v[24:27], v[144:159]
    ds_read_b64_tr_b16 v[60:61], v247 offset:19488
    ds_read_b64_tr_b16 v[62:63], v247 offset:19872
    s_waitcnt lgkmcnt(6)
    v_mfma_f32_32x32x16_bf16 v[160:175], v[48:51], v[24:27], v[160:175]
    ds_read_b64_tr_b16 v[32:33], v247 offset:19520
    ds_read_b64_tr_b16 v[34:35], v247 offset:19904
    s_cmp_lg_u32 s15, 0
    s_cbranch_scc1 L_kvs3a
    buffer_store_dwordx4 v[112:115], v244, s[16:19], s7 offen offset:2048
    s_branch L_kvs3b
L_kvs3a:
    buffer_store_dwordx4 v[112:115], v244, s[16:19], s7 offen offset:2048 sc1
L_kvs3b:
    s_waitcnt lgkmcnt(6)
    v_mfma_f32_32x32x16_bf16 v[176:191], v[52:55], v[24:27], v[176:191]
    ds_read_b64_tr_b16 v[36:37], v240 offset:12288
    ds_read_b64_tr_b16 v[38:39], v240 offset:13312
    s_waitcnt lgkmcnt(6)
    v_mfma_f32_32x32x16_bf16 v[192:207], v[56:59], v[24:27], v[192:207]
    ds_read_b64_tr_b16 v[40:41], v241 offset:12288
    ds_read_b64_tr_b16 v[42:43], v241 offset:13312
    s_waitcnt lgkmcnt(6)
    v_mfma_f32_32x32x16_bf16 v[208:223], v[60:63], v[24:27], v[208:223]
    ds_read_b64_tr_b16 v[44:45], v242 offset:12288
    ds_read_b64_tr_b16 v[46:47], v242 offset:13312
    s_waitcnt lgkmcnt(6)
    v_mfma_f32_32x32x16_bf16 v[224:239], v[32:35], v[24:27], v[224:239]
    ds_read_b64_tr_b16 v[48:49], v243 offset:12288
    ds_read_b64_tr_b16 v[50:51], v243 offset:13312
    buffer_load_dwordx4 v[24:27], v254, s[16:19], s13 offen offset:2048
    s_waitcnt vmcnt(41)
    s_waitcnt lgkmcnt(6)
    v_mfma_f32_32x32x16_bf16 v[128:143], v[36:39], v[28:31], v[128:143]
    ds_read_b64_tr_b16 v[52:53], v247 offset:20992
    ds_read_b64_tr_b16 v[54:55], v247 offset:21376
    s_cmp_lg_u32 s15, 0
    s_cbranch_scc1 L_kvs2a
    buffer_store_dwordx4 v[116:119], v244, s[16:19], s7 offen offset:2304
    s_branch L_kvs2b
L_kvs2a:
    buffer_store_dwordx4 v[116:119], v244, s[16:19], s7 offen offset:2304 sc1
L_kvs2b:
    s_waitcnt lgkmcnt(6)
    v_mfma_f32_32x32x16_bf16 v[144:159], v[40:43], v[28:31], v[144:159]
    ds_read_b64_tr_b16 v[56:57], v247 offset:21024
    ds_read_b64_tr_b16 v[58:59], v247 offset:21408
    s_waitcnt lgkmcnt(6)
    v_mfma_f32_32x32x16_bf16 v[160:175], v[44:47], v[28:31], v[160:175]
    ds_read_b64_tr_b16 v[60:61], v247 offset:21056
    ds_read_b64_tr_b16 v[62:63], v247 offset:21440
    s_cmp_lg_u32 s15, 0
    s_cbranch_scc1 L_kvs1a
    buffer_store_dwordx4 v[120:123], v244, s[16:19], s9 offen offset:2048
    s_branch L_kvs1b
L_kvs1a:
    buffer_store_dwordx4 v[120:123], v244, s[16:19], s9 offen offset:2048 sc1
L_kvs1b:
    s_waitcnt lgkmcnt(6)
    v_mfma_f32_32x32x16_bf16 v[176:191], v[48:51], v[28:31], v[176:191]
    s_waitcnt vmcnt(36)
    s_barrier
    v_add_u32 v240, 32768, v240
    v_add_u32 v241, 32768, v241
    v_add_u32 v242, 32768, v242
    v_add_u32 v243, 32768, v243
    v_add_u32 v247, 32768, v247
    ds_read_b64_tr_b16 v[32:33], v240 offset:0
    ds_read_b64_tr_b16 v[34:35], v240 offset:1024
    s_add_u32 m0, s60, 0
    s_mov_b32 s56, 2621440
    buffer_load_dwordx4 v245, s[36:39], s56 offen offset:0 lds
    s_waitcnt lgkmcnt(6)
    v_mfma_f32_32x32x16_bf16 v[192:207], v[52:55], v[28:31], v[192:207]
    ds_read_b64_tr_b16 v[36:37], v241 offset:0
    ds_read_b64_tr_b16 v[38:39], v241 offset:1024
    s_mov_b32 s56, 2653184
    buffer_load_dwordx4 v245, s[36:39], s56 offen offset:1024 lds
    s_waitcnt lgkmcnt(6)
    v_mfma_f32_32x32x16_bf16 v[208:223], v[56:59], v[28:31], v[208:223]
    ds_read_b64_tr_b16 v[40:41], v242 offset:0
    ds_read_b64_tr_b16 v[42:43], v242 offset:1024
    s_mov_b32 s56, 2684928
    buffer_load_dwordx4 v245, s[36:39], s56 offen offset:2048 lds
    s_waitcnt lgkmcnt(6)
    v_mfma_f32_32x32x16_bf16 v[224:239], v[60:63], v[28:31], v[224:239]
    ds_read_b64_tr_b16 v[44:45], v243 offset:0
    ds_read_b64_tr_b16 v[46:47], v243 offset:1024
    buffer_load_dwordx4 v[28:31], v254, s[16:19], s13 offen offset:3072
    s_add_u32 s13, s13, 4096
    s_mov_b32 s56, 2716672
    buffer_load_dwordx4 v245, s[36:39], s56 offen offset:3072 lds
    s_waitcnt vmcnt(32)
    s_waitcnt lgkmcnt(6)
    v_mfma_f32_32x32x16_bf16 v[128:143], v[32:35], v[0:3], v[128:143]
    ds_read_b64_tr_b16 v[48:49], v247 offset:16384
    ds_read_b64_tr_b16 v[50:51], v247 offset:16768
    s_cmp_lg_u32 s15, 0
    s_cbranch_scc1 L_kvs0a
    buffer_store_dwordx4 v[124:127], v244, s[16:19], s9 offen offset:2304
    s_branch L_kvs0b
L_kvs0a:
    buffer_store_dwordx4 v[124:127], v244, s[16:19], s9 offen offset:2304 sc1
L_kvs0b:
    s_add_u32 m0, s14, 16384
    s_add_u32 s56, s96, 880640
    buffer_load_dwordx4 v246, s[40:43], s56 offen offset:0 lds
    s_waitcnt lgkmcnt(6)
    v_mfma_f32_32x32x16_bf16 v[144:159], v[36:39], v[0:3], v[144:159]
    ds_read_b64_tr_b16 v[52:53], v247 offset:16416
    ds_read_b64_tr_b16 v[54:55], v247 offset:16800
    buffer_load_dwordx4 v250, s[40:43], s56 offen offset:1024 lds
    s_waitcnt lgkmcnt(6)
    v_mfma_f32_32x32x16_bf16 v[160:175], v[40:43], v[0:3], v[160:175]
    ds_read_b64_tr_b16 v[56:57], v247 offset:16448
    ds_read_b64_tr_b16 v[58:59], v247 offset:16832
    buffer_load_dwordx4 v252, s[40:43], s56 offen offset:2048 lds
    s_waitcnt lgkmcnt(6)
    v_mfma_f32_32x32x16_bf16 v[176:191], v[44:47], v[0:3], v[176:191]
    ds_read_b64_tr_b16 v[60:61], v240 offset:4096
    ds_read_b64_tr_b16 v[62:63], v240 offset:5120
    s_waitcnt lgkmcnt(6)
    v_mfma_f32_32x32x16_bf16 v[192:207], v[48:51], v[0:3], v[192:207]
    ds_read_b64_tr_b16 v[32:33], v241 offset:4096
    ds_read_b64_tr_b16 v[34:35], v241 offset:5120
    s_waitcnt lgkmcnt(6)
    v_mfma_f32_32x32x16_bf16 v[208:223], v[52:55], v[0:3], v[208:223]
    ds_read_b64_tr_b16 v[36:37], v242 offset:4096
    ds_read_b64_tr_b16 v[38:39], v242 offset:5120
    s_waitcnt lgkmcnt(6)
    v_mfma_f32_32x32x16_bf16 v[224:239], v[56:59], v[0:3], v[224:239]
    ds_read_b64_tr_b16 v[40:41], v243 offset:4096
    ds_read_b64_tr_b16 v[42:43], v243 offset:5120
    buffer_load_dwordx4 v[0:3], v254, s[16:19], s13 offen offset:0
    s_waitcnt vmcnt(34)
    s_waitcnt lgkmcnt(6)
    v_mfma_f32_32x32x16_bf16 v[128:143], v[60:63], v[4:7], v[128:143]
    ds_read_b64_tr_b16 v[44:45], v247 offset:17920
    ds_read_b64_tr_b16 v[46:47], v247 offset:18304
    s_waitcnt lgkmcnt(6)
    v_mfma_f32_32x32x16_bf16 v[144:159], v[32:35], v[4:7], v[144:159]
    ds_read_b64_tr_b16 v[48:49], v247 offset:17952
    ds_read_b64_tr_b16 v[50:51], v247 offset:18336
    s_waitcnt lgkmcnt(6)
    v_mfma_f32_32x32x16_bf16 v[160:175], v[36:39], v[4:7], v[160:175]
    ds_read_b64_tr_b16 v[52:53], v247 offset:17984
    ds_read_b64_tr_b16 v[54:55], v247 offset:18368
    s_waitcnt lgkmcnt(6)
    v_mfma_f32_32x32x16_bf16 v[176:191], v[40:43], v[4:7], v[176:191]
    ds_read_b64_tr_b16 v[56:57], v240 offset:8192
    ds_read_b64_tr_b16 v[58:59], v240 offset:9216
    s_waitcnt lgkmcnt(6)
    v_mfma_f32_32x32x16_bf16 v[192:207], v[44:47], v[4:7], v[192:207]
    ds_read_b64_tr_b16 v[60:61], v241 offset:8192
    ds_read_b64_tr_b16 v[62:63], v241 offset:9216
    s_waitcnt lgkmcnt(6)
    v_mfma_f32_32x32x16_bf16 v[208:223], v[48:51], v[4:7], v[208:223]
    ds_read_b64_tr_b16 v[32:33], v242 offset:8192
    ds_read_b64_tr_b16 v[34:35], v242 offset:9216
    s_waitcnt lgkmcnt(6)
    v_mfma_f32_32x32x16_bf16 v[224:239], v[52:55], v[4:7], v[224:239]
    ds_read_b64_tr_b16 v[36:37], v243 offset:8192
    ds_read_b64_tr_b16 v[38:39], v243 offset:9216
    buffer_load_dwordx4 v[4:7], v254, s[16:19], s13 offen offset:1024
    s_waitcnt vmcnt(32)
    s_waitcnt lgkmcnt(6)
    v_mfma_f32_32x32x16_bf16 v[128:143], v[56:59], v[8:11], v[128:143]
    ds_read_b64_tr_b16 v[40:41], v247 offset:19456
    ds_read_b64_tr_b16 v[42:43], v247 offset:19840
    s_waitcnt lgkmcnt(6)
    v_mfma_f32_32x32x16_bf16 v[144:159], v[60:63], v[8:11], v[144:159]
    ds_read_b64_tr_b16 v[44:45], v247 offset:19488
    ds_read_b64_tr_b16 v[46:47], v247 offset:19872
    s_waitcnt lgkmcnt(6)
    v_mfma_f32_32x32x16_bf16 v[160:175], v[32:35], v[8:11], v[160:175]
    ds_read_b64_tr_b16 v[48:49], v247 offset:19520
    ds_read_b64_tr_b16 v[50:51], v247 offset:19904
    s_waitcnt lgkmcnt(6)
    v_mfma_f32_32x32x16_bf16 v[176:191], v[36:39], v[8:11], v[176:191]
    ds_read_b64_tr_b16 v[52:53], v240 offset:12288
    ds_read_b64_tr_b16 v[54:55], v240 offset:13312
    s_waitcnt lgkmcnt(6)
    v_mfma_f32_32x32x16_bf16 v[192:207], v[40:43], v[8:11], v[192:207]
    ds_read_b64_tr_b16 v[56:57], v241 offset:12288
    ds_read_b64_tr_b16 v[58:59], v241 offset:13312
    s_waitcnt lgkmcnt(6)
    v_mfma_f32_32x32x16_bf16 v[208:223], v[44:47], v[8:11], v[208:223]
    ds_read_b64_tr_b16 v[60:61], v242 offset:12288
    ds_read_b64_tr_b16 v[62:63], v242 offset:13312
    s_waitcnt lgkmcnt(6)
    v_mfma_f32_32x32x16_bf16 v[224:239], v[48:51], v[8:11], v[224:239]
    ds_read_b64_tr_b16 v[32:33], v243 offset:12288
    ds_read_b64_tr_b16 v[34:35], v243 offset:13312
    buffer_load_dwordx4 v[8:11], v254, s[16:19], s13 offen offset:2048
    s_waitcnt vmcnt(27)
    s_waitcnt lgkmcnt(6)
    v_mfma_f32_32x32x16_bf16 v[128:143], v[52:55], v[12:15], v[128:143]
    ds_read_b64_tr_b16 v[36:37], v247 offset:20992
    ds_read_b64_tr_b16 v[38:39], v247 offset:21376
    s_waitcnt lgkmcnt(6)
    v_mfma_f32_32x32x16_bf16 v[144:159], v[56:59], v[12:15], v[144:159]
    ds_read_b64_tr_b16 v[40:41], v247 offset:21024
    ds_read_b64_tr_b16 v[42:43], v247 offset:21408
    s_waitcnt lgkmcnt(6)
    v_mfma_f32_32x32x16_bf16 v[160:175], v[60:63], v[12:15], v[160:175]
    ds_read_b64_tr_b16 v[44:45], v247 offset:21056
    ds_read_b64_tr_b16 v[46:47], v247 offset:21440
    s_waitcnt lgkmcnt(6)
    v_mfma_f32_32x32x16_bf16 v[176:191], v[32:35], v[12:15], v[176:191]
    s_barrier
    v_add_u32 v240, 32768, v240
    v_add_u32 v241, 32768, v241
    v_add_u32 v242, 32768, v242
    v_add_u32 v243, 32768, v243
    v_add_u32 v247, 32768, v247
    ds_read_b64_tr_b16 v[48:49], v240 offset:0
    ds_read_b64_tr_b16 v[50:51], v240 offset:1024
    s_add_u32 m0, s60, 32768
    s_mov_b32 s56, 3145728
    buffer_load_dwordx4 v245, s[36:39], s56 offen offset:0 lds
    s_waitcnt lgkmcnt(6)
    v_mfma_f32_32x32x16_bf16 v[192:207], v[36:39], v[12:15], v[192:207]
    ds_read_b64_tr_b16 v[52:53], v241 offset:0
    ds_read_b64_tr_b16 v[54:55], v241 offset:1024
    s_mov_b32 s56, 3177472
    buffer_load_dwordx4 v245, s[36:39], s56 offen offset:1024 lds
    s_waitcnt lgkmcnt(6)
    v_mfma_f32_32x32x16_bf16 v[208:223], v[40:43], v[12:15], v[208:223]
    ds_read_b64_tr_b16 v[56:57], v242 offset:0
    ds_read_b64_tr_b16 v[58:59], v242 offset:1024
    s_mov_b32 s56, 3209216
    buffer_load_dwordx4 v245, s[36:39], s56 offen offset:2048 lds
    s_waitcnt lgkmcnt(6)
    v_mfma_f32_32x32x16_bf16 v[224:239], v[44:47], v[12:15], v[224:239]
    ds_read_b64_tr_b16 v[60:61], v243 offset:0
    ds_read_b64_tr_b16 v[62:63], v243 offset:1024
    buffer_load_dwordx4 v[12:15], v254, s[16:19], s13 offen offset:3072
    s_add_u32 s13, s13, 4096
    s_mov_b32 s56, 3240960
    buffer_load_dwordx4 v245, s[36:39], s56 offen offset:3072 lds
    s_waitcnt vmcnt(25)
    s_waitcnt lgkmcnt(6)
    v_mfma_f32_32x32x16_bf16 v[128:143], v[48:51], v[16:19], v[128:143]
    ds_read_b64_tr_b16 v[32:33], v247 offset:16384
    ds_read_b64_tr_b16 v[34:35], v247 offset:16768
    s_add_u32 m0, s14, 49152
    s_add_u32 s56, s96, 1056768
    buffer_load_dwordx4 v246, s[40:43], s56 offen offset:0 lds
    s_waitcnt lgkmcnt(6)
    v_mfma_f32_32x32x16_bf16 v[144:159], v[52:55], v[16:19], v[144:159]
    ds_read_b64_tr_b16 v[36:37], v247 offset:16416
    ds_read_b64_tr_b16 v[38:39], v247 offset:16800
    buffer_load_dwordx4 v250, s[40:43], s56 offen offset:1024 lds
    s_waitcnt lgkmcnt(6)
    v_mfma_f32_32x32x16_bf16 v[160:175], v[56:59], v[16:19], v[160:175]
    ds_read_b64_tr_b16 v[40:41], v247 offset:16448
    ds_read_b64_tr_b16 v[42:43], v247 offset:16832
    buffer_load_dwordx4 v252, s[40:43], s56 offen offset:2048 lds
    s_waitcnt lgkmcnt(6)
    v_mfma_f32_32x32x16_bf16 v[176:191], v[60:63], v[16:19], v[176:191]
    ds_read_b64_tr_b16 v[44:45], v240 offset:4096
    ds_read_b64_tr_b16 v[46:47], v240 offset:5120
    s_waitcnt lgkmcnt(6)
    v_mfma_f32_32x32x16_bf16 v[192:207], v[32:35], v[16:19], v[192:207]
    ds_read_b64_tr_b16 v[48:49], v241 offset:4096
    ds_read_b64_tr_b16 v[50:51], v241 offset:5120
    s_waitcnt lgkmcnt(6)
    v_mfma_f32_32x32x16_bf16 v[208:223], v[36:39], v[16:19], v[208:223]
    ds_read_b64_tr_b16 v[52:53], v242 offset:4096
    ds_read_b64_tr_b16 v[54:55], v242 offset:5120
    s_waitcnt lgkmcnt(6)
    v_mfma_f32_32x32x16_bf16 v[224:239], v[40:43], v[16:19], v[224:239]
    ds_read_b64_tr_b16 v[56:57], v243 offset:4096
    ds_read_b64_tr_b16 v[58:59], v243 offset:5120
    buffer_load_dwordx4 v[16:19], v254, s[16:19], s13 offen offset:0
    s_waitcnt vmcnt(26)
    s_waitcnt lgkmcnt(6)
    v_mfma_f32_32x32x16_bf16 v[128:143], v[44:47], v[20:23], v[128:143]
    ds_read_b64_tr_b16 v[60:61], v247 offset:17920
    ds_read_b64_tr_b16 v[62:63], v247 offset:18304
    s_waitcnt lgkmcnt(6)
    v_mfma_f32_32x32x16_bf16 v[144:159], v[48:51], v[20:23], v[144:159]
    ds_read_b64_tr_b16 v[32:33], v247 offset:17952
    ds_read_b64_tr_b16 v[34:35], v247 offset:18336
    s_waitcnt lgkmcnt(6)
    v_mfma_f32_32x32x16_bf16 v[160:175], v[52:55], v[20:23], v[160:175]
    ds_read_b64_tr_b16 v[36:37], v247 offset:17984
    ds_read_b64_tr_b16 v[38:39], v247 offset:18368
    s_waitcnt lgkmcnt(6)
    v_mfma_f32_32x32x16_bf16 v[176:191], v[56:59], v[20:23], v[176:191]
    ds_read_b64_tr_b16 v[40:41], v240 offset:8192
    ds_read_b64_tr_b16 v[42:43], v240 offset:9216
    s_waitcnt lgkmcnt(6)
    v_mfma_f32_32x32x16_bf16 v[192:207], v[60:63], v[20:23], v[192:207]
    ds_read_b64_tr_b16 v[44:45], v241 offset:8192
    ds_read_b64_tr_b16 v[46:47], v241 offset:9216
    s_waitcnt lgkmcnt(6)
    v_mfma_f32_32x32x16_bf16 v[208:223], v[32:35], v[20:23], v[208:223]
    ds_read_b64_tr_b16 v[48:49], v242 offset:8192
    ds_read_b64_tr_b16 v[50:51], v242 offset:9216
    s_waitcnt lgkmcnt(6)
    v_mfma_f32_32x32x16_bf16 v[224:239], v[36:39], v[20:23], v[224:239]
    ds_read_b64_tr_b16 v[52:53], v243 offset:8192
    ds_read_b64_tr_b16 v[54:55], v243 offset:9216
    buffer_load_dwordx4 v[20:23], v254, s[16:19], s13 offen offset:1024
    s_waitcnt vmcnt(24)
    s_waitcnt lgkmcnt(6)
    v_mfma_f32_32x32x16_bf16 v[128:143], v[40:43], v[24:27], v[128:143]
    ds_read_b64_tr_b16 v[56:57], v247 offset:19456
    ds_read_b64_tr_b16 v[58:59], v247 offset:19840
    s_waitcnt lgkmcnt(6)
    v_mfma_f32_32x32x16_bf16 v[144:159], v[44:47], v[24:27], v[144:159]
    ds_read_b64_tr_b16 v[60:61], v247 offset:19488
    ds_read_b64_tr_b16 v[62:63], v247 offset:19872
    s_waitcnt lgkmcnt(6)
    v_mfma_f32_32x32x16_bf16 v[160:175], v[48:51], v[24:27], v[160:175]
    ds_read_b64_tr_b16 v[32:33], v247 offset:19520
    ds_read_b64_tr_b16 v[34:35], v247 offset:19904
    s_waitcnt lgkmcnt(6)
    v_mfma_f32_32x32x16_bf16 v[176:191], v[52:55], v[24:27], v[176:191]
    ds_read_b64_tr_b16 v[36:37], v240 offset:12288
    ds_read_b64_tr_b16 v[38:39], v240 offset:13312
    s_waitcnt lgkmcnt(6)
    v_mfma_f32_32x32x16_bf16 v[192:207], v[56:59], v[24:27], v[192:207]
    ds_read_b64_tr_b16 v[40:41], v241 offset:12288
    ds_read_b64_tr_b16 v[42:43], v241 offset:13312
    s_waitcnt lgkmcnt(6)
    v_mfma_f32_32x32x16_bf16 v[208:223], v[60:63], v[24:27], v[208:223]
    ds_read_b64_tr_b16 v[44:45], v242 offset:12288
    ds_read_b64_tr_b16 v[46:47], v242 offset:13312
    s_waitcnt lgkmcnt(6)
    v_mfma_f32_32x32x16_bf16 v[224:239], v[32:35], v[24:27], v[224:239]
    ds_read_b64_tr_b16 v[48:49], v243 offset:12288
    ds_read_b64_tr_b16 v[50:51], v243 offset:13312
    buffer_load_dwordx4 v[24:27], v254, s[16:19], s13 offen offset:2048
    s_waitcnt vmcnt(19)
    s_waitcnt lgkmcnt(6)
    v_mfma_f32_32x32x16_bf16 v[128:143], v[36:39], v[28:31], v[128:143]
    ds_read_b64_tr_b16 v[52:53], v247 offset:20992
    ds_read_b64_tr_b16 v[54:55], v247 offset:21376
    s_waitcnt lgkmcnt(6)
    v_mfma_f32_32x32x16_bf16 v[144:159], v[40:43], v[28:31], v[144:159]
    ds_read_b64_tr_b16 v[56:57], v247 offset:21024
    ds_read_b64_tr_b16 v[58:59], v247 offset:21408
    s_waitcnt lgkmcnt(6)
    v_mfma_f32_32x32x16_bf16 v[160:175], v[44:47], v[28:31], v[160:175]
    ds_read_b64_tr_b16 v[60:61], v247 offset:21056
    ds_read_b64_tr_b16 v[62:63], v247 offset:21440
    s_waitcnt lgkmcnt(6)
    v_mfma_f32_32x32x16_bf16 v[176:191], v[48:51], v[28:31], v[176:191]
    s_barrier
    v_add_u32 v240, 32768, v240
    v_add_u32 v241, 32768, v241
    v_add_u32 v242, 32768, v242
    v_add_u32 v243, 32768, v243
    v_add_u32 v247, 32768, v247
    ds_read_b64_tr_b16 v[32:33], v240 offset:0
    ds_read_b64_tr_b16 v[34:35], v240 offset:1024
    s_add_u32 m0, s60, 65536
    s_mov_b32 s56, 3670016
    buffer_load_dwordx4 v245, s[36:39], s56 offen offset:0 lds
    s_waitcnt lgkmcnt(6)
    v_mfma_f32_32x32x16_bf16 v[192:207], v[52:55], v[28:31], v[192:207]
    ds_read_b64_tr_b16 v[36:37], v241 offset:0
    ds_read_b64_tr_b16 v[38:39], v241 offset:1024
    s_mov_b32 s56, 3701760
    buffer_load_dwordx4 v245, s[36:39], s56 offen offset:1024 lds
    s_waitcnt lgkmcnt(6)
    v_mfma_f32_32x32x16_bf16 v[208:223], v[56:59], v[28:31], v[208:223]
    ds_read_b64_tr_b16 v[40:41], v242 offset:0
    ds_read_b64_tr_b16 v[42:43], v242 offset:1024
    s_mov_b32 s56, 3733504
    buffer_load_dwordx4 v245, s[36:39], s56 offen offset:2048 lds
    s_waitcnt lgkmcnt(6)
    v_mfma_f32_32x32x16_bf16 v[224:239], v[60:63], v[28:31], v[224:239]
    ds_read_b64_tr_b16 v[44:45], v243 offset:0
    ds_read_b64_tr_b16 v[46:47], v243 offset:1024
    buffer_load_dwordx4 v[28:31], v254, s[16:19], s13 offen offset:3072
    s_add_u32 s13, s13, 4096
    s_mov_b32 s56, 3765248
    buffer_load_dwordx4 v245, s[36:39], s56 offen offset:3072 lds
    s_waitcnt vmcnt(18)
    s_lshl_b32 s54, s48, 3
    s_add_u32 s54, s54, s49
    s_lshl_b32 s54, s54, 3
    s_add_u32 s54, s54, s50
    s_lshl_b32 s54, s54, 2
    s_add_u32 s54, s54, 58736640
    s_mov_b64 exec, 1
    buffer_store_dword v251, off, s[16:19], s54 sc1
    s_mov_b64 exec, -1
    s_waitcnt lgkmcnt(6)
    v_mfma_f32_32x32x16_bf16 v[128:143], v[32:35], v[0:3], v[128:143]
    ds_read_b64_tr_b16 v[48:49], v247 offset:16384
    ds_read_b64_tr_b16 v[50:51], v247 offset:16768
    s_add_u32 m0, s14, 81920
    s_add_u32 s56, s96, 1232896
    buffer_load_dwordx4 v246, s[40:43], s56 offen offset:0 lds
    s_waitcnt lgkmcnt(6)
    v_mfma_f32_32x32x16_bf16 v[144:159], v[36:39], v[0:3], v[144:159]
    ds_read_b64_tr_b16 v[52:53], v247 offset:16416
    ds_read_b64_tr_b16 v[54:55], v247 offset:16800
    buffer_load_dwordx4 v250, s[40:43], s56 offen offset:1024 lds
    s_waitcnt lgkmcnt(6)
    v_mfma_f32_32x32x16_bf16 v[160:175], v[40:43], v[0:3], v[160:175]
    ds_read_b64_tr_b16 v[56:57], v247 offset:16448
    ds_read_b64_tr_b16 v[58:59], v247 offset:16832
    buffer_load_dwordx4 v252, s[40:43], s56 offen offset:2048 lds
    s_waitcnt lgkmcnt(6)
    v_mfma_f32_32x32x16_bf16 v[176:191], v[44:47], v[0:3], v[176:191]
    ds_read_b64_tr_b16 v[60:61], v240 offset:4096
    ds_read_b64_tr_b16 v[62:63], v240 offset:5120
    v_mov_b32 v64, 0
    v_mov_b32 v65, 0
    v_mov_b32 v66, 0
    s_waitcnt lgkmcnt(6)
    v_mfma_f32_32x32x16_bf16 v[192:207], v[48:51], v[0:3], v[192:207]
    ds_read_b64_tr_b16 v[32:33], v241 offset:4096
    ds_read_b64_tr_b16 v[34:35], v241 offset:5120
    v_mov_b32 v67, 0
    v_mov_b32 v68, 0
    v_mov_b32 v69, 0
    s_waitcnt lgkmcnt(6)
    v_mfma_f32_32x32x16_bf16 v[208:223], v[52:55], v[0:3], v[208:223]
    ds_read_b64_tr_b16 v[36:37], v242 offset:4096
    ds_read_b64_tr_b16 v[38:39], v242 offset:5120
    v_mov_b32 v70, 0
    v_mov_b32 v71, 0
    v_mov_b32 v72, 0
    s_waitcnt lgkmcnt(6)
    v_mfma_f32_32x32x16_bf16 v[224:239], v[56:59], v[0:3], v[224:239]
    ds_read_b64_tr_b16 v[40:41], v243 offset:4096
    ds_read_b64_tr_b16 v[42:43], v243 offset:5120
    buffer_load_dwordx4 v[0:3], v254, s[16:19], s13 offen offset:0
    v_mov_b32 v73, 0
    v_mov_b32 v74, 0
    v_mov_b32 v75, 0
    s_waitcnt vmcnt(22)
    s_waitcnt lgkmcnt(6)
    v_mfma_f32_32x32x16_bf16 v[128:143], v[60:63], v[4:7], v[128:143]
    ds_read_b64_tr_b16 v[44:45], v247 offset:17920
    ds_read_b64_tr_b16 v[46:47], v247 offset:18304
    v_mov_b32 v76, 0
    v_mov_b32 v77, 0
    v_mov_b32 v78, 0
    s_waitcnt lgkmcnt(6)
    v_mfma_f32_32x32x16_bf16 v[144:159], v[32:35], v[4:7], v[144:159]
    ds_read_b64_tr_b16 v[48:49], v247 offset:17952
    ds_read_b64_tr_b16 v[50:51], v247 offset:18336
    v_mov_b32 v79, 0
    v_mov_b32 v80, 0
    v_mov_b32 v81, 0
    s_waitcnt lgkmcnt(6)
    v_mfma_f32_32x32x16_bf16 v[160:175], v[36:39], v[4:7], v[160:175]
    ds_read_b64_tr_b16 v[52:53], v247 offset:17984
    ds_read_b64_tr_b16 v[54:55], v247 offset:18368
    v_mov_b32 v82, 0
    v_mov_b32 v83, 0
    v_mov_b32 v84, 0
    s_waitcnt lgkmcnt(6)
    v_mfma_f32_32x32x16_bf16 v[176:191], v[40:43], v[4:7], v[176:191]
    ds_read_b64_tr_b16 v[56:57], v240 offset:8192
    ds_read_b64_tr_b16 v[58:59], v240 offset:9216
    v_mov_b32 v85, 0
    v_mov_b32 v86, 0
    v_mov_b32 v87, 0
    s_waitcnt lgkmcnt(6)
    v_mfma_f32_32x32x16_bf16 v[192:207], v[44:47], v[4:7], v[192:207]
    ds_read_b64_tr_b16 v[60:61], v241 offset:8192
    ds_read_b64_tr_b16 v[62:63], v241 offset:9216
    v_mov_b32 v88, 0
    v_mov_b32 v89, 0
    v_mov_b32 v90, 0
    s_waitcnt lgkmcnt(6)
    v_mfma_f32_32x32x16_bf16 v[208:223], v[48:51], v[4:7], v[208:223]
    ds_read_b64_tr_b16 v[32:33], v242 offset:8192
    ds_read_b64_tr_b16 v[34:35], v242 offset:9216
    v_mov_b32 v91, 0
    v_mov_b32 v92, 0
    v_mov_b32 v93, 0
    s_waitcnt lgkmcnt(6)
    v_mfma_f32_32x32x16_bf16 v[224:239], v[52:55], v[4:7], v[224:239]
    ds_read_b64_tr_b16 v[36:37], v243 offset:8192
    ds_read_b64_tr_b16 v[38:39], v243 offset:9216
    buffer_load_dwordx4 v[4:7], v254, s[16:19], s13 offen offset:1024
    v_mov_b32 v94, 0
    v_mov_b32 v95, 0
    v_mov_b32 v96, 0
    s_waitcnt vmcnt(22)
    s_waitcnt lgkmcnt(6)
    v_mfma_f32_32x32x16_bf16 v[128:143], v[56:59], v[8:11], v[128:143]
    ds_read_b64_tr_b16 v[40:41], v247 offset:19456
    ds_read_b64_tr_b16 v[42:43], v247 offset:19840
    v_mov_b32 v97, 0
    v_mov_b32 v98, 0
    v_mov_b32 v99, 0
    s_waitcnt lgkmcnt(6)
    v_mfma_f32_32x32x16_bf16 v[144:159], v[60:63], v[8:11], v[144:159]
    ds_read_b64_tr_b16 v[44:45], v247 offset:19488
    ds_read_b64_tr_b16 v[46:47], v247 offset:19872
    v_mov_b32 v100, 0
    v_mov_b32 v101, 0
    v_mov_b32 v102, 0
    s_waitcnt lgkmcnt(6)
    v_mfma_f32_32x32x16_bf16 v[160:175], v[32:35], v[8:11], v[160:175]
    ds_read_b64_tr_b16 v[48:49], v247 offset:19520
    ds_read_b64_tr_b16 v[50:51], v247 offset:19904
    v_mov_b32 v103, 0
    v_mov_b32 v104, 0
    v_mov_b32 v105, 0
    s_waitcnt lgkmcnt(6)
    v_mfma_f32_32x32x16_bf16 v[176:191], v[36:39], v[8:11], v[176:191]
    ds_read_b64_tr_b16 v[52:53], v240 offset:12288
    ds_read_b64_tr_b16 v[54:55], v240 offset:13312
    v_mov_b32 v106, 0
    v_mov_b32 v107, 0
    v_mov_b32 v108, 0
    s_waitcnt lgkmcnt(6)
    v_mfma_f32_32x32x16_bf16 v[192:207], v[40:43], v[8:11], v[192:207]
    ds_read_b64_tr_b16 v[56:57], v241 offset:12288
    ds_read_b64_tr_b16 v[58:59], v241 offset:13312
    v_mov_b32 v109, 0
    v_mov_b32 v110, 0
    v_mov_b32 v111, 0
    s_waitcnt lgkmcnt(6)
    v_mfma_f32_32x32x16_bf16 v[208:223], v[44:47], v[8:11], v[208:223]
    ds_read_b64_tr_b16 v[60:61], v242 offset:12288
    ds_read_b64_tr_b16 v[62:63], v242 offset:13312
    v_mov_b32 v112, 0
    v_mov_b32 v113, 0
    v_mov_b32 v114, 0
    s_waitcnt lgkmcnt(6)
    v_mfma_f32_32x32x16_bf16 v[224:239], v[48:51], v[8:11], v[224:239]
    ds_read_b64_tr_b16 v[32:33], v243 offset:12288
    ds_read_b64_tr_b16 v[34:35], v243 offset:13312
    buffer_load_dwordx4 v[8:11], v254, s[16:19], s13 offen offset:2048
    v_mov_b32 v115, 0
    v_mov_b32 v116, 0
    v_mov_b32 v117, 0
    s_waitcnt vmcnt(19)
    s_waitcnt lgkmcnt(6)
    v_mfma_f32_32x32x16_bf16 v[128:143], v[52:55], v[12:15], v[128:143]
    ds_read_b64_tr_b16 v[36:37], v247 offset:20992
    ds_read_b64_tr_b16 v[38:39], v247 offset:21376
    v_mov_b32 v118, 0
    v_mov_b32 v119, 0
    v_mov_b32 v120, 0
    s_waitcnt lgkmcnt(6)
    v_mfma_f32_32x32x16_bf16 v[144:159], v[56:59], v[12:15], v[144:159]
    ds_read_b64_tr_b16 v[40:41], v247 offset:21024
    ds_read_b64_tr_b16 v[42:43], v247 offset:21408
    v_mov_b32 v121, 0
    v_mov_b32 v122, 0
    v_mov_b32 v123, 0
    s_waitcnt lgkmcnt(6)
    v_mfma_f32_32x32x16_bf16 v[160:175], v[60:63], v[12:15], v[160:175]
    ds_read_b64_tr_b16 v[44:45], v247 offset:21056
    ds_read_b64_tr_b16 v[46:47], v247 offset:21440
    v_mov_b32 v124, 0
    v_mov_b32 v125, 0
    v_mov_b32 v126, 0
    s_waitcnt lgkmcnt(6)
    v_mfma_f32_32x32x16_bf16 v[176:191], v[32:35], v[12:15], v[176:191]
    v_mov_b32 v127, 0
    s_barrier
    v_add_u32 v240, 4294836224, v240
    v_add_u32 v241, 4294836224, v241
    v_add_u32 v242, 4294836224, v242
    v_add_u32 v243, 4294836224, v243
    v_add_u32 v247, 4294836224, v247
    ds_read_b64_tr_b16 v[48:49], v240 offset:0
    ds_read_b64_tr_b16 v[50:51], v240 offset:1024
    s_waitcnt lgkmcnt(6)
    v_mfma_f32_32x32x16_bf16 v[192:207], v[36:39], v[12:15], v[192:207]
    ds_read_b64_tr_b16 v[52:53], v241 offset:0
    ds_read_b64_tr_b16 v[54:55], v241 offset:1024
    s_waitcnt lgkmcnt(6)
    v_mfma_f32_32x32x16_bf16 v[208:223], v[40:43], v[12:15], v[208:223]
    ds_read_b64_tr_b16 v[56:57], v242 offset:0
    ds_read_b64_tr_b16 v[58:59], v242 offset:1024
    s_waitcnt lgkmcnt(6)
    v_mfma_f32_32x32x16_bf16 v[224:239], v[44:47], v[12:15], v[224:239]
    ds_read_b64_tr_b16 v[60:61], v243 offset:0
    ds_read_b64_tr_b16 v[62:63], v243 offset:1024
    buffer_load_dwordx4 v[12:15], v254, s[16:19], s13 offen offset:3072
    s_add_u32 s13, s13, 4096
    s_waitcnt vmcnt(15)
    s_waitcnt lgkmcnt(6)
    v_mfma_f32_32x32x16_bf16 v[128:143], v[48:51], v[16:19], v[128:143]
    ds_read_b64_tr_b16 v[32:33], v247 offset:16384
    ds_read_b64_tr_b16 v[34:35], v247 offset:16768
    s_waitcnt lgkmcnt(6)
    v_mfma_f32_32x32x16_bf16 v[144:159], v[52:55], v[16:19], v[144:159]
    ds_read_b64_tr_b16 v[36:37], v247 offset:16416
    ds_read_b64_tr_b16 v[38:39], v247 offset:16800
    s_waitcnt lgkmcnt(6)
    v_mfma_f32_32x32x16_bf16 v[160:175], v[56:59], v[16:19], v[160:175]
    ds_read_b64_tr_b16 v[40:41], v247 offset:16448
    ds_read_b64_tr_b16 v[42:43], v247 offset:16832
    s_waitcnt lgkmcnt(6)
    v_mfma_f32_32x32x16_bf16 v[176:191], v[60:63], v[16:19], v[176:191]
    ds_read_b64_tr_b16 v[44:45], v240 offset:4096
    ds_read_b64_tr_b16 v[46:47], v240 offset:5120
    s_waitcnt lgkmcnt(6)
    v_mfma_f32_32x32x16_bf16 v[192:207], v[32:35], v[16:19], v[192:207]
    ds_read_b64_tr_b16 v[48:49], v241 offset:4096
    ds_read_b64_tr_b16 v[50:51], v241 offset:5120
    s_waitcnt lgkmcnt(6)
    v_mfma_f32_32x32x16_bf16 v[208:223], v[36:39], v[16:19], v[208:223]
    ds_read_b64_tr_b16 v[52:53], v242 offset:4096
    ds_read_b64_tr_b16 v[54:55], v242 offset:5120
    s_waitcnt lgkmcnt(6)
    v_mfma_f32_32x32x16_bf16 v[224:239], v[40:43], v[16:19], v[224:239]
    ds_read_b64_tr_b16 v[56:57], v243 offset:4096
    ds_read_b64_tr_b16 v[58:59], v243 offset:5120
    buffer_load_dwordx4 v[16:19], v254, s[16:19], s13 offen offset:0
    s_waitcnt vmcnt(15)
    s_waitcnt lgkmcnt(6)
    v_mfma_f32_32x32x16_bf16 v[128:143], v[44:47], v[20:23], v[128:143]
    ds_read_b64_tr_b16 v[60:61], v247 offset:17920
    ds_read_b64_tr_b16 v[62:63], v247 offset:18304
    s_waitcnt lgkmcnt(6)
    v_mfma_f32_32x32x16_bf16 v[144:159], v[48:51], v[20:23], v[144:159]
    ds_read_b64_tr_b16 v[32:33], v247 offset:17952
    ds_read_b64_tr_b16 v[34:35], v247 offset:18336
    s_waitcnt lgkmcnt(6)
    v_mfma_f32_32x32x16_bf16 v[160:175], v[52:55], v[20:23], v[160:175]
    ds_read_b64_tr_b16 v[36:37], v247 offset:17984
    ds_read_b64_tr_b16 v[38:39], v247 offset:18368
    s_waitcnt lgkmcnt(6)
    v_mfma_f32_32x32x16_bf16 v[176:191], v[56:59], v[20:23], v[176:191]
    ds_read_b64_tr_b16 v[40:41], v240 offset:8192
    ds_read_b64_tr_b16 v[42:43], v240 offset:9216
    s_waitcnt lgkmcnt(6)
    v_mfma_f32_32x32x16_bf16 v[192:207], v[60:63], v[20:23], v[192:207]
    ds_read_b64_tr_b16 v[44:45], v241 offset:8192
    ds_read_b64_tr_b16 v[46:47], v241 offset:9216
    s_waitcnt lgkmcnt(6)
    v_mfma_f32_32x32x16_bf16 v[208:223], v[32:35], v[20:23], v[208:223]
    ds_read_b64_tr_b16 v[48:49], v242 offset:8192
    ds_read_b64_tr_b16 v[50:51], v242 offset:9216
    s_waitcnt lgkmcnt(6)
    v_mfma_f32_32x32x16_bf16 v[224:239], v[36:39], v[20:23], v[224:239]
    ds_read_b64_tr_b16 v[52:53], v243 offset:8192
    ds_read_b64_tr_b16 v[54:55], v243 offset:9216
    buffer_load_dwordx4 v[20:23], v254, s[16:19], s13 offen offset:1024
    s_waitcnt vmcnt(15)
    s_waitcnt lgkmcnt(6)
    v_mfma_f32_32x32x16_bf16 v[128:143], v[40:43], v[24:27], v[128:143]
    ds_read_b64_tr_b16 v[56:57], v247 offset:19456
    ds_read_b64_tr_b16 v[58:59], v247 offset:19840
    s_waitcnt lgkmcnt(6)
    v_mfma_f32_32x32x16_bf16 v[144:159], v[44:47], v[24:27], v[144:159]
    ds_read_b64_tr_b16 v[60:61], v247 offset:19488
    ds_read_b64_tr_b16 v[62:63], v247 offset:19872
    s_waitcnt lgkmcnt(6)
    v_mfma_f32_32x32x16_bf16 v[160:175], v[48:51], v[24:27], v[160:175]
    ds_read_b64_tr_b16 v[32:33], v247 offset:19520
    ds_read_b64_tr_b16 v[34:35], v247 offset:19904
    s_waitcnt lgkmcnt(6)
    v_mfma_f32_32x32x16_bf16 v[176:191], v[52:55], v[24:27], v[176:191]
    ds_read_b64_tr_b16 v[36:37], v240 offset:12288
    ds_read_b64_tr_b16 v[38:39], v240 offset:13312
    s_waitcnt lgkmcnt(6)
    v_mfma_f32_32x32x16_bf16 v[192:207], v[56:59], v[24:27], v[192:207]
    ds_read_b64_tr_b16 v[40:41], v241 offset:12288
    ds_read_b64_tr_b16 v[42:43], v241 offset:13312
    s_waitcnt lgkmcnt(6)
    v_mfma_f32_32x32x16_bf16 v[208:223], v[60:63], v[24:27], v[208:223]
    ds_read_b64_tr_b16 v[44:45], v242 offset:12288
    ds_read_b64_tr_b16 v[46:47], v242 offset:13312
    s_waitcnt lgkmcnt(6)
    v_mfma_f32_32x32x16_bf16 v[224:239], v[32:35], v[24:27], v[224:239]
    ds_read_b64_tr_b16 v[48:49], v243 offset:12288
    ds_read_b64_tr_b16 v[50:51], v243 offset:13312
    buffer_load_dwordx4 v[24:27], v254, s[16:19], s13 offen offset:2048
    s_waitcnt vmcnt(12)
    s_waitcnt lgkmcnt(6)
    v_mfma_f32_32x32x16_bf16 v[128:143], v[36:39], v[28:31], v[128:143]
    ds_read_b64_tr_b16 v[52:53], v247 offset:20992
    ds_read_b64_tr_b16 v[54:55], v247 offset:21376
    s_waitcnt lgkmcnt(6)
    v_mfma_f32_32x32x16_bf16 v[144:159], v[40:43], v[28:31], v[144:159]
    ds_read_b64_tr_b16 v[56:57], v247 offset:21024
    ds_read_b64_tr_b16 v[58:59], v247 offset:21408
    s_waitcnt lgkmcnt(6)
    v_mfma_f32_32x32x16_bf16 v[160:175], v[44:47], v[28:31], v[160:175]
    ds_read_b64_tr_b16 v[60:61], v247 offset:21056
    ds_read_b64_tr_b16 v[62:63], v247 offset:21440
    s_waitcnt lgkmcnt(6)
    v_mfma_f32_32x32x16_bf16 v[176:191], v[48:51], v[28:31], v[176:191]
    s_barrier
    v_add_u32 v240, 32768, v240
    v_add_u32 v241, 32768, v241
    v_add_u32 v242, 32768, v242
    v_add_u32 v243, 32768, v243
    v_add_u32 v247, 32768, v247
    ds_read_b64_tr_b16 v[32:33], v240 offset:0
    ds_read_b64_tr_b16 v[34:35], v240 offset:1024
    s_waitcnt lgkmcnt(6)
    v_mfma_f32_32x32x16_bf16 v[192:207], v[52:55], v[28:31], v[192:207]
    ds_read_b64_tr_b16 v[36:37], v241 offset:0
    ds_read_b64_tr_b16 v[38:39], v241 offset:1024
    s_waitcnt lgkmcnt(6)
    v_mfma_f32_32x32x16_bf16 v[208:223], v[56:59], v[28:31], v[208:223]
    ds_read_b64_tr_b16 v[40:41], v242 offset:0
    ds_read_b64_tr_b16 v[42:43], v242 offset:1024
    s_waitcnt lgkmcnt(6)
    v_mfma_f32_32x32x16_bf16 v[224:239], v[60:63], v[28:31], v[224:239]
    ds_read_b64_tr_b16 v[44:45], v243 offset:0
    ds_read_b64_tr_b16 v[46:47], v243 offset:1024
    buffer_load_dwordx4 v[28:31], v254, s[16:19], s13 offen offset:3072
    s_add_u32 s13, s13, 4096
    s_waitcnt vmcnt(7)
    s_waitcnt lgkmcnt(6)
    v_mfma_f32_32x32x16_bf16 v[128:143], v[32:35], v[0:3], v[128:143]
    ds_read_b64_tr_b16 v[48:49], v247 offset:16384
    ds_read_b64_tr_b16 v[50:51], v247 offset:16768
    s_waitcnt lgkmcnt(6)
    v_mfma_f32_32x32x16_bf16 v[144:159], v[36:39], v[0:3], v[144:159]
    ds_read_b64_tr_b16 v[52:53], v247 offset:16416
    ds_read_b64_tr_b16 v[54:55], v247 offset:16800
    s_waitcnt lgkmcnt(6)
    v_mfma_f32_32x32x16_bf16 v[160:175], v[40:43], v[0:3], v[160:175]
    ds_read_b64_tr_b16 v[56:57], v247 offset:16448
    ds_read_b64_tr_b16 v[58:59], v247 offset:16832
    s_waitcnt lgkmcnt(6)
    v_mfma_f32_32x32x16_bf16 v[176:191], v[44:47], v[0:3], v[176:191]
    ds_read_b64_tr_b16 v[60:61], v240 offset:4096
    ds_read_b64_tr_b16 v[62:63], v240 offset:5120
    s_waitcnt lgkmcnt(6)
    v_mfma_f32_32x32x16_bf16 v[192:207], v[48:51], v[0:3], v[192:207]
    ds_read_b64_tr_b16 v[32:33], v241 offset:4096
    ds_read_b64_tr_b16 v[34:35], v241 offset:5120
    s_waitcnt lgkmcnt(6)
    v_mfma_f32_32x32x16_bf16 v[208:223], v[52:55], v[0:3], v[208:223]
    ds_read_b64_tr_b16 v[36:37], v242 offset:4096
    ds_read_b64_tr_b16 v[38:39], v242 offset:5120
    s_waitcnt lgkmcnt(6)
    v_mfma_f32_32x32x16_bf16 v[224:239], v[56:59], v[0:3], v[224:239]
    ds_read_b64_tr_b16 v[40:41], v243 offset:4096
    ds_read_b64_tr_b16 v[42:43], v243 offset:5120
    s_waitcnt vmcnt(6)
    s_waitcnt lgkmcnt(6)
    v_mfma_f32_32x32x16_bf16 v[128:143], v[60:63], v[4:7], v[128:143]
    ds_read_b64_tr_b16 v[44:45], v247 offset:17920
    ds_read_b64_tr_b16 v[46:47], v247 offset:18304
    s_waitcnt lgkmcnt(6)
    v_mfma_f32_32x32x16_bf16 v[144:159], v[32:35], v[4:7], v[144:159]
    ds_read_b64_tr_b16 v[48:49], v247 offset:17952
    ds_read_b64_tr_b16 v[50:51], v247 offset:18336
    s_waitcnt lgkmcnt(6)
    v_mfma_f32_32x32x16_bf16 v[160:175], v[36:39], v[4:7], v[160:175]
    ds_read_b64_tr_b16 v[52:53], v247 offset:17984
    ds_read_b64_tr_b16 v[54:55], v247 offset:18368
    s_waitcnt lgkmcnt(6)
    v_mfma_f32_32x32x16_bf16 v[176:191], v[40:43], v[4:7], v[176:191]
    ds_read_b64_tr_b16 v[56:57], v240 offset:8192
    ds_read_b64_tr_b16 v[58:59], v240 offset:9216
    s_waitcnt lgkmcnt(6)
    v_mfma_f32_32x32x16_bf16 v[192:207], v[44:47], v[4:7], v[192:207]
    ds_read_b64_tr_b16 v[60:61], v241 offset:8192
    ds_read_b64_tr_b16 v[62:63], v241 offset:9216
    s_waitcnt lgkmcnt(6)
    v_mfma_f32_32x32x16_bf16 v[208:223], v[48:51], v[4:7], v[208:223]
    ds_read_b64_tr_b16 v[32:33], v242 offset:8192
    ds_read_b64_tr_b16 v[34:35], v242 offset:9216
    s_waitcnt lgkmcnt(6)
    v_mfma_f32_32x32x16_bf16 v[224:239], v[52:55], v[4:7], v[224:239]
    ds_read_b64_tr_b16 v[36:37], v243 offset:8192
    ds_read_b64_tr_b16 v[38:39], v243 offset:9216
    s_waitcnt vmcnt(5)
    s_waitcnt lgkmcnt(6)
    v_mfma_f32_32x32x16_bf16 v[128:143], v[56:59], v[8:11], v[128:143]
    ds_read_b64_tr_b16 v[40:41], v247 offset:19456
    ds_read_b64_tr_b16 v[42:43], v247 offset:19840
    s_waitcnt lgkmcnt(6)
    v_mfma_f32_32x32x16_bf16 v[144:159], v[60:63], v[8:11], v[144:159]
    ds_read_b64_tr_b16 v[44:45], v247 offset:19488
    ds_read_b64_tr_b16 v[46:47], v247 offset:19872
    s_waitcnt lgkmcnt(6)
    v_mfma_f32_32x32x16_bf16 v[160:175], v[32:35], v[8:11], v[160:175]
    ds_read_b64_tr_b16 v[48:49], v247 offset:19520
    ds_read_b64_tr_b16 v[50:51], v247 offset:19904
    s_waitcnt lgkmcnt(6)
    v_mfma_f32_32x32x16_bf16 v[176:191], v[36:39], v[8:11], v[176:191]
    ds_read_b64_tr_b16 v[52:53], v240 offset:12288
    ds_read_b64_tr_b16 v[54:55], v240 offset:13312
    s_waitcnt lgkmcnt(6)
    v_mfma_f32_32x32x16_bf16 v[192:207], v[40:43], v[8:11], v[192:207]
    ds_read_b64_tr_b16 v[56:57], v241 offset:12288
    ds_read_b64_tr_b16 v[58:59], v241 offset:13312
    s_waitcnt lgkmcnt(6)
    v_mfma_f32_32x32x16_bf16 v[208:223], v[44:47], v[8:11], v[208:223]
    ds_read_b64_tr_b16 v[60:61], v242 offset:12288
    ds_read_b64_tr_b16 v[62:63], v242 offset:13312
    s_waitcnt lgkmcnt(6)
    v_mfma_f32_32x32x16_bf16 v[224:239], v[48:51], v[8:11], v[224:239]
    ds_read_b64_tr_b16 v[32:33], v243 offset:12288
    ds_read_b64_tr_b16 v[34:35], v243 offset:13312
    s_waitcnt vmcnt(4)
    s_waitcnt lgkmcnt(6)
    v_mfma_f32_32x32x16_bf16 v[128:143], v[52:55], v[12:15], v[128:143]
    ds_read_b64_tr_b16 v[36:37], v247 offset:20992
    ds_read_b64_tr_b16 v[38:39], v247 offset:21376
    s_waitcnt lgkmcnt(6)
    v_mfma_f32_32x32x16_bf16 v[144:159], v[56:59], v[12:15], v[144:159]
    ds_read_b64_tr_b16 v[40:41], v247 offset:21024
    ds_read_b64_tr_b16 v[42:43], v247 offset:21408
    s_waitcnt lgkmcnt(6)
    v_mfma_f32_32x32x16_bf16 v[160:175], v[60:63], v[12:15], v[160:175]
    ds_read_b64_tr_b16 v[44:45], v247 offset:21056
    ds_read_b64_tr_b16 v[46:47], v247 offset:21440
    s_waitcnt lgkmcnt(6)
    v_mfma_f32_32x32x16_bf16 v[176:191], v[32:35], v[12:15], v[176:191]
    s_barrier
    v_add_u32 v240, 32768, v240
    v_add_u32 v241, 32768, v241
    v_add_u32 v242, 32768, v242
    v_add_u32 v243, 32768, v243
    v_add_u32 v247, 32768, v247
    s_mov_b32 s5, 98304
    s_lshl_b32 s6, s48, 19
    s_add_u32 s6, s6, s60
    s_add_u32 s7, s6, 18874368
    s_add_u32 s6, s6, 2097152
    s_add_u32 s11, s6, 507904
    ds_read_b64_tr_b16 v[48:49], v247 offset:16384
    ds_read_b64_tr_b16 v[50:51], v247 offset:16768
    s_add_u32 m0, s5, s60
    s_min_u32 s6, s6, s11
    buffer_load_dwordx4 v254, s[16:19], s6 offen offset:0 lds
    s_waitcnt lgkmcnt(6)
    v_mfma_f32_32x32x16_bf16 v[192:207], v[36:39], v[12:15], v[192:207]
    ds_read_b64_tr_b16 v[52:53], v247 offset:16416
    ds_read_b64_tr_b16 v[54:55], v247 offset:16800
    buffer_load_dwordx4 v254, s[16:19], s6 offen offset:1024 lds
    s_waitcnt lgkmcnt(6)
    v_mfma_f32_32x32x16_bf16 v[208:223], v[40:43], v[12:15], v[208:223]
    ds_read_b64_tr_b16 v[56:57], v247 offset:16448
    ds_read_b64_tr_b16 v[58:59], v247 offset:16832
    buffer_load_dwordx4 v254, s[16:19], s6 offen offset:2048 lds
    s_waitcnt lgkmcnt(6)
    v_mfma_f32_32x32x16_bf16 v[224:239], v[44:47], v[12:15], v[224:239]
    ds_read_b64_tr_b16 v[60:61], v247 offset:17920
    ds_read_b64_tr_b16 v[62:63], v247 offset:18304
    buffer_load_dwordx4 v254, s[16:19], s6 offen offset:3072 lds
    s_waitcnt vmcnt(7)
    s_waitcnt lgkmcnt(6)
    v_mfma_f32_32x32x16_bf16 v[192:207], v[48:51], v[16:19], v[192:207]
    ds_read_b64_tr_b16 v[32:33], v247 offset:17952
    ds_read_b64_tr_b16 v[34:35], v247 offset:18336
    s_add_u32 m0, m0, 16384
    s_add_u32 s6, s6, 16384
    buffer_load_dwordx4 v254, s[16:19], s7 offen offset:0 lds
    s_waitcnt lgkmcnt(6)
    v_mfma_f32_32x32x16_bf16 v[208:223], v[52:55], v[16:19], v[208:223]
    ds_read_b64_tr_b16 v[36:37], v247 offset:17984
    ds_read_b64_tr_b16 v[38:39], v247 offset:18368
    buffer_load_dwordx4 v254, s[16:19], s7 offen offset:1024 lds
    s_waitcnt lgkmcnt(6)
    v_mfma_f32_32x32x16_bf16 v[224:239], v[56:59], v[16:19], v[224:239]
    ds_read_b64_tr_b16 v[40:41], v247 offset:19456
    ds_read_b64_tr_b16 v[42:43], v247 offset:19840
    buffer_load_dwordx4 v254, s[16:19], s7 offen offset:2048 lds
    s_waitcnt vmcnt(9)
    s_waitcnt lgkmcnt(6)
    v_mfma_f32_32x32x16_bf16 v[192:207], v[60:63], v[20:23], v[192:207]
    ds_read_b64_tr_b16 v[44:45], v247 offset:19488
    ds_read_b64_tr_b16 v[46:47], v247 offset:19872
    buffer_load_dwordx4 v254, s[16:19], s7 offen offset:3072 lds
    s_waitcnt lgkmcnt(6)
    v_mfma_f32_32x32x16_bf16 v[208:223], v[32:35], v[20:23], v[208:223]
    ds_read_b64_tr_b16 v[48:49], v247 offset:19520
    ds_read_b64_tr_b16 v[50:51], v247 offset:19904
    s_add_u32 s5, s5, 32768
    s_cmp_eq_u32 s5, 163840
    s_cselect_b32 s5, 0, s5
    s_add_u32 m0, s5, s60
    s_min_u32 s6, s6, s11
    s_waitcnt lgkmcnt(6)
    v_mfma_f32_32x32x16_bf16 v[224:239], v[36:39], v[20:23], v[224:239]
    ds_read_b64_tr_b16 v[52:53], v247 offset:20992
    ds_read_b64_tr_b16 v[54:55], v247 offset:21376
    buffer_load_dwordx4 v254, s[16:19], s6 offen offset:0 lds
    s_waitcnt vmcnt(10)
    s_waitcnt lgkmcnt(6)
    v_mfma_f32_32x32x16_bf16 v[192:207], v[40:43], v[24:27], v[192:207]
    ds_read_b64_tr_b16 v[56:57], v247 offset:21024
    ds_read_b64_tr_b16 v[58:59], v247 offset:21408
    buffer_load_dwordx4 v254, s[16:19], s6 offen offset:1024 lds
    s_waitcnt lgkmcnt(6)
    v_mfma_f32_32x32x16_bf16 v[208:223], v[44:47], v[24:27], v[208:223]
    ds_read_b64_tr_b16 v[60:61], v247 offset:21056
    ds_read_b64_tr_b16 v[62:63], v247 offset:21440
    buffer_load_dwordx4 v254, s[16:19], s6 offen offset:2048 lds
    s_waitcnt lgkmcnt(6)
    v_mfma_f32_32x32x16_bf16 v[224:239], v[48:51], v[24:27], v[224:239]
    ds_read_b64_tr_b16 v[32:33], v240 offset:0
    ds_read_b64_tr_b16 v[34:35], v240 offset:1024
    buffer_load_dwordx4 v254, s[16:19], s6 offen offset:3072 lds
    s_waitcnt vmcnt(12)
    s_waitcnt lgkmcnt(6)
    v_mfma_f32_32x32x16_bf16 v[192:207], v[52:55], v[28:31], v[192:207]
    ds_read_b64_tr_b16 v[36:37], v241 offset:0
    ds_read_b64_tr_b16 v[38:39], v241 offset:1024
    s_add_u32 m0, m0, 16384
    s_add_u32 s6, s6, 16384
    buffer_load_dwordx4 v254, s[16:19], s7 offen offset:0 lds
    s_waitcnt lgkmcnt(6)
    v_mfma_f32_32x32x16_bf16 v[208:223], v[56:59], v[28:31], v[208:223]
    ds_read_b64_tr_b16 v[40:41], v242 offset:0
    ds_read_b64_tr_b16 v[42:43], v242 offset:1024
    buffer_load_dwordx4 v254, s[16:19], s7 offen offset:1024 lds
    s_waitcnt lgkmcnt(6)
    v_mfma_f32_32x32x16_bf16 v[224:239], v[60:63], v[28:31], v[224:239]
    ds_read_b64_tr_b16 v[44:45], v243 offset:0
    ds_read_b64_tr_b16 v[46:47], v243 offset:1024
    buffer_load_dwordx4 v254, s[16:19], s7 offen offset:2048 lds
    s_waitcnt lgkmcnt(6)
    v_mfma_f32_32x32x16_bf16 v[128:143], v[32:35], v[16:19], v[128:143]
    ds_read_b64_tr_b16 v[48:49], v240 offset:4096
    ds_read_b64_tr_b16 v[50:51], v240 offset:5120
    buffer_load_dwordx4 v254, s[16:19], s7 offen offset:3072 lds
    s_waitcnt lgkmcnt(6)
    v_mfma_f32_32x32x16_bf16 v[144:159], v[36:39], v[16:19], v[144:159]
    ds_read_b64_tr_b16 v[52:53], v241 offset:4096
    ds_read_b64_tr_b16 v[54:55], v241 offset:5120
    s_add_u32 s7, s7, 16384
    s_add_u32 s5, s5, 32768
    s_cmp_eq_u32 s5, 163840
    s_cselect_b32 s5, 0, s5
    s_add_u32 m0, s5, s60
    s_waitcnt lgkmcnt(6)
    v_mfma_f32_32x32x16_bf16 v[160:175], v[40:43], v[16:19], v[160:175]
    ds_read_b64_tr_b16 v[56:57], v242 offset:4096
    ds_read_b64_tr_b16 v[58:59], v242 offset:5120
    s_min_u32 s6, s6, s11
    buffer_load_dwordx4 v254, s[16:19], s6 offen offset:0 lds
    s_waitcnt lgkmcnt(6)
    v_mfma_f32_32x32x16_bf16 v[176:191], v[44:47], v[16:19], v[176:191]
    ds_read_b64_tr_b16 v[60:61], v243 offset:4096
    ds_read_b64_tr_b16 v[62:63], v243 offset:5120
    buffer_load_dwordx4 v254, s[16:19], s6 offen offset:1024 lds
    s_waitcnt lgkmcnt(6)
    v_mfma_f32_32x32x16_bf16 v[128:143], v[48:51], v[20:23], v[128:143]
    ds_read_b64_tr_b16 v[32:33], v240 offset:8192
    ds_read_b64_tr_b16 v[34:35], v240 offset:9216
    buffer_load_dwordx4 v254, s[16:19], s6 offen offset:2048 lds
    s_waitcnt lgkmcnt(6)
    v_mfma_f32_32x32x16_bf16 v[144:159], v[52:55], v[20:23], v[144:159]
    ds_read_b64_tr_b16 v[36:37], v241 offset:8192
    ds_read_b64_tr_b16 v[38:39], v241 offset:9216
    buffer_load_dwordx4 v254, s[16:19], s6 offen offset:3072 lds
    s_waitcnt lgkmcnt(6)
    v_mfma_f32_32x32x16_bf16 v[160:175], v[56:59], v[20:23], v[160:175]
    ds_read_b64_tr_b16 v[40:41], v242 offset:8192
    ds_read_b64_tr_b16 v[42:43], v242 offset:9216
    s_add_u32 m0, m0, 16384
    s_add_u32 s6, s6, 16384
    buffer_load_dwordx4 v254, s[16:19], s7 offen offset:0 lds
    s_waitcnt lgkmcnt(6)
    v_mfma_f32_32x32x16_bf16 v[176:191], v[60:63], v[20:23], v[176:191]
    ds_read_b64_tr_b16 v[44:45], v243 offset:8192
    ds_read_b64_tr_b16 v[46:47], v243 offset:9216
    buffer_load_dwordx4 v254, s[16:19], s7 offen offset:1024 lds
    s_waitcnt lgkmcnt(6)
    v_mfma_f32_32x32x16_bf16 v[128:143], v[32:35], v[24:27], v[128:143]
    ds_read_b64_tr_b16 v[48:49], v240 offset:12288
    ds_read_b64_tr_b16 v[50:51], v240 offset:13312
    buffer_load_dwordx4 v254, s[16:19], s7 offen offset:2048 lds
    s_waitcnt lgkmcnt(6)
    v_mfma_f32_32x32x16_bf16 v[144:159], v[36:39], v[24:27], v[144:159]
    ds_read_b64_tr_b16 v[52:53], v241 offset:12288
    ds_read_b64_tr_b16 v[54:55], v241 offset:13312
    buffer_load_dwordx4 v254, s[16:19], s7 offen offset:3072 lds
    s_waitcnt lgkmcnt(6)
    v_mfma_f32_32x32x16_bf16 v[160:175], v[40:43], v[24:27], v[160:175]
    ds_read_b64_tr_b16 v[56:57], v242 offset:12288
    ds_read_b64_tr_b16 v[58:59], v242 offset:13312
    s_add_u32 s7, s7, 16384
    s_add_u32 s5, s5, 32768
    s_cmp_eq_u32 s5, 163840
    s_cselect_b32 s5, 0, s5
    v_max_f32 v192, 0, v192
    s_waitcnt lgkmcnt(6)
    v_mfma_f32_32x32x16_bf16 v[176:191], v[44:47], v[24:27], v[176:191]
    ds_read_b64_tr_b16 v[60:61], v243 offset:12288
    ds_read_b64_tr_b16 v[62:63], v243 offset:13312
    v_mul_f32 v192, v192, v200
    v_max_f32 v193, 0, v193
    v_mul_f32 v193, v193, v201
    v_max_f32 v194, 0, v194
    v_mul_f32 v194, v194, v202
    s_waitcnt lgkmcnt(6)
    v_mfma_f32_32x32x16_bf16 v[128:143], v[48:51], v[28:31], v[128:143]
    v_max_f32 v195, 0, v195
    v_mul_f32 v195, v195, v203
    v_max_f32 v196, 0, v196
    v_mul_f32 v196, v196, v204
    v_max_f32 v197, 0, v197
    s_waitcnt lgkmcnt(4)
    v_mfma_f32_32x32x16_bf16 v[144:159], v[52:55], v[28:31], v[144:159]
    v_mul_f32 v197, v197, v205
    v_max_f32 v198, 0, v198
    v_mul_f32 v198, v198, v206
    v_max_f32 v199, 0, v199
    v_mul_f32 v199, v199, v207
    s_waitcnt lgkmcnt(2)
    v_mfma_f32_32x32x16_bf16 v[160:175], v[56:59], v[28:31], v[160:175]
    v_cvt_pk_bf16_f32 v192, v192, v193
    v_cvt_pk_bf16_f32 v193, v194, v195
    v_cvt_pk_bf16_f32 v194, v196, v197
    v_cvt_pk_bf16_f32 v195, v198, v199
    buffer_store_dwordx4 v[192:195], v253, s[16:19], s99 offen sc1
    s_waitcnt lgkmcnt(0)
    v_mfma_f32_32x32x16_bf16 v[176:191], v[60:63], v[28:31], v[176:191]
    v_max_f32 v208, 0, v208
    v_mul_f32 v208, v208, v216
    v_max_f32 v209, 0, v209
    v_mul_f32 v209, v209, v217
    v_max_f32 v210, 0, v210
    v_mul_f32 v210, v210, v218
    v_max_f32 v211, 0, v211
    v_mul_f32 v211, v211, v219
    v_max_f32 v212, 0, v212
    v_mul_f32 v212, v212, v220
    v_max_f32 v213, 0, v213
    v_mul_f32 v213, v213, v221
    v_max_f32 v214, 0, v214
    v_mul_f32 v214, v214, v222
    v_max_f32 v215, 0, v215
    v_mul_f32 v215, v215, v223
    v_cvt_pk_bf16_f32 v208, v208, v209
    v_cvt_pk_bf16_f32 v209, v210, v211
    v_cvt_pk_bf16_f32 v210, v212, v213
    v_cvt_pk_bf16_f32 v211, v214, v215
    buffer_store_dwordx4 v[208:211], v253, s[16:19], s100 offen sc1
    v_max_f32 v224, 0, v224
    v_mul_f32 v224, v224, v232
    v_max_f32 v225, 0, v225
    v_mul_f32 v225, v225, v233
    v_max_f32 v226, 0, v226
    v_mul_f32 v226, v226, v234
    v_max_f32 v227, 0, v227
    v_mul_f32 v227, v227, v235
    v_max_f32 v228, 0, v228
    v_mul_f32 v228, v228, v236
    v_max_f32 v229, 0, v229
    v_mul_f32 v229, v229, v237
    v_max_f32 v230, 0, v230
    v_mul_f32 v230, v230, v238
    v_max_f32 v231, 0, v231
    v_mul_f32 v231, v231, v239
    v_cvt_pk_bf16_f32 v224, v224, v225
    v_cvt_pk_bf16_f32 v225, v226, v227
    v_cvt_pk_bf16_f32 v226, v228, v229
    v_cvt_pk_bf16_f32 v227, v230, v231
    buffer_store_dwordx4 v[224:227], v253, s[16:19], s101 offen sc1
    s_mov_b32 s55, 0x3e0293ee
    s_sub_u32 s9, s52, 1
    s_lshr_b32 s9, s9, 1
    s_lshr_b32 s8, s52, 1
    s_add_u32 s8, s8, 2
    s_mov_b32 s10, 0x43800000
    s_mov_b32 s12, 0
    s_mov_b32 s62, 0x3f803f80
    s_mov_b32 s4, 98304
    v_add_u32 v252, s4, v254
    v_mov_b32 v32, 0
    v_mov_b32 v33, 0
    v_mov_b32 v34, 0
    v_mov_b32 v35, 0
    v_mov_b32 v36, 0
    v_mov_b32 v37, 0
    v_mov_b32 v38, 0
    v_mov_b32 v39, 0
    v_mov_b32 v40, 0
    v_mov_b32 v41, 0
    v_mov_b32 v42, 0
    v_mov_b32 v43, 0
    v_mov_b32 v44, 0
    v_mov_b32 v45, 0
    v_mov_b32 v46, 0
    v_mov_b32 v47, 0
    v_mul_f32 v128, s55, v128
    v_mul_f32 v129, s55, v129
    v_cvt_pk_bf16_f32 v128, v128, v129
    v_mul_f32 v130, s55, v130
    v_mul_f32 v131, s55, v131
    v_cvt_pk_bf16_f32 v129, v130, v131
    v_mul_f32 v132, s55, v132
    v_mul_f32 v133, s55, v133
    v_cvt_pk_bf16_f32 v132, v132, v133
    v_mul_f32 v134, s55, v134
    v_mul_f32 v135, s55, v135
    v_cvt_pk_bf16_f32 v133, v134, v135
    v_mul_f32 v136, s55, v136
    v_mul_f32 v137, s55, v137
    v_cvt_pk_bf16_f32 v130, v136, v137
    v_mul_f32 v138, s55, v138
    v_mul_f32 v139, s55, v139
    v_cvt_pk_bf16_f32 v131, v138, v139
    v_mul_f32 v140, s55, v140
    v_mul_f32 v141, s55, v141
    v_cvt_pk_bf16_f32 v134, v140, v141
    v_mul_f32 v142, s55, v142
    v_mul_f32 v143, s55, v143
    v_cvt_pk_bf16_f32 v135, v142, v143
    v_mul_f32 v144, s55, v144
    v_mul_f32 v145, s55, v145
    v_cvt_pk_bf16_f32 v136, v144, v145
    v_mul_f32 v146, s55, v146
    v_mul_f32 v147, s55, v147
    v_cvt_pk_bf16_f32 v137, v146, v147
    v_mul_f32 v148, s55, v148
    v_mul_f32 v149, s55, v149
    v_cvt_pk_bf16_f32 v140, v148, v149
    v_mul_f32 v150, s55, v150
    v_mul_f32 v151, s55, v151
    v_cvt_pk_bf16_f32 v141, v150, v151
    v_mul_f32 v152, s55, v152
    v_mul_f32 v153, s55, v153
    v_cvt_pk_bf16_f32 v138, v152, v153
    v_mul_f32 v154, s55, v154
    v_mul_f32 v155, s55, v155
    v_cvt_pk_bf16_f32 v139, v154, v155
    v_mul_f32 v156, s55, v156
    v_mul_f32 v157, s55, v157
    v_cvt_pk_bf16_f32 v142, v156, v157
    v_mul_f32 v158, s55, v158
    v_mul_f32 v159, s55, v159
    v_cvt_pk_bf16_f32 v143, v158, v159
    v_mul_f32 v160, s55, v160
    v_mul_f32 v161, s55, v161
    v_cvt_pk_bf16_f32 v144, v160, v161
    v_mul_f32 v162, s55, v162
    v_mul_f32 v163, s55, v163
    v_cvt_pk_bf16_f32 v145, v162, v163
    v_mul_f32 v164, s55, v164
    v_mul_f32 v165, s55, v165
    v_cvt_pk_bf16_f32 v148, v164, v165
    v_mul_f32 v166, s55, v166
    v_mul_f32 v167, s55, v167
    v_cvt_pk_bf16_f32 v149, v166, v167
    v_mul_f32 v168, s55, v168
    v_mul_f32 v169, s55, v169
    v_cvt_pk_bf16_f32 v146, v168, v169
    v_mul_f32 v170, s55, v170
    v_mul_f32 v171, s55, v171
    v_cvt_pk_bf16_f32 v147, v170, v171
    v_mul_f32 v172, s55, v172
    v_mul_f32 v173, s55, v173
    v_cvt_pk_bf16_f32 v150, v172, v173
    v_mul_f32 v174, s55, v174
    v_mul_f32 v175, s55, v175
    v_cvt_pk_bf16_f32 v151, v174, v175
    v_mul_f32 v176, s55, v176
    v_mul_f32 v177, s55, v177
    v_cvt_pk_bf16_f32 v152, v176, v177
    v_mul_f32 v178, s55, v178
    v_mul_f32 v179, s55, v179
    v_cvt_pk_bf16_f32 v153, v178, v179
    v_mul_f32 v180, s55, v180
    v_mul_f32 v181, s55, v181
    v_cvt_pk_bf16_f32 v156, v180, v181
    v_mul_f32 v182, s55, v182
    v_mul_f32 v183, s55, v183
    v_cvt_pk_bf16_f32 v157, v182, v183
    v_mul_f32 v184, s55, v184
    v_mul_f32 v185, s55, v185
    v_cvt_pk_bf16_f32 v154, v184, v185
    v_mul_f32 v186, s55, v186
    v_mul_f32 v187, s55, v187
    v_cvt_pk_bf16_f32 v155, v186, v187
    v_mul_f32 v188, s55, v188
    v_mul_f32 v189, s55, v189
    v_cvt_pk_bf16_f32 v158, v188, v189
    v_mul_f32 v190, s55, v190
    v_mul_f32 v191, s55, v191
    v_cvt_pk_bf16_f32 v159, v190, v191
    v_and_b32 v212, 31, v255
    v_lshrrev_b32 v213, 5, v255
    v_lshlrev_b32 v213, 2, v213
    v_sub_u32 v212, v212, v213
    s_waitcnt vmcnt(19)
    s_barrier
    ds_read_b128 v[160:163], v252 offset:0
    ds_read_b128 v[164:167], v252 offset:1024
    ds_read_b128 v[168:171], v252 offset:2048
    ds_read_b128 v[172:175], v252 offset:3072
    ds_read_b128 v[176:179], v252 offset:4096
    ds_read_b128 v[180:183], v252 offset:5120
    s_cmp_eq_u32 s52, 0
    s_cbranch_scc1 L_F0d
L_F0:
    s_waitcnt lgkmcnt(4)
    v_mfma_f32_32x32x16_bf16 v[0:15], v[160:163], v[128:131], v[32:47]
    ds_read_b128 v[184:187], v252 offset:6144
    s_add_u32 m0, s5, s60
    s_min_u32 s6, s6, s11
    v_mfma_f32_32x32x16_bf16 v[0:15], v[164:167], v[132:135], v[0:15]
    ds_read_b128 v[188:191], v252 offset:7168
    buffer_load_dwordx4 v254, s[16:19], s6 offen offset:0 lds
    s_waitcnt lgkmcnt(4)
    v_mfma_f32_32x32x16_bf16 v[0:15], v[168:171], v[136:139], v[0:15]
    ds_read_b128 v[160:163], v252 offset:8192
    buffer_load_dwordx4 v254, s[16:19], s6 offen offset:1024 lds
    v_mfma_f32_32x32x16_bf16 v[0:15], v[172:175], v[140:143], v[0:15]
    ds_read_b128 v[164:167], v252 offset:9216
    buffer_load_dwordx4 v254, s[16:19], s6 offen offset:2048 lds
    s_waitcnt lgkmcnt(4)
    v_mfma_f32_32x32x16_bf16 v[0:15], v[176:179], v[144:147], v[0:15]
    ds_read_b128 v[168:171], v252 offset:10240
    buffer_load_dwordx4 v254, s[16:19], s6 offen offset:3072 lds
    s_add_u32 m0, m0, 16384
    s_add_u32 s6, s6, 16384
    v_mfma_f32_32x32x16_bf16 v[0:15], v[180:183], v[148:151], v[0:15]
    ds_read_b128 v[172:175], v252 offset:11264
    buffer_load_dwordx4 v254, s[16:19], s7 offen offset:0 lds
    s_waitcnt lgkmcnt(4)
    v_mfma_f32_32x32x16_bf16 v[0:15], v[184:187], v[152:155], v[0:15]
    ds_read_b128 v[176:179], v252 offset:12288
    buffer_load_dwordx4 v254, s[16:19], s7 offen offset:1024 lds
    v_mfma_f32_32x32x16_bf16 v[0:15], v[188:191], v[156:159], v[0:15]
    ds_read_b128 v[180:183], v252 offset:13312
    buffer_load_dwordx4 v254, s[16:19], s7 offen offset:2048 lds
    s_nop 7
    s_nop 3
    v_max3_f32 v200, v0, v1, v2
    v_max3_f32 v200, v200, v3, v4
    v_max3_f32 v200, v200, v5, v6
    v_max3_f32 v200, v200, v7, v8
    v_max3_f32 v200, v200, v9, v10
    v_max3_f32 v200, v200, v11, v12
    v_max3_f32 v200, v200, v13, v14
    v_max_f32 v200, v200, v15
    v_mov_b32 v201, v200
    s_nop 1
    v_permlane32_swap_b32 v200, v201
    v_max_f32 v200, v200, v201
    v_sub_f32 v32, 0, v200
    v_sub_f32 v33, 0, v200
    v_sub_f32 v34, 0, v200
    v_sub_f32 v35, 0, v200
    v_sub_f32 v36, 0, v200
    v_sub_f32 v37, 0, v200
    v_sub_f32 v38, 0, v200
    v_sub_f32 v39, 0, v200
    v_sub_f32 v40, 0, v200
    v_sub_f32 v41, 0, v200
    v_sub_f32 v42, 0, v200
    v_sub_f32 v43, 0, v200
    v_sub_f32 v44, 0, v200
    v_sub_f32 v45, 0, v200
    v_sub_f32 v46, 0, v200
    v_sub_f32 v47, 0, v200
    s_waitcnt lgkmcnt(4)
    s_nop 0
    v_mfma_f32_32x32x16_bf16 v[16:31], v[160:163], v[128:131], v[32:47]
    ds_read_b128 v[184:187], v252 offset:14336
    buffer_load_dwordx4 v254, s[16:19], s7 offen offset:3072 lds
    s_add_u32 s7, s7, 16384
    s_add_u32 s5, s5, 32768
    s_cmp_eq_u32 s5, 163840
    s_cselect_b32 s5, 0, s5
    v_sub_f32 v0, v0, v200
    v_sub_f32 v1, v1, v200
    v_sub_f32 v2, v2, v200
    v_sub_f32 v3, v3, v200
    v_sub_f32 v4, v4, v200
    v_sub_f32 v5, v5, v200
    v_sub_f32 v6, v6, v200
    v_sub_f32 v7, v7, v200
    v_sub_f32 v8, v8, v200
    v_mfma_f32_32x32x16_bf16 v[16:31], v[164:167], v[132:135], v[16:31]
    ds_read_b128 v[188:191], v252 offset:15360
    v_sub_f32 v9, v9, v200
    v_sub_f32 v10, v10, v200
    v_sub_f32 v11, v11, v200
    v_sub_f32 v12, v12, v200
    v_sub_f32 v13, v13, v200
    v_sub_f32 v14, v14, v200
    v_sub_f32 v15, v15, v200
    v_exp_f32 v192, v0
    s_waitcnt lgkmcnt(4)
    v_mfma_f32_32x32x16_bf16 v[16:31], v[168:171], v[136:139], v[16:31]
    s_waitcnt vmcnt(16)
    s_barrier
    s_add_u32 s4, s4, 32768
    s_cmp_eq_u32 s4, 163840
    s_cselect_b32 s4, 0, s4
    v_add_u32 v252, s4, v254
    ds_read_b128 v[160:163], v252 offset:0
    v_exp_f32 v193, v1
    v_exp_f32 v194, v2
    v_exp_f32 v195, v3
    v_cvt_pk_bf16_f32 v48, v192, v193
    v_exp_f32 v196, v4
    v_mfma_f32_32x32x16_bf16 v[16:31], v[172:175], v[140:143], v[16:31]
    ds_read_b128 v[164:167], v252 offset:16384
    v_add_f32 v242, v192, v194
    v_exp_f32 v197, v5
    v_add_f32 v243, v193, v195
    v_cvt_pk_bf16_f32 v49, v194, v195
    v_exp_f32 v198, v6
    v_add_f32 v242, v242, v196
    s_waitcnt lgkmcnt(4)
    v_mfma_f32_32x32x16_bf16 v[16:31], v[176:179], v[144:147], v[16:31]
    ds_read_b128 v[168:171], v252 offset:1024
    v_exp_f32 v199, v7
    v_add_f32 v243, v243, v197
    v_cvt_pk_bf16_f32 v52, v196, v197
    v_exp_f32 v192, v8
    v_add_f32 v242, v242, v198
    v_exp_f32 v193, v9
    v_mfma_f32_32x32x16_bf16 v[16:31], v[180:183], v[148:151], v[16:31]
    ds_read_b128 v[172:175], v252 offset:17408
    v_add_f32 v243, v243, v199
    v_cvt_pk_bf16_f32 v53, v198, v199
    v_exp_f32 v194, v10
    v_add_f32 v242, v242, v192
    v_exp_f32 v195, v11
    v_add_f32 v243, v243, v193
    v_cvt_pk_bf16_f32 v50, v192, v193
    s_waitcnt lgkmcnt(4)
    v_mfma_f32_32x32x16_bf16 v[16:31], v[184:187], v[152:155], v[16:31]
    ds_read_b128 v[176:179], v252 offset:2048
    v_exp_f32 v196, v12
    v_add_f32 v242, v242, v194
    v_exp_f32 v197, v13
    v_add_f32 v243, v243, v195
    v_cvt_pk_bf16_f32 v51, v194, v195
    v_exp_f32 v198, v14
    v_mfma_f32_32x32x16_bf16 v[16:31], v[188:191], v[156:159], v[16:31]
    ds_read_b128 v[180:183], v252 offset:18432
    v_add_f32 v242, v242, v196
    v_exp_f32 v199, v15
    v_add_f32 v243, v243, v197
    v_cvt_pk_bf16_f32 v54, v196, v197
    v_add_f32 v242, v242, v198
    v_add_f32 v243, v243, v199
    v_cvt_pk_bf16_f32 v55, v198, v199
    v_add_f32 v242, v242, v243
    v_mov_b32 v240, v242
    s_nop 3
    s_waitcnt vmcnt(8)
    s_lshl_b32 s54, s52, 5
    s_add_u32 s54, s54, s48
    s_lshl_b32 s54, s54, 2
    s_add_u32 s54, s54, 58753024
    s_mov_b64 exec, 1
    buffer_store_dword v251, off, s[16:19], s54 sc1
    s_mov_b64 exec, -1
    s_cmp_eq_u32 s9, 0
    s_cbranch_scc1 L_tail
L_FULL:
    s_waitcnt lgkmcnt(4)
    v_mfma_f32_32x32x16_bf16 v[0:15], v[160:163], v[128:131], v[32:47]
    ds_read_b128 v[184:187], v252 offset:3072
    s_add_u32 m0, s5, s60
    s_min_u32 s6, s6, s11
    v_mfma_f32_32x32x16_bf16 v[64:79], v[164:167], v[48:51], v[64:79]
    ds_read_b128 v[188:191], v252 offset:19456
    buffer_load_dwordx4 v254, s[16:19], s6 offen offset:0 lds
    v_exp_f32 v192, v16
    v_exp_f32 v193, v17
    s_waitcnt lgkmcnt(4)
    v_mfma_f32_32x32x16_bf16 v[0:15], v[168:171], v[132:135], v[0:15]
    ds_read_b128 v[160:163], v252 offset:4096
    buffer_load_dwordx4 v254, s[16:19], s6 offen offset:1024 lds
    v_exp_f32 v194, v18
    v_exp_f32 v195, v19
    v_mfma_f32_32x32x16_bf16 v[80:95], v[172:175], v[48:51], v[80:95]
    ds_read_b128 v[164:167], v252 offset:20480
    buffer_load_dwordx4 v254, s[16:19], s6 offen offset:2048 lds
    v_cvt_pk_bf16_f32 v56, v192, v193
    v_exp_f32 v196, v20
    v_add_f32 v242, v192, v194
    s_waitcnt lgkmcnt(4)
    v_mfma_f32_32x32x16_bf16 v[0:15], v[176:179], v[136:139], v[0:15]
    ds_read_b128 v[168:171], v252 offset:5120
    buffer_load_dwordx4 v254, s[16:19], s6 offen offset:3072 lds
    s_add_u32 m0, m0, 16384
    s_add_u32 s6, s6, 16384
    v_exp_f32 v197, v21
    v_add_f32 v243, v193, v195
    v_cvt_pk_bf16_f32 v57, v194, v195
    v_mfma_f32_32x32x16_bf16 v[96:111], v[180:183], v[48:51], v[96:111]
    ds_read_b128 v[172:175], v252 offset:21504
    buffer_load_dwordx4 v254, s[16:19], s7 offen offset:0 lds
    v_exp_f32 v198, v22
    v_add_f32 v242, v242, v196
    v_exp_f32 v199, v23
    s_waitcnt lgkmcnt(4)
    v_mfma_f32_32x32x16_bf16 v[0:15], v[184:187], v[140:143], v[0:15]
    ds_read_b128 v[176:179], v252 offset:6144
    buffer_load_dwordx4 v254, s[16:19], s7 offen offset:1024 lds
    v_add_f32 v243, v243, v197
    v_cvt_pk_bf16_f32 v60, v196, v197
    v_exp_f32 v192, v24
    v_mfma_f32_32x32x16_bf16 v[112:127], v[188:191], v[48:51], v[112:127]
    ds_read_b128 v[180:183], v252 offset:22528
    buffer_load_dwordx4 v254, s[16:19], s7 offen offset:2048 lds
    v_add_f32 v242, v242, v198
    v_exp_f32 v193, v25
    s_waitcnt lgkmcnt(4)
    v_mfma_f32_32x32x16_bf16 v[0:15], v[160:163], v[144:147], v[0:15]
    ds_read_b128 v[184:187], v252 offset:7168
    buffer_load_dwordx4 v254, s[16:19], s7 offen offset:3072 lds
    s_add_u32 s7, s7, 16384
    s_add_u32 s5, s5, 32768
    s_cmp_eq_u32 s5, 163840
    s_cselect_b32 s5, 0, s5
    v_add_f32 v243, v243, v199
    v_cvt_pk_bf16_f32 v61, v198, v199
    v_exp_f32 v194, v26
    v_mfma_f32_32x32x16_bf16 v[64:79], v[164:167], v[52:55], v[64:79]
    ds_read_b128 v[188:191], v252 offset:23552
    v_add_f32 v242, v242, v192
    v_exp_f32 v195, v27
    v_add_f32 v243, v243, v193
    s_waitcnt lgkmcnt(4)
    v_mfma_f32_32x32x16_bf16 v[0:15], v[168:171], v[148:151], v[0:15]
    ds_read_b128 v[160:163], v252 offset:8192
    v_cvt_pk_bf16_f32 v58, v192, v193
    v_exp_f32 v196, v28
    v_add_f32 v242, v242, v194
    v_mfma_f32_32x32x16_bf16 v[80:95], v[172:175], v[52:55], v[80:95]
    ds_read_b128 v[164:167], v252 offset:24576
    v_exp_f32 v197, v29
    v_add_f32 v243, v243, v195
    v_cvt_pk_bf16_f32 v59, v194, v195
    s_waitcnt lgkmcnt(4)
    v_mfma_f32_32x32x16_bf16 v[0:15], v[176:179], v[152:155], v[0:15]
    ds_read_b128 v[168:171], v252 offset:9216
    v_exp_f32 v198, v30
    v_add_f32 v242, v242, v196
    v_exp_f32 v199, v31
    v_mfma_f32_32x32x16_bf16 v[96:111], v[180:183], v[52:55], v[96:111]
    ds_read_b128 v[172:175], v252 offset:25600
    v_add_f32 v243, v243, v197
    v_cvt_pk_bf16_f32 v62, v196, v197
    v_add_f32 v242, v242, v198
    s_waitcnt lgkmcnt(4)
    v_mfma_f32_32x32x16_bf16 v[0:15], v[184:187], v[156:159], v[0:15]
    ds_read_b128 v[176:179], v252 offset:10240
    v_add_f32 v243, v243, v199
    v_cvt_pk_bf16_f32 v63, v198, v199
    v_add_f32 v242, v242, v243
    v_cmp_lt_f32 vcc, s10, v242
    v_mfma_f32_32x32x16_bf16 v[112:127], v[188:191], v[52:55], v[112:127]
    ds_read_b128 v[180:183], v252 offset:26624
    s_cbranch_vccnz L_FULL_slow0
L_FULL_ret0:
    v_add_f32 v240, v240, v242
    s_waitcnt lgkmcnt(4)
    v_mfma_f32_32x32x16_bf16 v[16:31], v[160:163], v[128:131], v[32:47]
    ds_read_b128 v[184:187], v252 offset:11264
    v_mfma_f32_32x32x16_bf16 v[64:79], v[164:167], v[56:59], v[64:79]
    ds_read_b128 v[188:191], v252 offset:27648
    v_exp_f32 v192, v0
    v_exp_f32 v193, v1
    s_waitcnt lgkmcnt(4)
    v_mfma_f32_32x32x16_bf16 v[16:31], v[168:171], v[132:135], v[16:31]
    ds_read_b128 v[160:163], v252 offset:12288
    v_exp_f32 v194, v2
    v_exp_f32 v195, v3
    v_mfma_f32_32x32x16_bf16 v[80:95], v[172:175], v[56:59], v[80:95]
    ds_read_b128 v[164:167], v252 offset:28672
    v_cvt_pk_bf16_f32 v48, v192, v193
    v_exp_f32 v196, v4
    v_add_f32 v242, v192, v194
    s_waitcnt lgkmcnt(4)
    v_mfma_f32_32x32x16_bf16 v[16:31], v[176:179], v[136:139], v[16:31]
    ds_read_b128 v[168:171], v252 offset:13312
    v_exp_f32 v197, v5
    v_add_f32 v243, v193, v195
    v_cvt_pk_bf16_f32 v49, v194, v195
    v_mfma_f32_32x32x16_bf16 v[96:111], v[180:183], v[56:59], v[96:111]
    ds_read_b128 v[172:175], v252 offset:29696
    v_exp_f32 v198, v6
    v_add_f32 v242, v242, v196
    v_exp_f32 v199, v7
    s_waitcnt lgkmcnt(4)
    v_mfma_f32_32x32x16_bf16 v[16:31], v[184:187], v[140:143], v[16:31]
    ds_read_b128 v[176:179], v252 offset:14336
    v_add_f32 v243, v243, v197
    v_cvt_pk_bf16_f32 v52, v196, v197
    v_exp_f32 v192, v8
    v_mfma_f32_32x32x16_bf16 v[112:127], v[188:191], v[56:59], v[112:127]
    ds_read_b128 v[180:183], v252 offset:30720
    v_add_f32 v242, v242, v198
    v_exp_f32 v193, v9
    s_waitcnt lgkmcnt(4)
    v_mfma_f32_32x32x16_bf16 v[16:31], v[160:163], v[144:147], v[16:31]
    ds_read_b128 v[184:187], v252 offset:15360
    v_add_f32 v243, v243, v199
    v_cvt_pk_bf16_f32 v53, v198, v199
    v_exp_f32 v194, v10
    v_mfma_f32_32x32x16_bf16 v[64:79], v[164:167], v[60:63], v[64:79]
    ds_read_b128 v[188:191], v252 offset:31744
    v_add_f32 v242, v242, v192
    v_exp_f32 v195, v11
    v_add_f32 v243, v243, v193
    s_waitcnt lgkmcnt(4)
    v_mfma_f32_32x32x16_bf16 v[16:31], v[168:171], v[148:151], v[16:31]
    s_waitcnt vmcnt(16)
    s_barrier
    s_add_u32 s4, s4, 32768
    s_cmp_eq_u32 s4, 163840
    s_cselect_b32 s4, 0, s4
    v_add_u32 v252, s4, v254
    ds_read_b128 v[160:163], v252 offset:0
    v_cvt_pk_bf16_f32 v50, v192, v193
    v_exp_f32 v196, v12
    v_add_f32 v242, v242, v194
    v_mfma_f32_32x32x16_bf16 v[80:95], v[172:175], v[60:63], v[80:95]
    ds_read_b128 v[164:167], v252 offset:16384
    v_exp_f32 v197, v13
    v_add_f32 v243, v243, v195
    v_cvt_pk_bf16_f32 v51, v194, v195
    s_waitcnt lgkmcnt(4)
    v_mfma_f32_32x32x16_bf16 v[16:31], v[176:179], v[152:155], v[16:31]
    ds_read_b128 v[168:171], v252 offset:1024
    v_exp_f32 v198, v14
    v_add_f32 v242, v242, v196
    v_exp_f32 v199, v15
    v_mfma_f32_32x32x16_bf16 v[96:111], v[180:183], v[60:63], v[96:111]
    ds_read_b128 v[172:175], v252 offset:17408
    v_add_f32 v243, v243, v197
    v_cvt_pk_bf16_f32 v54, v196, v197
    v_add_f32 v242, v242, v198
    s_waitcnt lgkmcnt(4)
    v_mfma_f32_32x32x16_bf16 v[16:31], v[184:187], v[156:159], v[16:31]
    ds_read_b128 v[176:179], v252 offset:2048
    v_add_f32 v243, v243, v199
    v_cvt_pk_bf16_f32 v55, v198, v199
    v_add_f32 v242, v242, v243
    v_cmp_lt_f32 vcc, s10, v242
    v_mfma_f32_32x32x16_bf16 v[112:127], v[188:191], v[60:63], v[112:127]
    ds_read_b128 v[180:183], v252 offset:18432
    s_cbranch_vccnz L_FULL_slow1
L_FULL_ret1:
    v_add_f32 v240, v240, v242
    s_sub_u32 s9, s9, 1
    s_cmp_lg_u32 s9, 0
    s_cbranch_scc1 L_FULL
L_tail:
    s_bitcmp1_b32 s52, 0
    s_cbranch_scc1 L_E2
L_E1:
    s_waitcnt lgkmcnt(4)
    v_mfma_f32_32x32x16_bf16 v[0:15], v[160:163], v[128:131], v[32:47]
    ds_read_b128 v[184:187], v252 offset:3072
    s_add_u32 m0, s5, s60
    s_min_u32 s6, s6, s11
    v_mfma_f32_32x32x16_bf16 v[64:79], v[164:167], v[48:51], v[64:79]
    ds_read_b128 v[188:191], v252 offset:19456
    buffer_load_dwordx4 v254, s[16:19], s6 offen offset:0 lds
    v_exp_f32 v192, v16
    v_exp_f32 v193, v17
    s_waitcnt lgkmcnt(4)
    v_mfma_f32_32x32x16_bf16 v[0:15], v[168:171], v[132:135], v[0:15]
    ds_read_b128 v[160:163], v252 offset:4096
    buffer_load_dwordx4 v254, s[16:19], s6 offen offset:1024 lds
    v_exp_f32 v194, v18
    v_exp_f32 v195, v19
    v_mfma_f32_32x32x16_bf16 v[80:95], v[172:175], v[48:51], v[80:95]
    ds_read_b128 v[164:167], v252 offset:20480
    buffer_load_dwordx4 v254, s[16:19], s6 offen offset:2048 lds
    v_cvt_pk_bf16_f32 v56, v192, v193
    v_exp_f32 v196, v20
    v_add_f32 v242, v192, v194
    s_waitcnt lgkmcnt(4)
    v_mfma_f32_32x32x16_bf16 v[0:15], v[176:179], v[136:139], v[0:15]
    ds_read_b128 v[168:171], v252 offset:5120
    buffer_load_dwordx4 v254, s[16:19], s6 offen offset:3072 lds
    s_add_u32 m0, m0, 16384
    s_add_u32 s6, s6, 16384
    v_exp_f32 v197, v21
    v_add_f32 v243, v193, v195
    v_cvt_pk_bf16_f32 v57, v194, v195
    v_mfma_f32_32x32x16_bf16 v[96:111], v[180:183], v[48:51], v[96:111]
    ds_read_b128 v[172:175], v252 offset:21504
    buffer_load_dwordx4 v254, s[16:19], s7 offen offset:0 lds
    v_exp_f32 v198, v22
    v_add_f32 v242, v242, v196
    v_exp_f32 v199, v23
    s_waitcnt lgkmcnt(4)
    v_mfma_f32_32x32x16_bf16 v[0:15], v[184:187], v[140:143], v[0:15]
    ds_read_b128 v[176:179], v252 offset:6144
    buffer_load_dwordx4 v254, s[16:19], s7 offen offset:1024 lds
    v_add_f32 v243, v243, v197
    v_cvt_pk_bf16_f32 v60, v196, v197
    v_exp_f32 v192, v24
    v_mfma_f32_32x32x16_bf16 v[112:127], v[188:191], v[48:51], v[112:127]
    ds_read_b128 v[180:183], v252 offset:22528
    buffer_load_dwordx4 v254, s[16:19], s7 offen offset:2048 lds
    v_add_f32 v242, v242, v198
    v_exp_f32 v193, v25
    s_waitcnt lgkmcnt(4)
    v_mfma_f32_32x32x16_bf16 v[0:15], v[160:163], v[144:147], v[0:15]
    ds_read_b128 v[184:187], v252 offset:7168
    buffer_load_dwordx4 v254, s[16:19], s7 offen offset:3072 lds
    s_add_u32 s7, s7, 16384
    s_add_u32 s5, s5, 32768
    s_cmp_eq_u32 s5, 163840
    s_cselect_b32 s5, 0, s5
    v_add_f32 v243, v243, v199
    v_cvt_pk_bf16_f32 v61, v198, v199
    v_exp_f32 v194, v26
    v_mfma_f32_32x32x16_bf16 v[64:79], v[164:167], v[52:55], v[64:79]
    ds_read_b128 v[188:191], v252 offset:23552
    v_add_f32 v242, v242, v192
    v_exp_f32 v195, v27
    v_add_f32 v243, v243, v193
    s_waitcnt lgkmcnt(4)
    v_mfma_f32_32x32x16_bf16 v[0:15], v[168:171], v[148:151], v[0:15]
    ds_read_b128 v[160:163], v252 offset:24576
    v_cvt_pk_bf16_f32 v58, v192, v193
    v_exp_f32 v196, v28
    v_add_f32 v242, v242, v194
    v_mfma_f32_32x32x16_bf16 v[80:95], v[172:175], v[52:55], v[80:95]
    ds_read_b128 v[164:167], v252 offset:25600
    v_exp_f32 v197, v29
    v_add_f32 v243, v243, v195
    v_cvt_pk_bf16_f32 v59, v194, v195
    s_waitcnt lgkmcnt(4)
    v_mfma_f32_32x32x16_bf16 v[0:15], v[176:179], v[152:155], v[0:15]
    ds_read_b128 v[168:171], v252 offset:26624
    v_exp_f32 v198, v30
    v_add_f32 v242, v242, v196
    v_exp_f32 v199, v31
    v_mfma_f32_32x32x16_bf16 v[96:111], v[180:183], v[52:55], v[96:111]
    ds_read_b128 v[172:175], v252 offset:27648
    v_add_f32 v243, v243, v197
    v_cvt_pk_bf16_f32 v62, v196, v197
    v_add_f32 v242, v242, v198
    s_waitcnt lgkmcnt(4)
    v_mfma_f32_32x32x16_bf16 v[0:15], v[184:187], v[156:159], v[0:15]
    ds_read_b128 v[176:179], v252 offset:28672
    v_add_f32 v243, v243, v199
    v_cvt_pk_bf16_f32 v63, v198, v199
    v_add_f32 v242, v242, v243
    v_cmp_lt_f32 vcc, s10, v242
    v_mfma_f32_32x32x16_bf16 v[112:127], v[188:191], v[52:55], v[112:127]
    ds_read_b128 v[180:183], v252 offset:29696
    s_cbranch_vccnz L_E1_slow0
L_E1_ret0:
    v_add_f32 v240, v240, v242
    s_waitcnt lgkmcnt(4)
    v_mfma_f32_32x32x16_bf16 v[64:79], v[160:163], v[56:59], v[64:79]
    ds_read_b128 v[184:187], v252 offset:30720
    v_mov_b32 v207, 0xff800000
    v_cmp_le_i32 vcc, 0, v212
    s_nop 1
    v_cndmask_b32 v0, v207, v0, vcc
    v_cmp_le_i32 vcc, 1, v212
    s_nop 1
    v_cndmask_b32 v1, v207, v1, vcc
    v_cmp_le_i32 vcc, 2, v212
    s_nop 1
    v_cndmask_b32 v2, v207, v2, vcc
    v_cmp_le_i32 vcc, 3, v212
    s_nop 1
    v_cndmask_b32 v3, v207, v3, vcc
    v_cmp_le_i32 vcc, 8, v212
    s_nop 1
    v_cndmask_b32 v4, v207, v4, vcc
    v_mfma_f32_32x32x16_bf16 v[80:95], v[164:167], v[56:59], v[80:95]
    ds_read_b128 v[188:191], v252 offset:31744
    v_cmp_le_i32 vcc, 9, v212
    s_nop 1
    v_cndmask_b32 v5, v207, v5, vcc
    v_cmp_le_i32 vcc, 10, v212
    s_nop 1
    v_cndmask_b32 v6, v207, v6, vcc
    v_cmp_le_i32 vcc, 11, v212
    s_nop 1
    v_cndmask_b32 v7, v207, v7, vcc
    v_cmp_le_i32 vcc, 16, v212
    s_nop 1
    v_cndmask_b32 v8, v207, v8, vcc
    v_cmp_le_i32 vcc, 17, v212
    s_nop 1
    v_cndmask_b32 v9, v207, v9, vcc
    v_cmp_le_i32 vcc, 18, v212
    s_waitcnt lgkmcnt(4)
    v_mfma_f32_32x32x16_bf16 v[96:111], v[168:171], v[56:59], v[96:111]
    s_waitcnt vmcnt(16)
    s_barrier
    s_add_u32 s4, s4, 32768
    s_cmp_eq_u32 s4, 163840
    s_cselect_b32 s4, 0, s4
    v_add_u32 v252, s4, v254
    ds_read_b128 v[160:163], v252 offset:0
    v_cndmask_b32 v10, v207, v10, vcc
    v_cmp_le_i32 vcc, 19, v212
    s_nop 1
    v_cndmask_b32 v11, v207, v11, vcc
    v_cmp_le_i32 vcc, 24, v212
    s_nop 1
    v_cndmask_b32 v12, v207, v12, vcc
    v_cmp_le_i32 vcc, 25, v212
    s_nop 1
    v_cndmask_b32 v13, v207, v13, vcc
    v_cmp_le_i32 vcc, 26, v212
    s_nop 1
    v_cndmask_b32 v14, v207, v14, vcc
    v_cmp_le_i32 vcc, 27, v212
    s_nop 1
    v_cndmask_b32 v15, v207, v15, vcc
    v_mfma_f32_32x32x16_bf16 v[112:127], v[172:175], v[56:59], v[112:127]
    ds_read_b128 v[164:167], v252 offset:16384
    v_exp_f32 v192, v0
    v_exp_f32 v193, v1
    v_exp_f32 v194, v2
    v_exp_f32 v195, v3
    v_cvt_pk_bf16_f32 v48, v192, v193
    v_exp_f32 v196, v4
    v_add_f32 v242, v192, v194
    s_waitcnt lgkmcnt(4)
    v_mfma_f32_32x32x16_bf16 v[64:79], v[176:179], v[60:63], v[64:79]
    ds_read_b128 v[168:171], v252 offset:1024
    v_exp_f32 v197, v5
    v_add_f32 v243, v193, v195
    v_cvt_pk_bf16_f32 v49, v194, v195
    v_exp_f32 v198, v6
    v_add_f32 v242, v242, v196
    v_exp_f32 v199, v7
    v_add_f32 v243, v243, v197
    v_cvt_pk_bf16_f32 v52, v196, v197
    v_mfma_f32_32x32x16_bf16 v[80:95], v[180:183], v[60:63], v[80:95]
    ds_read_b128 v[172:175], v252 offset:17408
    v_exp_f32 v192, v8
    v_add_f32 v242, v242, v198
    v_exp_f32 v193, v9
    v_add_f32 v243, v243, v199
    v_cvt_pk_bf16_f32 v53, v198, v199
    v_exp_f32 v194, v10
    v_add_f32 v242, v242, v192
    s_waitcnt lgkmcnt(4)
    v_mfma_f32_32x32x16_bf16 v[96:111], v[184:187], v[60:63], v[96:111]
    ds_read_b128 v[176:179], v252 offset:2048
    v_exp_f32 v195, v11
    v_add_f32 v243, v243, v193
    v_cvt_pk_bf16_f32 v50, v192, v193
    v_exp_f32 v196, v12
    v_add_f32 v242, v242, v194
    v_exp_f32 v197, v13
    v_add_f32 v243, v243, v195
    v_cvt_pk_bf16_f32 v51, v194, v195
    v_mfma_f32_32x32x16_bf16 v[112:127], v[188:191], v[60:63], v[112:127]
    ds_read_b128 v[180:183], v252 offset:18432
    v_exp_f32 v198, v14
    v_add_f32 v242, v242, v196
    v_exp_f32 v199, v15
    v_add_f32 v243, v243, v197
    v_cvt_pk_bf16_f32 v54, v196, v197
    v_add_f32 v242, v242, v198
    v_add_f32 v243, v243, v199
    v_cvt_pk_bf16_f32 v55, v198, v199
    v_add_f32 v242, v242, v243
    v_cmp_lt_f32 vcc, s10, v242
    s_cbranch_vccnz L_E1_slow1
L_E1_ret1:
    v_add_f32 v240, v240, v242
L_E3:
    ds_read_b128 v[184:187], v252 offset:16384
    ds_read_b128 v[188:191], v252 offset:17408
    ds_read_b128 v[160:163], v252 offset:18432
    ds_read_b128 v[164:167], v252 offset:19456
    ds_read_b128 v[168:171], v252 offset:20480
    ds_read_b128 v[172:175], v252 offset:21504
    s_waitcnt lgkmcnt(4)
    v_mfma_f32_32x32x16_bf16 v[64:79], v[184:187], v[48:51], v[64:79]
    ds_read_b128 v[176:179], v252 offset:22528
    v_mfma_f32_32x32x16_bf16 v[80:95], v[188:191], v[48:51], v[80:95]
    ds_read_b128 v[180:183], v252 offset:23552
    s_waitcnt lgkmcnt(4)
    v_mfma_f32_32x32x16_bf16 v[96:111], v[160:163], v[48:51], v[96:111]
    s_waitcnt vmcnt(8)
    s_add_u32 s54, s8, 2
    s_cmp_gt_u32 s54, s53
    s_cbranch_scc1 L_E3_nodma
    s_add_u32 m0, s5, s60
    s_min_u32 s6, s6, s11
    buffer_load_dwordx4 v254, s[16:19], s6 offen offset:0 lds
    buffer_load_dwordx4 v254, s[16:19], s6 offen offset:1024 lds
    buffer_load_dwordx4 v254, s[16:19], s6 offen offset:2048 lds
    buffer_load_dwordx4 v254, s[16:19], s6 offen offset:3072 lds
    s_add_u32 m0, m0, 16384
    s_add_u32 s6, s6, 16384
    buffer_load_dwordx4 v254, s[16:19], s7 offen offset:0 lds
    buffer_load_dwordx4 v254, s[16:19], s7 offen offset:1024 lds
    buffer_load_dwordx4 v254, s[16:19], s7 offen offset:2048 lds
    buffer_load_dwordx4 v254, s[16:19], s7 offen offset:3072 lds
    s_add_u32 s7, s7, 16384
    s_add_u32 s5, s5, 32768
    s_cmp_eq_u32 s5, 163840
    s_cselect_b32 s5, 0, s5
L_E3_nodma:
    s_barrier
    s_add_u32 s4, s4, 32768
    s_cmp_eq_u32 s4, 163840
    s_cselect_b32 s4, 0, s4
    v_add_u32 v252, s4, v254
    v_mfma_f32_32x32x16_bf16 v[112:127], v[164:167], v[48:51], v[112:127]
    s_waitcnt lgkmcnt(2)
    v_mfma_f32_32x32x16_bf16 v[64:79], v[168:171], v[52:55], v[64:79]
    v_mfma_f32_32x32x16_bf16 v[80:95], v[172:175], v[52:55], v[80:95]
    s_waitcnt lgkmcnt(0)
    v_mfma_f32_32x32x16_bf16 v[96:111], v[176:179], v[52:55], v[96:111]
    v_mfma_f32_32x32x16_bf16 v[112:127], v[180:183], v[52:55], v[112:127]
L_epi:
    s_nop 7
    v_mov_b32 v201, v240
    v_mov_b32 v200, v240
    s_nop 1
    v_permlane32_swap_b32 v200, v201
    v_add_f32 v200, v200, v201
    v_rcp_f32 v200, v200
    s_mul_i32 s55, s52, 350208
    s_lshl_b32 s54, s48, 12
    s_add_u32 s55, s55, s54
    s_add_u32 s9, s55, 35651584
    v_mul_f32 v64, v64, v200
    v_mul_f32 v65, v65, v200
    v_mul_f32 v66, v66, v200
    v_mul_f32 v67, v67, v200
    v_mul_f32 v68, v68, v200
    v_mul_f32 v69, v69, v200
    v_mul_f32 v70, v70, v200
    v_mul_f32 v71, v71, v200
    v_cvt_pk_bf16_f32 v64, v64, v65
    v_cvt_pk_bf16_f32 v65, v66, v67
    v_cvt_pk_bf16_f32 v66, v68, v69
    v_cvt_pk_bf16_f32 v67, v70, v71
    buffer_store_dwordx4 v[64:67], v253, s[16:19], s9 offen offset:0 sc1
    v_mul_f32 v72, v72, v200
    v_mul_f32 v73, v73, v200
    v_mul_f32 v74, v74, v200
    v_mul_f32 v75, v75, v200
    v_mul_f32 v76, v76, v200
    v_mul_f32 v77, v77, v200
    v_mul_f32 v78, v78, v200
    v_mul_f32 v79, v79, v200
    v_cvt_pk_bf16_f32 v72, v72, v73
    v_cvt_pk_bf16_f32 v73, v74, v75
    v_cvt_pk_bf16_f32 v74, v76, v77
    v_cvt_pk_bf16_f32 v75, v78, v79
    buffer_store_dwordx4 v[72:75], v253, s[16:19], s9 offen offset:512 sc1
    v_mul_f32 v80, v80, v200
    v_mul_f32 v81, v81, v200
    v_mul_f32 v82, v82, v200
    v_mul_f32 v83, v83, v200
    v_mul_f32 v84, v84, v200
    v_mul_f32 v85, v85, v200
    v_mul_f32 v86, v86, v200
    v_mul_f32 v87, v87, v200
    v_cvt_pk_bf16_f32 v80, v80, v81
    v_cvt_pk_bf16_f32 v81, v82, v83
    v_cvt_pk_bf16_f32 v82, v84, v85
    v_cvt_pk_bf16_f32 v83, v86, v87
    buffer_store_dwordx4 v[80:83], v253, s[16:19], s9 offen offset:1024 sc1
    v_mul_f32 v88, v88, v200
    v_mul_f32 v89, v89, v200
    v_mul_f32 v90, v90, v200
    v_mul_f32 v91, v91, v200
    v_mul_f32 v92, v92, v200
    v_mul_f32 v93, v93, v200
    v_mul_f32 v94, v94, v200
    v_mul_f32 v95, v95, v200
    v_cvt_pk_bf16_f32 v88, v88, v89
    v_cvt_pk_bf16_f32 v89, v90, v91
    v_cvt_pk_bf16_f32 v90, v92, v93
    v_cvt_pk_bf16_f32 v91, v94, v95
    buffer_store_dwordx4 v[88:91], v253, s[16:19], s9 offen offset:1536 sc1
    v_mul_f32 v96, v96, v200
    v_mul_f32 v97, v97, v200
    v_mul_f32 v98, v98, v200
    v_mul_f32 v99, v99, v200
    v_mul_f32 v100, v100, v200
    v_mul_f32 v101, v101, v200
    v_mul_f32 v102, v102, v200
    v_mul_f32 v103, v103, v200
    v_cvt_pk_bf16_f32 v96, v96, v97
    v_cvt_pk_bf16_f32 v97, v98, v99
    v_cvt_pk_bf16_f32 v98, v100, v101
    v_cvt_pk_bf16_f32 v99, v102, v103
    buffer_store_dwordx4 v[96:99], v253, s[16:19], s9 offen offset:2048 sc1
    v_mul_f32 v104, v104, v200
    v_mul_f32 v105, v105, v200
    v_mul_f32 v106, v106, v200
    v_mul_f32 v107, v107, v200
    v_mul_f32 v108, v108, v200
    v_mul_f32 v109, v109, v200
    v_mul_f32 v110, v110, v200
    v_mul_f32 v111, v111, v200
    v_cvt_pk_bf16_f32 v104, v104, v105
    v_cvt_pk_bf16_f32 v105, v106, v107
    v_cvt_pk_bf16_f32 v106, v108, v109
    v_cvt_pk_bf16_f32 v107, v110, v111
    buffer_store_dwordx4 v[104:107], v253, s[16:19], s9 offen offset:2560 sc1
    v_mul_f32 v112, v112, v200
    v_mul_f32 v113, v113, v200
    v_mul_f32 v114, v114, v200
    v_mul_f32 v115, v115, v200
    v_mul_f32 v116, v116, v200
    v_mul_f32 v117, v117, v200
    v_mul_f32 v118, v118, v200
    v_mul_f32 v119, v119, v200
    v_cvt_pk_bf16_f32 v112, v112, v113
    v_cvt_pk_bf16_f32 v113, v114, v115
    v_cvt_pk_bf16_f32 v114, v116, v117
    v_cvt_pk_bf16_f32 v115, v118, v119
    buffer_store_dwordx4 v[112:115], v253, s[16:19], s9 offen offset:3072 sc1
    v_mul_f32 v120, v120, v200
    v_mul_f32 v121, v121, v200
    v_mul_f32 v122, v122, v200
    v_mul_f32 v123, v123, v200
    v_mul_f32 v124, v124, v200
    v_mul_f32 v125, v125, v200
    v_mul_f32 v126, v126, v200
    v_mul_f32 v127, v127, v200
    v_cvt_pk_bf16_f32 v120, v120, v121
    v_cvt_pk_bf16_f32 v121, v122, v123
    v_cvt_pk_bf16_f32 v122, v124, v125
    v_cvt_pk_bf16_f32 v123, v126, v127
    buffer_store_dwordx4 v[120:123], v253, s[16:19], s9 offen offset:3584 sc1
    s_load_dwordx2 s[96:97], s[0:1], 40
    s_load_dwordx2 s[98:99], s[0:1], 72
    s_load_dwordx2 s[100:101], s[0:1], 80
    s_and_b32 s15, s2, 3
    s_bfe_u32 s13, s2, 0x10002
    s_lshl_b32 s13, s13, 3
    s_lshr_b32 s54, s2, 5
    s_add_u32 s13, s13, s54
    s_bfe_u32 s14, s2, 0x20003
    s_waitcnt lgkmcnt(0)
    s_mov_b32 s20, s96
    s_and_b32 s21, s97, 0xffff
    s_mov_b32 s22, 4194304
    s_mov_b32 s23, 0x20000
    s_mov_b32 s24, s98
    s_and_b32 s25, s99, 0xffff
    s_mov_b32 s26, 0
    s_mov_b32 s27, 0x20000
    s_mov_b32 s28, s100
    s_and_b32 s29, s101, 0xffff
    s_mov_b32 s30, 2097152
    s_mov_b32 s31, 0x20000
    s_lshl_b32 s101, s13, 2
    s_add_u32 s101, s101, s14
    s_mul_i32 s54, s15, 11
    s_add_u32 s55, s54, 11
    s_min_u32 s55, s55, 43
    s_lshl_b32 s26, s55, 15
    s_lshl_b32 s97, s54, 15
    s_lshl_b32 s96, s13, 3
    s_add_u32 s96, s96, s50
    s_mul_i32 s96, s96, 171
    s_lshl_b32 s96, s96, 10
    s_add_u32 s99, s96, 35651584
    s_add_u32 s98, s99, 173056
    s_add_u32 s54, s54, 128
    s_lshl_b32 s54, s54, 10
    s_add_u32 s96, s99, s54
    s_add_u32 s54, s53, 29
    s_mul_i32 s55, s54, 205
    s_lshr_b32 s55, s55, 10
    s_mul_i32 s55, s55, 5
    s_sub_u32 s54, s54, s55
    s_lshl_b32 s100, s54, 15
    v_lshrrev_b32 v228, 4, v255
    v_and_b32 v229, 15, v255
    v_lshlrev_b32 v230, 1, v228
    v_xor_b32 v229, v229, v230
    v_mov_b32 v230, s50
    v_lshl_add_u32 v228, v230, 3, v228
    v_lshlrev_b32 v228, 10, v228
    s_lshl_b32 s54, s14, 8
    v_add_u32 v228, s54, v228
    v_lshl_add_u32 v214, v229, 4, v228
    v_xor_b32 v229, 8, v229
    v_lshl_add_u32 v215, v229, 4, v228
    v_add_u32 v215, 3072, v215
    s_and_b32 s54, s50, 1
    s_lshl_b32 s54, s54, 13
    s_lshr_b32 s55, s50, 2
    s_lshl_b32 s55, s55, 10
    s_add_u32 s54, s54, s55
    s_add_u32 s54, s54, s100
    v_add_u32 v216, s54, v254
    v_bfe_u32 v228, v255, 2, 3
    v_lshrrev_b32 v229, 5, v255
    v_lshl_add_u32 v229, v229, 4, v228
    v_lshlrev_b32 v229, 8, v229
    v_and_b32 v230, 3, v255
    v_lshl_add_u32 v229, v230, 3, v229
    s_lshl_b32 s55, s55, 3
    s_add_u32 s55, s55, 16384
    s_add_u32 s55, s55, s100
    v_add_u32 v229, s55, v229
    s_bfe_u32 s54, s50, 0x10001
    s_lshl_b32 s54, s54, 2
    v_xor_b32 v228, s54, v228
    v_xor_b32 v218, 0, v228
    v_lshl_add_u32 v218, v218, 5, v229
    v_xor_b32 v219, 1, v228
    v_lshl_add_u32 v219, v219, 5, v229
    v_xor_b32 v220, 2, v228
    v_lshl_add_u32 v220, v220, 5, v229
    v_xor_b32 v221, 3, v228
    v_lshl_add_u32 v221, v221, 5, v229
    v_and_b32 v228, 15, v255
    v_lshlrev_b32 v228, 10, v228
    v_lshrrev_b32 v229, 4, v255
    v_lshl_add_u32 v234, v229, 3, v228
    s_lshl_b32 s61, s13, 17
    s_and_b32 s54, s50, 1
    s_lshl_b32 s54, s54, 16
    s_add_u32 s61, s61, s54
    s_lshl_b32 s54, s15, 14
    s_add_u32 s61, s61, s54
    s_lshl_b32 s54, s14, 8
    s_add_u32 s61, s61, s54
    s_bfe_u32 s54, s50, 0x10001
    s_lshl_b32 s54, s54, 7
    s_add_u32 s61, s61, s54
    s_lshr_b32 s54, s50, 2
    s_lshl_b32 s54, s54, 6
    s_add_u32 s61, s61, s54
    v_add_u32 v234, s61, v234
    buffer_load_dwordx2 v[222:223], v234, s[32:35], 0 offen
    buffer_load_dwordx2 v[224:225], v234, s[32:35], 0 offen offset:32
    v_lshlrev_b32 v236, 2, v255
    s_mov_b32 s10, 0
    s_mov_b32 s9, 0
L_idle:
    s_cmp_gt_u32 s8, s53
    s_cbranch_scc1 L_p4
    s_waitcnt vmcnt(8)
    s_add_u32 s9, s9, 1
    s_cmp_lg_u32 s9, 2
    s_cbranch_scc1 L_nofl
    s_lshl_b32 s54, s52, 5
    s_add_u32 s54, s54, s48
    s_lshl_b32 s54, s54, 2
    s_add_u32 s54, s54, 58769408
    s_mov_b64 exec, 1
    buffer_store_dword v251, off, s[16:19], s54 sc1
    s_mov_b64 exec, -1
L_nofl:
    s_lshl_b32 s55, s13, 9
    s_add_u32 s55, s55, 58753024
    s_add_u32 s54, s8, 4
    s_cmp_le_u32 s54, s53
    s_cbranch_scc1 L_nopoll
    s_cmp_lg_u32 s10, 0
    s_cbranch_scc1 L_nopoll
    buffer_load_dword v237, v236, s[16:19], s55 offen sc1
    buffer_load_dword v238, v236, s[16:19], s55 offen offset:256 sc1
    s_mov_b32 s10, s8
L_nopoll:
    s_add_u32 s54, s8, 3
    s_cmp_gt_u32 s54, s53
    s_cbranch_scc1 L_idle_p4
    s_add_u32 m0, s5, s60
    s_min_u32 s6, s6, s11
    buffer_load_dwordx4 v254, s[16:19], s6 offen offset:0 lds
    buffer_load_dwordx4 v254, s[16:19], s6 offen offset:1024 lds
    buffer_load_dwordx4 v254, s[16:19], s6 offen offset:2048 lds
    buffer_load_dwordx4 v254, s[16:19], s6 offen offset:3072 lds
    s_add_u32 m0, m0, 16384
    s_add_u32 s6, s6, 16384
    buffer_load_dwordx4 v254, s[16:19], s7 offen offset:0 lds
    buffer_load_dwordx4 v254, s[16:19], s7 offen offset:1024 lds
    buffer_load_dwordx4 v254, s[16:19], s7 offen offset:2048 lds
    buffer_load_dwordx4 v254, s[16:19], s7 offen offset:3072 lds
    s_add_u32 s7, s7, 16384
    s_add_u32 s5, s5, 32768
    s_cmp_eq_u32 s5, 163840
    s_cselect_b32 s5, 0, s5
    s_branch L_idle_bar
L_idle_p4:
    s_cmp_lg_u32 s12, 0
    s_cbranch_scc1 L_idle_p4b
    s_cmp_lg_u32 s10, s8
    s_cbranch_scc1 L_pw
    s_waitcnt vmcnt(0)
L_pw:
    v_cmp_ne_u32 vcc, s51, v237
    s_cbranch_vccz L_ph0_ok
    s_mov_b32 s57, 0x40000
L_ph0:
    s_sleep 4
    buffer_load_dword v237, v236, s[16:19], s55 offen sc1
    s_waitcnt vmcnt(0)
    v_cmp_ne_u32 vcc, s51, v237
    s_sub_u32 s57, s57, 1
    s_cbranch_scc1 L_ph0_ok
    s_cbranch_vccnz L_ph0
L_ph0_ok:
    s_add_u32 s55, s55, 256
    v_cmp_ne_u32 vcc, s51, v238
    s_cbranch_vccz L_ph1_ok
    s_mov_b32 s57, 0x40000
L_ph1:
    s_sleep 4
    buffer_load_dword v238, v236, s[16:19], s55 offen sc1
    s_waitcnt vmcnt(0)
    v_cmp_ne_u32 vcc, s51, v238
    s_sub_u32 s57, s57, 1
    s_cbranch_scc1 L_ph1_ok
    s_cbranch_vccnz L_ph1
L_ph1_ok:
L_idle_p4b:
    s_min_u32 s96, s96, s98
    s_add_u32 m0, s59, s100
    s_add_u32 s56, s96, 700416
    buffer_load_dwordx4 v254, s[16:19], s96 offen lds
    buffer_load_dwordx4 v254, s[16:19], s96 offen offset:1024 lds
    s_add_u32 m0, m0, 8192
    s_add_u32 s96, s96, 2048
    buffer_load_dwordx4 v254, s[16:19], s56 offen lds
    buffer_load_dwordx4 v254, s[16:19], s56 offen offset:1024 lds
    s_add_u32 m0, m0, 8192
    s_add_u32 s56, s97, 32768
    buffer_load_dwordx4 v214, s[24:27], s97 offen lds
    buffer_load_dwordx4 v215, s[24:27], s97 offen offset:1024 lds
    s_add_u32 m0, m0, 8192
    s_add_u32 s97, s97, 65536
    buffer_load_dwordx4 v214, s[24:27], s56 offen lds
    buffer_load_dwordx4 v215, s[24:27], s56 offen offset:1024 lds
    s_add_u32 s100, s100, 32768
    s_cmp_eq_u32 s100, 163840
    s_cselect_b32 s100, 0, s100
    s_add_u32 s12, s12, 1
    s_add_u32 s54, s8, 3
    s_sub_u32 s54, s54, s53
    s_cmp_lt_u32 s12, s54
    s_cbranch_scc1 L_idle_p4b
L_idle_bar:
    s_barrier
    s_add_u32 s8, s8, 1
    s_branch L_idle
L_p4:
    s_add_u32 s54, s53, 29
    s_mul_i32 s55, s54, 205
    s_lshr_b32 s55, s55, 10
    s_mul_i32 s55, s55, 5
    s_sub_u32 s54, s54, s55
    s_lshl_b32 s4, s54, 15
    v_bfe_u32 v228, v255, 3, 2
    v_lshlrev_b32 v228, 7, v228
    v_and_b32 v229, 7, v255
    v_lshl_add_u32 v236, v229, 2, v228
    s_lshl_b32 s5, s13, 9
    s_lshl_b32 s54, s15, 5
    s_add_u32 s5, s5, s54
    s_add_u32 s5, s5, 58769408
    ds_read_b128 v[128:131], v216 offset:0
    ds_read_b64_tr_b16 v[160:161], v218 offset:0
    ds_read_b64_tr_b16 v[162:163], v218 offset:2048
    ds_read_b128 v[132:135], v216 offset:2048
    ds_read_b128 v[136:139], v216 offset:4096
    ds_read_b128 v[140:143], v216 offset:6144
    ds_read_b64_tr_b16 v[164:165], v219 offset:0
    ds_read_b64_tr_b16 v[166:167], v219 offset:2048
    ds_read_b64_tr_b16 v[168:169], v220 offset:0
    ds_read_b64_tr_b16 v[170:171], v220 offset:2048
    ds_read_b64_tr_b16 v[172:173], v221 offset:0
    ds_read_b64_tr_b16 v[174:175], v221 offset:2048
    s_waitcnt lgkmcnt(9)
    v_mfma_f32_16x16x32_bf16 v[0:3], v[160:163], v[128:131], 0
    s_min_u32 s96, s96, s98
    s_add_u32 m0, s59, s100
    s_add_u32 s56, s96, 700416
    s_waitcnt lgkmcnt(8)
    v_mfma_f32_16x16x32_bf16 v[4:7], v[160:163], v[132:135], 0
    buffer_load_dwordx4 v254, s[16:19], s96 offen lds
    s_waitcnt lgkmcnt(7)
    v_mfma_f32_16x16x32_bf16 v[8:11], v[160:163], v[136:139], 0
    buffer_load_dwordx4 v254, s[16:19], s96 offen offset:1024 lds
    s_add_u32 m0, m0, 8192
    s_add_u32 s96, s96, 2048
    buffer_load_dwordx4 v254, s[16:19], s56 offen lds
    buffer_load_dwordx4 v254, s[16:19], s56 offen offset:1024 lds
    s_add_u32 m0, m0, 8192
    s_add_u32 s56, s97, 32768
    buffer_load_dwordx4 v214, s[24:27], s97 offen lds
    buffer_load_dwordx4 v215, s[24:27], s97 offen offset:1024 lds
    s_add_u32 m0, m0, 8192
    s_add_u32 s97, s97, 65536
    buffer_load_dwordx4 v214, s[24:27], s56 offen lds
    buffer_load_dwordx4 v215, s[24:27], s56 offen offset:1024 lds
    s_add_u32 s100, s100, 32768
    s_cmp_eq_u32 s100, 163840
    s_cselect_b32 s100, 0, s100
    s_waitcnt vmcnt(16)
    s_barrier
    s_add_u32 s54, s4, 32768
    s_cmp_eq_u32 s54, 163840
    s_cselect_b32 s54, 0, s54
    s_sub_u32 s55, s54, s4
    s_mov_b32 s4, s54
    v_add_u32 v216, s55, v216
    v_add_u32 v218, s55, v218
    v_add_u32 v219, s55, v219
    v_add_u32 v220, s55, v220
    v_add_u32 v221, s55, v221
    buffer_load_dword v237, v236, s[16:19], s5 offen sc1
    ds_read_b128 v[144:147], v216 offset:0
    s_min_u32 s96, s96, s98
    s_add_u32 m0, s59, s100
    s_add_u32 s56, s96, 700416
    s_waitcnt lgkmcnt(7)
    v_mfma_f32_16x16x32_bf16 v[12:15], v[160:163], v[140:143], 0
    ds_read_b64_tr_b16 v[176:177], v218 offset:0
    buffer_load_dwordx4 v254, s[16:19], s96 offen lds
    s_waitcnt lgkmcnt(6)
    v_mfma_f32_16x16x32_bf16 v[16:19], v[164:167], v[128:131], 0
    ds_read_b64_tr_b16 v[178:179], v218 offset:2048
    buffer_load_dwordx4 v254, s[16:19], s96 offen offset:1024 lds
    v_mfma_f32_16x16x32_bf16 v[20:23], v[164:167], v[132:135], 0
    ds_read_b128 v[148:151], v216 offset:2048
    s_add_u32 m0, m0, 8192
    s_add_u32 s96, s96, 2048
    buffer_load_dwordx4 v254, s[16:19], s56 offen lds
    v_mfma_f32_16x16x32_bf16 v[24:27], v[164:167], v[136:139], 0
    ds_read_b128 v[152:155], v216 offset:4096
    buffer_load_dwordx4 v254, s[16:19], s56 offen offset:1024 lds
    v_mfma_f32_16x16x32_bf16 v[28:31], v[164:167], v[140:143], 0
    ds_read_b128 v[156:159], v216 offset:6144
    s_add_u32 m0, m0, 8192
    s_add_u32 s56, s97, 32768
    buffer_load_dwordx4 v214, s[24:27], s97 offen lds
    s_waitcnt lgkmcnt(8)
    v_mfma_f32_16x16x32_bf16 v[32:35], v[168:171], v[128:131], 0
    ds_read_b64_tr_b16 v[180:181], v219 offset:0
    buffer_load_dwordx4 v215, s[24:27], s97 offen offset:1024 lds
    v_mfma_f32_16x16x32_bf16 v[36:39], v[168:171], v[132:135], 0
    ds_read_b64_tr_b16 v[182:183], v219 offset:2048
    s_add_u32 m0, m0, 8192
    s_add_u32 s97, s97, 65536
    buffer_load_dwordx4 v214, s[24:27], s56 offen lds
    v_mfma_f32_16x16x32_bf16 v[40:43], v[168:171], v[136:139], 0
    ds_read_b64_tr_b16 v[184:185], v220 offset:0
    buffer_load_dwordx4 v215, s[24:27], s56 offen offset:1024 lds
    v_mfma_f32_16x16x32_bf16 v[44:47], v[168:171], v[140:143], 0
    ds_read_b64_tr_b16 v[186:187], v220 offset:2048
    s_add_u32 s100, s100, 32768
    s_cmp_eq_u32 s100, 163840
    s_cselect_b32 s100, 0, s100
    s_waitcnt lgkmcnt(10)
    v_mfma_f32_16x16x32_bf16 v[48:51], v[172:175], v[128:131], 0
    ds_read_b64_tr_b16 v[188:189], v221 offset:0
    v_mfma_f32_16x16x32_bf16 v[52:55], v[172:175], v[132:135], 0
    ds_read_b64_tr_b16 v[190:191], v221 offset:2048
    v_mfma_f32_16x16x32_bf16 v[56:59], v[172:175], v[136:139], 0
    v_mfma_f32_16x16x32_bf16 v[60:63], v[172:175], v[140:143], 0
    s_waitcnt lgkmcnt(9)
    v_mfma_f32_16x16x32_bf16 v[0:3], v[176:179], v[144:147], v[0:3]
    s_waitcnt lgkmcnt(8)
    v_mfma_f32_16x16x32_bf16 v[4:7], v[176:179], v[148:151], v[4:7]
    s_waitcnt lgkmcnt(7)
    v_mfma_f32_16x16x32_bf16 v[8:11], v[176:179], v[152:155], v[8:11]
    s_waitcnt vmcnt(17)
    s_barrier
    s_add_u32 s54, s4, 32768
    s_cmp_eq_u32 s54, 163840
    s_cselect_b32 s54, 0, s54
    s_sub_u32 s55, s54, s4
    s_mov_b32 s4, s54
    v_add_u32 v216, s55, v216
    v_add_u32 v218, s55, v218
    v_add_u32 v219, s55, v219
    v_add_u32 v220, s55, v220
    v_add_u32 v221, s55, v221
    ds_read_b128 v[128:131], v216 offset:0
    s_min_u32 s96, s96, s98
    s_add_u32 m0, s59, s100
    s_add_u32 s56, s96, 700416
    s_waitcnt lgkmcnt(7)
    v_mfma_f32_16x16x32_bf16 v[12:15], v[176:179], v[156:159], v[12:15]
    ds_read_b64_tr_b16 v[160:161], v218 offset:0
    buffer_load_dwordx4 v254, s[16:19], s96 offen lds
    s_waitcnt lgkmcnt(6)
    v_mfma_f32_16x16x32_bf16 v[16:19], v[180:183], v[144:147], v[16:19]
    ds_read_b64_tr_b16 v[162:163], v218 offset:2048
    buffer_load_dwordx4 v254, s[16:19], s96 offen offset:1024 lds
    v_mfma_f32_16x16x32_bf16 v[20:23], v[180:183], v[148:151], v[20:23]
    ds_read_b128 v[132:135], v216 offset:2048
    s_add_u32 m0, m0, 8192
    s_add_u32 s96, s96, 2048
    buffer_load_dwordx4 v254, s[16:19], s56 offen lds
    v_mfma_f32_16x16x32_bf16 v[24:27], v[180:183], v[152:155], v[24:27]
    ds_read_b128 v[136:139], v216 offset:4096
    buffer_load_dwordx4 v254, s[16:19], s56 offen offset:1024 lds
    v_mfma_f32_16x16x32_bf16 v[28:31], v[180:183], v[156:159], v[28:31]
    ds_read_b128 v[140:143], v216 offset:6144
    s_add_u32 m0, m0, 8192
    s_add_u32 s56, s97, 32768
    buffer_load_dwordx4 v214, s[24:27], s97 offen lds
    s_waitcnt lgkmcnt(8)
    v_mfma_f32_16x16x32_bf16 v[32:35], v[184:187], v[144:147], v[32:35]
    ds_read_b64_tr_b16 v[164:165], v219 offset:0
    buffer_load_dwordx4 v215, s[24:27], s97 offen offset:1024 lds
    v_mfma_f32_16x16x32_bf16 v[36:39], v[184:187], v[148:151], v[36:39]
    ds_read_b64_tr_b16 v[166:167], v219 offset:2048
    s_add_u32 m0, m0, 8192
    s_add_u32 s97, s97, 65536
    buffer_load_dwordx4 v214, s[24:27], s56 offen lds
    v_mfma_f32_16x16x32_bf16 v[40:43], v[184:187], v[152:155], v[40:43]
    ds_read_b64_tr_b16 v[168:169], v220 offset:0
    buffer_load_dwordx4 v215, s[24:27], s56 offen offset:1024 lds
    v_mfma_f32_16x16x32_bf16 v[44:47], v[184:187], v[156:159], v[44:47]
    ds_read_b64_tr_b16 v[170:171], v220 offset:2048
    s_add_u32 s100, s100, 32768
    s_cmp_eq_u32 s100, 163840
    s_cselect_b32 s100, 0, s100
    s_waitcnt lgkmcnt(10)
    v_mfma_f32_16x16x32_bf16 v[48:51], v[188:191], v[144:147], v[48:51]
    ds_read_b64_tr_b16 v[172:173], v221 offset:0
    v_mfma_f32_16x16x32_bf16 v[52:55], v[188:191], v[148:151], v[52:55]
    ds_read_b64_tr_b16 v[174:175], v221 offset:2048
    v_mfma_f32_16x16x32_bf16 v[56:59], v[188:191], v[152:155], v[56:59]
    v_mfma_f32_16x16x32_bf16 v[60:63], v[188:191], v[156:159], v[60:63]
    s_waitcnt lgkmcnt(9)
    v_mfma_f32_16x16x32_bf16 v[0:3], v[160:163], v[128:131], v[0:3]
    s_waitcnt lgkmcnt(8)
    v_mfma_f32_16x16x32_bf16 v[4:7], v[160:163], v[132:135], v[4:7]
    s_waitcnt lgkmcnt(7)
    v_mfma_f32_16x16x32_bf16 v[8:11], v[160:163], v[136:139], v[8:11]
    s_waitcnt vmcnt(17)
    s_barrier
    s_add_u32 s54, s4, 32768
    s_cmp_eq_u32 s54, 163840
    s_cselect_b32 s54, 0, s54
    s_sub_u32 s55, s54, s4
    s_mov_b32 s4, s54
    v_add_u32 v216, s55, v216
    v_add_u32 v218, s55, v218
    v_add_u32 v219, s55, v219
    v_add_u32 v220, s55, v220
    v_add_u32 v221, s55, v221
    s_waitcnt vmcnt(16)
    v_cmp_ne_u32 vcc, s51, v237
    s_cbranch_vccz L_pc_ok
    s_mov_b32 s57, 0x40000
L_pc:
    s_sleep 4
    buffer_load_dword v237, v236, s[16:19], s5 offen sc1
    s_waitcnt vmcnt(0)
    v_cmp_ne_u32 vcc, s51, v237
    s_sub_u32 s57, s57, 1
    s_cbranch_scc1 L_pc_ok
    s_cbranch_vccnz L_pc
L_pc_ok:
    ds_read_b128 v[144:147], v216 offset:0
    s_lshl_b32 s56, s15, 15
    s_add_u32 s96, s99, s56
    s_lshl_b32 s97, s15, 20
    s_waitcnt lgkmcnt(7)
    v_mfma_f32_16x16x32_bf16 v[12:15], v[160:163], v[140:143], v[12:15]
    ds_read_b64_tr_b16 v[176:177], v218 offset:0
    s_add_u32 m0, s59, s100
    s_add_u32 s56, s96, 700416
    buffer_load_dwordx4 v254, s[16:19], s96 offen lds
    s_waitcnt lgkmcnt(6)
    v_mfma_f32_16x16x32_bf16 v[16:19], v[164:167], v[128:131], v[16:19]
    ds_read_b64_tr_b16 v[178:179], v218 offset:2048
    buffer_load_dwordx4 v254, s[16:19], s96 offen offset:1024 lds
    v_mfma_f32_16x16x32_bf16 v[20:23], v[164:167], v[132:135], v[20:23]
    ds_read_b128 v[148:151], v216 offset:2048
    s_add_u32 m0, m0, 8192
    s_add_u32 s96, s96, 2048
    buffer_load_dwordx4 v254, s[16:19], s56 offen lds
    v_mfma_f32_16x16x32_bf16 v[24:27], v[164:167], v[136:139], v[24:27]
    ds_read_b128 v[152:155], v216 offset:4096
    buffer_load_dwordx4 v254, s[16:19], s56 offen offset:1024 lds
    v_mfma_f32_16x16x32_bf16 v[28:31], v[164:167], v[140:143], v[28:31]
    ds_read_b128 v[156:159], v216 offset:6144
    s_add_u32 m0, m0, 8192
    s_add_u32 s56, s97, 32768
    buffer_load_dwordx4 v214, s[20:23], s97 offen lds
    s_waitcnt lgkmcnt(8)
    v_mfma_f32_16x16x32_bf16 v[32:35], v[168:171], v[128:131], v[32:35]
    ds_read_b64_tr_b16 v[180:181], v219 offset:0
    buffer_load_dwordx4 v215, s[20:23], s97 offen offset:1024 lds
    v_mfma_f32_16x16x32_bf16 v[36:39], v[168:171], v[132:135], v[36:39]
    ds_read_b64_tr_b16 v[182:183], v219 offset:2048
    s_add_u32 m0, m0, 8192
    s_add_u32 s97, s97, 65536
    buffer_load_dwordx4 v214, s[20:23], s56 offen lds
    v_mfma_f32_16x16x32_bf16 v[40:43], v[168:171], v[136:139], v[40:43]
    ds_read_b64_tr_b16 v[184:185], v220 offset:0
    buffer_load_dwordx4 v215, s[20:23], s56 offen offset:1024 lds
    v_mfma_f32_16x16x32_bf16 v[44:47], v[168:171], v[140:143], v[44:47]
    ds_read_b64_tr_b16 v[186:187], v220 offset:2048
    s_add_u32 s100, s100, 32768
    s_cmp_eq_u32 s100, 163840
    s_cselect_b32 s100, 0, s100
    s_waitcnt lgkmcnt(10)
    v_mfma_f32_16x16x32_bf16 v[48:51], v[172:175], v[128:131], v[48:51]
    ds_read_b64_tr_b16 v[188:189], v221 offset:0
    v_mfma_f32_16x16x32_bf16 v[52:55], v[172:175], v[132:135], v[52:55]
    ds_read_b64_tr_b16 v[190:191], v221 offset:2048
    v_mfma_f32_16x16x32_bf16 v[56:59], v[172:175], v[136:139], v[56:59]
    v_mfma_f32_16x16x32_bf16 v[60:63], v[172:175], v[140:143], v[60:63]
    s_waitcnt lgkmcnt(9)
    v_mfma_f32_16x16x32_bf16 v[0:3], v[176:179], v[144:147], v[0:3]
    s_waitcnt lgkmcnt(8)
    v_mfma_f32_16x16x32_bf16 v[4:7], v[176:179], v[148:151], v[4:7]
    s_waitcnt lgkmcnt(7)
    v_mfma_f32_16x16x32_bf16 v[8:11], v[176:179], v[152:155], v[8:11]
    s_waitcnt vmcnt(16)
    s_barrier
    s_add_u32 s54, s4, 32768
    s_cmp_eq_u32 s54, 163840
    s_cselect_b32 s54, 0, s54
    s_sub_u32 s55, s54, s4
    s_mov_b32 s4, s54
    v_add_u32 v216, s55, v216
    v_add_u32 v218, s55, v218
    v_add_u32 v219, s55, v219
    v_add_u32 v220, s55, v220
    v_add_u32 v221, s55, v221
    ds_read_b128 v[128:131], v216 offset:0
    s_add_u32 m0, s59, s100
    s_add_u32 s56, s96, 700416
    buffer_load_dwordx4 v254, s[16:19], s96 offen lds
    s_waitcnt lgkmcnt(7)
    v_mfma_f32_16x16x32_bf16 v[12:15], v[176:179], v[156:159], v[12:15]
    ds_read_b64_tr_b16 v[160:161], v218 offset:0
    buffer_load_dwordx4 v254, s[16:19], s96 offen offset:1024 lds
    s_waitcnt lgkmcnt(6)
    v_mfma_f32_16x16x32_bf16 v[16:19], v[180:183], v[144:147], v[16:19]
    ds_read_b64_tr_b16 v[162:163], v218 offset:2048
    s_add_u32 m0, m0, 8192
    s_add_u32 s96, s96, 2048
    buffer_load_dwordx4 v254, s[16:19], s56 offen lds
    v_mfma_f32_16x16x32_bf16 v[20:23], v[180:183], v[148:151], v[20:23]
    ds_read_b128 v[132:135], v216 offset:2048
    buffer_load_dwordx4 v254, s[16:19], s56 offen offset:1024 lds
    v_mfma_f32_16x16x32_bf16 v[24:27], v[180:183], v[152:155], v[24:27]
    ds_read_b128 v[136:139], v216 offset:4096
    s_add_u32 m0, m0, 8192
    s_add_u32 s56, s97, 32768
    buffer_load_dwordx4 v214, s[20:23], s97 offen lds
    v_mfma_f32_16x16x32_bf16 v[28:31], v[180:183], v[156:159], v[28:31]
    ds_read_b128 v[140:143], v216 offset:6144
    buffer_load_dwordx4 v215, s[20:23], s97 offen offset:1024 lds
    s_waitcnt lgkmcnt(8)
    v_mfma_f32_16x16x32_bf16 v[32:35], v[184:187], v[144:147], v[32:35]
    ds_read_b64_tr_b16 v[164:165], v219 offset:0
    s_add_u32 m0, m0, 8192
    s_add_u32 s97, s97, 65536
    buffer_load_dwordx4 v214, s[20:23], s56 offen lds
    v_mfma_f32_16x16x32_bf16 v[36:39], v[184:187], v[148:151], v[36:39]
    ds_read_b64_tr_b16 v[166:167], v219 offset:2048
    buffer_load_dwordx4 v215, s[20:23], s56 offen offset:1024 lds
    v_mfma_f32_16x16x32_bf16 v[40:43], v[184:187], v[152:155], v[40:43]
    ds_read_b64_tr_b16 v[168:169], v220 offset:0
    s_add_u32 s100, s100, 32768
    s_cmp_eq_u32 s100, 163840
    s_cselect_b32 s100, 0, s100
    v_mfma_f32_16x16x32_bf16 v[44:47], v[184:187], v[156:159], v[44:47]
    ds_read_b64_tr_b16 v[170:171], v220 offset:2048
    s_waitcnt lgkmcnt(10)
    v_mfma_f32_16x16x32_bf16 v[48:51], v[188:191], v[144:147], v[48:51]
    ds_read_b64_tr_b16 v[172:173], v221 offset:0
    v_mfma_f32_16x16x32_bf16 v[52:55], v[188:191], v[148:151], v[52:55]
    ds_read_b64_tr_b16 v[174:175], v221 offset:2048
    v_mfma_f32_16x16x32_bf16 v[56:59], v[188:191], v[152:155], v[56:59]
    v_mfma_f32_16x16x32_bf16 v[60:63], v[188:191], v[156:159], v[60:63]
    s_waitcnt lgkmcnt(9)
    v_mfma_f32_16x16x32_bf16 v[0:3], v[160:163], v[128:131], v[0:3]
    s_waitcnt lgkmcnt(8)
    v_mfma_f32_16x16x32_bf16 v[4:7], v[160:163], v[132:135], v[4:7]
    s_waitcnt lgkmcnt(7)
    v_mfma_f32_16x16x32_bf16 v[8:11], v[160:163], v[136:139], v[8:11]
    s_waitcnt vmcnt(16)
    s_barrier
    s_add_u32 s54, s4, 32768
    s_cmp_eq_u32 s54, 163840
    s_cselect_b32 s54, 0, s54
    s_sub_u32 s55, s54, s4
    s_mov_b32 s4, s54
    v_add_u32 v216, s55, v216
    v_add_u32 v218, s55, v218
    v_add_u32 v219, s55, v219
    v_add_u32 v220, s55, v220
    v_add_u32 v221, s55, v221
    ds_read_b128 v[144:147], v216 offset:0
    s_add_u32 m0, s59, s100
    s_add_u32 s56, s96, 700416
    buffer_load_dwordx4 v254, s[16:19], s96 offen lds
    s_waitcnt lgkmcnt(7)
    v_mfma_f32_16x16x32_bf16 v[12:15], v[160:163], v[140:143], v[12:15]
    ds_read_b64_tr_b16 v[176:177], v218 offset:0
    buffer_load_dwordx4 v254, s[16:19], s96 offen offset:1024 lds
    s_waitcnt lgkmcnt(6)
    v_mfma_f32_16x16x32_bf16 v[16:19], v[164:167], v[128:131], v[16:19]
    ds_read_b64_tr_b16 v[178:179], v218 offset:2048
    s_add_u32 m0, m0, 8192
    s_add_u32 s96, s96, 2048
    buffer_load_dwordx4 v254, s[16:19], s56 offen lds
    v_mfma_f32_16x16x32_bf16 v[20:23], v[164:167], v[132:135], v[20:23]
    ds_read_b128 v[148:151], v216 offset:2048
    buffer_load_dwordx4 v254, s[16:19], s56 offen offset:1024 lds
    v_mfma_f32_16x16x32_bf16 v[24:27], v[164:167], v[136:139], v[24:27]
    ds_read_b128 v[152:155], v216 offset:4096
    s_add_u32 m0, m0, 8192
    s_add_u32 s56, s97, 32768
    buffer_load_dwordx4 v214, s[20:23], s97 offen lds
    v_mfma_f32_16x16x32_bf16 v[28:31], v[164:167], v[140:143], v[28:31]
    ds_read_b128 v[156:159], v216 offset:6144
    buffer_load_dwordx4 v215, s[20:23], s97 offen offset:1024 lds
    s_waitcnt lgkmcnt(8)
    v_mfma_f32_16x16x32_bf16 v[32:35], v[168:171], v[128:131], v[32:35]
    ds_read_b64_tr_b16 v[180:181], v219 offset:0
    s_add_u32 m0, m0, 8192
    s_add_u32 s97, s97, 65536
    buffer_load_dwordx4 v214, s[20:23], s56 offen lds
    v_mfma_f32_16x16x32_bf16 v[36:39], v[168:171], v[132:135], v[36:39]
    ds_read_b64_tr_b16 v[182:183], v219 offset:2048
    buffer_load_dwordx4 v215, s[20:23], s56 offen offset:1024 lds
    v_mfma_f32_16x16x32_bf16 v[40:43], v[168:171], v[136:139], v[40:43]
    ds_read_b64_tr_b16 v[184:185], v220 offset:0
    s_add_u32 s100, s100, 32768
    s_cmp_eq_u32 s100, 163840
    s_cselect_b32 s100, 0, s100
    v_mfma_f32_16x16x32_bf16 v[44:47], v[168:171], v[140:143], v[44:47]
    ds_read_b64_tr_b16 v[186:187], v220 offset:2048
    s_waitcnt lgkmcnt(10)
    v_mfma_f32_16x16x32_bf16 v[48:51], v[172:175], v[128:131], v[48:51]
    ds_read_b64_tr_b16 v[188:189], v221 offset:0
    v_mfma_f32_16x16x32_bf16 v[52:55], v[172:175], v[132:135], v[52:55]
    ds_read_b64_tr_b16 v[190:191], v221 offset:2048
    v_mfma_f32_16x16x32_bf16 v[56:59], v[172:175], v[136:139], v[56:59]
    v_mfma_f32_16x16x32_bf16 v[60:63], v[172:175], v[140:143], v[60:63]
    s_waitcnt lgkmcnt(9)
    v_mfma_f32_16x16x32_bf16 v[0:3], v[176:179], v[144:147], v[0:3]
    s_waitcnt lgkmcnt(8)
    v_mfma_f32_16x16x32_bf16 v[4:7], v[176:179], v[148:151], v[4:7]
    s_waitcnt lgkmcnt(7)
    v_mfma_f32_16x16x32_bf16 v[8:11], v[176:179], v[152:155], v[8:11]
    s_waitcnt vmcnt(16)
    s_barrier
    s_add_u32 s54, s4, 32768
    s_cmp_eq_u32 s54, 163840
    s_cselect_b32 s54, 0, s54
    s_sub_u32 s55, s54, s4
    s_mov_b32 s4, s54
    v_add_u32 v216, s55, v216
    v_add_u32 v218, s55, v218
    v_add_u32 v219, s55, v219
    v_add_u32 v220, s55, v220
    v_add_u32 v221, s55, v221
    ds_read_b128 v[128:131], v216 offset:0
    s_add_u32 m0, s59, s100
    s_add_u32 s56, s96, 700416
    buffer_load_dwordx4 v254, s[16:19], s96 offen lds
    s_waitcnt lgkmcnt(7)
    v_mfma_f32_16x16x32_bf16 v[12:15], v[176:179], v[156:159], v[12:15]
    ds_read_b64_tr_b16 v[160:161], v218 offset:0
    buffer_load_dwordx4 v254, s[16:19], s96 offen offset:1024 lds
    s_waitcnt lgkmcnt(6)
    v_mfma_f32_16x16x32_bf16 v[16:19], v[180:183], v[144:147], v[16:19]
    ds_read_b64_tr_b16 v[162:163], v218 offset:2048
    s_add_u32 m0, m0, 8192
    s_add_u32 s96, s96, 2048
    buffer_load_dwordx4 v254, s[16:19], s56 offen lds
    v_mfma_f32_16x16x32_bf16 v[20:23], v[180:183], v[148:151], v[20:23]
    ds_read_b128 v[132:135], v216 offset:2048
    buffer_load_dwordx4 v254, s[16:19], s56 offen offset:1024 lds
    v_mfma_f32_16x16x32_bf16 v[24:27], v[180:183], v[152:155], v[24:27]
    ds_read_b128 v[136:139], v216 offset:4096
    s_add_u32 m0, m0, 8192
    s_add_u32 s56, s97, 32768
    buffer_load_dwordx4 v214, s[20:23], s97 offen lds
    v_mfma_f32_16x16x32_bf16 v[28:31], v[180:183], v[156:159], v[28:31]
    ds_read_b128 v[140:143], v216 offset:6144
    buffer_load_dwordx4 v215, s[20:23], s97 offen offset:1024 lds
    s_waitcnt lgkmcnt(8)
    v_mfma_f32_16x16x32_bf16 v[32:35], v[184:187], v[144:147], v[32:35]
    ds_read_b64_tr_b16 v[164:165], v219 offset:0
    s_add_u32 m0, m0, 8192
    s_add_u32 s97, s97, 65536
    buffer_load_dwordx4 v214, s[20:23], s56 offen lds
    v_mfma_f32_16x16x32_bf16 v[36:39], v[184:187], v[148:151], v[36:39]
    ds_read_b64_tr_b16 v[166:167], v219 offset:2048
    buffer_load_dwordx4 v215, s[20:23], s56 offen offset:1024 lds
    v_mfma_f32_16x16x32_bf16 v[40:43], v[184:187], v[152:155], v[40:43]
    ds_read_b64_tr_b16 v[168:169], v220 offset:0
    s_add_u32 s100, s100, 32768
    s_cmp_eq_u32 s100, 163840
    s_cselect_b32 s100, 0, s100
    v_mfma_f32_16x16x32_bf16 v[44:47], v[184:187], v[156:159], v[44:47]
    ds_read_b64_tr_b16 v[170:171], v220 offset:2048
    s_waitcnt lgkmcnt(10)
    v_mfma_f32_16x16x32_bf16 v[48:51], v[188:191], v[144:147], v[48:51]
    ds_read_b64_tr_b16 v[172:173], v221 offset:0
    v_mfma_f32_16x16x32_bf16 v[52:55], v[188:191], v[148:151], v[52:55]
    ds_read_b64_tr_b16 v[174:175], v221 offset:2048
    v_mfma_f32_16x16x32_bf16 v[56:59], v[188:191], v[152:155], v[56:59]
    v_mfma_f32_16x16x32_bf16 v[60:63], v[188:191], v[156:159], v[60:63]
    s_waitcnt lgkmcnt(9)
    v_mfma_f32_16x16x32_bf16 v[0:3], v[160:163], v[128:131], v[0:3]
    s_waitcnt lgkmcnt(8)
    v_mfma_f32_16x16x32_bf16 v[4:7], v[160:163], v[132:135], v[4:7]
    s_waitcnt lgkmcnt(7)
    v_mfma_f32_16x16x32_bf16 v[8:11], v[160:163], v[136:139], v[8:11]
    s_waitcnt vmcnt(16)
    s_barrier
    s_add_u32 s54, s4, 32768
    s_cmp_eq_u32 s54, 163840
    s_cselect_b32 s54, 0, s54
    s_sub_u32 s55, s54, s4
    s_mov_b32 s4, s54
    v_add_u32 v216, s55, v216
    v_add_u32 v218, s55, v218
    v_add_u32 v219, s55, v219
    v_add_u32 v220, s55, v220
    v_add_u32 v221, s55, v221
    ds_read_b128 v[144:147], v216 offset:0
    s_add_u32 m0, s59, s100
    s_add_u32 s56, s96, 700416
    buffer_load_dwordx4 v254, s[16:19], s96 offen lds
    s_waitcnt lgkmcnt(7)
    v_mfma_f32_16x16x32_bf16 v[12:15], v[160:163], v[140:143], v[12:15]
    ds_read_b64_tr_b16 v[176:177], v218 offset:0
    buffer_load_dwordx4 v254, s[16:19], s96 offen offset:1024 lds
    s_waitcnt lgkmcnt(6)
    v_mfma_f32_16x16x32_bf16 v[16:19], v[164:167], v[128:131], v[16:19]
    ds_read_b64_tr_b16 v[178:179], v218 offset:2048
    s_add_u32 m0, m0, 8192
    s_add_u32 s96, s96, 2048
    buffer_load_dwordx4 v254, s[16:19], s56 offen lds
    v_mfma_f32_16x16x32_bf16 v[20:23], v[164:167], v[132:135], v[20:23]
    ds_read_b128 v[148:151], v216 offset:2048
    buffer_load_dwordx4 v254, s[16:19], s56 offen offset:1024 lds
    v_mfma_f32_16x16x32_bf16 v[24:27], v[164:167], v[136:139], v[24:27]
    ds_read_b128 v[152:155], v216 offset:4096
    s_add_u32 m0, m0, 8192
    s_add_u32 s56, s97, 32768
    buffer_load_dwordx4 v214, s[20:23], s97 offen lds
    v_mfma_f32_16x16x32_bf16 v[28:31], v[164:167], v[140:143], v[28:31]
    ds_read_b128 v[156:159], v216 offset:6144
    buffer_load_dwordx4 v215, s[20:23], s97 offen offset:1024 lds
    s_waitcnt lgkmcnt(8)
    v_mfma_f32_16x16x32_bf16 v[32:35], v[168:171], v[128:131], v[32:35]
    ds_read_b64_tr_b16 v[180:181], v219 offset:0
    s_add_u32 m0, m0, 8192
    s_add_u32 s97, s97, 65536
    buffer_load_dwordx4 v214, s[20:23], s56 offen lds
    v_mfma_f32_16x16x32_bf16 v[36:39], v[168:171], v[132:135], v[36:39]
    ds_read_b64_tr_b16 v[182:183], v219 offset:2048
    buffer_load_dwordx4 v215, s[20:23], s56 offen offset:1024 lds
    v_mfma_f32_16x16x32_bf16 v[40:43], v[168:171], v[136:139], v[40:43]
    ds_read_b64_tr_b16 v[184:185], v220 offset:0
    s_add_u32 s100, s100, 32768
    s_cmp_eq_u32 s100, 163840
    s_cselect_b32 s100, 0, s100
    v_mfma_f32_16x16x32_bf16 v[44:47], v[168:171], v[140:143], v[44:47]
    ds_read_b64_tr_b16 v[186:187], v220 offset:2048
    s_waitcnt lgkmcnt(10)
    v_mfma_f32_16x16x32_bf16 v[48:51], v[172:175], v[128:131], v[48:51]
    ds_read_b64_tr_b16 v[188:189], v221 offset:0
    v_mfma_f32_16x16x32_bf16 v[52:55], v[172:175], v[132:135], v[52:55]
    ds_read_b64_tr_b16 v[190:191], v221 offset:2048
    v_mfma_f32_16x16x32_bf16 v[56:59], v[172:175], v[136:139], v[56:59]
    v_mfma_f32_16x16x32_bf16 v[60:63], v[172:175], v[140:143], v[60:63]
    s_waitcnt lgkmcnt(9)
    v_mfma_f32_16x16x32_bf16 v[0:3], v[176:179], v[144:147], v[0:3]
    s_waitcnt lgkmcnt(8)
    v_mfma_f32_16x16x32_bf16 v[4:7], v[176:179], v[148:151], v[4:7]
    s_waitcnt lgkmcnt(7)
    v_mfma_f32_16x16x32_bf16 v[8:11], v[176:179], v[152:155], v[8:11]
    s_waitcnt vmcnt(16)
    s_barrier
    s_add_u32 s54, s4, 32768
    s_cmp_eq_u32 s54, 163840
    s_cselect_b32 s54, 0, s54
    s_sub_u32 s55, s54, s4
    s_mov_b32 s4, s54
    v_add_u32 v216, s55, v216
    v_add_u32 v218, s55, v218
    v_add_u32 v219, s55, v219
    v_add_u32 v220, s55, v220
    v_add_u32 v221, s55, v221
    ds_read_b128 v[128:131], v216 offset:0
    s_add_u32 m0, s59, s100
    s_add_u32 s56, s96, 700416
    buffer_load_dwordx4 v254, s[16:19], s96 offen lds
    s_waitcnt lgkmcnt(7)
    v_mfma_f32_16x16x32_bf16 v[12:15], v[176:179], v[156:159], v[12:15]
    ds_read_b64_tr_b16 v[160:161], v218 offset:0
    buffer_load_dwordx4 v254, s[16:19], s96 offen offset:1024 lds
    s_waitcnt lgkmcnt(6)
    v_mfma_f32_16x16x32_bf16 v[16:19], v[180:183], v[144:147], v[16:19]
    ds_read_b64_tr_b16 v[162:163], v218 offset:2048
    s_add_u32 m0, m0, 8192
    s_add_u32 s96, s96, 2048
    buffer_load_dwordx4 v254, s[16:19], s56 offen lds
    v_mfma_f32_16x16x32_bf16 v[20:23], v[180:183], v[148:151], v[20:23]
    ds_read_b128 v[132:135], v216 offset:2048
    buffer_load_dwordx4 v254, s[16:19], s56 offen offset:1024 lds
    v_mfma_f32_16x16x32_bf16 v[24:27], v[180:183], v[152:155], v[24:27]
    ds_read_b128 v[136:139], v216 offset:4096
    s_add_u32 m0, m0, 8192
    s_add_u32 s56, s97, 32768
    buffer_load_dwordx4 v214, s[20:23], s97 offen lds
    v_mfma_f32_16x16x32_bf16 v[28:31], v[180:183], v[156:159], v[28:31]
    ds_read_b128 v[140:143], v216 offset:6144
    buffer_load_dwordx4 v215, s[20:23], s97 offen offset:1024 lds
    s_waitcnt lgkmcnt(8)
    v_mfma_f32_16x16x32_bf16 v[32:35], v[184:187], v[144:147], v[32:35]
    ds_read_b64_tr_b16 v[164:165], v219 offset:0
    s_add_u32 m0, m0, 8192
    s_add_u32 s97, s97, 65536
    buffer_load_dwordx4 v214, s[20:23], s56 offen lds
    v_mfma_f32_16x16x32_bf16 v[36:39], v[184:187], v[148:151], v[36:39]
    ds_read_b64_tr_b16 v[166:167], v219 offset:2048
    buffer_load_dwordx4 v215, s[20:23], s56 offen offset:1024 lds
    v_mfma_f32_16x16x32_bf16 v[40:43], v[184:187], v[152:155], v[40:43]
    ds_read_b64_tr_b16 v[168:169], v220 offset:0
    s_add_u32 s100, s100, 32768
    s_cmp_eq_u32 s100, 163840
    s_cselect_b32 s100, 0, s100
    v_mfma_f32_16x16x32_bf16 v[44:47], v[184:187], v[156:159], v[44:47]
    ds_read_b64_tr_b16 v[170:171], v220 offset:2048
    s_waitcnt lgkmcnt(10)
    v_mfma_f32_16x16x32_bf16 v[48:51], v[188:191], v[144:147], v[48:51]
    ds_read_b64_tr_b16 v[172:173], v221 offset:0
    v_mfma_f32_16x16x32_bf16 v[52:55], v[188:191], v[148:151], v[52:55]
    ds_read_b64_tr_b16 v[174:175], v221 offset:2048
    v_mfma_f32_16x16x32_bf16 v[56:59], v[188:191], v[152:155], v[56:59]
    v_mfma_f32_16x16x32_bf16 v[60:63], v[188:191], v[156:159], v[60:63]
    s_waitcnt lgkmcnt(9)
    v_mfma_f32_16x16x32_bf16 v[0:3], v[160:163], v[128:131], v[0:3]
    s_waitcnt lgkmcnt(8)
    v_mfma_f32_16x16x32_bf16 v[4:7], v[160:163], v[132:135], v[4:7]
    s_waitcnt lgkmcnt(7)
    v_mfma_f32_16x16x32_bf16 v[8:11], v[160:163], v[136:139], v[8:11]
    s_waitcnt vmcnt(16)
    s_barrier
    s_add_u32 s54, s4, 32768
    s_cmp_eq_u32 s54, 163840
    s_cselect_b32 s54, 0, s54
    s_sub_u32 s55, s54, s4
    s_mov_b32 s4, s54
    v_add_u32 v216, s55, v216
    v_add_u32 v218, s55, v218
    v_add_u32 v219, s55, v219
    v_add_u32 v220, s55, v220
    v_add_u32 v221, s55, v221
    ds_read_b128 v[144:147], v216 offset:0
    s_add_u32 m0, s59, s100
    s_add_u32 s56, s96, 700416
    buffer_load_dwordx4 v254, s[16:19], s96 offen lds
    s_waitcnt lgkmcnt(7)
    v_mfma_f32_16x16x32_bf16 v[12:15], v[160:163], v[140:143], v[12:15]
    ds_read_b64_tr_b16 v[176:177], v218 offset:0
    buffer_load_dwordx4 v254, s[16:19], s96 offen offset:1024 lds
    s_waitcnt lgkmcnt(6)
    v_mfma_f32_16x16x32_bf16 v[16:19], v[164:167], v[128:131], v[16:19]
    ds_read_b64_tr_b16 v[178:179], v218 offset:2048
    s_add_u32 m0, m0, 8192
    s_add_u32 s96, s96, 2048
    buffer_load_dwordx4 v254, s[16:19], s56 offen lds
    v_mfma_f32_16x16x32_bf16 v[20:23], v[164:167], v[132:135], v[20:23]
    ds_read_b128 v[148:151], v216 offset:2048
    buffer_load_dwordx4 v254, s[16:19], s56 offen offset:1024 lds
    v_mfma_f32_16x16x32_bf16 v[24:27], v[164:167], v[136:139], v[24:27]
    ds_read_b128 v[152:155], v216 offset:4096
    s_add_u32 m0, m0, 8192
    s_add_u32 s56, s97, 32768
    buffer_load_dwordx4 v214, s[20:23], s97 offen lds
    v_mfma_f32_16x16x32_bf16 v[28:31], v[164:167], v[140:143], v[28:31]
    ds_read_b128 v[156:159], v216 offset:6144
    buffer_load_dwordx4 v215, s[20:23], s97 offen offset:1024 lds
    s_waitcnt lgkmcnt(8)
    v_mfma_f32_16x16x32_bf16 v[32:35], v[168:171], v[128:131], v[32:35]
    ds_read_b64_tr_b16 v[180:181], v219 offset:0
    s_add_u32 m0, m0, 8192
    s_add_u32 s97, s97, 65536
    buffer_load_dwordx4 v214, s[20:23], s56 offen lds
    v_mfma_f32_16x16x32_bf16 v[36:39], v[168:171], v[132:135], v[36:39]
    ds_read_b64_tr_b16 v[182:183], v219 offset:2048
    buffer_load_dwordx4 v215, s[20:23], s56 offen offset:1024 lds
    v_mfma_f32_16x16x32_bf16 v[40:43], v[168:171], v[136:139], v[40:43]
    ds_read_b64_tr_b16 v[184:185], v220 offset:0
    s_add_u32 s100, s100, 32768
    s_cmp_eq_u32 s100, 163840
    s_cselect_b32 s100, 0, s100
    v_mfma_f32_16x16x32_bf16 v[44:47], v[168:171], v[140:143], v[44:47]
    ds_read_b64_tr_b16 v[186:187], v220 offset:2048
    s_waitcnt lgkmcnt(10)
    v_mfma_f32_16x16x32_bf16 v[48:51], v[172:175], v[128:131], v[48:51]
    ds_read_b64_tr_b16 v[188:189], v221 offset:0
    v_mfma_f32_16x16x32_bf16 v[52:55], v[172:175], v[132:135], v[52:55]
    ds_read_b64_tr_b16 v[190:191], v221 offset:2048
    v_mfma_f32_16x16x32_bf16 v[56:59], v[172:175], v[136:139], v[56:59]
    v_mfma_f32_16x16x32_bf16 v[60:63], v[172:175], v[140:143], v[60:63]
    s_waitcnt lgkmcnt(9)
    v_mfma_f32_16x16x32_bf16 v[0:3], v[176:179], v[144:147], v[0:3]
    s_waitcnt lgkmcnt(8)
    v_mfma_f32_16x16x32_bf16 v[4:7], v[176:179], v[148:151], v[4:7]
    s_waitcnt lgkmcnt(7)
    v_mfma_f32_16x16x32_bf16 v[8:11], v[176:179], v[152:155], v[8:11]
    s_waitcnt vmcnt(16)
    s_barrier
    s_add_u32 s54, s4, 32768
    s_cmp_eq_u32 s54, 163840
    s_cselect_b32 s54, 0, s54
    s_sub_u32 s55, s54, s4
    s_mov_b32 s4, s54
    v_add_u32 v216, s55, v216
    v_add_u32 v218, s55, v218
    v_add_u32 v219, s55, v219
    v_add_u32 v220, s55, v220
    v_add_u32 v221, s55, v221
    ds_read_b128 v[128:131], v216 offset:0
    s_add_u32 m0, s59, s100
    s_add_u32 s56, s96, 700416
    buffer_load_dwordx4 v254, s[16:19], s96 offen lds
    s_waitcnt lgkmcnt(7)
    v_mfma_f32_16x16x32_bf16 v[12:15], v[176:179], v[156:159], v[12:15]
    ds_read_b64_tr_b16 v[160:161], v218 offset:0
    buffer_load_dwordx4 v254, s[16:19], s96 offen offset:1024 lds
    s_waitcnt lgkmcnt(6)
    v_mfma_f32_16x16x32_bf16 v[16:19], v[180:183], v[144:147], v[16:19]
    ds_read_b64_tr_b16 v[162:163], v218 offset:2048
    s_add_u32 m0, m0, 8192
    s_add_u32 s96, s96, 2048
    buffer_load_dwordx4 v254, s[16:19], s56 offen lds
    v_mfma_f32_16x16x32_bf16 v[20:23], v[180:183], v[148:151], v[20:23]
    ds_read_b128 v[132:135], v216 offset:2048
    buffer_load_dwordx4 v254, s[16:19], s56 offen offset:1024 lds
    v_mfma_f32_16x16x32_bf16 v[24:27], v[180:183], v[152:155], v[24:27]
    ds_read_b128 v[136:139], v216 offset:4096
    s_add_u32 m0, m0, 8192
    s_add_u32 s56, s97, 32768
    buffer_load_dwordx4 v214, s[20:23], s97 offen lds
    v_mfma_f32_16x16x32_bf16 v[28:31], v[180:183], v[156:159], v[28:31]
    ds_read_b128 v[140:143], v216 offset:6144
    buffer_load_dwordx4 v215, s[20:23], s97 offen offset:1024 lds
    s_waitcnt lgkmcnt(8)
    v_mfma_f32_16x16x32_bf16 v[32:35], v[184:187], v[144:147], v[32:35]
    ds_read_b64_tr_b16 v[164:165], v219 offset:0
    s_add_u32 m0, m0, 8192
    s_add_u32 s97, s97, 65536
    buffer_load_dwordx4 v214, s[20:23], s56 offen lds
    v_mfma_f32_16x16x32_bf16 v[36:39], v[184:187], v[148:151], v[36:39]
    ds_read_b64_tr_b16 v[166:167], v219 offset:2048
    buffer_load_dwordx4 v215, s[20:23], s56 offen offset:1024 lds
    v_mfma_f32_16x16x32_bf16 v[40:43], v[184:187], v[152:155], v[40:43]
    ds_read_b64_tr_b16 v[168:169], v220 offset:0
    s_add_u32 s100, s100, 32768
    s_cmp_eq_u32 s100, 163840
    s_cselect_b32 s100, 0, s100
    v_mfma_f32_16x16x32_bf16 v[44:47], v[184:187], v[156:159], v[44:47]
    ds_read_b64_tr_b16 v[170:171], v220 offset:2048
    s_waitcnt lgkmcnt(10)
    v_mfma_f32_16x16x32_bf16 v[48:51], v[188:191], v[144:147], v[48:51]
    ds_read_b64_tr_b16 v[172:173], v221 offset:0
    v_mfma_f32_16x16x32_bf16 v[52:55], v[188:191], v[148:151], v[52:55]
    ds_read_b64_tr_b16 v[174:175], v221 offset:2048
    v_mfma_f32_16x16x32_bf16 v[56:59], v[188:191], v[152:155], v[56:59]
    v_mfma_f32_16x16x32_bf16 v[60:63], v[188:191], v[156:159], v[60:63]
    s_waitcnt lgkmcnt(9)
    v_mfma_f32_16x16x32_bf16 v[0:3], v[160:163], v[128:131], v[0:3]
    s_waitcnt lgkmcnt(8)
    v_mfma_f32_16x16x32_bf16 v[4:7], v[160:163], v[132:135], v[4:7]
    s_waitcnt lgkmcnt(7)
    v_mfma_f32_16x16x32_bf16 v[8:11], v[160:163], v[136:139], v[8:11]
    s_waitcnt vmcnt(16)
    s_barrier
    s_add_u32 s54, s4, 32768
    s_cmp_eq_u32 s54, 163840
    s_cselect_b32 s54, 0, s54
    s_sub_u32 s55, s54, s4
    s_mov_b32 s4, s54
    v_add_u32 v216, s55, v216
    v_add_u32 v218, s55, v218
    v_add_u32 v219, s55, v219
    v_add_u32 v220, s55, v220
    v_add_u32 v221, s55, v221
    ds_read_b128 v[144:147], v216 offset:0
    s_add_u32 m0, s59, s100
    s_add_u32 s56, s96, 700416
    buffer_load_dwordx4 v254, s[16:19], s96 offen lds
    s_waitcnt lgkmcnt(7)
    v_mfma_f32_16x16x32_bf16 v[12:15], v[160:163], v[140:143], v[12:15]
    ds_read_b64_tr_b16 v[176:177], v218 offset:0
    buffer_load_dwordx4 v254, s[16:19], s96 offen offset:1024 lds
    s_waitcnt lgkmcnt(6)
    v_mfma_f32_16x16x32_bf16 v[16:19], v[164:167], v[128:131], v[16:19]
    ds_read_b64_tr_b16 v[178:179], v218 offset:2048
    s_add_u32 m0, m0, 8192
    s_add_u32 s96, s96, 2048
    buffer_load_dwordx4 v254, s[16:19], s56 offen lds
    v_mfma_f32_16x16x32_bf16 v[20:23], v[164:167], v[132:135], v[20:23]
    ds_read_b128 v[148:151], v216 offset:2048
    buffer_load_dwordx4 v254, s[16:19], s56 offen offset:1024 lds
    v_mfma_f32_16x16x32_bf16 v[24:27], v[164:167], v[136:139], v[24:27]
    ds_read_b128 v[152:155], v216 offset:4096
    s_add_u32 m0, m0, 8192
    s_add_u32 s56, s97, 32768
    buffer_load_dwordx4 v214, s[20:23], s97 offen lds
    v_mfma_f32_16x16x32_bf16 v[28:31], v[164:167], v[140:143], v[28:31]
    ds_read_b128 v[156:159], v216 offset:6144
    buffer_load_dwordx4 v215, s[20:23], s97 offen offset:1024 lds
    s_waitcnt lgkmcnt(8)
    v_mfma_f32_16x16x32_bf16 v[32:35], v[168:171], v[128:131], v[32:35]
    ds_read_b64_tr_b16 v[180:181], v219 offset:0
    s_add_u32 m0, m0, 8192
    s_add_u32 s97, s97, 65536
    buffer_load_dwordx4 v214, s[20:23], s56 offen lds
    v_mfma_f32_16x16x32_bf16 v[36:39], v[168:171], v[132:135], v[36:39]
    ds_read_b64_tr_b16 v[182:183], v219 offset:2048
    buffer_load_dwordx4 v215, s[20:23], s56 offen offset:1024 lds
    v_mfma_f32_16x16x32_bf16 v[40:43], v[168:171], v[136:139], v[40:43]
    ds_read_b64_tr_b16 v[184:185], v220 offset:0
    s_add_u32 s100, s100, 32768
    s_cmp_eq_u32 s100, 163840
    s_cselect_b32 s100, 0, s100
    v_mfma_f32_16x16x32_bf16 v[44:47], v[168:171], v[140:143], v[44:47]
    ds_read_b64_tr_b16 v[186:187], v220 offset:2048
    s_waitcnt lgkmcnt(10)
    v_mfma_f32_16x16x32_bf16 v[48:51], v[172:175], v[128:131], v[48:51]
    ds_read_b64_tr_b16 v[188:189], v221 offset:0
    v_mfma_f32_16x16x32_bf16 v[52:55], v[172:175], v[132:135], v[52:55]
    ds_read_b64_tr_b16 v[190:191], v221 offset:2048
    v_mfma_f32_16x16x32_bf16 v[56:59], v[172:175], v[136:139], v[56:59]
    v_mfma_f32_16x16x32_bf16 v[60:63], v[172:175], v[140:143], v[60:63]
    s_waitcnt lgkmcnt(9)
    v_mfma_f32_16x16x32_bf16 v[0:3], v[176:179], v[144:147], v[0:3]
    s_waitcnt lgkmcnt(8)
    v_mfma_f32_16x16x32_bf16 v[4:7], v[176:179], v[148:151], v[4:7]
    s_waitcnt lgkmcnt(7)
    v_mfma_f32_16x16x32_bf16 v[8:11], v[176:179], v[152:155], v[8:11]
    s_waitcnt vmcnt(16)
    s_barrier
    s_add_u32 s54, s4, 32768
    s_cmp_eq_u32 s54, 163840
    s_cselect_b32 s54, 0, s54
    s_sub_u32 s55, s54, s4
    s_mov_b32 s4, s54
    v_add_u32 v216, s55, v216
    v_add_u32 v218, s55, v218
    v_add_u32 v219, s55, v219
    v_add_u32 v220, s55, v220
    v_add_u32 v221, s55, v221
    ds_read_b128 v[128:131], v216 offset:0
    s_add_u32 m0, s59, s100
    s_add_u32 s56, s96, 700416
    buffer_load_dwordx4 v254, s[16:19], s96 offen lds
    s_waitcnt lgkmcnt(7)
    v_mfma_f32_16x16x32_bf16 v[12:15], v[176:179], v[156:159], v[12:15]
    ds_read_b64_tr_b16 v[160:161], v218 offset:0
    buffer_load_dwordx4 v254, s[16:19], s96 offen offset:1024 lds
    s_waitcnt lgkmcnt(6)
    v_mfma_f32_16x16x32_bf16 v[16:19], v[180:183], v[144:147], v[16:19]
    ds_read_b64_tr_b16 v[162:163], v218 offset:2048
    s_add_u32 m0, m0, 8192
    s_add_u32 s96, s96, 2048
    buffer_load_dwordx4 v254, s[16:19], s56 offen lds
    v_mfma_f32_16x16x32_bf16 v[20:23], v[180:183], v[148:151], v[20:23]
    ds_read_b128 v[132:135], v216 offset:2048
    buffer_load_dwordx4 v254, s[16:19], s56 offen offset:1024 lds
    v_mfma_f32_16x16x32_bf16 v[24:27], v[180:183], v[152:155], v[24:27]
    ds_read_b128 v[136:139], v216 offset:4096
    s_add_u32 m0, m0, 8192
    s_add_u32 s56, s97, 32768
    buffer_load_dwordx4 v214, s[20:23], s97 offen lds
    v_mfma_f32_16x16x32_bf16 v[28:31], v[180:183], v[156:159], v[28:31]
    ds_read_b128 v[140:143], v216 offset:6144
    buffer_load_dwordx4 v215, s[20:23], s97 offen offset:1024 lds
    s_waitcnt lgkmcnt(8)
    v_mfma_f32_16x16x32_bf16 v[32:35], v[184:187], v[144:147], v[32:35]
    ds_read_b64_tr_b16 v[164:165], v219 offset:0
    s_add_u32 m0, m0, 8192
    s_add_u32 s97, s97, 65536
    buffer_load_dwordx4 v214, s[20:23], s56 offen lds
    v_mfma_f32_16x16x32_bf16 v[36:39], v[184:187], v[148:151], v[36:39]
    ds_read_b64_tr_b16 v[166:167], v219 offset:2048
    buffer_load_dwordx4 v215, s[20:23], s56 offen offset:1024 lds
    v_mfma_f32_16x16x32_bf16 v[40:43], v[184:187], v[152:155], v[40:43]
    ds_read_b64_tr_b16 v[168:169], v220 offset:0
    s_add_u32 s100, s100, 32768
    s_cmp_eq_u32 s100, 163840
    s_cselect_b32 s100, 0, s100
    v_mfma_f32_16x16x32_bf16 v[44:47], v[184:187], v[156:159], v[44:47]
    ds_read_b64_tr_b16 v[170:171], v220 offset:2048
    s_waitcnt lgkmcnt(10)
    v_mfma_f32_16x16x32_bf16 v[48:51], v[188:191], v[144:147], v[48:51]
    ds_read_b64_tr_b16 v[172:173], v221 offset:0
    v_mfma_f32_16x16x32_bf16 v[52:55], v[188:191], v[148:151], v[52:55]
    ds_read_b64_tr_b16 v[174:175], v221 offset:2048
    v_mfma_f32_16x16x32_bf16 v[56:59], v[188:191], v[152:155], v[56:59]
    v_mfma_f32_16x16x32_bf16 v[60:63], v[188:191], v[156:159], v[60:63]
    s_waitcnt lgkmcnt(9)
    v_mfma_f32_16x16x32_bf16 v[0:3], v[160:163], v[128:131], v[0:3]
    s_waitcnt lgkmcnt(8)
    v_mfma_f32_16x16x32_bf16 v[4:7], v[160:163], v[132:135], v[4:7]
    s_waitcnt lgkmcnt(7)
    v_mfma_f32_16x16x32_bf16 v[8:11], v[160:163], v[136:139], v[8:11]
    s_waitcnt vmcnt(16)
    s_barrier
    s_add_u32 s54, s4, 32768
    s_cmp_eq_u32 s54, 163840
    s_cselect_b32 s54, 0, s54
    s_sub_u32 s55, s54, s4
    s_mov_b32 s4, s54
    v_add_u32 v216, s55, v216
    v_add_u32 v218, s55, v218
    v_add_u32 v219, s55, v219
    v_add_u32 v220, s55, v220
    v_add_u32 v221, s55, v221
    ds_read_b128 v[144:147], v216 offset:0
    s_add_u32 m0, s59, s100
    s_add_u32 s56, s96, 700416
    buffer_load_dwordx4 v254, s[16:19], s96 offen lds
    s_waitcnt lgkmcnt(7)
    v_mfma_f32_16x16x32_bf16 v[12:15], v[160:163], v[140:143], v[12:15]
    ds_read_b64_tr_b16 v[176:177], v218 offset:0
    buffer_load_dwordx4 v254, s[16:19], s96 offen offset:1024 lds
    s_waitcnt lgkmcnt(6)
    v_mfma_f32_16x16x32_bf16 v[16:19], v[164:167], v[128:131], v[16:19]
    ds_read_b64_tr_b16 v[178:179], v218 offset:2048
    s_add_u32 m0, m0, 8192
    s_add_u32 s96, s96, 2048
    buffer_load_dwordx4 v254, s[16:19], s56 offen lds
    v_mfma_f32_16x16x32_bf16 v[20:23], v[164:167], v[132:135], v[20:23]
    ds_read_b128 v[148:151], v216 offset:2048
    buffer_load_dwordx4 v254, s[16:19], s56 offen offset:1024 lds
    v_mfma_f32_16x16x32_bf16 v[24:27], v[164:167], v[136:139], v[24:27]
    ds_read_b128 v[152:155], v216 offset:4096
    s_add_u32 m0, m0, 8192
    s_add_u32 s56, s97, 32768
    buffer_load_dwordx4 v214, s[20:23], s97 offen lds
    v_mfma_f32_16x16x32_bf16 v[28:31], v[164:167], v[140:143], v[28:31]
    ds_read_b128 v[156:159], v216 offset:6144
    buffer_load_dwordx4 v215, s[20:23], s97 offen offset:1024 lds
    s_waitcnt lgkmcnt(8)
    v_mfma_f32_16x16x32_bf16 v[32:35], v[168:171], v[128:131], v[32:35]
    ds_read_b64_tr_b16 v[180:181], v219 offset:0
    s_add_u32 m0, m0, 8192
    s_add_u32 s97, s97, 65536
    buffer_load_dwordx4 v214, s[20:23], s56 offen lds
    v_mfma_f32_16x16x32_bf16 v[36:39], v[168:171], v[132:135], v[36:39]
    ds_read_b64_tr_b16 v[182:183], v219 offset:2048
    buffer_load_dwordx4 v215, s[20:23], s56 offen offset:1024 lds
    v_mfma_f32_16x16x32_bf16 v[40:43], v[168:171], v[136:139], v[40:43]
    ds_read_b64_tr_b16 v[184:185], v220 offset:0
    s_add_u32 s100, s100, 32768
    s_cmp_eq_u32 s100, 163840
    s_cselect_b32 s100, 0, s100
    v_mfma_f32_16x16x32_bf16 v[44:47], v[168:171], v[140:143], v[44:47]
    ds_read_b64_tr_b16 v[186:187], v220 offset:2048
    s_waitcnt lgkmcnt(10)
    v_mfma_f32_16x16x32_bf16 v[48:51], v[172:175], v[128:131], v[48:51]
    ds_read_b64_tr_b16 v[188:189], v221 offset:0
    v_mfma_f32_16x16x32_bf16 v[52:55], v[172:175], v[132:135], v[52:55]
    ds_read_b64_tr_b16 v[190:191], v221 offset:2048
    v_mfma_f32_16x16x32_bf16 v[56:59], v[172:175], v[136:139], v[56:59]
    v_mfma_f32_16x16x32_bf16 v[60:63], v[172:175], v[140:143], v[60:63]
    s_waitcnt lgkmcnt(9)
    v_mfma_f32_16x16x32_bf16 v[0:3], v[176:179], v[144:147], v[0:3]
    s_waitcnt lgkmcnt(8)
    v_mfma_f32_16x16x32_bf16 v[4:7], v[176:179], v[148:151], v[4:7]
    s_waitcnt lgkmcnt(7)
    v_mfma_f32_16x16x32_bf16 v[8:11], v[176:179], v[152:155], v[8:11]
    s_waitcnt vmcnt(16)
    s_barrier
    s_add_u32 s54, s4, 32768
    s_cmp_eq_u32 s54, 163840
    s_cselect_b32 s54, 0, s54
    s_sub_u32 s55, s54, s4
    s_mov_b32 s4, s54
    v_add_u32 v216, s55, v216
    v_add_u32 v218, s55, v218
    v_add_u32 v219, s55, v219
    v_add_u32 v220, s55, v220
    v_add_u32 v221, s55, v221
    ds_read_b128 v[128:131], v216 offset:0
    s_add_u32 m0, s59, s100
    s_add_u32 s56, s96, 700416
    buffer_load_dwordx4 v254, s[16:19], s96 offen lds
    s_waitcnt lgkmcnt(7)
    v_mfma_f32_16x16x32_bf16 v[12:15], v[176:179], v[156:159], v[12:15]
    ds_read_b64_tr_b16 v[160:161], v218 offset:0
    buffer_load_dwordx4 v254, s[16:19], s96 offen offset:1024 lds
    s_waitcnt lgkmcnt(6)
    v_mfma_f32_16x16x32_bf16 v[16:19], v[180:183], v[144:147], v[16:19]
    ds_read_b64_tr_b16 v[162:163], v218 offset:2048
    s_add_u32 m0, m0, 8192
    s_add_u32 s96, s96, 2048
    buffer_load_dwordx4 v254, s[16:19], s56 offen lds
    v_mfma_f32_16x16x32_bf16 v[20:23], v[180:183], v[148:151], v[20:23]
    ds_read_b128 v[132:135], v216 offset:2048
    buffer_load_dwordx4 v254, s[16:19], s56 offen offset:1024 lds
    v_mfma_f32_16x16x32_bf16 v[24:27], v[180:183], v[152:155], v[24:27]
    ds_read_b128 v[136:139], v216 offset:4096
    s_add_u32 m0, m0, 8192
    s_add_u32 s56, s97, 32768
    buffer_load_dwordx4 v214, s[20:23], s97 offen lds
    v_mfma_f32_16x16x32_bf16 v[28:31], v[180:183], v[156:159], v[28:31]
    ds_read_b128 v[140:143], v216 offset:6144
    buffer_load_dwordx4 v215, s[20:23], s97 offen offset:1024 lds
    s_waitcnt lgkmcnt(8)
    v_mfma_f32_16x16x32_bf16 v[32:35], v[184:187], v[144:147], v[32:35]
    ds_read_b64_tr_b16 v[164:165], v219 offset:0
    s_add_u32 m0, m0, 8192
    s_add_u32 s97, s97, 65536
    buffer_load_dwordx4 v214, s[20:23], s56 offen lds
    v_mfma_f32_16x16x32_bf16 v[36:39], v[184:187], v[148:151], v[36:39]
    ds_read_b64_tr_b16 v[166:167], v219 offset:2048
    buffer_load_dwordx4 v215, s[20:23], s56 offen offset:1024 lds
    v_mfma_f32_16x16x32_bf16 v[40:43], v[184:187], v[152:155], v[40:43]
    ds_read_b64_tr_b16 v[168:169], v220 offset:0
    s_add_u32 s100, s100, 32768
    s_cmp_eq_u32 s100, 163840
    s_cselect_b32 s100, 0, s100
    v_mfma_f32_16x16x32_bf16 v[44:47], v[184:187], v[156:159], v[44:47]
    ds_read_b64_tr_b16 v[170:171], v220 offset:2048
    s_waitcnt lgkmcnt(10)
    v_mfma_f32_16x16x32_bf16 v[48:51], v[188:191], v[144:147], v[48:51]
    ds_read_b64_tr_b16 v[172:173], v221 offset:0
    v_mfma_f32_16x16x32_bf16 v[52:55], v[188:191], v[148:151], v[52:55]
    ds_read_b64_tr_b16 v[174:175], v221 offset:2048
    v_mfma_f32_16x16x32_bf16 v[56:59], v[188:191], v[152:155], v[56:59]
    v_mfma_f32_16x16x32_bf16 v[60:63], v[188:191], v[156:159], v[60:63]
    s_waitcnt lgkmcnt(9)
    v_mfma_f32_16x16x32_bf16 v[0:3], v[160:163], v[128:131], v[0:3]
    s_waitcnt lgkmcnt(8)
    v_mfma_f32_16x16x32_bf16 v[4:7], v[160:163], v[132:135], v[4:7]
    s_waitcnt lgkmcnt(7)
    v_mfma_f32_16x16x32_bf16 v[8:11], v[160:163], v[136:139], v[8:11]
    s_waitcnt vmcnt(16)
    s_barrier
    s_add_u32 s54, s4, 32768
    s_cmp_eq_u32 s54, 163840
    s_cselect_b32 s54, 0, s54
    s_sub_u32 s55, s54, s4
    s_mov_b32 s4, s54
    v_add_u32 v216, s55, v216
    v_add_u32 v218, s55, v218
    v_add_u32 v219, s55, v219
    v_add_u32 v220, s55, v220
    v_add_u32 v221, s55, v221
    ds_read_b128 v[144:147], v216 offset:0
    s_add_u32 m0, s59, s100
    s_add_u32 s56, s96, 700416
    buffer_load_dwordx4 v254, s[16:19], s96 offen lds
    s_waitcnt lgkmcnt(7)
    v_mfma_f32_16x16x32_bf16 v[12:15], v[160:163], v[140:143], v[12:15]
    ds_read_b64_tr_b16 v[176:177], v218 offset:0
    buffer_load_dwordx4 v254, s[16:19], s96 offen offset:1024 lds
    s_waitcnt lgkmcnt(6)
    v_mfma_f32_16x16x32_bf16 v[16:19], v[164:167], v[128:131], v[16:19]
    ds_read_b64_tr_b16 v[178:179], v218 offset:2048
    s_add_u32 m0, m0, 8192
    s_add_u32 s96, s96, 2048
    buffer_load_dwordx4 v254, s[16:19], s56 offen lds
    v_mfma_f32_16x16x32_bf16 v[20:23], v[164:167], v[132:135], v[20:23]
    ds_read_b128 v[148:151], v216 offset:2048
    buffer_load_dwordx4 v254, s[16:19], s56 offen offset:1024 lds
    v_mfma_f32_16x16x32_bf16 v[24:27], v[164:167], v[136:139], v[24:27]
    ds_read_b128 v[152:155], v216 offset:4096
    s_add_u32 m0, m0, 8192
    s_add_u32 s56, s97, 32768
    buffer_load_dwordx4 v214, s[20:23], s97 offen lds
    v_mfma_f32_16x16x32_bf16 v[28:31], v[164:167], v[140:143], v[28:31]
    ds_read_b128 v[156:159], v216 offset:6144
    buffer_load_dwordx4 v215, s[20:23], s97 offen offset:1024 lds
    s_waitcnt lgkmcnt(8)
    v_mfma_f32_16x16x32_bf16 v[32:35], v[168:171], v[128:131], v[32:35]
    ds_read_b64_tr_b16 v[180:181], v219 offset:0
    s_add_u32 m0, m0, 8192
    s_add_u32 s97, s97, 65536
    buffer_load_dwordx4 v214, s[20:23], s56 offen lds
    v_mfma_f32_16x16x32_bf16 v[36:39], v[168:171], v[132:135], v[36:39]
    ds_read_b64_tr_b16 v[182:183], v219 offset:2048
    buffer_load_dwordx4 v215, s[20:23], s56 offen offset:1024 lds
    v_mfma_f32_16x16x32_bf16 v[40:43], v[168:171], v[136:139], v[40:43]
    ds_read_b64_tr_b16 v[184:185], v220 offset:0
    s_add_u32 s100, s100, 32768
    s_cmp_eq_u32 s100, 163840
    s_cselect_b32 s100, 0, s100
    v_mfma_f32_16x16x32_bf16 v[44:47], v[168:171], v[140:143], v[44:47]
    ds_read_b64_tr_b16 v[186:187], v220 offset:2048
    s_waitcnt lgkmcnt(10)
    v_mfma_f32_16x16x32_bf16 v[48:51], v[172:175], v[128:131], v[48:51]
    ds_read_b64_tr_b16 v[188:189], v221 offset:0
    v_mfma_f32_16x16x32_bf16 v[52:55], v[172:175], v[132:135], v[52:55]
    ds_read_b64_tr_b16 v[190:191], v221 offset:2048
    v_mfma_f32_16x16x32_bf16 v[56:59], v[172:175], v[136:139], v[56:59]
    v_mfma_f32_16x16x32_bf16 v[60:63], v[172:175], v[140:143], v[60:63]
    s_waitcnt lgkmcnt(9)
    v_mfma_f32_16x16x32_bf16 v[0:3], v[176:179], v[144:147], v[0:3]
    s_waitcnt lgkmcnt(8)
    v_mfma_f32_16x16x32_bf16 v[4:7], v[176:179], v[148:151], v[4:7]
    s_waitcnt lgkmcnt(7)
    v_mfma_f32_16x16x32_bf16 v[8:11], v[176:179], v[152:155], v[8:11]
    s_waitcnt vmcnt(16)
    s_barrier
    s_add_u32 s54, s4, 32768
    s_cmp_eq_u32 s54, 163840
    s_cselect_b32 s54, 0, s54
    s_sub_u32 s55, s54, s4
    s_mov_b32 s4, s54
    v_add_u32 v216, s55, v216
    v_add_u32 v218, s55, v218
    v_add_u32 v219, s55, v219
    v_add_u32 v220, s55, v220
    v_add_u32 v221, s55, v221
    ds_read_b128 v[128:131], v216 offset:0
    s_add_u32 m0, s59, s100
    s_add_u32 s56, s96, 700416
    buffer_load_dwordx4 v254, s[16:19], s96 offen lds
    s_waitcnt lgkmcnt(7)
    v_mfma_f32_16x16x32_bf16 v[12:15], v[176:179], v[156:159], v[12:15]
    ds_read_b64_tr_b16 v[160:161], v218 offset:0
    buffer_load_dwordx4 v254, s[16:19], s96 offen offset:1024 lds
    s_waitcnt lgkmcnt(6)
    v_mfma_f32_16x16x32_bf16 v[16:19], v[180:183], v[144:147], v[16:19]
    ds_read_b64_tr_b16 v[162:163], v218 offset:2048
    s_add_u32 m0, m0, 8192
    s_add_u32 s96, s96, 2048
    buffer_load_dwordx4 v254, s[16:19], s56 offen lds
    v_mfma_f32_16x16x32_bf16 v[20:23], v[180:183], v[148:151], v[20:23]
    ds_read_b128 v[132:135], v216 offset:2048
    buffer_load_dwordx4 v254, s[16:19], s56 offen offset:1024 lds
    v_mfma_f32_16x16x32_bf16 v[24:27], v[180:183], v[152:155], v[24:27]
    ds_read_b128 v[136:139], v216 offset:4096
    s_add_u32 m0, m0, 8192
    s_add_u32 s56, s97, 32768
    buffer_load_dwordx4 v214, s[20:23], s97 offen lds
    v_mfma_f32_16x16x32_bf16 v[28:31], v[180:183], v[156:159], v[28:31]
    ds_read_b128 v[140:143], v216 offset:6144
    buffer_load_dwordx4 v215, s[20:23], s97 offen offset:1024 lds
    s_waitcnt lgkmcnt(8)
    v_mfma_f32_16x16x32_bf16 v[32:35], v[184:187], v[144:147], v[32:35]
    ds_read_b64_tr_b16 v[164:165], v219 offset:0
    s_add_u32 m0, m0, 8192
    s_add_u32 s97, s97, 65536
    buffer_load_dwordx4 v214, s[20:23], s56 offen lds
    v_mfma_f32_16x16x32_bf16 v[36:39], v[184:187], v[148:151], v[36:39]
    ds_read_b64_tr_b16 v[166:167], v219 offset:2048
    buffer_load_dwordx4 v215, s[20:23], s56 offen offset:1024 lds
    v_mfma_f32_16x16x32_bf16 v[40:43], v[184:187], v[152:155], v[40:43]
    ds_read_b64_tr_b16 v[168:169], v220 offset:0
    s_add_u32 s100, s100, 32768
    s_cmp_eq_u32 s100, 163840
    s_cselect_b32 s100, 0, s100
    v_mfma_f32_16x16x32_bf16 v[44:47], v[184:187], v[156:159], v[44:47]
    ds_read_b64_tr_b16 v[170:171], v220 offset:2048
    s_waitcnt lgkmcnt(10)
    v_mfma_f32_16x16x32_bf16 v[48:51], v[188:191], v[144:147], v[48:51]
    ds_read_b64_tr_b16 v[172:173], v221 offset:0
    v_mfma_f32_16x16x32_bf16 v[52:55], v[188:191], v[148:151], v[52:55]
    ds_read_b64_tr_b16 v[174:175], v221 offset:2048
    v_mfma_f32_16x16x32_bf16 v[56:59], v[188:191], v[152:155], v[56:59]
    v_mfma_f32_16x16x32_bf16 v[60:63], v[188:191], v[156:159], v[60:63]
    s_waitcnt lgkmcnt(9)
    v_mfma_f32_16x16x32_bf16 v[0:3], v[160:163], v[128:131], v[0:3]
    s_waitcnt lgkmcnt(8)
    v_mfma_f32_16x16x32_bf16 v[4:7], v[160:163], v[132:135], v[4:7]
    s_waitcnt lgkmcnt(7)
    v_mfma_f32_16x16x32_bf16 v[8:11], v[160:163], v[136:139], v[8:11]
    s_waitcnt vmcnt(16)
    s_barrier
    s_add_u32 s54, s4, 32768
    s_cmp_eq_u32 s54, 163840
    s_cselect_b32 s54, 0, s54
    s_sub_u32 s55, s54, s4
    s_mov_b32 s4, s54
    v_add_u32 v216, s55, v216
    v_add_u32 v218, s55, v218
    v_add_u32 v219, s55, v219
    v_add_u32 v220, s55, v220
    v_add_u32 v221, s55, v221
    ds_read_b128 v[144:147], v216 offset:0
    s_add_u32 m0, s59, s100
    s_add_u32 s56, s96, 700416
    buffer_load_dwordx4 v254, s[16:19], s96 offen lds
    s_waitcnt lgkmcnt(7)
    v_mfma_f32_16x16x32_bf16 v[12:15], v[160:163], v[140:143], v[12:15]
    ds_read_b64_tr_b16 v[176:177], v218 offset:0
    buffer_load_dwordx4 v254, s[16:19], s96 offen offset:1024 lds
    s_waitcnt lgkmcnt(6)
    v_mfma_f32_16x16x32_bf16 v[16:19], v[164:167], v[128:131], v[16:19]
    ds_read_b64_tr_b16 v[178:179], v218 offset:2048
    s_add_u32 m0, m0, 8192
    s_add_u32 s96, s96, 2048
    buffer_load_dwordx4 v254, s[16:19], s56 offen lds
    v_mfma_f32_16x16x32_bf16 v[20:23], v[164:167], v[132:135], v[20:23]
    ds_read_b128 v[148:151], v216 offset:2048
    buffer_load_dwordx4 v254, s[16:19], s56 offen offset:1024 lds
    v_mfma_f32_16x16x32_bf16 v[24:27], v[164:167], v[136:139], v[24:27]
    ds_read_b128 v[152:155], v216 offset:4096
    s_add_u32 m0, m0, 8192
    s_add_u32 s56, s97, 32768
    buffer_load_dwordx4 v214, s[20:23], s97 offen lds
    v_mfma_f32_16x16x32_bf16 v[28:31], v[164:167], v[140:143], v[28:31]
    ds_read_b128 v[156:159], v216 offset:6144
    buffer_load_dwordx4 v215, s[20:23], s97 offen offset:1024 lds
    s_waitcnt lgkmcnt(8)
    v_mfma_f32_16x16x32_bf16 v[32:35], v[168:171], v[128:131], v[32:35]
    ds_read_b64_tr_b16 v[180:181], v219 offset:0
    s_add_u32 m0, m0, 8192
    s_add_u32 s97, s97, 65536
    buffer_load_dwordx4 v214, s[20:23], s56 offen lds
    v_mfma_f32_16x16x32_bf16 v[36:39], v[168:171], v[132:135], v[36:39]
    ds_read_b64_tr_b16 v[182:183], v219 offset:2048
    buffer_load_dwordx4 v215, s[20:23], s56 offen offset:1024 lds
    v_mfma_f32_16x16x32_bf16 v[40:43], v[168:171], v[136:139], v[40:43]
    ds_read_b64_tr_b16 v[184:185], v220 offset:0
    s_add_u32 s100, s100, 32768
    s_cmp_eq_u32 s100, 163840
    s_cselect_b32 s100, 0, s100
    v_mfma_f32_16x16x32_bf16 v[44:47], v[168:171], v[140:143], v[44:47]
    ds_read_b64_tr_b16 v[186:187], v220 offset:2048
    s_waitcnt lgkmcnt(10)
    v_mfma_f32_16x16x32_bf16 v[48:51], v[172:175], v[128:131], v[48:51]
    ds_read_b64_tr_b16 v[188:189], v221 offset:0
    v_mfma_f32_16x16x32_bf16 v[52:55], v[172:175], v[132:135], v[52:55]
    ds_read_b64_tr_b16 v[190:191], v221 offset:2048
    v_mfma_f32_16x16x32_bf16 v[56:59], v[172:175], v[136:139], v[56:59]
    v_mfma_f32_16x16x32_bf16 v[60:63], v[172:175], v[140:143], v[60:63]
    s_waitcnt lgkmcnt(9)
    v_mfma_f32_16x16x32_bf16 v[0:3], v[176:179], v[144:147], v[0:3]
    s_waitcnt lgkmcnt(8)
    v_mfma_f32_16x16x32_bf16 v[4:7], v[176:179], v[148:151], v[4:7]
    s_waitcnt lgkmcnt(7)
    v_mfma_f32_16x16x32_bf16 v[8:11], v[176:179], v[152:155], v[8:11]
    s_waitcnt vmcnt(16)
    s_barrier
    s_add_u32 s54, s4, 32768
    s_cmp_eq_u32 s54, 163840
    s_cselect_b32 s54, 0, s54
    s_sub_u32 s55, s54, s4
    s_mov_b32 s4, s54
    v_add_u32 v216, s55, v216
    v_add_u32 v218, s55, v218
    v_add_u32 v219, s55, v219
    v_add_u32 v220, s55, v220
    v_add_u32 v221, s55, v221
    ds_read_b128 v[128:131], v216 offset:0
    s_add_u32 m0, s59, s100
    s_add_u32 s56, s96, 700416
    buffer_load_dwordx4 v254, s[16:19], s96 offen lds
    s_waitcnt lgkmcnt(7)
    v_mfma_f32_16x16x32_bf16 v[12:15], v[176:179], v[156:159], v[12:15]
    ds_read_b64_tr_b16 v[160:161], v218 offset:0
    buffer_load_dwordx4 v254, s[16:19], s96 offen offset:1024 lds
    s_waitcnt lgkmcnt(6)
    v_mfma_f32_16x16x32_bf16 v[16:19], v[180:183], v[144:147], v[16:19]
    ds_read_b64_tr_b16 v[162:163], v218 offset:2048
    s_add_u32 m0, m0, 8192
    s_add_u32 s96, s96, 2048
    buffer_load_dwordx4 v254, s[16:19], s56 offen lds
    v_mfma_f32_16x16x32_bf16 v[20:23], v[180:183], v[148:151], v[20:23]
    ds_read_b128 v[132:135], v216 offset:2048
    buffer_load_dwordx4 v254, s[16:19], s56 offen offset:1024 lds
    v_mfma_f32_16x16x32_bf16 v[24:27], v[180:183], v[152:155], v[24:27]
    ds_read_b128 v[136:139], v216 offset:4096
    s_add_u32 m0, m0, 8192
    s_add_u32 s56, s97, 32768
    buffer_load_dwordx4 v214, s[20:23], s97 offen lds
    v_mfma_f32_16x16x32_bf16 v[28:31], v[180:183], v[156:159], v[28:31]
    ds_read_b128 v[140:143], v216 offset:6144
    buffer_load_dwordx4 v215, s[20:23], s97 offen offset:1024 lds
    s_waitcnt lgkmcnt(8)
    v_mfma_f32_16x16x32_bf16 v[32:35], v[184:187], v[144:147], v[32:35]
    ds_read_b64_tr_b16 v[164:165], v219 offset:0
    s_add_u32 m0, m0, 8192
    s_add_u32 s97, s97, 65536
    buffer_load_dwordx4 v214, s[20:23], s56 offen lds
    v_mfma_f32_16x16x32_bf16 v[36:39], v[184:187], v[148:151], v[36:39]
    ds_read_b64_tr_b16 v[166:167], v219 offset:2048
    buffer_load_dwordx4 v215, s[20:23], s56 offen offset:1024 lds
    v_mfma_f32_16x16x32_bf16 v[40:43], v[184:187], v[152:155], v[40:43]
    ds_read_b64_tr_b16 v[168:169], v220 offset:0
    s_add_u32 s100, s100, 32768
    s_cmp_eq_u32 s100, 163840
    s_cselect_b32 s100, 0, s100
    v_mfma_f32_16x16x32_bf16 v[44:47], v[184:187], v[156:159], v[44:47]
    ds_read_b64_tr_b16 v[170:171], v220 offset:2048
    s_waitcnt lgkmcnt(10)
    v_mfma_f32_16x16x32_bf16 v[48:51], v[188:191], v[144:147], v[48:51]
    ds_read_b64_tr_b16 v[172:173], v221 offset:0
    v_mfma_f32_16x16x32_bf16 v[52:55], v[188:191], v[148:151], v[52:55]
    ds_read_b64_tr_b16 v[174:175], v221 offset:2048
    v_mfma_f32_16x16x32_bf16 v[56:59], v[188:191], v[152:155], v[56:59]
    v_mfma_f32_16x16x32_bf16 v[60:63], v[188:191], v[156:159], v[60:63]
    s_waitcnt lgkmcnt(9)
    v_mfma_f32_16x16x32_bf16 v[0:3], v[160:163], v[128:131], v[0:3]
    s_waitcnt lgkmcnt(8)
    v_mfma_f32_16x16x32_bf16 v[4:7], v[160:163], v[132:135], v[4:7]
    s_waitcnt lgkmcnt(7)
    v_mfma_f32_16x16x32_bf16 v[8:11], v[160:163], v[136:139], v[8:11]
    s_waitcnt vmcnt(16)
    s_barrier
    s_add_u32 s54, s4, 32768
    s_cmp_eq_u32 s54, 163840
    s_cselect_b32 s54, 0, s54
    s_sub_u32 s55, s54, s4
    s_mov_b32 s4, s54
    v_add_u32 v216, s55, v216
    v_add_u32 v218, s55, v218
    v_add_u32 v219, s55, v219
    v_add_u32 v220, s55, v220
    v_add_u32 v221, s55, v221
    ds_read_b128 v[144:147], v216 offset:0
    s_waitcnt lgkmcnt(7)
    v_mfma_f32_16x16x32_bf16 v[12:15], v[160:163], v[140:143], v[12:15]
    ds_read_b64_tr_b16 v[176:177], v218 offset:0
    s_waitcnt lgkmcnt(6)
    v_mfma_f32_16x16x32_bf16 v[16:19], v[164:167], v[128:131], v[16:19]
    ds_read_b64_tr_b16 v[178:179], v218 offset:2048
    v_mfma_f32_16x16x32_bf16 v[20:23], v[164:167], v[132:135], v[20:23]
    ds_read_b128 v[148:151], v216 offset:2048
    v_mfma_f32_16x16x32_bf16 v[24:27], v[164:167], v[136:139], v[24:27]
    ds_read_b128 v[152:155], v216 offset:4096
    v_mfma_f32_16x16x32_bf16 v[28:31], v[164:167], v[140:143], v[28:31]
    ds_read_b128 v[156:159], v216 offset:6144
    s_waitcnt lgkmcnt(8)
    v_mfma_f32_16x16x32_bf16 v[32:35], v[168:171], v[128:131], v[32:35]
    ds_read_b64_tr_b16 v[180:181], v219 offset:0
    v_mfma_f32_16x16x32_bf16 v[36:39], v[168:171], v[132:135], v[36:39]
    ds_read_b64_tr_b16 v[182:183], v219 offset:2048
    v_mfma_f32_16x16x32_bf16 v[40:43], v[168:171], v[136:139], v[40:43]
    ds_read_b64_tr_b16 v[184:185], v220 offset:0
    v_mfma_f32_16x16x32_bf16 v[44:47], v[168:171], v[140:143], v[44:47]
    ds_read_b64_tr_b16 v[186:187], v220 offset:2048
    s_waitcnt lgkmcnt(10)
    v_mfma_f32_16x16x32_bf16 v[48:51], v[172:175], v[128:131], v[48:51]
    ds_read_b64_tr_b16 v[188:189], v221 offset:0
    v_mfma_f32_16x16x32_bf16 v[52:55], v[172:175], v[132:135], v[52:55]
    ds_read_b64_tr_b16 v[190:191], v221 offset:2048
    v_mfma_f32_16x16x32_bf16 v[56:59], v[172:175], v[136:139], v[56:59]
    v_mfma_f32_16x16x32_bf16 v[60:63], v[172:175], v[140:143], v[60:63]
    s_waitcnt lgkmcnt(9)
    v_mfma_f32_16x16x32_bf16 v[0:3], v[176:179], v[144:147], v[0:3]
    s_waitcnt lgkmcnt(8)
    v_mfma_f32_16x16x32_bf16 v[4:7], v[176:179], v[148:151], v[4:7]
    s_waitcnt lgkmcnt(7)
    v_mfma_f32_16x16x32_bf16 v[8:11], v[176:179], v[152:155], v[8:11]
    s_waitcnt vmcnt(8)
    s_barrier
    s_add_u32 s54, s4, 32768
    s_cmp_eq_u32 s54, 163840
    s_cselect_b32 s54, 0, s54
    s_sub_u32 s55, s54, s4
    s_mov_b32 s4, s54
    v_add_u32 v216, s55, v216
    v_add_u32 v218, s55, v218
    v_add_u32 v219, s55, v219
    v_add_u32 v220, s55, v220
    v_add_u32 v221, s55, v221
    ds_read_b128 v[128:131], v216 offset:0
    s_waitcnt lgkmcnt(7)
    v_mfma_f32_16x16x32_bf16 v[12:15], v[176:179], v[156:159], v[12:15]
    ds_read_b64_tr_b16 v[160:161], v218 offset:0
    s_waitcnt lgkmcnt(6)
    v_mfma_f32_16x16x32_bf16 v[16:19], v[180:183], v[144:147], v[16:19]
    ds_read_b64_tr_b16 v[162:163], v218 offset:2048
    v_mfma_f32_16x16x32_bf16 v[20:23], v[180:183], v[148:151], v[20:23]
    ds_read_b128 v[132:135], v216 offset:2048
    v_mfma_f32_16x16x32_bf16 v[24:27], v[180:183], v[152:155], v[24:27]
    ds_read_b128 v[136:139], v216 offset:4096
    v_mfma_f32_16x16x32_bf16 v[28:31], v[180:183], v[156:159], v[28:31]
    ds_read_b128 v[140:143], v216 offset:6144
    s_waitcnt lgkmcnt(8)
    v_mfma_f32_16x16x32_bf16 v[32:35], v[184:187], v[144:147], v[32:35]
    ds_read_b64_tr_b16 v[164:165], v219 offset:0
    v_mfma_f32_16x16x32_bf16 v[36:39], v[184:187], v[148:151], v[36:39]
    ds_read_b64_tr_b16 v[166:167], v219 offset:2048
    v_mfma_f32_16x16x32_bf16 v[40:43], v[184:187], v[152:155], v[40:43]
    ds_read_b64_tr_b16 v[168:169], v220 offset:0
    v_mfma_f32_16x16x32_bf16 v[44:47], v[184:187], v[156:159], v[44:47]
    ds_read_b64_tr_b16 v[170:171], v220 offset:2048
    s_waitcnt lgkmcnt(10)
    v_mfma_f32_16x16x32_bf16 v[48:51], v[188:191], v[144:147], v[48:51]
    ds_read_b64_tr_b16 v[172:173], v221 offset:0
    v_mfma_f32_16x16x32_bf16 v[52:55], v[188:191], v[148:151], v[52:55]
    ds_read_b64_tr_b16 v[174:175], v221 offset:2048
    v_mfma_f32_16x16x32_bf16 v[56:59], v[188:191], v[152:155], v[56:59]
    v_mfma_f32_16x16x32_bf16 v[60:63], v[188:191], v[156:159], v[60:63]
    s_waitcnt lgkmcnt(9)
    v_mfma_f32_16x16x32_bf16 v[0:3], v[160:163], v[128:131], v[0:3]
    s_waitcnt lgkmcnt(8)
    v_mfma_f32_16x16x32_bf16 v[4:7], v[160:163], v[132:135], v[4:7]
    s_waitcnt lgkmcnt(7)
    v_mfma_f32_16x16x32_bf16 v[8:11], v[160:163], v[136:139], v[8:11]
    s_waitcnt vmcnt(0)
    s_barrier
    s_add_u32 s54, s4, 32768
    s_cmp_eq_u32 s54, 163840
    s_cselect_b32 s54, 0, s54
    s_sub_u32 s55, s54, s4
    s_mov_b32 s4, s54
    v_add_u32 v216, s55, v216
    v_add_u32 v218, s55, v218
    v_add_u32 v219, s55, v219
    v_add_u32 v220, s55, v220
    v_add_u32 v221, s55, v221
    ds_read_b128 v[144:147], v216 offset:0
    s_waitcnt lgkmcnt(7)
    v_mfma_f32_16x16x32_bf16 v[12:15], v[160:163], v[140:143], v[12:15]
    ds_read_b64_tr_b16 v[176:177], v218 offset:0
    s_waitcnt lgkmcnt(6)
    v_mfma_f32_16x16x32_bf16 v[16:19], v[164:167], v[128:131], v[16:19]
    ds_read_b64_tr_b16 v[178:179], v218 offset:2048
    v_mfma_f32_16x16x32_bf16 v[20:23], v[164:167], v[132:135], v[20:23]
    ds_read_b128 v[148:151], v216 offset:2048
    v_mfma_f32_16x16x32_bf16 v[24:27], v[164:167], v[136:139], v[24:27]
    ds_read_b128 v[152:155], v216 offset:4096
    v_mfma_f32_16x16x32_bf16 v[28:31], v[164:167], v[140:143], v[28:31]
    ds_read_b128 v[156:159], v216 offset:6144
    s_waitcnt lgkmcnt(8)
    v_mfma_f32_16x16x32_bf16 v[32:35], v[168:171], v[128:131], v[32:35]
    ds_read_b64_tr_b16 v[180:181], v219 offset:0
    v_mfma_f32_16x16x32_bf16 v[36:39], v[168:171], v[132:135], v[36:39]
    ds_read_b64_tr_b16 v[182:183], v219 offset:2048
    v_mfma_f32_16x16x32_bf16 v[40:43], v[168:171], v[136:139], v[40:43]
    ds_read_b64_tr_b16 v[184:185], v220 offset:0
    v_mfma_f32_16x16x32_bf16 v[44:47], v[168:171], v[140:143], v[44:47]
    ds_read_b64_tr_b16 v[186:187], v220 offset:2048
    s_waitcnt lgkmcnt(10)
    v_mfma_f32_16x16x32_bf16 v[48:51], v[172:175], v[128:131], v[48:51]
    ds_read_b64_tr_b16 v[188:189], v221 offset:0
    v_mfma_f32_16x16x32_bf16 v[52:55], v[172:175], v[132:135], v[52:55]
    ds_read_b64_tr_b16 v[190:191], v221 offset:2048
    v_mfma_f32_16x16x32_bf16 v[56:59], v[172:175], v[136:139], v[56:59]
    v_mfma_f32_16x16x32_bf16 v[60:63], v[172:175], v[140:143], v[60:63]
    s_waitcnt lgkmcnt(9)
    v_mfma_f32_16x16x32_bf16 v[0:3], v[176:179], v[144:147], v[0:3]
    s_waitcnt lgkmcnt(8)
    v_mfma_f32_16x16x32_bf16 v[4:7], v[176:179], v[148:151], v[4:7]
    s_waitcnt lgkmcnt(7)
    v_mfma_f32_16x16x32_bf16 v[8:11], v[176:179], v[152:155], v[8:11]
    s_waitcnt lgkmcnt(6)
    v_mfma_f32_16x16x32_bf16 v[12:15], v[176:179], v[156:159], v[12:15]
    s_waitcnt lgkmcnt(4)
    v_mfma_f32_16x16x32_bf16 v[16:19], v[180:183], v[144:147], v[16:19]
    v_mfma_f32_16x16x32_bf16 v[20:23], v[180:183], v[148:151], v[20:23]
    v_mfma_f32_16x16x32_bf16 v[24:27], v[180:183], v[152:155], v[24:27]
    v_mfma_f32_16x16x32_bf16 v[28:31], v[180:183], v[156:159], v[28:31]
    s_waitcnt lgkmcnt(2)
    v_mfma_f32_16x16x32_bf16 v[32:35], v[184:187], v[144:147], v[32:35]
    v_mfma_f32_16x16x32_bf16 v[36:39], v[184:187], v[148:151], v[36:39]
    v_mfma_f32_16x16x32_bf16 v[40:43], v[184:187], v[152:155], v[40:43]
    v_mfma_f32_16x16x32_bf16 v[44:47], v[184:187], v[156:159], v[44:47]
    s_waitcnt lgkmcnt(0)
    v_mfma_f32_16x16x32_bf16 v[48:51], v[188:191], v[144:147], v[48:51]
    v_mfma_f32_16x16x32_bf16 v[52:55], v[188:191], v[148:151], v[52:55]
    v_mfma_f32_16x16x32_bf16 v[56:59], v[188:191], v[152:155], v[56:59]
    v_mfma_f32_16x16x32_bf16 v[60:63], v[188:191], v[156:159], v[60:63]
    s_barrier
    s_lshl_b32 s54, s50, 13
    v_add_u32 v226, s54, v254
    s_xor_b32 s54, s54, 32768
    v_add_u32 v227, s54, v254
    ds_write_b128 v226, v[32:35] offset:0
    ds_write_b128 v226, v[36:39] offset:1024
    ds_write_b128 v226, v[40:43] offset:2048
    ds_write_b128 v226, v[44:47] offset:3072
    ds_write_b128 v226, v[48:51] offset:4096
    ds_write_b128 v226, v[52:55] offset:5120
    ds_write_b128 v226, v[56:59] offset:6144
    ds_write_b128 v226, v[60:63] offset:7168
    s_waitcnt lgkmcnt(0)
    s_barrier
    ds_read_b128 v[128:131], v227 offset:0
    ds_read_b128 v[132:135], v227 offset:1024
    ds_read_b128 v[136:139], v227 offset:2048
    ds_read_b128 v[140:143], v227 offset:3072
    ds_read_b128 v[144:147], v227 offset:4096
    ds_read_b128 v[148:151], v227 offset:5120
    ds_read_b128 v[152:155], v227 offset:6144
    ds_read_b128 v[156:159], v227 offset:7168
    s_lshl_b32 s54, s101, 18
    s_lshl_b32 s55, s15, 14
    s_add_u32 s54, s54, s59
    s_add_u32 s54, s54, 67108864
    s_lshl_b32 s56, s15, 16
    s_add_u32 s56, s56, s54
    s_add_u32 s54, s54, s55
    v_mov_b32 v228, 0xff
    v_and_b32 v229, 0xff, v251
    s_waitcnt lgkmcnt(7)
    v_add_f32 v128, v128, v0
    v_add_f32 v129, v129, v1
    v_add_f32 v130, v130, v2
    v_add_f32 v131, v131, v3
    s_waitcnt lgkmcnt(6)
    v_add_f32 v132, v132, v4
    v_add_f32 v133, v133, v5
    v_add_f32 v134, v134, v6
    v_add_f32 v135, v135, v7
    s_waitcnt lgkmcnt(5)
    v_add_f32 v136, v136, v8
    v_add_f32 v137, v137, v9
    v_add_f32 v138, v138, v10
    v_add_f32 v139, v139, v11
    s_waitcnt lgkmcnt(4)
    v_add_f32 v140, v140, v12
    v_add_f32 v141, v141, v13
    v_add_f32 v142, v142, v14
    v_add_f32 v143, v143, v15
    s_waitcnt lgkmcnt(3)
    v_add_f32 v144, v144, v16
    v_add_f32 v145, v145, v17
    v_add_f32 v146, v146, v18
    v_add_f32 v147, v147, v19
    s_waitcnt lgkmcnt(2)
    v_add_f32 v148, v148, v20
    v_add_f32 v149, v149, v21
    v_add_f32 v150, v150, v22
    v_add_f32 v151, v151, v23
    s_waitcnt lgkmcnt(1)
    v_add_f32 v152, v152, v24
    v_add_f32 v153, v153, v25
    v_add_f32 v154, v154, v26
    v_add_f32 v155, v155, v27
    s_waitcnt lgkmcnt(0)
    v_add_f32 v156, v156, v28
    v_add_f32 v157, v157, v29
    v_add_f32 v158, v158, v30
    v_add_f32 v159, v159, v31
    s_branch P4_fin
L_E2:
    ds_read_b128 v[184:187], v252 offset:16384
    ds_read_b128 v[188:191], v252 offset:17408
    ds_read_b128 v[160:163], v252 offset:18432
    ds_read_b128 v[164:167], v252 offset:19456
    ds_read_b128 v[168:171], v252 offset:20480
    ds_read_b128 v[172:175], v252 offset:21504
    s_waitcnt lgkmcnt(4)
    v_mfma_f32_32x32x16_bf16 v[64:79], v[184:187], v[48:51], v[64:79]
    ds_read_b128 v[176:179], v252 offset:22528
    v_mov_b32 v207, 0xff800000
    v_cmp_le_i32 vcc, 0, v212
    s_nop 1
    v_cndmask_b32 v16, v207, v16, vcc
    v_cmp_le_i32 vcc, 1, v212
    s_nop 1
    v_cndmask_b32 v17, v207, v17, vcc
    v_cmp_le_i32 vcc, 2, v212
    s_nop 1
    v_cndmask_b32 v18, v207, v18, vcc
    v_cmp_le_i32 vcc, 3, v212
    s_nop 1
    v_cndmask_b32 v19, v207, v19, vcc
    v_cmp_le_i32 vcc, 8, v212
    s_nop 1
    v_cndmask_b32 v20, v207, v20, vcc
    v_mfma_f32_32x32x16_bf16 v[80:95], v[188:191], v[48:51], v[80:95]
    ds_read_b128 v[180:183], v252 offset:23552
    v_cmp_le_i32 vcc, 9, v212
    s_nop 1
    v_cndmask_b32 v21, v207, v21, vcc
    v_cmp_le_i32 vcc, 10, v212
    s_nop 1
    v_cndmask_b32 v22, v207, v22, vcc
    v_cmp_le_i32 vcc, 11, v212
    s_nop 1
    v_cndmask_b32 v23, v207, v23, vcc
    v_cmp_le_i32 vcc, 16, v212
    s_nop 1
    v_cndmask_b32 v24, v207, v24, vcc
    v_cmp_le_i32 vcc, 17, v212
    s_nop 1
    v_cndmask_b32 v25, v207, v25, vcc
    v_cmp_le_i32 vcc, 18, v212
    s_waitcnt lgkmcnt(4)
    v_mfma_f32_32x32x16_bf16 v[96:111], v[160:163], v[48:51], v[96:111]
    ds_read_b128 v[184:187], v252 offset:24576
    v_cndmask_b32 v26, v207, v26, vcc
    v_cmp_le_i32 vcc, 19, v212
    s_nop 1
    v_cndmask_b32 v27, v207, v27, vcc
    v_cmp_le_i32 vcc, 24, v212
    s_nop 1
    v_cndmask_b32 v28, v207, v28, vcc
    v_cmp_le_i32 vcc, 25, v212
    s_nop 1
    v_cndmask_b32 v29, v207, v29, vcc
    v_cmp_le_i32 vcc, 26, v212
    s_nop 1
    v_cndmask_b32 v30, v207, v30, vcc
    v_cmp_le_i32 vcc, 27, v212
    s_nop 1
    v_cndmask_b32 v31, v207, v31, vcc
    v_mfma_f32_32x32x16_bf16 v[112:127], v[164:167], v[48:51], v[112:127]
    ds_read_b128 v[188:191], v252 offset:25600
    v_exp_f32 v192, v16
    v_exp_f32 v193, v17
    v_exp_f32 v194, v18
    v_exp_f32 v195, v19
    v_cvt_pk_bf16_f32 v56, v192, v193
    v_exp_f32 v196, v20
    v_add_f32 v242, v192, v194
    s_waitcnt lgkmcnt(4)
    v_mfma_f32_32x32x16_bf16 v[64:79], v[168:171], v[52:55], v[64:79]
    ds_read_b128 v[160:163], v252 offset:26624
    v_exp_f32 v197, v21
    v_add_f32 v243, v193, v195
    v_cvt_pk_bf16_f32 v57, v194, v195
    v_exp_f32 v198, v22
    v_add_f32 v242, v242, v196
    v_exp_f32 v199, v23
    v_add_f32 v243, v243, v197
    v_cvt_pk_bf16_f32 v60, v196, v197
    v_mfma_f32_32x32x16_bf16 v[80:95], v[172:175], v[52:55], v[80:95]
    ds_read_b128 v[164:167], v252 offset:27648
    v_exp_f32 v192, v24
    v_add_f32 v242, v242, v198
    v_exp_f32 v193, v25
    v_add_f32 v243, v243, v199
    v_cvt_pk_bf16_f32 v61, v198, v199
    v_exp_f32 v194, v26
    v_add_f32 v242, v242, v192
    s_waitcnt lgkmcnt(4)
    v_mfma_f32_32x32x16_bf16 v[96:111], v[176:179], v[52:55], v[96:111]
    ds_read_b128 v[168:171], v252 offset:28672
    v_exp_f32 v195, v27
    v_add_f32 v243, v243, v193
    v_cvt_pk_bf16_f32 v58, v192, v193
    v_exp_f32 v196, v28
    v_add_f32 v242, v242, v194
    v_exp_f32 v197, v29
    v_add_f32 v243, v243, v195
    v_cvt_pk_bf16_f32 v59, v194, v195
    v_mfma_f32_32x32x16_bf16 v[112:127], v[180:183], v[52:55], v[112:127]
    ds_read_b128 v[172:175], v252 offset:29696
    v_exp_f32 v198, v30
    v_add_f32 v242, v242, v196
    v_exp_f32 v199, v31
    v_add_f32 v243, v243, v197
    v_cvt_pk_bf16_f32 v62, v196, v197
    v_add_f32 v242, v242, v198
    v_add_f32 v243, v243, v199
    v_cvt_pk_bf16_f32 v63, v198, v199
    v_add_f32 v242, v242, v243
    v_cmp_lt_f32 vcc, s10, v242
    s_cbranch_vccnz L_E2_slow0
L_E2_ret0:
    v_add_f32 v240, v240, v242
    s_waitcnt lgkmcnt(4)
    v_mfma_f32_32x32x16_bf16 v[64:79], v[184:187], v[56:59], v[64:79]
    ds_read_b128 v[176:179], v252 offset:30720
    v_mfma_f32_32x32x16_bf16 v[80:95], v[188:191], v[56:59], v[80:95]
    ds_read_b128 v[180:183], v252 offset:31744
    s_waitcnt lgkmcnt(4)
    v_mfma_f32_32x32x16_bf16 v[96:111], v[160:163], v[56:59], v[96:111]
    s_waitcnt vmcnt(8)
    s_add_u32 s54, s8, 2
    s_cmp_gt_u32 s54, s53
    s_cbranch_scc1 L_E2_nodma
    s_add_u32 m0, s5, s60
    s_min_u32 s6, s6, s11
    buffer_load_dwordx4 v254, s[16:19], s6 offen offset:0 lds
    buffer_load_dwordx4 v254, s[16:19], s6 offen offset:1024 lds
    buffer_load_dwordx4 v254, s[16:19], s6 offen offset:2048 lds
    buffer_load_dwordx4 v254, s[16:19], s6 offen offset:3072 lds
    s_add_u32 m0, m0, 16384
    s_add_u32 s6, s6, 16384
    buffer_load_dwordx4 v254, s[16:19], s7 offen offset:0 lds
    buffer_load_dwordx4 v254, s[16:19], s7 offen offset:1024 lds
    buffer_load_dwordx4 v254, s[16:19], s7 offen offset:2048 lds
    buffer_load_dwordx4 v254, s[16:19], s7 offen offset:3072 lds
    s_add_u32 s7, s7, 16384
    s_add_u32 s5, s5, 32768
    s_cmp_eq_u32 s5, 163840
    s_cselect_b32 s5, 0, s5
L_E2_nodma:
    s_barrier
    s_add_u32 s4, s4, 32768
    s_cmp_eq_u32 s4, 163840
    s_cselect_b32 s4, 0, s4
    v_add_u32 v252, s4, v254
    v_mfma_f32_32x32x16_bf16 v[112:127], v[164:167], v[56:59], v[112:127]
    s_waitcnt lgkmcnt(2)
    v_mfma_f32_32x32x16_bf16 v[64:79], v[168:171], v[60:63], v[64:79]
    v_mfma_f32_32x32x16_bf16 v[80:95], v[172:175], v[60:63], v[80:95]
    s_waitcnt lgkmcnt(0)
    v_mfma_f32_32x32x16_bf16 v[96:111], v[176:179], v[60:63], v[96:111]
    v_mfma_f32_32x32x16_bf16 v[112:127], v[180:183], v[60:63], v[112:127]
    s_branch L_epi
L_F0d:
    s_waitcnt lgkmcnt(4)
    v_mfma_f32_32x32x16_bf16 v[0:15], v[160:163], v[128:131], v[32:47]
    ds_read_b128 v[184:187], v252 offset:6144
    s_add_u32 m0, s5, s60
    s_min_u32 s6, s6, s11
    v_mfma_f32_32x32x16_bf16 v[0:15], v[164:167], v[132:135], v[0:15]
    ds_read_b128 v[188:191], v252 offset:7168
    buffer_load_dwordx4 v254, s[16:19], s6 offen offset:0 lds
    s_waitcnt lgkmcnt(4)
    v_mfma_f32_32x32x16_bf16 v[0:15], v[168:171], v[136:139], v[0:15]
    buffer_load_dwordx4 v254, s[16:19], s6 offen offset:1024 lds
    buffer_load_dwordx4 v254, s[16:19], s6 offen offset:2048 lds
    buffer_load_dwordx4 v254, s[16:19], s6 offen offset:3072 lds
    s_add_u32 m0, m0, 16384
    s_add_u32 s6, s6, 16384
    buffer_load_dwordx4 v254, s[16:19], s7 offen offset:0 lds
    buffer_load_dwordx4 v254, s[16:19], s7 offen offset:1024 lds
    buffer_load_dwordx4 v254, s[16:19], s7 offen offset:2048 lds
    buffer_load_dwordx4 v254, s[16:19], s7 offen offset:3072 lds
    s_add_u32 s7, s7, 16384
    s_add_u32 s5, s5, 32768
    s_cmp_eq_u32 s5, 163840
    s_cselect_b32 s5, 0, s5
    s_waitcnt vmcnt(16)
    s_barrier
    s_add_u32 s4, s4, 32768
    s_cmp_eq_u32 s4, 163840
    s_cselect_b32 s4, 0, s4
    v_add_u32 v252, s4, v254
    ds_read_b128 v[160:163], v252 offset:0
    v_mfma_f32_32x32x16_bf16 v[0:15], v[172:175], v[140:143], v[0:15]
    ds_read_b128 v[164:167], v252 offset:16384
    s_waitcnt lgkmcnt(4)
    v_mfma_f32_32x32x16_bf16 v[0:15], v[176:179], v[144:147], v[0:15]
    ds_read_b128 v[168:171], v252 offset:1024
    v_mfma_f32_32x32x16_bf16 v[0:15], v[180:183], v[148:151], v[0:15]
    ds_read_b128 v[172:175], v252 offset:17408
    s_waitcnt lgkmcnt(4)
    v_mfma_f32_32x32x16_bf16 v[0:15], v[184:187], v[152:155], v[0:15]
    ds_read_b128 v[176:179], v252 offset:2048
    v_mfma_f32_32x32x16_bf16 v[0:15], v[188:191], v[156:159], v[0:15]
    ds_read_b128 v[180:183], v252 offset:18432
    s_nop 7
    s_nop 3
    v_mov_b32 v207, 0xff800000
    v_cmp_le_i32 vcc, 0, v212
    s_nop 1
    v_cndmask_b32 v0, v207, v0, vcc
    v_cmp_le_i32 vcc, 1, v212
    s_nop 1
    v_cndmask_b32 v1, v207, v1, vcc
    v_cmp_le_i32 vcc, 2, v212
    s_nop 1
    v_cndmask_b32 v2, v207, v2, vcc
    v_cmp_le_i32 vcc, 3, v212
    s_nop 1
    v_cndmask_b32 v3, v207, v3, vcc
    v_cmp_le_i32 vcc, 8, v212
    s_nop 1
    v_cndmask_b32 v4, v207, v4, vcc
    v_cmp_le_i32 vcc, 9, v212
    s_nop 1
    v_cndmask_b32 v5, v207, v5, vcc
    v_cmp_le_i32 vcc, 10, v212
    s_nop 1
    v_cndmask_b32 v6, v207, v6, vcc
    v_cmp_le_i32 vcc, 11, v212
    s_nop 1
    v_cndmask_b32 v7, v207, v7, vcc
    v_cmp_le_i32 vcc, 16, v212
    s_nop 1
    v_cndmask_b32 v8, v207, v8, vcc
    v_cmp_le_i32 vcc, 17, v212
    s_nop 1
    v_cndmask_b32 v9, v207, v9, vcc
    v_cmp_le_i32 vcc, 18, v212
    s_nop 1
    v_cndmask_b32 v10, v207, v10, vcc
    v_cmp_le_i32 vcc, 19, v212
    s_nop 1
    v_cndmask_b32 v11, v207, v11, vcc
    v_cmp_le_i32 vcc, 24, v212
    s_nop 1
    v_cndmask_b32 v12, v207, v12, vcc
    v_cmp_le_i32 vcc, 25, v212
    s_nop 1
    v_cndmask_b32 v13, v207, v13, vcc
    v_cmp_le_i32 vcc, 26, v212
    s_nop 1
    v_cndmask_b32 v14, v207, v14, vcc
    v_cmp_le_i32 vcc, 27, v212
    s_nop 1
    v_cndmask_b32 v15, v207, v15, vcc
    v_max3_f32 v200, v0, v1, v2
    v_max3_f32 v200, v200, v3, v4
    v_max3_f32 v200, v200, v5, v6
    v_max3_f32 v200, v200, v7, v8
    v_max3_f32 v200, v200, v9, v10
    v_max3_f32 v200, v200, v11, v12
    v_max3_f32 v200, v200, v13, v14
    v_max_f32 v200, v200, v15
    v_mov_b32 v201, v200
    s_nop 1
    v_permlane32_swap_b32 v200, v201
    v_max_f32 v200, v200, v201
    v_sub_f32 v32, 0, v200
    v_sub_f32 v33, 0, v200
    v_sub_f32 v34, 0, v200
    v_sub_f32 v35, 0, v200
    v_sub_f32 v36, 0, v200
    v_sub_f32 v37, 0, v200
    v_sub_f32 v38, 0, v200
    v_sub_f32 v39, 0, v200
    v_sub_f32 v40, 0, v200
    v_sub_f32 v41, 0, v200
    v_sub_f32 v42, 0, v200
    v_sub_f32 v43, 0, v200
    v_sub_f32 v44, 0, v200
    v_sub_f32 v45, 0, v200
    v_sub_f32 v46, 0, v200
    v_sub_f32 v47, 0, v200
    v_sub_f32 v0, v0, v200
    v_sub_f32 v1, v1, v200
    v_sub_f32 v2, v2, v200
    v_sub_f32 v3, v3, v200
    v_sub_f32 v4, v4, v200
    v_sub_f32 v5, v5, v200
    v_sub_f32 v6, v6, v200
    v_sub_f32 v7, v7, v200
    v_sub_f32 v8, v8, v200
    v_sub_f32 v9, v9, v200
    v_sub_f32 v10, v10, v200
    v_sub_f32 v11, v11, v200
    v_sub_f32 v12, v12, v200
    v_sub_f32 v13, v13, v200
    v_sub_f32 v14, v14, v200
    v_sub_f32 v15, v15, v200
    v_exp_f32 v192, v0
    v_exp_f32 v193, v1
    v_exp_f32 v194, v2
    v_exp_f32 v195, v3
    v_cvt_pk_bf16_f32 v48, v192, v193
    v_exp_f32 v196, v4
    v_add_f32 v242, v192, v194
    v_exp_f32 v197, v5
    v_add_f32 v243, v193, v195
    v_cvt_pk_bf16_f32 v49, v194, v195
    v_exp_f32 v198, v6
    v_add_f32 v242, v242, v196
    v_exp_f32 v199, v7
    v_add_f32 v243, v243, v197
    v_cvt_pk_bf16_f32 v52, v196, v197
    v_exp_f32 v192, v8
    v_add_f32 v242, v242, v198
    v_exp_f32 v193, v9
    v_add_f32 v243, v243, v199
    v_cvt_pk_bf16_f32 v53, v198, v199
    v_exp_f32 v194, v10
    v_add_f32 v242, v242, v192
    v_exp_f32 v195, v11
    v_add_f32 v243, v243, v193
    v_cvt_pk_bf16_f32 v50, v192, v193
    v_exp_f32 v196, v12
    v_add_f32 v242, v242, v194
    v_exp_f32 v197, v13
    v_add_f32 v243, v243, v195
    v_cvt_pk_bf16_f32 v51, v194, v195
    v_exp_f32 v198, v14
    v_add_f32 v242, v242, v196
    v_exp_f32 v199, v15
    v_add_f32 v243, v243, v197
    v_cvt_pk_bf16_f32 v54, v196, v197
    v_add_f32 v242, v242, v198
    v_add_f32 v243, v243, v199
    v_cvt_pk_bf16_f32 v55, v198, v199
    v_add_f32 v242, v242, v243
    v_mov_b32 v240, v242
    s_waitcnt vmcnt(8)
    s_lshl_b32 s54, s52, 5
    s_add_u32 s54, s54, s48
    s_lshl_b32 s54, s54, 2
    s_add_u32 s54, s54, 58753024
    s_mov_b64 exec, 1
    buffer_store_dword v251, off, s[16:19], s54 sc1
    s_mov_b64 exec, -1
    s_branch L_E3
H_start:
    s_lshl_b32 s10, s2, 3
    s_and_b32 s54, s50, 3
    s_lshl_b32 s54, s54, 1
    s_add_u32 s10, s10, s54
    s_lshl_b32 s54, s10, 10
    buffer_load_dwordx4 v[8:11], v254, s[32:35], s54 offen
    buffer_load_dwordx4 v[32:35], v254, s[32:35], s54 offen offset:1024
    s_lshr_b32 s54, s2, 3
    s_lshl_b32 s54, s54, 1
    s_and_b32 s55, s50, 1
    s_add_u32 s54, s54, s55
    s_lshl_b32 s11, s54, 15
    s_lshl_b32 s12, s54, 13
    s_and_b32 s54, s2, 7
    s_lshl_b32 s54, s54, 10
    s_add_u32 s12, s12, s54
    v_lshlrev_b32 v48, 10, v255
    v_lshlrev_b32 v49, 7, v255
    s_bfe_u32 s54, s50, 0x10001
    s_add_u32 s54, s54, 1
    s_min_u32 s54, s54, 7
    s_lshl_b32 s55, s54, 7
    s_add_u32 s55, s55, s11
    s_lshl_b32 s54, s54, 19
    s_add_u32 s54, s54, s12
    s_mov_b64 exec, 0xffffffff
    buffer_load_dword v248, v48, s[20:23], s55 offen
    s_mov_b64 exec, 0xff
    buffer_load_dword v248, v49, s[24:27], s54 offen
    buffer_load_dword v248, v49, s[28:31], s54 offen
    s_mov_b64 exec, -1
    v_and_b32 v40, 15, v255
    v_lshrrev_b32 v41, 1, v40
    v_lshrrev_b32 v42, 4, v255
    v_xor_b32 v41, v41, v42
    s_and_b32 s54, s50, 3
    s_lshl_b32 s54, s54, 13
    s_add_u32 s54, s54, 32768
    v_lshlrev_b32 v40, 7, v40
    v_add_u32 v40, s54, v40
    v_lshl_add_u32 v240, v41, 4, v40
    v_xor_b32 v41, 4, v41
    v_lshl_add_u32 v247, v41, 4, v40
    v_bfe_u32 v40, v255, 2, 2
    v_lshl_add_u32 v41, v42, 3, v40
    v_lshlrev_b32 v41, 8, v41
    v_and_b32 v43, 3, v255
    v_lshl_add_u32 v41, v43, 3, v41
    s_lshr_b32 s54, s50, 2
    s_lshl_b32 s54, s54, 13
    s_add_u32 s54, s54, 98304
    v_add_u32 v41, s54, v41
    v_and_b32 v42, 1, v42
    v_lshl_add_u32 v40, v42, 2, v40
    v_xor_b32 v56, 0, v40
    v_lshl_add_u32 v56, v56, 5, v41
    v_xor_b32 v57, 1, v40
    v_lshl_add_u32 v57, v57, 5, v41
    v_xor_b32 v58, 2, v40
    v_lshl_add_u32 v58, v58, 5, v41
    v_xor_b32 v59, 3, v40
    v_lshl_add_u32 v59, v59, 5, v41
    v_xor_b32 v60, 4, v40
    v_lshl_add_u32 v60, v60, 5, v41
    v_xor_b32 v61, 5, v40
    v_lshl_add_u32 v61, v61, 5, v41
    v_xor_b32 v62, 6, v40
    v_lshl_add_u32 v62, v62, 5, v41
    v_xor_b32 v63, 7, v40
    v_lshl_add_u32 v63, v63, 5, v41
    s_waitcnt vmcnt(3)
    v_add_u32 v251, 1, v251
    s_nop 0
    v_readfirstlane_b32 s51, v251
    v_lshlrev_b32 v12, 16, v8
    v_and_b32 v13, 0xffff0000, v8
    v_lshlrev_b32 v14, 16, v9
    v_and_b32 v15, 0xffff0000, v9
    v_lshlrev_b32 v16, 16, v10
    v_and_b32 v17, 0xffff0000, v10
    v_lshlrev_b32 v18, 16, v11
    v_and_b32 v19, 0xffff0000, v11
    v_add_f32 v20, v12, v13
    v_add_f32 v20, v20, v14
    v_add_f32 v20, v20, v15
    v_add_f32 v20, v20, v16
    v_add_f32 v20, v20, v17
    v_add_f32 v20, v20, v18
    v_add_f32 v20, v20, v19
    s_nop 1
    v_add_f32_dpp v22, v20, v20 quad_perm:[1,0,3,2] row_mask:0xf bank_mask:0xf
    s_nop 1
    v_add_f32_dpp v20, v22, v22 quad_perm:[2,3,0,1] row_mask:0xf bank_mask:0xf
    s_nop 1
    v_add_f32_dpp v22, v20, v20 row_half_mirror row_mask:0xf bank_mask:0xf
    s_nop 1
    v_add_f32_dpp v20, v22, v22 row_mirror row_mask:0xf bank_mask:0xf
    s_nop 0
    v_readlane_b32 s96, v20, 0
    v_readlane_b32 s97, v20, 16
    v_readlane_b32 s98, v20, 32
    v_readlane_b32 s99, v20, 48
    v_mov_b32 v20, s96
    v_add_f32 v20, s97, v20
    v_add_f32 v20, s98, v20
    v_add_f32 v20, s99, v20
    v_mul_f32 v20, 0x3b000000, v20
    v_sub_f32 v24, v12, v20
    v_sub_f32 v25, v13, v20
    v_sub_f32 v26, v14, v20
    v_sub_f32 v27, v15, v20
    v_sub_f32 v28, v16, v20
    v_sub_f32 v29, v17, v20
    v_sub_f32 v30, v18, v20
    v_sub_f32 v31, v19, v20
    v_mul_f32 v21, v24, v24
    v_fmac_f32 v21, v25, v25
    v_fmac_f32 v21, v26, v26
    v_fmac_f32 v21, v27, v27
    v_fmac_f32 v21, v28, v28
    v_fmac_f32 v21, v29, v29
    v_fmac_f32 v21, v30, v30
    v_fmac_f32 v21, v31, v31
    s_nop 1
    v_add_f32_dpp v22, v21, v21 quad_perm:[1,0,3,2] row_mask:0xf bank_mask:0xf
    s_nop 1
    v_add_f32_dpp v21, v22, v22 quad_perm:[2,3,0,1] row_mask:0xf bank_mask:0xf
    s_nop 1
    v_add_f32_dpp v22, v21, v21 row_half_mirror row_mask:0xf bank_mask:0xf
    s_nop 1
    v_add_f32_dpp v21, v22, v22 row_mirror row_mask:0xf bank_mask:0xf
    s_nop 0
    v_readlane_b32 s96, v21, 0
    v_readlane_b32 s97, v21, 16
    v_readlane_b32 s98, v21, 32
    v_readlane_b32 s99, v21, 48
    v_mov_b32 v21, s96
    v_add_f32 v21, s97, v21
    v_add_f32 v21, s98, v21
    v_add_f32 v21, s99, v21
    v_mul_f32 v21, 0x3b000000, v21
    v_cvt_pk_bf16_f32 v21, v21, v21
    v_lshlrev_b32 v21, 16, v21
    v_add_f32 v21, 0x3727c5ac, v21
    v_cvt_pk_bf16_f32 v21, v21, v21
    v_lshlrev_b32 v21, 16, v21
    v_sqrt_f32 v21, v21
    s_nop 0
    v_cvt_pk_bf16_f32 v21, v21, v21
    v_lshlrev_b32 v21, 16, v21
    v_rcp_f32 v21, v21
    v_cvt_pk_bf16_f32 v20, v20, v20
    v_lshlrev_b32 v20, 16, v20
    v_sub_f32 v24, v12, v20
    v_sub_f32 v25, v13, v20
    v_sub_f32 v26, v14, v20
    v_sub_f32 v27, v15, v20
    v_sub_f32 v28, v16, v20
    v_sub_f32 v29, v17, v20
    v_sub_f32 v30, v18, v20
    v_sub_f32 v31, v19, v20
    v_cvt_pk_bf16_f32 v8, v24, v25
    v_cvt_pk_bf16_f32 v9, v26, v27
    v_cvt_pk_bf16_f32 v10, v28, v29
    v_cvt_pk_bf16_f32 v11, v30, v31
    v_lshlrev_b32 v24, 16, v8
    v_and_b32 v25, 0xffff0000, v8
    v_lshlrev_b32 v26, 16, v9
    v_and_b32 v27, 0xffff0000, v9
    v_lshlrev_b32 v28, 16, v10
    v_and_b32 v29, 0xffff0000, v10
    v_lshlrev_b32 v30, 16, v11
    v_and_b32 v31, 0xffff0000, v11
    v_mul_f32 v24, v24, v21
    v_mul_f32 v25, v25, v21
    v_mul_f32 v26, v26, v21
    v_mul_f32 v27, v27, v21
    v_mul_f32 v28, v28, v21
    v_mul_f32 v29, v29, v21
    v_mul_f32 v30, v30, v21
    v_mul_f32 v31, v31, v21
    v_cvt_pk_bf16_f32 v8, v24, v25
    v_cvt_pk_bf16_f32 v9, v26, v27
    v_cvt_pk_bf16_f32 v10, v28, v29
    v_cvt_pk_bf16_f32 v11, v30, v31
    s_and_b32 s54, s10, 7
    s_lshl_b32 s54, s54, 4
    s_add_u32 s54, s54, 0
    v_lshlrev_b32 v0, 7, v255
    v_add_u32 v0, s54, v0
    ds_write_b128 v0, v[8:11]
    s_add_u32 s10, s10, 1
    v_mov_b32 v36, v32
    v_mov_b32 v37, v33
    v_mov_b32 v38, v34
    v_mov_b32 v39, v35
    s_nop 1
    v_mov_b32 v8, v36
    v_mov_b32 v9, v37
    v_mov_b32 v10, v38
    v_mov_b32 v11, v39
    v_lshlrev_b32 v12, 16, v8
    v_and_b32 v13, 0xffff0000, v8
    v_lshlrev_b32 v14, 16, v9
    v_and_b32 v15, 0xffff0000, v9
    v_lshlrev_b32 v16, 16, v10
    v_and_b32 v17, 0xffff0000, v10
    v_lshlrev_b32 v18, 16, v11
    v_and_b32 v19, 0xffff0000, v11
    v_add_f32 v20, v12, v13
    v_add_f32 v20, v20, v14
    v_add_f32 v20, v20, v15
    v_add_f32 v20, v20, v16
    v_add_f32 v20, v20, v17
    v_add_f32 v20, v20, v18
    v_add_f32 v20, v20, v19
    s_nop 1
    v_add_f32_dpp v22, v20, v20 quad_perm:[1,0,3,2] row_mask:0xf bank_mask:0xf
    s_nop 1
    v_add_f32_dpp v20, v22, v22 quad_perm:[2,3,0,1] row_mask:0xf bank_mask:0xf
    s_nop 1
    v_add_f32_dpp v22, v20, v20 row_half_mirror row_mask:0xf bank_mask:0xf
    s_nop 1
    v_add_f32_dpp v20, v22, v22 row_mirror row_mask:0xf bank_mask:0xf
    s_nop 0
    v_readlane_b32 s96, v20, 0
    v_readlane_b32 s97, v20, 16
    v_readlane_b32 s98, v20, 32
    v_readlane_b32 s99, v20, 48
    v_mov_b32 v20, s96
    v_add_f32 v20, s97, v20
    v_add_f32 v20, s98, v20
    v_add_f32 v20, s99, v20
    v_mul_f32 v20, 0x3b000000, v20
    v_sub_f32 v24, v12, v20
    v_sub_f32 v25, v13, v20
    v_sub_f32 v26, v14, v20
    v_sub_f32 v27, v15, v20
    v_sub_f32 v28, v16, v20
    v_sub_f32 v29, v17, v20
    v_sub_f32 v30, v18, v20
    v_sub_f32 v31, v19, v20
    v_mul_f32 v21, v24, v24
    v_fmac_f32 v21, v25, v25
    v_fmac_f32 v21, v26, v26
    v_fmac_f32 v21, v27, v27
    v_fmac_f32 v21, v28, v28
    v_fmac_f32 v21, v29, v29
    v_fmac_f32 v21, v30, v30
    v_fmac_f32 v21, v31, v31
    s_nop 1
    v_add_f32_dpp v22, v21, v21 quad_perm:[1,0,3,2] row_mask:0xf bank_mask:0xf
    s_nop 1
    v_add_f32_dpp v21, v22, v22 quad_perm:[2,3,0,1] row_mask:0xf bank_mask:0xf
    s_nop 1
    v_add_f32_dpp v22, v21, v21 row_half_mirror row_mask:0xf bank_mask:0xf
    s_nop 1
    v_add_f32_dpp v21, v22, v22 row_mirror row_mask:0xf bank_mask:0xf
    s_nop 0
    v_readlane_b32 s96, v21, 0
    v_readlane_b32 s97, v21, 16
    v_readlane_b32 s98, v21, 32
    v_readlane_b32 s99, v21, 48
    v_mov_b32 v21, s96
    v_add_f32 v21, s97, v21
    v_add_f32 v21, s98, v21
    v_add_f32 v21, s99, v21
    v_mul_f32 v21, 0x3b000000, v21
    v_cvt_pk_bf16_f32 v21, v21, v21
    v_lshlrev_b32 v21, 16, v21
    v_add_f32 v21, 0x3727c5ac, v21
    v_cvt_pk_bf16_f32 v21, v21, v21
    v_lshlrev_b32 v21, 16, v21
    v_sqrt_f32 v21, v21
    s_nop 0
    v_cvt_pk_bf16_f32 v21, v21, v21
    v_lshlrev_b32 v21, 16, v21
    v_rcp_f32 v21, v21
    v_cvt_pk_bf16_f32 v20, v20, v20
    v_lshlrev_b32 v20, 16, v20
    v_sub_f32 v24, v12, v20
    v_sub_f32 v25, v13, v20
    v_sub_f32 v26, v14, v20
    v_sub_f32 v27, v15, v20
    v_sub_f32 v28, v16, v20
    v_sub_f32 v29, v17, v20
    v_sub_f32 v30, v18, v20
    v_sub_f32 v31, v19, v20
    v_cvt_pk_bf16_f32 v8, v24, v25
    v_cvt_pk_bf16_f32 v9, v26, v27
    v_cvt_pk_bf16_f32 v10, v28, v29
    v_cvt_pk_bf16_f32 v11, v30, v31
    v_lshlrev_b32 v24, 16, v8
    v_and_b32 v25, 0xffff0000, v8
    v_lshlrev_b32 v26, 16, v9
    v_and_b32 v27, 0xffff0000, v9
    v_lshlrev_b32 v28, 16, v10
    v_and_b32 v29, 0xffff0000, v10
    v_lshlrev_b32 v30, 16, v11
    v_and_b32 v31, 0xffff0000, v11
    v_mul_f32 v24, v24, v21
    v_mul_f32 v25, v25, v21
    v_mul_f32 v26, v26, v21
    v_mul_f32 v27, v27, v21
    v_mul_f32 v28, v28, v21
    v_mul_f32 v29, v29, v21
    v_mul_f32 v30, v30, v21
    v_mul_f32 v31, v31, v21
    v_cvt_pk_bf16_f32 v8, v24, v25
    v_cvt_pk_bf16_f32 v9, v26, v27
    v_cvt_pk_bf16_f32 v10, v28, v29
    v_cvt_pk_bf16_f32 v11, v30, v31
    s_and_b32 s54, s10, 7
    s_lshl_b32 s54, s54, 4
    s_add_u32 s54, s54, 0
    v_lshlrev_b32 v0, 7, v255
    v_add_u32 v0, s54, v0
    ds_write_b128 v0, v[8:11]
    s_waitcnt lgkmcnt(0)
    s_barrier
    s_and_b32 s54, s50, 3
    s_lshl_b32 s55, s54, 11
    v_add_u32 v0, s55, v254
    ds_read_b128 v[8:11], v0
    ds_read_b128 v[12:15], v0 offset:1024
    v_lshrrev_b32 v1, 4, v255
    v_lshlrev_b32 v1, 10, v1
    v_bfe_u32 v2, v255, 3, 1
    v_lshl_add_u32 v1, v2, 9, v1
    v_and_b32 v2, 7, v255
    v_lshl_add_u32 v1, v2, 4, v1
    s_lshl_b32 s54, s54, 13
    s_lshr_b32 s55, s2, 2
    s_lshl_b32 s55, s55, 15
    s_add_u32 s54, s54, s55
    s_and_b32 s55, s2, 3
    s_lshl_b32 s55, s55, 7
    s_add_u32 s54, s54, s55
    s_add_u32 s55, s54, 4096
    s_waitcnt lgkmcnt(0)
    buffer_store_dwordx4 v[8:11], v1, s[16:19], s54 offen sc1
    buffer_store_dwordx4 v[12:15], v1, s[16:19], s55 offen sc1
    ds_read_b128 v[192:195], v240 offset:0
    ds_read_b64_tr_b16 v[224:225], v56 offset:0
    ds_read_b64_tr_b16 v[226:227], v56 offset:1024
    ds_read_b128 v[196:199], v240 offset:2048
    ds_read_b64_tr_b16 v[228:229], v57 offset:0
    ds_read_b64_tr_b16 v[230:231], v57 offset:1024
    ds_read_b128 v[200:203], v240 offset:4096
    ds_read_b64_tr_b16 v[232:233], v58 offset:0
    ds_read_b64_tr_b16 v[234:235], v58 offset:1024
    ds_read_b128 v[204:207], v240 offset:6144
    s_waitcnt lgkmcnt(7)
    v_mfma_f32_16x16x32_bf16 v[64:67], v[192:195], v[224:227], 0
    ds_read_b64_tr_b16 v[236:237], v59 offset:0
    s_waitcnt lgkmcnt(7)
    v_mfma_f32_16x16x32_bf16 v[68:71], v[196:199], v[224:227], 0
    ds_read_b64_tr_b16 v[238:239], v59 offset:1024
    s_waitcnt lgkmcnt(5)
    v_mfma_f32_16x16x32_bf16 v[72:75], v[200:203], v[224:227], 0
    s_waitcnt lgkmcnt(2)
    v_mfma_f32_16x16x32_bf16 v[76:79], v[204:207], v[224:227], 0
    v_mfma_f32_16x16x32_bf16 v[80:83], v[192:195], v[228:231], 0
    ds_read_b64_tr_b16 v[224:225], v60 offset:0
    v_mfma_f32_16x16x32_bf16 v[84:87], v[196:199], v[228:231], 0
    ds_read_b64_tr_b16 v[226:227], v60 offset:1024
    v_mfma_f32_16x16x32_bf16 v[88:91], v[200:203], v[228:231], 0
    v_mfma_f32_16x16x32_bf16 v[92:95], v[204:207], v[228:231], 0
    v_mfma_f32_16x16x32_bf16 v[96:99], v[192:195], v[232:235], 0
    ds_read_b64_tr_b16 v[228:229], v61 offset:0
    v_mfma_f32_16x16x32_bf16 v[100:103], v[196:199], v[232:235], 0
    ds_read_b64_tr_b16 v[230:231], v61 offset:1024
    v_mfma_f32_16x16x32_bf16 v[104:107], v[200:203], v[232:235], 0
    v_mfma_f32_16x16x32_bf16 v[108:111], v[204:207], v[232:235], 0
    s_waitcnt lgkmcnt(4)
    v_mfma_f32_16x16x32_bf16 v[112:115], v[192:195], v[236:239], 0
    ds_read_b64_tr_b16 v[232:233], v62 offset:0
    v_mfma_f32_16x16x32_bf16 v[116:119], v[196:199], v[236:239], 0
    ds_read_b64_tr_b16 v[234:235], v62 offset:1024
    v_mfma_f32_16x16x32_bf16 v[120:123], v[200:203], v[236:239], 0
    v_mfma_f32_16x16x32_bf16 v[124:127], v[204:207], v[236:239], 0
    s_waitcnt lgkmcnt(4)
    v_mfma_f32_16x16x32_bf16 v[128:131], v[192:195], v[224:227], 0
    ds_read_b64_tr_b16 v[236:237], v63 offset:0
    v_mfma_f32_16x16x32_bf16 v[132:135], v[196:199], v[224:227], 0
    ds_read_b64_tr_b16 v[238:239], v63 offset:1024
    v_mfma_f32_16x16x32_bf16 v[136:139], v[200:203], v[224:227], 0
    v_mfma_f32_16x16x32_bf16 v[140:143], v[204:207], v[224:227], 0
    s_waitcnt lgkmcnt(4)
    v_mfma_f32_16x16x32_bf16 v[144:147], v[192:195], v[228:231], 0
    s_waitcnt lgkmcnt(0)
    s_barrier
    ds_read_b128 v[208:211], v247 offset:0
    s_bfe_u32 s54, s50, 0x10001
    s_add_u32 s54, s54, 3
    s_min_u32 s54, s54, 7
    s_lshl_b32 s55, s54, 7
    s_add_u32 s55, s55, s11
    s_lshl_b32 s54, s54, 19
    s_add_u32 s54, s54, s12
    s_mov_b64 exec, 0xffffffff
    buffer_load_dword v248, v48, s[20:23], s55 offen
    s_mov_b64 exec, 0xff
    buffer_load_dword v248, v49, s[24:27], s54 offen
    buffer_load_dword v248, v49, s[28:31], s54 offen
    s_mov_b64 exec, -1
    v_mfma_f32_16x16x32_bf16 v[148:151], v[196:199], v[228:231], 0
    ds_read_b64_tr_b16 v[224:225], v56 offset:16384
    s_lshl_b32 s54, s48, 6
    s_lshl_b32 s55, s49, 3
    v_mfma_f32_16x16x32_bf16 v[152:155], v[200:203], v[228:231], 0
    ds_read_b64_tr_b16 v[226:227], v56 offset:17408
    s_add_u32 s54, s54, s55
    s_and_b32 s55, s50, 3
    v_mfma_f32_16x16x32_bf16 v[156:159], v[204:207], v[228:231], 0
    ds_read_b128 v[212:215], v247 offset:2048
    s_lshl_b32 s55, s55, 1
    s_add_u32 s54, s54, s55
    v_mfma_f32_16x16x32_bf16 v[160:163], v[192:195], v[232:235], 0
    ds_read_b64_tr_b16 v[228:229], v57 offset:16384
    s_lshl_b32 s54, s54, 13
    s_add_u32 s6, s54, 18874368
    v_mfma_f32_16x16x32_bf16 v[164:167], v[196:199], v[232:235], 0
    ds_read_b64_tr_b16 v[230:231], v57 offset:17408
    s_add_u32 s7, s6, 4096
    s_add_u32 s8, s6, 8192
    v_mfma_f32_16x16x32_bf16 v[168:171], v[200:203], v[232:235], 0
    ds_read_b128 v[216:219], v247 offset:4096
    s_add_u32 s9, s6, 12288
    v_and_b32 v44, 15, v255
    v_mfma_f32_16x16x32_bf16 v[172:175], v[204:207], v[232:235], 0
    v_lshlrev_b32 v44, 4, v44
    v_bfe_u32 v45, v255, 4, 1
    v_mfma_f32_16x16x32_bf16 v[176:179], v[192:195], v[236:239], 0
    ds_read_b64_tr_b16 v[232:233], v58 offset:16384
    v_lshl_add_u32 v46, v45, 9, v44
    v_lshrrev_b32 v47, 5, v255
    v_mfma_f32_16x16x32_bf16 v[180:183], v[196:199], v[236:239], 0
    ds_read_b64_tr_b16 v[234:235], v58 offset:17408
    v_lshl_add_u32 v244, v47, 12, v46
    v_mul_u32_u24 v45, 175104, v45
    v_mfma_f32_16x16x32_bf16 v[184:187], v[200:203], v[236:239], 0
    ds_read_b128 v[220:223], v247 offset:6144
    v_add_u32 v44, v44, v45
    v_lshl_add_u32 v253, v47, 8, v44
    v_mfma_f32_16x16x32_bf16 v[188:191], v[204:207], v[236:239], 0
    s_lshl_b32 s54, s49, 2
    s_sub_u32 s52, 56, s54
    s_waitcnt lgkmcnt(7)
    v_mfma_f32_16x16x32_bf16 v[64:67], v[208:211], v[224:227], v[64:67]
    ds_read_b64_tr_b16 v[236:237], v59 offset:16384
    s_add_u32 s52, s52, s50
    s_lshl_b32 s54, s49, 1
    s_waitcnt lgkmcnt(7)
    v_mfma_f32_16x16x32_bf16 v[68:71], v[212:215], v[224:227], v[68:71]
    ds_read_b64_tr_b16 v[238:239], v59 offset:17408
    s_sub_u32 s53, 32, s54
    s_lshl_b32 s13, s52, 15
    s_waitcnt lgkmcnt(5)
    v_mfma_f32_16x16x32_bf16 v[72:75], v[216:219], v[224:227], v[72:75]
    s_mul_i32 s55, s52, 350208
    s_add_u32 s55, s55, 35782656
    s_waitcnt lgkmcnt(2)
    v_mfma_f32_16x16x32_bf16 v[76:79], v[220:223], v[224:227], v[76:79]
    s_mul_i32 s96, s48, 96
    s_mul_i32 s54, s48, 1536
    v_mfma_f32_16x16x32_bf16 v[80:83], v[208:211], v[228:231], v[80:83]
    ds_read_b64_tr_b16 v[224:225], v60 offset:16384
    s_add_u32 s99, s54, s55
    s_add_u32 s100, s99, 512
    v_mfma_f32_16x16x32_bf16 v[84:87], v[212:215], v[228:231], v[84:87]
    ds_read_b64_tr_b16 v[226:227], v60 offset:17408
    s_add_u32 s101, s99, 1024
    v_mfma_f32_16x16x32_bf16 v[88:91], v[216:219], v[228:231], v[88:91]
    v_mfma_f32_16x16x32_bf16 v[92:95], v[220:223], v[228:231], v[92:95]
    v_mfma_f32_16x16x32_bf16 v[96:99], v[208:211], v[232:235], v[96:99]
    ds_read_b64_tr_b16 v[228:229], v61 offset:16384
    v_mfma_f32_16x16x32_bf16 v[100:103], v[212:215], v[232:235], v[100:103]
    ds_read_b64_tr_b16 v[230:231], v61 offset:17408
    v_mfma_f32_16x16x32_bf16 v[104:107], v[216:219], v[232:235], v[104:107]
    v_mfma_f32_16x16x32_bf16 v[108:111], v[220:223], v[232:235], v[108:111]
    s_waitcnt lgkmcnt(4)
    v_mfma_f32_16x16x32_bf16 v[112:115], v[208:211], v[236:239], v[112:115]
    ds_read_b64_tr_b16 v[232:233], v62 offset:16384
    v_mfma_f32_16x16x32_bf16 v[116:119], v[212:215], v[236:239], v[116:119]
    ds_read_b64_tr_b16 v[234:235], v62 offset:17408
    v_mfma_f32_16x16x32_bf16 v[120:123], v[216:219], v[236:239], v[120:123]
    v_mfma_f32_16x16x32_bf16 v[124:127], v[220:223], v[236:239], v[124:127]
    s_waitcnt lgkmcnt(4)
    v_mfma_f32_16x16x32_bf16 v[128:131], v[208:211], v[224:227], v[128:131]
    ds_read_b64_tr_b16 v[236:237], v63 offset:16384
    v_mfma_f32_16x16x32_bf16 v[132:135], v[212:215], v[224:227], v[132:135]
    ds_read_b64_tr_b16 v[238:239], v63 offset:17408
    v_mfma_f32_16x16x32_bf16 v[136:139], v[216:219], v[224:227], v[136:139]
    v_mfma_f32_16x16x32_bf16 v[140:143], v[220:223], v[224:227], v[140:143]
    s_waitcnt lgkmcnt(4)
    v_mfma_f32_16x16x32_bf16 v[144:147], v[208:211], v[228:231], v[144:147]
    s_waitcnt lgkmcnt(0)
    s_barrier
    v_add_u32 v240, 32768, v240
    v_add_u32 v247, 32768, v247
    s_getreg_b32 s15, hwreg(HW_REG_XCC_ID)
    s_lshl_b32 s15, s15, 28
    s_add_u32 s15, s15, s51
    s_cmp_lg_u32 s50, 4
    s_cbranch_scc1 H_noxc
    s_lshl_b32 s54, s48, 3
    s_add_u32 s54, s54, s49
    s_lshl_b32 s54, s54, 2
    s_add_u32 s54, s54, 58785792
    v_mov_b32 v52, s15
    s_mov_b64 exec, 1
    buffer_store_dword v52, off, s[16:19], s54 sc1
    s_mov_b64 exec, -1
H_noxc:
    ds_read_b128 v[192:195], v240 offset:0
    v_mfma_f32_16x16x32_bf16 v[148:151], v[212:215], v[228:231], v[148:151]
    ds_read_b64_tr_b16 v[224:225], v56 offset:32768
    v_mfma_f32_16x16x32_bf16 v[152:155], v[216:219], v[228:231], v[152:155]
    ds_read_b64_tr_b16 v[226:227], v56 offset:33792
    v_mfma_f32_16x16x32_bf16 v[156:159], v[220:223], v[228:231], v[156:159]
    ds_read_b128 v[196:199], v240 offset:2048
    v_mfma_f32_16x16x32_bf16 v[160:163], v[208:211], v[232:235], v[160:163]
    ds_read_b64_tr_b16 v[228:229], v57 offset:32768
    v_mfma_f32_16x16x32_bf16 v[164:167], v[212:215], v[232:235], v[164:167]
    ds_read_b64_tr_b16 v[230:231], v57 offset:33792
    v_mfma_f32_16x16x32_bf16 v[168:171], v[216:219], v[232:235], v[168:171]
    ds_read_b128 v[200:203], v240 offset:4096
    v_mfma_f32_16x16x32_bf16 v[172:175], v[220:223], v[232:235], v[172:175]
    v_mfma_f32_16x16x32_bf16 v[176:179], v[208:211], v[236:239], v[176:179]
    ds_read_b64_tr_b16 v[232:233], v58 offset:32768
    v_mfma_f32_16x16x32_bf16 v[180:183], v[212:215], v[236:239], v[180:183]
    ds_read_b64_tr_b16 v[234:235], v58 offset:33792
    v_mfma_f32_16x16x32_bf16 v[184:187], v[216:219], v[236:239], v[184:187]
    ds_read_b128 v[204:207], v240 offset:6144
    v_mfma_f32_16x16x32_bf16 v[188:191], v[220:223], v[236:239], v[188:191]
    s_waitcnt lgkmcnt(7)
    v_mfma_f32_16x16x32_bf16 v[64:67], v[192:195], v[224:227], v[64:67]
    ds_read_b64_tr_b16 v[236:237], v59 offset:32768
    s_waitcnt lgkmcnt(7)
    v_mfma_f32_16x16x32_bf16 v[68:71], v[196:199], v[224:227], v[68:71]
    ds_read_b64_tr_b16 v[238:239], v59 offset:33792
    s_waitcnt lgkmcnt(5)
    v_mfma_f32_16x16x32_bf16 v[72:75], v[200:203], v[224:227], v[72:75]
    s_waitcnt lgkmcnt(2)
    v_mfma_f32_16x16x32_bf16 v[76:79], v[204:207], v[224:227], v[76:79]
    v_mfma_f32_16x16x32_bf16 v[80:83], v[192:195], v[228:231], v[80:83]
    ds_read_b64_tr_b16 v[224:225], v60 offset:32768
    v_mfma_f32_16x16x32_bf16 v[84:87], v[196:199], v[228:231], v[84:87]
    ds_read_b64_tr_b16 v[226:227], v60 offset:33792
    v_mfma_f32_16x16x32_bf16 v[88:91], v[200:203], v[228:231], v[88:91]
    v_mfma_f32_16x16x32_bf16 v[92:95], v[204:207], v[228:231], v[92:95]
    v_mfma_f32_16x16x32_bf16 v[96:99], v[192:195], v[232:235], v[96:99]
    ds_read_b64_tr_b16 v[228:229], v61 offset:32768
    v_mfma_f32_16x16x32_bf16 v[100:103], v[196:199], v[232:235], v[100:103]
    ds_read_b64_tr_b16 v[230:231], v61 offset:33792
    v_mfma_f32_16x16x32_bf16 v[104:107], v[200:203], v[232:235], v[104:107]
    v_mfma_f32_16x16x32_bf16 v[108:111], v[204:207], v[232:235], v[108:111]
    s_waitcnt lgkmcnt(4)
    v_mfma_f32_16x16x32_bf16 v[112:115], v[192:195], v[236:239], v[112:115]
    ds_read_b64_tr_b16 v[232:233], v62 offset:32768
    v_mfma_f32_16x16x32_bf16 v[116:119], v[196:199], v[236:239], v[116:119]
    ds_read_b64_tr_b16 v[234:235], v62 offset:33792
    v_mfma_f32_16x16x32_bf16 v[120:123], v[200:203], v[236:239], v[120:123]
    v_mfma_f32_16x16x32_bf16 v[124:127], v[204:207], v[236:239], v[124:127]
    s_waitcnt lgkmcnt(4)
    v_mfma_f32_16x16x32_bf16 v[128:131], v[192:195], v[224:227], v[128:131]
    ds_read_b64_tr_b16 v[236:237], v63 offset:32768
    v_mfma_f32_16x16x32_bf16 v[132:135], v[196:199], v[224:227], v[132:135]
    ds_read_b64_tr_b16 v[238:239], v63 offset:33792
    v_mfma_f32_16x16x32_bf16 v[136:139], v[200:203], v[224:227], v[136:139]
    v_mfma_f32_16x16x32_bf16 v[140:143], v[204:207], v[224:227], v[140:143]
    s_waitcnt lgkmcnt(4)
    v_mfma_f32_16x16x32_bf16 v[144:147], v[192:195], v[228:231], v[144:147]
    s_waitcnt lgkmcnt(0)
    s_barrier
    s_waitcnt vmcnt(3)
    s_lshr_b32 s54, s10, 1
    s_lshl_b32 s54, s54, 2
    s_add_u32 s54, s54, 58724352
    s_mov_b64 exec, 1
    buffer_store_dword v251, off, s[16:19], s54 sc1
    s_mov_b64 exec, -1
    s_cmp_lt_u32 s48, 28
    s_cselect_b32 s101, s101, 2146435072
    s_cmp_lt_u32 s48, 29
    s_cselect_b32 s99, s99, 2146435072
    s_cselect_b32 s100, s100, 2146435072
    ds_read_b128 v[208:211], v247 offset:0
    s_bfe_u32 s54, s50, 0x10001
    s_add_u32 s54, s54, 5
    s_min_u32 s54, s54, 7
    s_lshl_b32 s55, s54, 7
    s_add_u32 s55, s55, s11
    s_lshl_b32 s54, s54, 19
    s_add_u32 s54, s54, s12
    s_mov_b64 exec, 0xffffffff
    buffer_load_dword v248, v48, s[20:23], s55 offen
    s_mov_b64 exec, 0xff
    buffer_load_dword v248, v49, s[24:27], s54 offen
    buffer_load_dword v248, v49, s[28:31], s54 offen
    s_mov_b64 exec, -1
    v_mfma_f32_16x16x32_bf16 v[148:151], v[196:199], v[228:231], v[148:151]
    ds_read_b64_tr_b16 v[224:225], v56 offset:49152
    v_mfma_f32_16x16x32_bf16 v[152:155], v[200:203], v[228:231], v[152:155]
    ds_read_b64_tr_b16 v[226:227], v56 offset:50176
    v_mfma_f32_16x16x32_bf16 v[156:159], v[204:207], v[228:231], v[156:159]
    ds_read_b128 v[212:215], v247 offset:2048
    v_mfma_f32_16x16x32_bf16 v[160:163], v[192:195], v[232:235], v[160:163]
    ds_read_b64_tr_b16 v[228:229], v57 offset:49152
    v_mfma_f32_16x16x32_bf16 v[164:167], v[196:199], v[232:235], v[164:167]
    ds_read_b64_tr_b16 v[230:231], v57 offset:50176
    v_mfma_f32_16x16x32_bf16 v[168:171], v[200:203], v[232:235], v[168:171]
    ds_read_b128 v[216:219], v247 offset:4096
    v_mfma_f32_16x16x32_bf16 v[172:175], v[204:207], v[232:235], v[172:175]
    v_mfma_f32_16x16x32_bf16 v[176:179], v[192:195], v[236:239], v[176:179]
    ds_read_b64_tr_b16 v[232:233], v58 offset:49152
    v_mfma_f32_16x16x32_bf16 v[180:183], v[196:199], v[236:239], v[180:183]
    ds_read_b64_tr_b16 v[234:235], v58 offset:50176
    v_mfma_f32_16x16x32_bf16 v[184:187], v[200:203], v[236:239], v[184:187]
    ds_read_b128 v[220:223], v247 offset:6144
    v_mfma_f32_16x16x32_bf16 v[188:191], v[204:207], v[236:239], v[188:191]
    s_waitcnt lgkmcnt(7)
    v_mfma_f32_16x16x32_bf16 v[64:67], v[208:211], v[224:227], v[64:67]
    ds_read_b64_tr_b16 v[236:237], v59 offset:49152
    s_waitcnt lgkmcnt(7)
    v_mfma_f32_16x16x32_bf16 v[68:71], v[212:215], v[224:227], v[68:71]
    ds_read_b64_tr_b16 v[238:239], v59 offset:50176
    s_waitcnt lgkmcnt(5)
    v_mfma_f32_16x16x32_bf16 v[72:75], v[216:219], v[224:227], v[72:75]
    s_waitcnt lgkmcnt(2)
    v_mfma_f32_16x16x32_bf16 v[76:79], v[220:223], v[224:227], v[76:79]
    v_mfma_f32_16x16x32_bf16 v[80:83], v[208:211], v[228:231], v[80:83]
    ds_read_b64_tr_b16 v[224:225], v60 offset:49152
    v_mfma_f32_16x16x32_bf16 v[84:87], v[212:215], v[228:231], v[84:87]
    ds_read_b64_tr_b16 v[226:227], v60 offset:50176
    v_mfma_f32_16x16x32_bf16 v[88:91], v[216:219], v[228:231], v[88:91]
    v_mfma_f32_16x16x32_bf16 v[92:95], v[220:223], v[228:231], v[92:95]
    v_mfma_f32_16x16x32_bf16 v[96:99], v[208:211], v[232:235], v[96:99]
    ds_read_b64_tr_b16 v[228:229], v61 offset:49152
    v_mfma_f32_16x16x32_bf16 v[100:103], v[212:215], v[232:235], v[100:103]
    ds_read_b64_tr_b16 v[230:231], v61 offset:50176
    v_mfma_f32_16x16x32_bf16 v[104:107], v[216:219], v[232:235], v[104:107]
    v_mfma_f32_16x16x32_bf16 v[108:111], v[220:223], v[232:235], v[108:111]
    s_waitcnt lgkmcnt(4)
    v_mfma_f32_16x16x32_bf16 v[112:115], v[208:211], v[236:239], v[112:115]
    ds_read_b64_tr_b16 v[232:233], v62 offset:49152
    v_mfma_f32_16x16x32_bf16 v[116:119], v[212:215], v[236:239], v[116:119]
    ds_read_b64_tr_b16 v[234:235], v62 offset:50176
    v_mfma_f32_16x16x32_bf16 v[120:123], v[216:219], v[236:239], v[120:123]
    v_mfma_f32_16x16x32_bf16 v[124:127], v[220:223], v[236:239], v[124:127]
    s_waitcnt lgkmcnt(4)
    v_mfma_f32_16x16x32_bf16 v[128:131], v[208:211], v[224:227], v[128:131]
    ds_read_b64_tr_b16 v[236:237], v63 offset:49152
    v_mfma_f32_16x16x32_bf16 v[132:135], v[212:215], v[224:227], v[132:135]
    ds_read_b64_tr_b16 v[238:239], v63 offset:50176
    v_mfma_f32_16x16x32_bf16 v[136:139], v[216:219], v[224:227], v[136:139]
    v_mfma_f32_16x16x32_bf16 v[140:143], v[220:223], v[224:227], v[140:143]
    s_waitcnt lgkmcnt(4)
    v_mfma_f32_16x16x32_bf16 v[144:147], v[208:211], v[228:231], v[144:147]
    s_waitcnt lgkmcnt(0)
    s_barrier
    v_add_u32 v240, 4294901760, v240
    v_add_u32 v247, 4294901760, v247
    ds_read_b128 v[192:195], v240 offset:0
    s_bfe_u32 s54, s50, 0x10001
    s_add_u32 s54, s54, 7
    s_min_u32 s54, s54, 7
    s_lshl_b32 s55, s54, 7
    s_add_u32 s55, s55, s11
    s_lshl_b32 s54, s54, 19
    s_add_u32 s54, s54, s12
    s_mov_b64 exec, 0xffffffff
    buffer_load_dword v248, v48, s[20:23], s55 offen
    s_mov_b64 exec, 0xff
    buffer_load_dword v248, v49, s[24:27], s54 offen
    buffer_load_dword v248, v49, s[28:31], s54 offen
    s_mov_b64 exec, -1
    v_mfma_f32_16x16x32_bf16 v[148:151], v[212:215], v[228:231], v[148:151]
    ds_read_b64_tr_b16 v[224:225], v56 offset:0
    v_mfma_f32_16x16x32_bf16 v[152:155], v[216:219], v[228:231], v[152:155]
    ds_read_b64_tr_b16 v[226:227], v56 offset:1024
    v_mfma_f32_16x16x32_bf16 v[156:159], v[220:223], v[228:231], v[156:159]
    ds_read_b128 v[196:199], v240 offset:2048
    v_mfma_f32_16x16x32_bf16 v[160:163], v[208:211], v[232:235], v[160:163]
    ds_read_b64_tr_b16 v[228:229], v57 offset:0
    v_mfma_f32_16x16x32_bf16 v[164:167], v[212:215], v[232:235], v[164:167]
    ds_read_b64_tr_b16 v[230:231], v57 offset:1024
    v_mfma_f32_16x16x32_bf16 v[168:171], v[216:219], v[232:235], v[168:171]
    ds_read_b128 v[200:203], v240 offset:4096
    v_mfma_f32_16x16x32_bf16 v[172:175], v[220:223], v[232:235], v[172:175]
    v_mfma_f32_16x16x32_bf16 v[176:179], v[208:211], v[236:239], v[176:179]
    ds_read_b64_tr_b16 v[232:233], v58 offset:0
    v_mfma_f32_16x16x32_bf16 v[180:183], v[212:215], v[236:239], v[180:183]
    ds_read_b64_tr_b16 v[234:235], v58 offset:1024
    v_mfma_f32_16x16x32_bf16 v[184:187], v[216:219], v[236:239], v[184:187]
    ds_read_b128 v[204:207], v240 offset:6144
    v_mfma_f32_16x16x32_bf16 v[188:191], v[220:223], v[236:239], v[188:191]
    s_waitcnt lgkmcnt(7)
    v_mfma_f32_16x16x32_bf16 v[64:67], v[192:195], v[224:227], v[64:67]
    ds_read_b64_tr_b16 v[236:237], v59 offset:0
    s_waitcnt lgkmcnt(7)
    v_mfma_f32_16x16x32_bf16 v[68:71], v[196:199], v[224:227], v[68:71]
    ds_read_b64_tr_b16 v[238:239], v59 offset:1024
    s_waitcnt lgkmcnt(5)
    v_mfma_f32_16x16x32_bf16 v[72:75], v[200:203], v[224:227], v[72:75]
    s_waitcnt lgkmcnt(2)
    v_mfma_f32_16x16x32_bf16 v[76:79], v[204:207], v[224:227], v[76:79]
    v_mfma_f32_16x16x32_bf16 v[80:83], v[192:195], v[228:231], v[80:83]
    ds_read_b64_tr_b16 v[224:225], v60 offset:0
    v_mfma_f32_16x16x32_bf16 v[84:87], v[196:199], v[228:231], v[84:87]
    ds_read_b64_tr_b16 v[226:227], v60 offset:1024
    v_mfma_f32_16x16x32_bf16 v[88:91], v[200:203], v[228:231], v[88:91]
    v_mfma_f32_16x16x32_bf16 v[92:95], v[204:207], v[228:231], v[92:95]
    v_mfma_f32_16x16x32_bf16 v[96:99], v[192:195], v[232:235], v[96:99]
    ds_read_b64_tr_b16 v[228:229], v61 offset:0
    v_mfma_f32_16x16x32_bf16 v[100:103], v[196:199], v[232:235], v[100:103]
    ds_read_b64_tr_b16 v[230:231], v61 offset:1024
    v_mfma_f32_16x16x32_bf16 v[104:107], v[200:203], v[232:235], v[104:107]
    v_mfma_f32_16x16x32_bf16 v[108:111], v[204:207], v[232:235], v[108:111]
    s_waitcnt lgkmcnt(4)
    v_mfma_f32_16x16x32_bf16 v[112:115], v[192:195], v[236:239], v[112:115]
    ds_read_b64_tr_b16 v[232:233], v62 offset:0
    v_mfma_f32_16x16x32_bf16 v[116:119], v[196:199], v[236:239], v[116:119]
    ds_read_b64_tr_b16 v[234:235], v62 offset:1024
    v_mfma_f32_16x16x32_bf16 v[120:123], v[200:203], v[236:239], v[120:123]
    v_mfma_f32_16x16x32_bf16 v[124:127], v[204:207], v[236:239], v[124:127]
    s_waitcnt lgkmcnt(4)
    v_mfma_f32_16x16x32_bf16 v[128:131], v[192:195], v[224:227], v[128:131]
    ds_read_b64_tr_b16 v[236:237], v63 offset:0
    v_mfma_f32_16x16x32_bf16 v[132:135], v[196:199], v[224:227], v[132:135]
    ds_read_b64_tr_b16 v[238:239], v63 offset:1024
    v_mfma_f32_16x16x32_bf16 v[136:139], v[200:203], v[224:227], v[136:139]
    v_mfma_f32_16x16x32_bf16 v[140:143], v[204:207], v[224:227], v[140:143]
    s_waitcnt lgkmcnt(4)
    v_mfma_f32_16x16x32_bf16 v[144:147], v[192:195], v[228:231], v[144:147]
    s_waitcnt lgkmcnt(0)
    s_barrier
    ds_read_b128 v[208:211], v247 offset:0
    v_mfma_f32_16x16x32_bf16 v[148:151], v[196:199], v[228:231], v[148:151]
    ds_read_b64_tr_b16 v[224:225], v56 offset:16384
    v_mfma_f32_16x16x32_bf16 v[152:155], v[200:203], v[228:231], v[152:155]
    ds_read_b64_tr_b16 v[226:227], v56 offset:17408
    v_mfma_f32_16x16x32_bf16 v[156:159], v[204:207], v[228:231], v[156:159]
    ds_read_b128 v[212:215], v247 offset:2048
    v_mfma_f32_16x16x32_bf16 v[160:163], v[192:195], v[232:235], v[160:163]
    ds_read_b64_tr_b16 v[228:229], v57 offset:16384
    v_mfma_f32_16x16x32_bf16 v[164:167], v[196:199], v[232:235], v[164:167]
    ds_read_b64_tr_b16 v[230:231], v57 offset:17408
    v_mfma_f32_16x16x32_bf16 v[168:171], v[200:203], v[232:235], v[168:171]
    ds_read_b128 v[216:219], v247 offset:4096
    v_mfma_f32_16x16x32_bf16 v[172:175], v[204:207], v[232:235], v[172:175]
    v_mfma_f32_16x16x32_bf16 v[176:179], v[192:195], v[236:239], v[176:179]
    ds_read_b64_tr_b16 v[232:233], v58 offset:16384
    v_mfma_f32_16x16x32_bf16 v[180:183], v[196:199], v[236:239], v[180:183]
    ds_read_b64_tr_b16 v[234:235], v58 offset:17408
    v_mfma_f32_16x16x32_bf16 v[184:187], v[200:203], v[236:239], v[184:187]
    ds_read_b128 v[220:223], v247 offset:6144
    v_mfma_f32_16x16x32_bf16 v[188:191], v[204:207], v[236:239], v[188:191]
    s_waitcnt lgkmcnt(7)
    v_mfma_f32_16x16x32_bf16 v[64:67], v[208:211], v[224:227], v[64:67]
    ds_read_b64_tr_b16 v[236:237], v59 offset:16384
    s_waitcnt lgkmcnt(7)
    v_mfma_f32_16x16x32_bf16 v[68:71], v[212:215], v[224:227], v[68:71]
    ds_read_b64_tr_b16 v[238:239], v59 offset:17408
    s_waitcnt lgkmcnt(5)
    v_mfma_f32_16x16x32_bf16 v[72:75], v[216:219], v[224:227], v[72:75]
    s_waitcnt lgkmcnt(2)
    v_mfma_f32_16x16x32_bf16 v[76:79], v[220:223], v[224:227], v[76:79]
    v_mfma_f32_16x16x32_bf16 v[80:83], v[208:211], v[228:231], v[80:83]
    ds_read_b64_tr_b16 v[224:225], v60 offset:16384
    v_mfma_f32_16x16x32_bf16 v[84:87], v[212:215], v[228:231], v[84:87]
    ds_read_b64_tr_b16 v[226:227], v60 offset:17408
    v_mfma_f32_16x16x32_bf16 v[88:91], v[216:219], v[228:231], v[88:91]
    v_mfma_f32_16x16x32_bf16 v[92:95], v[220:223], v[228:231], v[92:95]
    v_mfma_f32_16x16x32_bf16 v[96:99], v[208:211], v[232:235], v[96:99]
    ds_read_b64_tr_b16 v[228:229], v61 offset:16384
    v_mfma_f32_16x16x32_bf16 v[100:103], v[212:215], v[232:235], v[100:103]
    ds_read_b64_tr_b16 v[230:231], v61 offset:17408
    v_mfma_f32_16x16x32_bf16 v[104:107], v[216:219], v[232:235], v[104:107]
    v_mfma_f32_16x16x32_bf16 v[108:111], v[220:223], v[232:235], v[108:111]
    s_waitcnt lgkmcnt(4)
    v_mfma_f32_16x16x32_bf16 v[112:115], v[208:211], v[236:239], v[112:115]
    ds_read_b64_tr_b16 v[232:233], v62 offset:16384
    v_mfma_f32_16x16x32_bf16 v[116:119], v[212:215], v[236:239], v[116:119]
    ds_read_b64_tr_b16 v[234:235], v62 offset:17408
    v_mfma_f32_16x16x32_bf16 v[120:123], v[216:219], v[236:239], v[120:123]
    v_mfma_f32_16x16x32_bf16 v[124:127], v[220:223], v[236:239], v[124:127]
    s_waitcnt lgkmcnt(4)
    v_mfma_f32_16x16x32_bf16 v[128:131], v[208:211], v[224:227], v[128:131]
    ds_read_b64_tr_b16 v[236:237], v63 offset:16384
    v_mfma_f32_16x16x32_bf16 v[132:135], v[212:215], v[224:227], v[132:135]
    ds_read_b64_tr_b16 v[238:239], v63 offset:17408
    v_mfma_f32_16x16x32_bf16 v[136:139], v[216:219], v[224:227], v[136:139]
    v_mfma_f32_16x16x32_bf16 v[140:143], v[220:223], v[224:227], v[140:143]
    s_waitcnt lgkmcnt(4)
    v_mfma_f32_16x16x32_bf16 v[144:147], v[208:211], v[228:231], v[144:147]
    s_waitcnt lgkmcnt(0)
    s_barrier
    v_add_u32 v240, 32768, v240
    v_add_u32 v247, 32768, v247
    ds_read_b128 v[192:195], v240 offset:0
    s_lshr_b32 s54, s2, 3
    s_lshl_b32 s54, s54, 2
    s_and_b32 s55, s50, 3
    s_add_u32 s54, s54, s55
    s_lshl_b32 s11, s54, 2
    s_lshl_b32 s54, s54, 15
    s_and_b32 s55, s2, 7
    s_lshl_b32 s55, s55, 10
    s_add_u32 s54, s54, s55
    v_lshrrev_b32 v48, 3, v255
    v_lshlrev_b32 v48, 13, v48
    v_and_b32 v49, 7, v255
    v_lshl_add_u32 v48, v49, 7, v48
    s_mov_b64 exec, 0xffffffff
    buffer_load_dword v248, v48, s[36:39], s54 offen
    s_mov_b64 exec, -1
    v_mfma_f32_16x16x32_bf16 v[148:151], v[212:215], v[228:231], v[148:151]
    ds_read_b64_tr_b16 v[224:225], v56 offset:32768
    v_mfma_f32_16x16x32_bf16 v[152:155], v[216:219], v[228:231], v[152:155]
    ds_read_b64_tr_b16 v[226:227], v56 offset:33792
    v_mfma_f32_16x16x32_bf16 v[156:159], v[220:223], v[228:231], v[156:159]
    ds_read_b128 v[196:199], v240 offset:2048
    v_mfma_f32_16x16x32_bf16 v[160:163], v[208:211], v[232:235], v[160:163]
    ds_read_b64_tr_b16 v[228:229], v57 offset:32768
    v_mfma_f32_16x16x32_bf16 v[164:167], v[212:215], v[232:235], v[164:167]
    ds_read_b64_tr_b16 v[230:231], v57 offset:33792
    v_mfma_f32_16x16x32_bf16 v[168:171], v[216:219], v[232:235], v[168:171]
    ds_read_b128 v[200:203], v240 offset:4096
    v_mfma_f32_16x16x32_bf16 v[172:175], v[220:223], v[232:235], v[172:175]
    v_mfma_f32_16x16x32_bf16 v[176:179], v[208:211], v[236:239], v[176:179]
    ds_read_b64_tr_b16 v[232:233], v58 offset:32768
    v_mfma_f32_16x16x32_bf16 v[180:183], v[212:215], v[236:239], v[180:183]
    ds_read_b64_tr_b16 v[234:235], v58 offset:33792
    v_mfma_f32_16x16x32_bf16 v[184:187], v[216:219], v[236:239], v[184:187]
    ds_read_b128 v[204:207], v240 offset:6144
    v_mfma_f32_16x16x32_bf16 v[188:191], v[220:223], v[236:239], v[188:191]
    s_waitcnt lgkmcnt(7)
    v_mfma_f32_16x16x32_bf16 v[64:67], v[192:195], v[224:227], v[64:67]
    ds_read_b64_tr_b16 v[236:237], v59 offset:32768
    s_waitcnt lgkmcnt(7)
    v_mfma_f32_16x16x32_bf16 v[68:71], v[196:199], v[224:227], v[68:71]
    ds_read_b64_tr_b16 v[238:239], v59 offset:33792
    s_waitcnt lgkmcnt(5)
    v_mfma_f32_16x16x32_bf16 v[72:75], v[200:203], v[224:227], v[72:75]
    s_waitcnt lgkmcnt(2)
    v_mfma_f32_16x16x32_bf16 v[76:79], v[204:207], v[224:227], v[76:79]
    v_mfma_f32_16x16x32_bf16 v[80:83], v[192:195], v[228:231], v[80:83]
    ds_read_b64_tr_b16 v[224:225], v60 offset:32768
    v_mfma_f32_16x16x32_bf16 v[84:87], v[196:199], v[228:231], v[84:87]
    ds_read_b64_tr_b16 v[226:227], v60 offset:33792
    v_mfma_f32_16x16x32_bf16 v[88:91], v[200:203], v[228:231], v[88:91]
    v_mfma_f32_16x16x32_bf16 v[92:95], v[204:207], v[228:231], v[92:95]
    v_mfma_f32_16x16x32_bf16 v[96:99], v[192:195], v[232:235], v[96:99]
    ds_read_b64_tr_b16 v[228:229], v61 offset:32768
    v_mfma_f32_16x16x32_bf16 v[100:103], v[196:199], v[232:235], v[100:103]
    ds_read_b64_tr_b16 v[230:231], v61 offset:33792
    v_mfma_f32_16x16x32_bf16 v[104:107], v[200:203], v[232:235], v[104:107]
    v_mfma_f32_16x16x32_bf16 v[108:111], v[204:207], v[232:235], v[108:111]
    s_waitcnt lgkmcnt(4)
    v_mfma_f32_16x16x32_bf16 v[112:115], v[192:195], v[236:239], v[112:115]
    ds_read_b64_tr_b16 v[232:233], v62 offset:32768
    v_mfma_f32_16x16x32_bf16 v[116:119], v[196:199], v[236:239], v[116:119]
    ds_read_b64_tr_b16 v[234:235], v62 offset:33792
    v_mfma_f32_16x16x32_bf16 v[120:123], v[200:203], v[236:239], v[120:123]
    v_mfma_f32_16x16x32_bf16 v[124:127], v[204:207], v[236:239], v[124:127]
    s_waitcnt lgkmcnt(4)
    v_mfma_f32_16x16x32_bf16 v[128:131], v[192:195], v[224:227], v[128:131]
    ds_read_b64_tr_b16 v[236:237], v63 offset:32768
    v_mfma_f32_16x16x32_bf16 v[132:135], v[196:199], v[224:227], v[132:135]
    ds_read_b64_tr_b16 v[238:239], v63 offset:33792
    v_mfma_f32_16x16x32_bf16 v[136:139], v[200:203], v[224:227], v[136:139]
    v_mfma_f32_16x16x32_bf16 v[140:143], v[204:207], v[224:227], v[140:143]
    s_waitcnt lgkmcnt(4)
    v_mfma_f32_16x16x32_bf16 v[144:147], v[192:195], v[228:231], v[144:147]
    s_waitcnt lgkmcnt(0)
    s_barrier
    ds_read_b128 v[208:211], v247 offset:0
    v_bfe_u32 v48, v255, 2, 2
    v_add_u32 v48, s11, v48
    v_mul_u32_u24 v48, 2752, v48
    v_and_b32 v49, 3, v255
    v_lshlrev_b32 v49, 7, v49
    v_min_u32 v49, 380, v49
    v_add_u32 v48, v48, v49
    s_and_b32 s54, s2, 7
    s_mul_i32 s54, s54, 384
    s_mov_b64 exec, 0xffff
    buffer_load_dword v248, v48, s[40:43], s54 offen
    buffer_load_dword v248, v48, s[44:47], s54 offen
    s_mov_b64 exec, -1
    v_mfma_f32_16x16x32_bf16 v[148:151], v[196:199], v[228:231], v[148:151]
    ds_read_b64_tr_b16 v[224:225], v56 offset:49152
    v_mfma_f32_16x16x32_bf16 v[152:155], v[200:203], v[228:231], v[152:155]
    ds_read_b64_tr_b16 v[226:227], v56 offset:50176
    v_mfma_f32_16x16x32_bf16 v[156:159], v[204:207], v[228:231], v[156:159]
    ds_read_b128 v[212:215], v247 offset:2048
    v_mfma_f32_16x16x32_bf16 v[160:163], v[192:195], v[232:235], v[160:163]
    ds_read_b64_tr_b16 v[228:229], v57 offset:49152
    v_mfma_f32_16x16x32_bf16 v[164:167], v[196:199], v[232:235], v[164:167]
    ds_read_b64_tr_b16 v[230:231], v57 offset:50176
    v_mfma_f32_16x16x32_bf16 v[168:171], v[200:203], v[232:235], v[168:171]
    ds_read_b128 v[216:219], v247 offset:4096
    v_mfma_f32_16x16x32_bf16 v[172:175], v[204:207], v[232:235], v[172:175]
    v_mfma_f32_16x16x32_bf16 v[176:179], v[192:195], v[236:239], v[176:179]
    ds_read_b64_tr_b16 v[232:233], v58 offset:49152
    v_mfma_f32_16x16x32_bf16 v[180:183], v[196:199], v[236:239], v[180:183]
    ds_read_b64_tr_b16 v[234:235], v58 offset:50176
    v_mfma_f32_16x16x32_bf16 v[184:187], v[200:203], v[236:239], v[184:187]
    ds_read_b128 v[220:223], v247 offset:6144
    v_mfma_f32_16x16x32_bf16 v[188:191], v[204:207], v[236:239], v[188:191]
    s_waitcnt lgkmcnt(7)
    v_mfma_f32_16x16x32_bf16 v[64:67], v[208:211], v[224:227], v[64:67]
    ds_read_b64_tr_b16 v[236:237], v59 offset:49152
    s_waitcnt lgkmcnt(7)
    v_mfma_f32_16x16x32_bf16 v[68:71], v[212:215], v[224:227], v[68:71]
    ds_read_b64_tr_b16 v[238:239], v59 offset:50176
    s_waitcnt lgkmcnt(5)
    v_mfma_f32_16x16x32_bf16 v[72:75], v[216:219], v[224:227], v[72:75]
    s_waitcnt lgkmcnt(2)
    v_mfma_f32_16x16x32_bf16 v[76:79], v[220:223], v[224:227], v[76:79]
    v_mfma_f32_16x16x32_bf16 v[80:83], v[208:211], v[228:231], v[80:83]
    ds_read_b64_tr_b16 v[224:225], v60 offset:49152
    v_mfma_f32_16x16x32_bf16 v[84:87], v[212:215], v[228:231], v[84:87]
    ds_read_b64_tr_b16 v[226:227], v60 offset:50176
    v_mfma_f32_16x16x32_bf16 v[88:91], v[216:219], v[228:231], v[88:91]
    v_mfma_f32_16x16x32_bf16 v[92:95], v[220:223], v[228:231], v[92:95]
    v_mfma_f32_16x16x32_bf16 v[96:99], v[208:211], v[232:235], v[96:99]
    ds_read_b64_tr_b16 v[228:229], v61 offset:49152
    v_mfma_f32_16x16x32_bf16 v[100:103], v[212:215], v[232:235], v[100:103]
    ds_read_b64_tr_b16 v[230:231], v61 offset:50176
    v_mfma_f32_16x16x32_bf16 v[104:107], v[216:219], v[232:235], v[104:107]
    v_mfma_f32_16x16x32_bf16 v[108:111], v[220:223], v[232:235], v[108:111]
    s_waitcnt lgkmcnt(4)
    v_mfma_f32_16x16x32_bf16 v[112:115], v[208:211], v[236:239], v[112:115]
    ds_read_b64_tr_b16 v[232:233], v62 offset:49152
    v_mfma_f32_16x16x32_bf16 v[116:119], v[212:215], v[236:239], v[116:119]
    ds_read_b64_tr_b16 v[234:235], v62 offset:50176
    v_mfma_f32_16x16x32_bf16 v[120:123], v[216:219], v[236:239], v[120:123]
    v_mfma_f32_16x16x32_bf16 v[124:127], v[220:223], v[236:239], v[124:127]
    s_waitcnt lgkmcnt(4)
    v_mfma_f32_16x16x32_bf16 v[128:131], v[208:211], v[224:227], v[128:131]
    ds_read_b64_tr_b16 v[236:237], v63 offset:49152
    v_mfma_f32_16x16x32_bf16 v[132:135], v[212:215], v[224:227], v[132:135]
    ds_read_b64_tr_b16 v[238:239], v63 offset:50176
    v_mfma_f32_16x16x32_bf16 v[136:139], v[216:219], v[224:227], v[136:139]
    v_mfma_f32_16x16x32_bf16 v[140:143], v[220:223], v[224:227], v[140:143]
    s_waitcnt lgkmcnt(4)
    v_mfma_f32_16x16x32_bf16 v[144:147], v[208:211], v[228:231], v[144:147]
    s_waitcnt lgkmcnt(0)
    s_barrier
    v_add_u32 v240, 32768, v240
    v_add_u32 v247, 32768, v247
    v_and_b32 v50, 15, v255
    v_lshlrev_b32 v50, 2, v50
    s_lshl_b32 s54, s49, 3
    s_sub_u32 s54, 60, s54
    s_lshl_b32 s54, s54, 6
    v_bfe_u32 v51, v255, 4, 1
    v_mul_lo_u32 v51, v51, s54
    v_add_u32 v50, v50, v51
    s_lshl_b32 s61, s52, 6
    s_sub_u32 s61, s61, s54
    s_add_u32 s61, s61, 58724352
    buffer_load_dword v249, v50, s[16:19], s61 offen sc1
    ds_read_b128 v[192:195], v240 offset:0
    v_mfma_f32_16x16x32_bf16 v[148:151], v[212:215], v[228:231], v[148:151]
    ds_read_b64_tr_b16 v[224:225], v56 offset:0
    v_mfma_f32_16x16x32_bf16 v[152:155], v[216:219], v[228:231], v[152:155]
    ds_read_b64_tr_b16 v[226:227], v56 offset:1024
    v_mfma_f32_16x16x32_bf16 v[156:159], v[220:223], v[228:231], v[156:159]
    ds_read_b128 v[196:199], v240 offset:2048
    v_mfma_f32_16x16x32_bf16 v[160:163], v[208:211], v[232:235], v[160:163]
    ds_read_b64_tr_b16 v[228:229], v57 offset:0
    v_mfma_f32_16x16x32_bf16 v[164:167], v[212:215], v[232:235], v[164:167]
    ds_read_b64_tr_b16 v[230:231], v57 offset:1024
    v_mfma_f32_16x16x32_bf16 v[168:171], v[216:219], v[232:235], v[168:171]
    ds_read_b128 v[200:203], v240 offset:4096
    v_mfma_f32_16x16x32_bf16 v[172:175], v[220:223], v[232:235], v[172:175]
    v_mfma_f32_16x16x32_bf16 v[176:179], v[208:211], v[236:239], v[176:179]
    ds_read_b64_tr_b16 v[232:233], v58 offset:0
    v_mfma_f32_16x16x32_bf16 v[180:183], v[212:215], v[236:239], v[180:183]
    ds_read_b64_tr_b16 v[234:235], v58 offset:1024
    v_mfma_f32_16x16x32_bf16 v[184:187], v[216:219], v[236:239], v[184:187]
    ds_read_b128 v[204:207], v240 offset:6144
    v_mfma_f32_16x16x32_bf16 v[188:191], v[220:223], v[236:239], v[188:191]
    s_waitcnt lgkmcnt(7)
    v_mfma_f32_16x16x32_bf16 v[64:67], v[192:195], v[224:227], v[64:67]
    ds_read_b64_tr_b16 v[236:237], v59 offset:0
    s_waitcnt lgkmcnt(7)
    v_mfma_f32_16x16x32_bf16 v[68:71], v[196:199], v[224:227], v[68:71]
    ds_read_b64_tr_b16 v[238:239], v59 offset:1024
    s_waitcnt lgkmcnt(5)
    v_mfma_f32_16x16x32_bf16 v[72:75], v[200:203], v[224:227], v[72:75]
    s_waitcnt lgkmcnt(2)
    v_mfma_f32_16x16x32_bf16 v[76:79], v[204:207], v[224:227], v[76:79]
    v_mfma_f32_16x16x32_bf16 v[80:83], v[192:195], v[228:231], v[80:83]
    ds_read_b64_tr_b16 v[224:225], v60 offset:0
    v_mfma_f32_16x16x32_bf16 v[84:87], v[196:199], v[228:231], v[84:87]
    ds_read_b64_tr_b16 v[226:227], v60 offset:1024
    v_mfma_f32_16x16x32_bf16 v[88:91], v[200:203], v[228:231], v[88:91]
    v_mfma_f32_16x16x32_bf16 v[92:95], v[204:207], v[228:231], v[92:95]
    v_mfma_f32_16x16x32_bf16 v[96:99], v[192:195], v[232:235], v[96:99]
    ds_read_b64_tr_b16 v[228:229], v61 offset:0
    v_mfma_f32_16x16x32_bf16 v[100:103], v[196:199], v[232:235], v[100:103]
    ds_read_b64_tr_b16 v[230:231], v61 offset:1024
    v_mfma_f32_16x16x32_bf16 v[104:107], v[200:203], v[232:235], v[104:107]
    v_mfma_f32_16x16x32_bf16 v[108:111], v[204:207], v[232:235], v[108:111]
    s_waitcnt lgkmcnt(4)
    v_mfma_f32_16x16x32_bf16 v[112:115], v[192:195], v[236:239], v[112:115]
    ds_read_b64_tr_b16 v[232:233], v62 offset:0
    v_mfma_f32_16x16x32_bf16 v[116:119], v[196:199], v[236:239], v[116:119]
    ds_read_b64_tr_b16 v[234:235], v62 offset:1024
    v_mfma_f32_16x16x32_bf16 v[120:123], v[200:203], v[236:239], v[120:123]
    v_mfma_f32_16x16x32_bf16 v[124:127], v[204:207], v[236:239], v[124:127]
    s_waitcnt lgkmcnt(4)
    v_mfma_f32_16x16x32_bf16 v[128:131], v[192:195], v[224:227], v[128:131]
    ds_read_b64_tr_b16 v[236:237], v63 offset:0
    v_mfma_f32_16x16x32_bf16 v[132:135], v[196:199], v[224:227], v[132:135]
    ds_read_b64_tr_b16 v[238:239], v63 offset:1024
    v_mfma_f32_16x16x32_bf16 v[136:139], v[200:203], v[224:227], v[136:139]
    v_mfma_f32_16x16x32_bf16 v[140:143], v[204:207], v[224:227], v[140:143]
    s_waitcnt lgkmcnt(4)
    v_mfma_f32_16x16x32_bf16 v[144:147], v[192:195], v[228:231], v[144:147]
    s_waitcnt lgkmcnt(0)
    s_barrier
    v_and_b32 v52, 7, v255
    v_lshlrev_b32 v52, 2, v52
    s_lshl_b32 s54, s48, 5
    s_add_u32 s54, s54, 58785792
    buffer_load_dword v53, v52, s[16:19], s54 offen sc1
    ds_read_b128 v[208:211], v247 offset:0
    v_mfma_f32_16x16x32_bf16 v[148:151], v[196:199], v[228:231], v[148:151]
    ds_read_b64_tr_b16 v[224:225], v56 offset:16384
    v_mfma_f32_16x16x32_bf16 v[152:155], v[200:203], v[228:231], v[152:155]
    ds_read_b64_tr_b16 v[226:227], v56 offset:17408
    v_mfma_f32_16x16x32_bf16 v[156:159], v[204:207], v[228:231], v[156:159]
    ds_read_b128 v[212:215], v247 offset:2048
    v_mfma_f32_16x16x32_bf16 v[160:163], v[192:195], v[232:235], v[160:163]
    ds_read_b64_tr_b16 v[228:229], v57 offset:16384
    v_mfma_f32_16x16x32_bf16 v[164:167], v[196:199], v[232:235], v[164:167]
    ds_read_b64_tr_b16 v[230:231], v57 offset:17408
    v_mfma_f32_16x16x32_bf16 v[168:171], v[200:203], v[232:235], v[168:171]
    ds_read_b128 v[216:219], v247 offset:4096
    v_mfma_f32_16x16x32_bf16 v[172:175], v[204:207], v[232:235], v[172:175]
    v_mfma_f32_16x16x32_bf16 v[176:179], v[192:195], v[236:239], v[176:179]
    ds_read_b64_tr_b16 v[232:233], v58 offset:16384
    v_mfma_f32_16x16x32_bf16 v[180:183], v[196:199], v[236:239], v[180:183]
    ds_read_b64_tr_b16 v[234:235], v58 offset:17408
    v_mfma_f32_16x16x32_bf16 v[184:187], v[200:203], v[236:239], v[184:187]
    ds_read_b128 v[220:223], v247 offset:6144
    v_mfma_f32_16x16x32_bf16 v[188:191], v[204:207], v[236:239], v[188:191]
    s_waitcnt lgkmcnt(7)
    v_mfma_f32_16x16x32_bf16 v[64:67], v[208:211], v[224:227], v[64:67]
    ds_read_b64_tr_b16 v[236:237], v59 offset:16384
    s_waitcnt lgkmcnt(7)
    v_mfma_f32_16x16x32_bf16 v[68:71], v[212:215], v[224:227], v[68:71]
    ds_read_b64_tr_b16 v[238:239], v59 offset:17408
    s_waitcnt lgkmcnt(5)
    v_mfma_f32_16x16x32_bf16 v[72:75], v[216:219], v[224:227], v[72:75]
    s_waitcnt lgkmcnt(2)
    v_mfma_f32_16x16x32_bf16 v[76:79], v[220:223], v[224:227], v[76:79]
    v_mfma_f32_16x16x32_bf16 v[80:83], v[208:211], v[228:231], v[80:83]
    ds_read_b64_tr_b16 v[224:225], v60 offset:16384
    v_mfma_f32_16x16x32_bf16 v[84:87], v[212:215], v[228:231], v[84:87]
    ds_read_b64_tr_b16 v[226:227], v60 offset:17408
    v_mfma_f32_16x16x32_bf16 v[88:91], v[216:219], v[228:231], v[88:91]
    v_mfma_f32_16x16x32_bf16 v[92:95], v[220:223], v[228:231], v[92:95]
    v_mfma_f32_16x16x32_bf16 v[96:99], v[208:211], v[232:235], v[96:99]
    ds_read_b64_tr_b16 v[228:229], v61 offset:16384
    v_mfma_f32_16x16x32_bf16 v[100:103], v[212:215], v[232:235], v[100:103]
    ds_read_b64_tr_b16 v[230:231], v61 offset:17408
    v_mfma_f32_16x16x32_bf16 v[104:107], v[216:219], v[232:235], v[104:107]
    v_mfma_f32_16x16x32_bf16 v[108:111], v[220:223], v[232:235], v[108:111]
    s_waitcnt lgkmcnt(4)
    v_mfma_f32_16x16x32_bf16 v[112:115], v[208:211], v[236:239], v[112:115]
    ds_read_b64_tr_b16 v[232:233], v62 offset:16384
    v_mfma_f32_16x16x32_bf16 v[116:119], v[212:215], v[236:239], v[116:119]
    ds_read_b64_tr_b16 v[234:235], v62 offset:17408
    v_mfma_f32_16x16x32_bf16 v[120:123], v[216:219], v[236:239], v[120:123]
    v_mfma_f32_16x16x32_bf16 v[124:127], v[220:223], v[236:239], v[124:127]
    s_waitcnt lgkmcnt(4)
    v_mfma_f32_16x16x32_bf16 v[128:131], v[208:211], v[224:227], v[128:131]
    ds_read_b64_tr_b16 v[236:237], v63 offset:16384
    v_mfma_f32_16x16x32_bf16 v[132:135], v[212:215], v[224:227], v[132:135]
    ds_read_b64_tr_b16 v[238:239], v63 offset:17408
    v_mfma_f32_16x16x32_bf16 v[136:139], v[216:219], v[224:227], v[136:139]
    v_mfma_f32_16x16x32_bf16 v[140:143], v[220:223], v[224:227], v[140:143]
    s_waitcnt lgkmcnt(4)
    v_mfma_f32_16x16x32_bf16 v[144:147], v[208:211], v[228:231], v[144:147]
    s_waitcnt vmcnt(1)
    v_cmp_ne_u32 vcc, s51, v249
    s_cbranch_vccz H_pxn_ok
    s_mov_b32 s57, 0x40000
H_pxn:
    s_sleep 4
    buffer_load_dword v249, v50, s[16:19], s61 offen sc1
    s_waitcnt vmcnt(0)
    v_cmp_ne_u32 vcc, s51, v249
    s_sub_u32 s57, s57, 1
    s_cbranch_scc1 H_pxn_ok
    s_cbranch_vccnz H_pxn
H_pxn_ok:
    s_waitcnt lgkmcnt(0)
    s_barrier
    v_add_u32 v240, 4294901760, v240
    v_add_u32 v247, 4294901760, v247
    v_and_b32 v50, 15, v255
    v_lshlrev_b32 v50, 7, v50
    s_lshl_b32 s54, s49, 3
    s_sub_u32 s54, 60, s54
    s_lshl_b32 s54, s54, 15
    v_bfe_u32 v51, v255, 4, 1
    v_mul_lo_u32 v51, v51, s54
    v_add_u32 v50, v50, v51
    s_sub_u32 s61, s13, s54
    s_and_b32 s54, s48, 3
    s_lshl_b32 s54, s54, 11
    s_add_u32 s61, s61, s54
    s_mov_b64 exec, 0xffffffff
    buffer_load_dword v248, v50, s[16:19], s61 offen
    s_mov_b64 exec, -1
    s_add_u32 s61, s61, 8192
    ds_read_b128 v[192:195], v240 offset:0
    v_mfma_f32_16x16x32_bf16 v[148:151], v[212:215], v[228:231], v[148:151]
    ds_read_b64_tr_b16 v[224:225], v56 offset:32768
    v_mfma_f32_16x16x32_bf16 v[152:155], v[216:219], v[228:231], v[152:155]
    ds_read_b64_tr_b16 v[226:227], v56 offset:33792
    v_mfma_f32_16x16x32_bf16 v[156:159], v[220:223], v[228:231], v[156:159]
    ds_read_b128 v[196:199], v240 offset:2048
    v_mfma_f32_16x16x32_bf16 v[160:163], v[208:211], v[232:235], v[160:163]
    ds_read_b64_tr_b16 v[228:229], v57 offset:32768
    v_mfma_f32_16x16x32_bf16 v[164:167], v[212:215], v[232:235], v[164:167]
    ds_read_b64_tr_b16 v[230:231], v57 offset:33792
    v_mfma_f32_16x16x32_bf16 v[168:171], v[216:219], v[232:235], v[168:171]
    ds_read_b128 v[200:203], v240 offset:4096
    v_mfma_f32_16x16x32_bf16 v[172:175], v[220:223], v[232:235], v[172:175]
    v_mfma_f32_16x16x32_bf16 v[176:179], v[208:211], v[236:239], v[176:179]
    ds_read_b64_tr_b16 v[232:233], v58 offset:32768
    v_mfma_f32_16x16x32_bf16 v[180:183], v[212:215], v[236:239], v[180:183]
    ds_read_b64_tr_b16 v[234:235], v58 offset:33792
    v_mfma_f32_16x16x32_bf16 v[184:187], v[216:219], v[236:239], v[184:187]
    ds_read_b128 v[204:207], v240 offset:6144
    v_mfma_f32_16x16x32_bf16 v[188:191], v[220:223], v[236:239], v[188:191]
    s_waitcnt lgkmcnt(7)
    v_mfma_f32_16x16x32_bf16 v[64:67], v[192:195], v[224:227], v[64:67]
    ds_read_b64_tr_b16 v[236:237], v59 offset:32768
    s_waitcnt lgkmcnt(7)
    v_mfma_f32_16x16x32_bf16 v[68:71], v[196:199], v[224:227], v[68:71]
    ds_read_b64_tr_b16 v[238:239], v59 offset:33792
    s_waitcnt lgkmcnt(5)
    v_mfma_f32_16x16x32_bf16 v[72:75], v[200:203], v[224:227], v[72:75]
    s_waitcnt lgkmcnt(2)
    v_mfma_f32_16x16x32_bf16 v[76:79], v[204:207], v[224:227], v[76:79]
    v_mfma_f32_16x16x32_bf16 v[80:83], v[192:195], v[228:231], v[80:83]
    ds_read_b64_tr_b16 v[224:225], v60 offset:32768
    v_mfma_f32_16x16x32_bf16 v[84:87], v[196:199], v[228:231], v[84:87]
    ds_read_b64_tr_b16 v[226:227], v60 offset:33792
    v_mfma_f32_16x16x32_bf16 v[88:91], v[200:203], v[228:231], v[88:91]
    v_mfma_f32_16x16x32_bf16 v[92:95], v[204:207], v[228:231], v[92:95]
    v_mfma_f32_16x16x32_bf16 v[96:99], v[192:195], v[232:235], v[96:99]
    ds_read_b64_tr_b16 v[228:229], v61 offset:32768
    v_mfma_f32_16x16x32_bf16 v[100:103], v[196:199], v[232:235], v[100:103]
    ds_read_b64_tr_b16 v[230:231], v61 offset:33792
    v_mfma_f32_16x16x32_bf16 v[104:107], v[200:203], v[232:235], v[104:107]
    v_mfma_f32_16x16x32_bf16 v[108:111], v[204:207], v[232:235], v[108:111]
    s_waitcnt lgkmcnt(4)
    v_mfma_f32_16x16x32_bf16 v[112:115], v[192:195], v[236:239], v[112:115]
    ds_read_b64_tr_b16 v[232:233], v62 offset:32768
    v_mfma_f32_16x16x32_bf16 v[116:119], v[196:199], v[236:239], v[116:119]
    ds_read_b64_tr_b16 v[234:235], v62 offset:33792
    v_mfma_f32_16x16x32_bf16 v[120:123], v[200:203], v[236:239], v[120:123]
    v_mfma_f32_16x16x32_bf16 v[124:127], v[204:207], v[236:239], v[124:127]
    s_waitcnt lgkmcnt(4)
    v_mfma_f32_16x16x32_bf16 v[128:131], v[192:195], v[224:227], v[128:131]
    ds_read_b64_tr_b16 v[236:237], v63 offset:32768
    v_mfma_f32_16x16x32_bf16 v[132:135], v[196:199], v[224:227], v[132:135]
    ds_read_b64_tr_b16 v[238:239], v63 offset:33792
    v_mfma_f32_16x16x32_bf16 v[136:139], v[200:203], v[224:227], v[136:139]
    v_mfma_f32_16x16x32_bf16 v[140:143], v[204:207], v[224:227], v[140:143]
    s_waitcnt lgkmcnt(4)
    v_mfma_f32_16x16x32_bf16 v[144:147], v[192:195], v[228:231], v[144:147]
    s_waitcnt lgkmcnt(0)
    s_barrier
    s_mov_b64 exec, 0xffffffff
    buffer_load_dword v248, v50, s[16:19], s61 offen
    s_mov_b64 exec, -1
    s_add_u32 s61, s61, 8192
    ds_read_b128 v[208:211], v247 offset:0
    v_mfma_f32_16x16x32_bf16 v[148:151], v[196:199], v[228:231], v[148:151]
    ds_read_b64_tr_b16 v[224:225], v56 offset:49152
    v_mfma_f32_16x16x32_bf16 v[152:155], v[200:203], v[228:231], v[152:155]
    ds_read_b64_tr_b16 v[226:227], v56 offset:50176
    v_mfma_f32_16x16x32_bf16 v[156:159], v[204:207], v[228:231], v[156:159]
    ds_read_b128 v[212:215], v247 offset:2048
    v_mfma_f32_16x16x32_bf16 v[160:163], v[192:195], v[232:235], v[160:163]
    ds_read_b64_tr_b16 v[228:229], v57 offset:49152
    v_mfma_f32_16x16x32_bf16 v[164:167], v[196:199], v[232:235], v[164:167]
    ds_read_b64_tr_b16 v[230:231], v57 offset:50176
    v_mfma_f32_16x16x32_bf16 v[168:171], v[200:203], v[232:235], v[168:171]
    ds_read_b128 v[216:219], v247 offset:4096
    v_mfma_f32_16x16x32_bf16 v[172:175], v[204:207], v[232:235], v[172:175]
    v_mfma_f32_16x16x32_bf16 v[176:179], v[192:195], v[236:239], v[176:179]
    ds_read_b64_tr_b16 v[232:233], v58 offset:49152
    v_mfma_f32_16x16x32_bf16 v[180:183], v[196:199], v[236:239], v[180:183]
    ds_read_b64_tr_b16 v[234:235], v58 offset:50176
    v_mfma_f32_16x16x32_bf16 v[184:187], v[200:203], v[236:239], v[184:187]
    ds_read_b128 v[220:223], v247 offset:6144
    v_mfma_f32_16x16x32_bf16 v[188:191], v[204:207], v[236:239], v[188:191]
    s_waitcnt lgkmcnt(7)
    v_mfma_f32_16x16x32_bf16 v[64:67], v[208:211], v[224:227], v[64:67]
    ds_read_b64_tr_b16 v[236:237], v59 offset:49152
    s_waitcnt lgkmcnt(7)
    v_mfma_f32_16x16x32_bf16 v[68:71], v[212:215], v[224:227], v[68:71]
    ds_read_b64_tr_b16 v[238:239], v59 offset:50176
    s_waitcnt lgkmcnt(5)
    v_mfma_f32_16x16x32_bf16 v[72:75], v[216:219], v[224:227], v[72:75]
    s_waitcnt lgkmcnt(2)
    v_mfma_f32_16x16x32_bf16 v[76:79], v[220:223], v[224:227], v[76:79]
    v_mfma_f32_16x16x32_bf16 v[80:83], v[208:211], v[228:231], v[80:83]
    ds_read_b64_tr_b16 v[224:225], v60 offset:49152
    v_mfma_f32_16x16x32_bf16 v[84:87], v[212:215], v[228:231], v[84:87]
    ds_read_b64_tr_b16 v[226:227], v60 offset:50176
    v_mfma_f32_16x16x32_bf16 v[88:91], v[216:219], v[228:231], v[88:91]
    v_mfma_f32_16x16x32_bf16 v[92:95], v[220:223], v[228:231], v[92:95]
    v_mfma_f32_16x16x32_bf16 v[96:99], v[208:211], v[232:235], v[96:99]
    ds_read_b64_tr_b16 v[228:229], v61 offset:49152
    v_mfma_f32_16x16x32_bf16 v[100:103], v[212:215], v[232:235], v[100:103]
    ds_read_b64_tr_b16 v[230:231], v61 offset:50176
    v_mfma_f32_16x16x32_bf16 v[104:107], v[216:219], v[232:235], v[104:107]
    v_mfma_f32_16x16x32_bf16 v[108:111], v[220:223], v[232:235], v[108:111]
    s_waitcnt lgkmcnt(4)
    v_mfma_f32_16x16x32_bf16 v[112:115], v[208:211], v[236:239], v[112:115]
    ds_read_b64_tr_b16 v[232:233], v62 offset:49152
    v_mfma_f32_16x16x32_bf16 v[116:119], v[212:215], v[236:239], v[116:119]
    ds_read_b64_tr_b16 v[234:235], v62 offset:50176
    v_mfma_f32_16x16x32_bf16 v[120:123], v[216:219], v[236:239], v[120:123]
    v_mfma_f32_16x16x32_bf16 v[124:127], v[220:223], v[236:239], v[124:127]
    s_waitcnt lgkmcnt(4)
    v_mfma_f32_16x16x32_bf16 v[128:131], v[208:211], v[224:227], v[128:131]
    ds_read_b64_tr_b16 v[236:237], v63 offset:49152
    v_mfma_f32_16x16x32_bf16 v[132:135], v[212:215], v[224:227], v[132:135]
    ds_read_b64_tr_b16 v[238:239], v63 offset:50176
    v_mfma_f32_16x16x32_bf16 v[136:139], v[216:219], v[224:227], v[136:139]
    v_mfma_f32_16x16x32_bf16 v[140:143], v[220:223], v[224:227], v[140:143]
    s_waitcnt lgkmcnt(4)
    v_mfma_f32_16x16x32_bf16 v[144:147], v[208:211], v[228:231], v[144:147]
    s_waitcnt lgkmcnt(0)
    s_barrier
    v_add_u32 v240, 32768, v240
    v_add_u32 v247, 32768, v247
    s_mov_b64 exec, 0xffffffff
    buffer_load_dword v248, v50, s[16:19], s61 offen
    s_mov_b64 exec, -1
    s_add_u32 s61, s61, 8192
    ds_read_b128 v[192:195], v240 offset:0
    v_mfma_f32_16x16x32_bf16 v[148:151], v[212:215], v[228:231], v[148:151]
    ds_read_b64_tr_b16 v[224:225], v56 offset:0
    v_mfma_f32_16x16x32_bf16 v[152:155], v[216:219], v[228:231], v[152:155]
    ds_read_b64_tr_b16 v[226:227], v56 offset:1024
    v_mfma_f32_16x16x32_bf16 v[156:159], v[220:223], v[228:231], v[156:159]
    ds_read_b128 v[196:199], v240 offset:2048
    v_mfma_f32_16x16x32_bf16 v[160:163], v[208:211], v[232:235], v[160:163]
    ds_read_b64_tr_b16 v[228:229], v57 offset:0
    v_mfma_f32_16x16x32_bf16 v[164:167], v[212:215], v[232:235], v[164:167]
    ds_read_b64_tr_b16 v[230:231], v57 offset:1024
    v_mfma_f32_16x16x32_bf16 v[168:171], v[216:219], v[232:235], v[168:171]
    ds_read_b128 v[200:203], v240 offset:4096
    v_mfma_f32_16x16x32_bf16 v[172:175], v[220:223], v[232:235], v[172:175]
    v_mfma_f32_16x16x32_bf16 v[176:179], v[208:211], v[236:239], v[176:179]
    ds_read_b64_tr_b16 v[232:233], v58 offset:0
    v_mfma_f32_16x16x32_bf16 v[180:183], v[212:215], v[236:239], v[180:183]
    ds_read_b64_tr_b16 v[234:235], v58 offset:1024
    v_mfma_f32_16x16x32_bf16 v[184:187], v[216:219], v[236:239], v[184:187]
    ds_read_b128 v[204:207], v240 offset:6144
    v_mfma_f32_16x16x32_bf16 v[188:191], v[220:223], v[236:239], v[188:191]
    s_waitcnt lgkmcnt(7)
    v_mfma_f32_16x16x32_bf16 v[64:67], v[192:195], v[224:227], v[64:67]
    ds_read_b64_tr_b16 v[236:237], v59 offset:0
    s_waitcnt lgkmcnt(7)
    v_mfma_f32_16x16x32_bf16 v[68:71], v[196:199], v[224:227], v[68:71]
    ds_read_b64_tr_b16 v[238:239], v59 offset:1024
    s_waitcnt lgkmcnt(5)
    v_mfma_f32_16x16x32_bf16 v[72:75], v[200:203], v[224:227], v[72:75]
    s_waitcnt lgkmcnt(2)
    v_mfma_f32_16x16x32_bf16 v[76:79], v[204:207], v[224:227], v[76:79]
    v_mfma_f32_16x16x32_bf16 v[80:83], v[192:195], v[228:231], v[80:83]
    ds_read_b64_tr_b16 v[224:225], v60 offset:0
    v_mfma_f32_16x16x32_bf16 v[84:87], v[196:199], v[228:231], v[84:87]
    ds_read_b64_tr_b16 v[226:227], v60 offset:1024
    v_mfma_f32_16x16x32_bf16 v[88:91], v[200:203], v[228:231], v[88:91]
    v_mfma_f32_16x16x32_bf16 v[92:95], v[204:207], v[228:231], v[92:95]
    v_mfma_f32_16x16x32_bf16 v[96:99], v[192:195], v[232:235], v[96:99]
    ds_read_b64_tr_b16 v[228:229], v61 offset:0
    v_mfma_f32_16x16x32_bf16 v[100:103], v[196:199], v[232:235], v[100:103]
    ds_read_b64_tr_b16 v[230:231], v61 offset:1024
    v_mfma_f32_16x16x32_bf16 v[104:107], v[200:203], v[232:235], v[104:107]
    v_mfma_f32_16x16x32_bf16 v[108:111], v[204:207], v[232:235], v[108:111]
    s_waitcnt lgkmcnt(4)
    v_mfma_f32_16x16x32_bf16 v[112:115], v[192:195], v[236:239], v[112:115]
    ds_read_b64_tr_b16 v[232:233], v62 offset:0
    v_mfma_f32_16x16x32_bf16 v[116:119], v[196:199], v[236:239], v[116:119]
    ds_read_b64_tr_b16 v[234:235], v62 offset:1024
    v_mfma_f32_16x16x32_bf16 v[120:123], v[200:203], v[236:239], v[120:123]
    v_mfma_f32_16x16x32_bf16 v[124:127], v[204:207], v[236:239], v[124:127]
    s_waitcnt lgkmcnt(4)
    v_mfma_f32_16x16x32_bf16 v[128:131], v[192:195], v[224:227], v[128:131]
    ds_read_b64_tr_b16 v[236:237], v63 offset:0
    v_mfma_f32_16x16x32_bf16 v[132:135], v[196:199], v[224:227], v[132:135]
    ds_read_b64_tr_b16 v[238:239], v63 offset:1024
    v_mfma_f32_16x16x32_bf16 v[136:139], v[200:203], v[224:227], v[136:139]
    v_mfma_f32_16x16x32_bf16 v[140:143], v[204:207], v[224:227], v[140:143]
    s_waitcnt lgkmcnt(4)
    v_mfma_f32_16x16x32_bf16 v[144:147], v[192:195], v[228:231], v[144:147]
    s_waitcnt lgkmcnt(0)
    s_barrier
    s_mov_b64 exec, 0xffffffff
    buffer_load_dword v248, v50, s[16:19], s61 offen
    s_mov_b64 exec, -1
    s_add_u32 s61, s61, 8192
    ds_read_b128 v[208:211], v247 offset:0
    buffer_load_dwordx4 v[0:3], v254, s[16:19], s13 offen offset:0
    v_mfma_f32_16x16x32_bf16 v[148:151], v[196:199], v[228:231], v[148:151]
    ds_read_b64_tr_b16 v[224:225], v56 offset:16384
    buffer_load_dwordx4 v[4:7], v254, s[16:19], s13 offen offset:1024
    v_mfma_f32_16x16x32_bf16 v[152:155], v[200:203], v[228:231], v[152:155]
    ds_read_b64_tr_b16 v[226:227], v56 offset:17408
    buffer_load_dwordx4 v[8:11], v254, s[16:19], s13 offen offset:2048
    v_mfma_f32_16x16x32_bf16 v[156:159], v[204:207], v[228:231], v[156:159]
    ds_read_b128 v[212:215], v247 offset:2048
    buffer_load_dwordx4 v[12:15], v254, s[16:19], s13 offen offset:3072
    v_mfma_f32_16x16x32_bf16 v[160:163], v[192:195], v[232:235], v[160:163]
    ds_read_b64_tr_b16 v[228:229], v57 offset:16384
    s_add_u32 s13, s13, 4096
    v_mfma_f32_16x16x32_bf16 v[164:167], v[196:199], v[232:235], v[164:167]
    ds_read_b64_tr_b16 v[230:231], v57 offset:17408
    v_mfma_f32_16x16x32_bf16 v[168:171], v[200:203], v[232:235], v[168:171]
    ds_read_b128 v[216:219], v247 offset:4096
    v_mfma_f32_16x16x32_bf16 v[172:175], v[204:207], v[232:235], v[172:175]
    v_mfma_f32_16x16x32_bf16 v[176:179], v[192:195], v[236:239], v[176:179]
    ds_read_b64_tr_b16 v[232:233], v58 offset:16384
    v_mfma_f32_16x16x32_bf16 v[180:183], v[196:199], v[236:239], v[180:183]
    ds_read_b64_tr_b16 v[234:235], v58 offset:17408
    v_mfma_f32_16x16x32_bf16 v[184:187], v[200:203], v[236:239], v[184:187]
    ds_read_b128 v[220:223], v247 offset:6144
    v_mfma_f32_16x16x32_bf16 v[188:191], v[204:207], v[236:239], v[188:191]
    s_waitcnt lgkmcnt(7)
    v_mfma_f32_16x16x32_bf16 v[64:67], v[208:211], v[224:227], v[64:67]
    ds_read_b64_tr_b16 v[236:237], v59 offset:16384
    s_waitcnt lgkmcnt(7)
    v_mfma_f32_16x16x32_bf16 v[68:71], v[212:215], v[224:227], v[68:71]
    ds_read_b64_tr_b16 v[238:239], v59 offset:17408
    s_waitcnt lgkmcnt(5)
    v_mfma_f32_16x16x32_bf16 v[72:75], v[216:219], v[224:227], v[72:75]
    s_waitcnt lgkmcnt(2)
    v_mfma_f32_16x16x32_bf16 v[76:79], v[220:223], v[224:227], v[76:79]
    v_mfma_f32_16x16x32_bf16 v[80:83], v[208:211], v[228:231], v[80:83]
    ds_read_b64_tr_b16 v[224:225], v60 offset:16384
    v_mfma_f32_16x16x32_bf16 v[84:87], v[212:215], v[228:231], v[84:87]
    ds_read_b64_tr_b16 v[226:227], v60 offset:17408
    v_mfma_f32_16x16x32_bf16 v[88:91], v[216:219], v[228:231], v[88:91]
    v_mfma_f32_16x16x32_bf16 v[92:95], v[220:223], v[228:231], v[92:95]
    v_mfma_f32_16x16x32_bf16 v[96:99], v[208:211], v[232:235], v[96:99]
    ds_read_b64_tr_b16 v[228:229], v61 offset:16384
    v_mfma_f32_16x16x32_bf16 v[100:103], v[212:215], v[232:235], v[100:103]
    ds_read_b64_tr_b16 v[230:231], v61 offset:17408
    v_mfma_f32_16x16x32_bf16 v[104:107], v[216:219], v[232:235], v[104:107]
    v_mfma_f32_16x16x32_bf16 v[108:111], v[220:223], v[232:235], v[108:111]
    s_waitcnt lgkmcnt(4)
    v_mfma_f32_16x16x32_bf16 v[112:115], v[208:211], v[236:239], v[112:115]
    ds_read_b64_tr_b16 v[232:233], v62 offset:16384
    v_mfma_f32_16x16x32_bf16 v[116:119], v[212:215], v[236:239], v[116:119]
    ds_read_b64_tr_b16 v[234:235], v62 offset:17408
    v_mfma_f32_16x16x32_bf16 v[120:123], v[216:219], v[236:239], v[120:123]
    v_mfma_f32_16x16x32_bf16 v[124:127], v[220:223], v[236:239], v[124:127]
    s_waitcnt lgkmcnt(4)
    v_mfma_f32_16x16x32_bf16 v[128:131], v[208:211], v[224:227], v[128:131]
    ds_read_b64_tr_b16 v[236:237], v63 offset:16384
    v_mfma_f32_16x16x32_bf16 v[132:135], v[212:215], v[224:227], v[132:135]
    ds_read_b64_tr_b16 v[238:239], v63 offset:17408
    v_mfma_f32_16x16x32_bf16 v[136:139], v[216:219], v[224:227], v[136:139]
    v_mfma_f32_16x16x32_bf16 v[140:143], v[220:223], v[224:227], v[140:143]
    s_waitcnt lgkmcnt(4)
    v_mfma_f32_16x16x32_bf16 v[144:147], v[208:211], v[228:231], v[144:147]
    s_waitcnt lgkmcnt(0)
    s_barrier
    v_add_u32 v240, 32768, v240
    v_add_u32 v247, 32768, v247
    s_waitcnt vmcnt(8)
    v_cmp_ne_u32 vcc, s15, v53
    s_nop 1
    s_or_b32 s15, vcc_lo, vcc_hi
    ds_read_b128 v[192:195], v240 offset:0
    buffer_load_dwordx4 v[16:19], v254, s[16:19], s13 offen offset:0
    v_mfma_f32_16x16x32_bf16 v[148:151], v[212:215], v[228:231], v[148:151]
    ds_read_b64_tr_b16 v[224:225], v56 offset:32768
    buffer_load_dwordx4 v[20:23], v254, s[16:19], s13 offen offset:1024
    v_mfma_f32_16x16x32_bf16 v[152:155], v[216:219], v[228:231], v[152:155]
    ds_read_b64_tr_b16 v[226:227], v56 offset:33792
    buffer_load_dwordx4 v[24:27], v254, s[16:19], s13 offen offset:2048
    v_mfma_f32_16x16x32_bf16 v[156:159], v[220:223], v[228:231], v[156:159]
    ds_read_b128 v[196:199], v240 offset:2048
    buffer_load_dwordx4 v[28:31], v254, s[16:19], s13 offen offset:3072
    v_mfma_f32_16x16x32_bf16 v[160:163], v[208:211], v[232:235], v[160:163]
    ds_read_b64_tr_b16 v[228:229], v57 offset:32768
    s_add_u32 s13, s13, 4096
    v_mfma_f32_16x16x32_bf16 v[164:167], v[212:215], v[232:235], v[164:167]
    ds_read_b64_tr_b16 v[230:231], v57 offset:33792
    v_mfma_f32_16x16x32_bf16 v[168:171], v[216:219], v[232:235], v[168:171]
    ds_read_b128 v[200:203], v240 offset:4096
    v_mfma_f32_16x16x32_bf16 v[172:175], v[220:223], v[232:235], v[172:175]
    v_mfma_f32_16x16x32_bf16 v[176:179], v[208:211], v[236:239], v[176:179]
    ds_read_b64_tr_b16 v[232:233], v58 offset:32768
    v_mfma_f32_16x16x32_bf16 v[180:183], v[212:215], v[236:239], v[180:183]
    ds_read_b64_tr_b16 v[234:235], v58 offset:33792
    v_mfma_f32_16x16x32_bf16 v[184:187], v[216:219], v[236:239], v[184:187]
    ds_read_b128 v[204:207], v240 offset:6144
    v_mfma_f32_16x16x32_bf16 v[188:191], v[220:223], v[236:239], v[188:191]
    s_waitcnt lgkmcnt(7)
    v_mfma_f32_16x16x32_bf16 v[64:67], v[192:195], v[224:227], v[64:67]
    ds_read_b64_tr_b16 v[236:237], v59 offset:32768
    s_waitcnt lgkmcnt(7)
    v_mfma_f32_16x16x32_bf16 v[68:71], v[196:199], v[224:227], v[68:71]
    ds_read_b64_tr_b16 v[238:239], v59 offset:33792
    s_waitcnt lgkmcnt(5)
    v_mfma_f32_16x16x32_bf16 v[72:75], v[200:203], v[224:227], v[72:75]
    s_waitcnt lgkmcnt(2)
    v_mfma_f32_16x16x32_bf16 v[76:79], v[204:207], v[224:227], v[76:79]
    v_mfma_f32_16x16x32_bf16 v[80:83], v[192:195], v[228:231], v[80:83]
    ds_read_b64_tr_b16 v[224:225], v60 offset:32768
    v_mfma_f32_16x16x32_bf16 v[84:87], v[196:199], v[228:231], v[84:87]
    ds_read_b64_tr_b16 v[226:227], v60 offset:33792
    v_mfma_f32_16x16x32_bf16 v[88:91], v[200:203], v[228:231], v[88:91]
    v_mfma_f32_16x16x32_bf16 v[92:95], v[204:207], v[228:231], v[92:95]
    v_mfma_f32_16x16x32_bf16 v[96:99], v[192:195], v[232:235], v[96:99]
    ds_read_b64_tr_b16 v[228:229], v61 offset:32768
    v_mfma_f32_16x16x32_bf16 v[100:103], v[196:199], v[232:235], v[100:103]
    ds_read_b64_tr_b16 v[230:231], v61 offset:33792
    v_mfma_f32_16x16x32_bf16 v[104:107], v[200:203], v[232:235], v[104:107]
    v_mfma_f32_16x16x32_bf16 v[108:111], v[204:207], v[232:235], v[108:111]
    s_waitcnt lgkmcnt(4)
    v_mfma_f32_16x16x32_bf16 v[112:115], v[192:195], v[236:239], v[112:115]
    ds_read_b64_tr_b16 v[232:233], v62 offset:32768
    v_mfma_f32_16x16x32_bf16 v[116:119], v[196:199], v[236:239], v[116:119]
    ds_read_b64_tr_b16 v[234:235], v62 offset:33792
    v_mfma_f32_16x16x32_bf16 v[120:123], v[200:203], v[236:239], v[120:123]
    v_mfma_f32_16x16x32_bf16 v[124:127], v[204:207], v[236:239], v[124:127]
    s_waitcnt lgkmcnt(4)
    v_mfma_f32_16x16x32_bf16 v[128:131], v[192:195], v[224:227], v[128:131]
    ds_read_b64_tr_b16 v[236:237], v63 offset:32768
    v_mfma_f32_16x16x32_bf16 v[132:135], v[196:199], v[224:227], v[132:135]
    ds_read_b64_tr_b16 v[238:239], v63 offset:33792
    v_mfma_f32_16x16x32_bf16 v[136:139], v[200:203], v[224:227], v[136:139]
    v_mfma_f32_16x16x32_bf16 v[140:143], v[204:207], v[224:227], v[140:143]
    s_waitcnt lgkmcnt(4)
    v_mfma_f32_16x16x32_bf16 v[144:147], v[192:195], v[228:231], v[144:147]
    s_waitcnt lgkmcnt(0)
    s_barrier
    ds_read_b128 v[208:211], v247 offset:0
    v_mfma_f32_16x16x32_bf16 v[148:151], v[196:199], v[228:231], v[148:151]
    ds_read_b64_tr_b16 v[224:225], v56 offset:49152
    v_mfma_f32_16x16x32_bf16 v[152:155], v[200:203], v[228:231], v[152:155]
    ds_read_b64_tr_b16 v[226:227], v56 offset:50176
    v_mfma_f32_16x16x32_bf16 v[156:159], v[204:207], v[228:231], v[156:159]
    ds_read_b128 v[212:215], v247 offset:2048
    v_mfma_f32_16x16x32_bf16 v[160:163], v[192:195], v[232:235], v[160:163]
    ds_read_b64_tr_b16 v[228:229], v57 offset:49152
    v_mfma_f32_16x16x32_bf16 v[164:167], v[196:199], v[232:235], v[164:167]
    ds_read_b64_tr_b16 v[230:231], v57 offset:50176
    v_mfma_f32_16x16x32_bf16 v[168:171], v[200:203], v[232:235], v[168:171]
    ds_read_b128 v[216:219], v247 offset:4096
    v_mfma_f32_16x16x32_bf16 v[172:175], v[204:207], v[232:235], v[172:175]
    v_mfma_f32_16x16x32_bf16 v[176:179], v[192:195], v[236:239], v[176:179]
    ds_read_b64_tr_b16 v[232:233], v58 offset:49152
    v_mfma_f32_16x16x32_bf16 v[180:183], v[196:199], v[236:239], v[180:183]
    ds_read_b64_tr_b16 v[234:235], v58 offset:50176
    v_mfma_f32_16x16x32_bf16 v[184:187], v[200:203], v[236:239], v[184:187]
    ds_read_b128 v[220:223], v247 offset:6144
    v_mfma_f32_16x16x32_bf16 v[188:191], v[204:207], v[236:239], v[188:191]
    s_waitcnt lgkmcnt(7)
    v_mfma_f32_16x16x32_bf16 v[64:67], v[208:211], v[224:227], v[64:67]
    ds_read_b64_tr_b16 v[236:237], v59 offset:49152
    s_waitcnt lgkmcnt(7)
    v_mfma_f32_16x16x32_bf16 v[68:71], v[212:215], v[224:227], v[68:71]
    ds_read_b64_tr_b16 v[238:239], v59 offset:50176
    s_waitcnt lgkmcnt(5)
    v_mfma_f32_16x16x32_bf16 v[72:75], v[216:219], v[224:227], v[72:75]
    s_waitcnt lgkmcnt(2)
    v_mfma_f32_16x16x32_bf16 v[76:79], v[220:223], v[224:227], v[76:79]
    v_mfma_f32_16x16x32_bf16 v[80:83], v[208:211], v[228:231], v[80:83]
    ds_read_b64_tr_b16 v[224:225], v60 offset:49152
    v_mfma_f32_16x16x32_bf16 v[84:87], v[212:215], v[228:231], v[84:87]
    ds_read_b64_tr_b16 v[226:227], v60 offset:50176
    v_mfma_f32_16x16x32_bf16 v[88:91], v[216:219], v[228:231], v[88:91]
    v_mfma_f32_16x16x32_bf16 v[92:95], v[220:223], v[228:231], v[92:95]
    v_mfma_f32_16x16x32_bf16 v[96:99], v[208:211], v[232:235], v[96:99]
    ds_read_b64_tr_b16 v[228:229], v61 offset:49152
    v_cvt_pk_bf16_f32 v64, v64, v65
    v_cvt_pk_bf16_f32 v65, v66, v67
    v_cvt_pk_bf16_f32 v66, v68, v69
    v_mfma_f32_16x16x32_bf16 v[100:103], v[212:215], v[232:235], v[100:103]
    ds_read_b64_tr_b16 v[230:231], v61 offset:50176
    v_cvt_pk_bf16_f32 v67, v70, v71
    v_cvt_pk_bf16_f32 v68, v72, v73
    v_cvt_pk_bf16_f32 v69, v74, v75
    v_mfma_f32_16x16x32_bf16 v[104:107], v[216:219], v[232:235], v[104:107]
    v_cvt_pk_bf16_f32 v70, v76, v77
    v_cvt_pk_bf16_f32 v71, v78, v79
    v_mfma_f32_16x16x32_bf16 v[108:111], v[220:223], v[232:235], v[108:111]
    s_waitcnt lgkmcnt(4)
    v_mfma_f32_16x16x32_bf16 v[112:115], v[208:211], v[236:239], v[112:115]
    ds_read_b64_tr_b16 v[232:233], v62 offset:49152
    v_cvt_pk_bf16_f32 v72, v80, v81
    v_cvt_pk_bf16_f32 v73, v82, v83
    v_cvt_pk_bf16_f32 v74, v84, v85
    v_mfma_f32_16x16x32_bf16 v[116:119], v[212:215], v[236:239], v[116:119]
    ds_read_b64_tr_b16 v[234:235], v62 offset:50176
    v_cvt_pk_bf16_f32 v75, v86, v87
    v_cvt_pk_bf16_f32 v76, v88, v89
    v_cvt_pk_bf16_f32 v77, v90, v91
    v_mfma_f32_16x16x32_bf16 v[120:123], v[216:219], v[236:239], v[120:123]
    v_cvt_pk_bf16_f32 v78, v92, v93
    v_cvt_pk_bf16_f32 v79, v94, v95
    v_mfma_f32_16x16x32_bf16 v[124:127], v[220:223], v[236:239], v[124:127]
    s_waitcnt lgkmcnt(4)
    v_mfma_f32_16x16x32_bf16 v[128:131], v[208:211], v[224:227], v[128:131]
    ds_read_b64_tr_b16 v[236:237], v63 offset:49152
    v_cvt_pk_bf16_f32 v80, v96, v97
    v_cvt_pk_bf16_f32 v81, v98, v99
    v_cvt_pk_bf16_f32 v82, v100, v101
    v_mfma_f32_16x16x32_bf16 v[132:135], v[212:215], v[224:227], v[132:135]
    ds_read_b64_tr_b16 v[238:239], v63 offset:50176
    v_cvt_pk_bf16_f32 v83, v102, v103
    v_cvt_pk_bf16_f32 v84, v104, v105
    v_cvt_pk_bf16_f32 v85, v106, v107
    v_mfma_f32_16x16x32_bf16 v[136:139], v[216:219], v[224:227], v[136:139]
    v_cvt_pk_bf16_f32 v86, v108, v109
    v_cvt_pk_bf16_f32 v87, v110, v111
    v_mfma_f32_16x16x32_bf16 v[140:143], v[220:223], v[224:227], v[140:143]
    s_waitcnt lgkmcnt(4)
    v_mfma_f32_16x16x32_bf16 v[144:147], v[208:211], v[228:231], v[144:147]
    v_cvt_pk_bf16_f32 v88, v112, v113
    v_cvt_pk_bf16_f32 v89, v114, v115
    v_cvt_pk_bf16_f32 v90, v116, v117
    v_mfma_f32_16x16x32_bf16 v[148:151], v[212:215], v[228:231], v[148:151]
    v_cvt_pk_bf16_f32 v91, v118, v119
    v_cvt_pk_bf16_f32 v92, v120, v121
    v_cvt_pk_bf16_f32 v93, v122, v123
    v_mfma_f32_16x16x32_bf16 v[152:155], v[216:219], v[228:231], v[152:155]
    v_cvt_pk_bf16_f32 v94, v124, v125
    v_cvt_pk_bf16_f32 v95, v126, v127
    v_mfma_f32_16x16x32_bf16 v[156:159], v[220:223], v[228:231], v[156:159]
    v_cvt_pk_bf16_f32 v96, v128, v129
    v_cvt_pk_bf16_f32 v97, v130, v131
    v_cvt_pk_bf16_f32 v98, v132, v133
    v_cvt_pk_bf16_f32 v99, v134, v135
    v_cvt_pk_bf16_f32 v100, v136, v137
    v_cvt_pk_bf16_f32 v101, v138, v139
    v_cvt_pk_bf16_f32 v102, v140, v141
    v_cvt_pk_bf16_f32 v103, v142, v143
    s_waitcnt lgkmcnt(0)
    s_barrier
    v_bfe_u32 v48, v255, 2, 2
    v_and_b32 v49, 3, v255
    v_lshlrev_b32 v49, 3, v49
    v_add_u32 v49, 0, v49
    v_lshrrev_b32 v50, 5, v255
    v_lshl_add_u32 v50, v50, 3, v48
    v_mul_u32_u24 v51, 96, v50
    v_add_u32 v51, v51, v49
    v_lshl_add_u32 v49, v50, 8, v49
    v_bfe_u32 v50, v255, 4, 1
    v_lshl_add_u32 v49, v50, 5, v49
    v_xor_b32 v240, 0, v48
    v_lshl_add_u32 v240, v240, 6, v49
    v_xor_b32 v241, 1, v48
    v_lshl_add_u32 v241, v241, 6, v49
    v_xor_b32 v242, 2, v48
    v_lshl_add_u32 v242, v242, 6, v49
    v_xor_b32 v243, 3, v48
    v_lshl_add_u32 v243, v243, 6, v49
    v_mul_u32_u24 v48, 6272, v50
    v_add_u32 v247, v51, v48
    ds_read_b64_tr_b16 v[32:33], v240 offset:0
    ds_read_b64_tr_b16 v[34:35], v240 offset:1024
    ds_read_b64_tr_b16 v[36:37], v241 offset:0
    ds_read_b64_tr_b16 v[38:39], v241 offset:1024
    ds_read_b64_tr_b16 v[40:41], v242 offset:0
    ds_read_b64_tr_b16 v[42:43], v242 offset:1024
    ds_read_b64_tr_b16 v[44:45], v243 offset:0
    ds_read_b64_tr_b16 v[46:47], v243 offset:1024
    v_mfma_f32_16x16x32_bf16 v[160:163], v[208:211], v[232:235], v[160:163]
    v_mfma_f32_16x16x32_bf16 v[164:167], v[212:215], v[232:235], v[164:167]
    v_mfma_f32_16x16x32_bf16 v[168:171], v[216:219], v[232:235], v[168:171]
    v_mfma_f32_16x16x32_bf16 v[172:175], v[220:223], v[232:235], v[172:175]
    v_mfma_f32_16x16x32_bf16 v[176:179], v[208:211], v[236:239], v[176:179]
    v_cvt_pk_bf16_f32 v104, v144, v145
    v_cvt_pk_bf16_f32 v105, v146, v147
    v_cvt_pk_bf16_f32 v106, v148, v149
    v_mfma_f32_16x16x32_bf16 v[180:183], v[212:215], v[236:239], v[180:183]
    v_cvt_pk_bf16_f32 v107, v150, v151
    v_cvt_pk_bf16_f32 v108, v152, v153
    v_cvt_pk_bf16_f32 v109, v154, v155
    v_mfma_f32_16x16x32_bf16 v[184:187], v[216:219], v[236:239], v[184:187]
    v_cvt_pk_bf16_f32 v110, v156, v157
    v_cvt_pk_bf16_f32 v111, v158, v159
    v_mfma_f32_16x16x32_bf16 v[188:191], v[220:223], v[236:239], v[188:191]
    v_cvt_pk_bf16_f32 v112, v160, v161
    v_cvt_pk_bf16_f32 v113, v162, v163
    v_cvt_pk_bf16_f32 v114, v164, v165
    v_cvt_pk_bf16_f32 v115, v166, v167
    v_cvt_pk_bf16_f32 v116, v168, v169
    v_cvt_pk_bf16_f32 v117, v170, v171
    v_cvt_pk_bf16_f32 v118, v172, v173
    v_cvt_pk_bf16_f32 v119, v174, v175
    v_cvt_pk_bf16_f32 v120, v176, v177
    v_cvt_pk_bf16_f32 v121, v178, v179
    v_cvt_pk_bf16_f32 v122, v180, v181
    v_cvt_pk_bf16_f32 v123, v182, v183
    v_cvt_pk_bf16_f32 v124, v184, v185
    v_cvt_pk_bf16_f32 v125, v186, v187
    v_cvt_pk_bf16_f32 v126, v188, v189
    v_cvt_pk_bf16_f32 v127, v190, v191
    s_waitcnt vmcnt(7)
    s_waitcnt lgkmcnt(6)
    v_mfma_f32_32x32x16_bf16 v[128:143], v[32:35], v[0:3], 0
    ds_read_b64_tr_b16 v[48:49], v247 offset:16384
    ds_read_b64_tr_b16 v[50:51], v247 offset:16768
    s_waitcnt lgkmcnt(6)
    v_mfma_f32_32x32x16_bf16 v[144:159], v[36:39], v[0:3], 0
    ds_read_b64_tr_b16 v[52:53], v247 offset:16416
    ds_read_b64_tr_b16 v[54:55], v247 offset:16800
    s_waitcnt lgkmcnt(6)
    v_mfma_f32_32x32x16_bf16 v[160:175], v[40:43], v[0:3], 0
    ds_read_b64_tr_b16 v[56:57], v247 offset:16448
    ds_read_b64_tr_b16 v[58:59], v247 offset:16832
    s_cmp_lg_u32 s15, 0
    s_cbranch_scc1 H_kvs15a
    buffer_store_dwordx4 v[64:67], v244, s[16:19], s6 offen offset:0
    s_branch H_kvs15b
H_kvs15a:
    buffer_store_dwordx4 v[64:67], v244, s[16:19], s6 offen offset:0 sc1
H_kvs15b:
    s_waitcnt lgkmcnt(6)
    v_mfma_f32_32x32x16_bf16 v[176:191], v[44:47], v[0:3], 0
    ds_read_b64_tr_b16 v[60:61], v240 offset:4096
    ds_read_b64_tr_b16 v[62:63], v240 offset:5120
    s_waitcnt lgkmcnt(6)
    v_mfma_f32_32x32x16_bf16 v[192:207], v[48:51], v[0:3], 0
    ds_read_b64_tr_b16 v[32:33], v241 offset:4096
    ds_read_b64_tr_b16 v[34:35], v241 offset:5120
    s_waitcnt lgkmcnt(6)
    v_mfma_f32_32x32x16_bf16 v[208:223], v[52:55], v[0:3], 0
    ds_read_b64_tr_b16 v[36:37], v242 offset:4096
    ds_read_b64_tr_b16 v[38:39], v242 offset:5120
    s_waitcnt lgkmcnt(6)
    v_mfma_f32_32x32x16_bf16 v[224:239], v[56:59], v[0:3], 0
    ds_read_b64_tr_b16 v[40:41], v243 offset:4096
    ds_read_b64_tr_b16 v[42:43], v243 offset:5120
    buffer_load_dwordx4 v[0:3], v254, s[16:19], s13 offen offset:0
    s_waitcnt vmcnt(8)
    s_waitcnt lgkmcnt(6)
    v_mfma_f32_32x32x16_bf16 v[128:143], v[60:63], v[4:7], v[128:143]
    ds_read_b64_tr_b16 v[44:45], v247 offset:17920
    ds_read_b64_tr_b16 v[46:47], v247 offset:18304
    s_cmp_lg_u32 s15, 0
    s_cbranch_scc1 H_kvs14a
    buffer_store_dwordx4 v[68:71], v244, s[16:19], s8 offen offset:0
    s_branch H_kvs14b
H_kvs14a:
    buffer_store_dwordx4 v[68:71], v244, s[16:19], s8 offen offset:0 sc1
H_kvs14b:
    s_waitcnt lgkmcnt(6)
    v_mfma_f32_32x32x16_bf16 v[144:159], v[32:35], v[4:7], v[144:159]
    ds_read_b64_tr_b16 v[48:49], v247 offset:17952
    ds_read_b64_tr_b16 v[50:51], v247 offset:18336
    s_waitcnt lgkmcnt(6)
    v_mfma_f32_32x32x16_bf16 v[160:175], v[36:39], v[4:7], v[160:175]
    ds_read_b64_tr_b16 v[52:53], v247 offset:17984
    ds_read_b64_tr_b16 v[54:55], v247 offset:18368
    s_cmp_lg_u32 s15, 0
    s_cbranch_scc1 H_kvs13a
    buffer_store_dwordx4 v[72:75], v244, s[16:19], s6 offen offset:256
    s_branch H_kvs13b
H_kvs13a:
    buffer_store_dwordx4 v[72:75], v244, s[16:19], s6 offen offset:256 sc1
H_kvs13b:
    s_waitcnt lgkmcnt(6)
    v_mfma_f32_32x32x16_bf16 v[176:191], v[40:43], v[4:7], v[176:191]
    ds_read_b64_tr_b16 v[56:57], v240 offset:8192
    ds_read_b64_tr_b16 v[58:59], v240 offset:9216
    s_waitcnt lgkmcnt(6)
    v_mfma_f32_32x32x16_bf16 v[192:207], v[44:47], v[4:7], v[192:207]
    ds_read_b64_tr_b16 v[60:61], v241 offset:8192
    ds_read_b64_tr_b16 v[62:63], v241 offset:9216
    s_waitcnt lgkmcnt(6)
    v_mfma_f32_32x32x16_bf16 v[208:223], v[48:51], v[4:7], v[208:223]
    ds_read_b64_tr_b16 v[32:33], v242 offset:8192
    ds_read_b64_tr_b16 v[34:35], v242 offset:9216
    s_waitcnt lgkmcnt(6)
    v_mfma_f32_32x32x16_bf16 v[224:239], v[52:55], v[4:7], v[224:239]
    ds_read_b64_tr_b16 v[36:37], v243 offset:8192
    ds_read_b64_tr_b16 v[38:39], v243 offset:9216
    buffer_load_dwordx4 v[4:7], v254, s[16:19], s13 offen offset:1024
    s_waitcnt vmcnt(10)
    s_waitcnt lgkmcnt(6)
    v_mfma_f32_32x32x16_bf16 v[128:143], v[56:59], v[8:11], v[128:143]
    ds_read_b64_tr_b16 v[40:41], v247 offset:19456
    ds_read_b64_tr_b16 v[42:43], v247 offset:19840
    s_cmp_lg_u32 s15, 0
    s_cbranch_scc1 H_kvs12a
    buffer_store_dwordx4 v[76:79], v244, s[16:19], s8 offen offset:256
    s_branch H_kvs12b
H_kvs12a:
    buffer_store_dwordx4 v[76:79], v244, s[16:19], s8 offen offset:256 sc1
H_kvs12b:
    s_waitcnt lgkmcnt(6)
    v_mfma_f32_32x32x16_bf16 v[144:159], v[60:63], v[8:11], v[144:159]
    ds_read_b64_tr_b16 v[44:45], v247 offset:19488
    ds_read_b64_tr_b16 v[46:47], v247 offset:19872
    s_waitcnt lgkmcnt(6)
    v_mfma_f32_32x32x16_bf16 v[160:175], v[32:35], v[8:11], v[160:175]
    ds_read_b64_tr_b16 v[48:49], v247 offset:19520
    ds_read_b64_tr_b16 v[50:51], v247 offset:19904
    s_cmp_lg_u32 s15, 0
    s_cbranch_scc1 H_kvs11a
    buffer_store_dwordx4 v[80:83], v244, s[16:19], s6 offen offset:1024
    s_branch H_kvs11b
H_kvs11a:
    buffer_store_dwordx4 v[80:83], v244, s[16:19], s6 offen offset:1024 sc1
H_kvs11b:
    s_waitcnt lgkmcnt(6)
    v_mfma_f32_32x32x16_bf16 v[176:191], v[36:39], v[8:11], v[176:191]
    ds_read_b64_tr_b16 v[52:53], v240 offset:12288
    ds_read_b64_tr_b16 v[54:55], v240 offset:13312
    s_waitcnt lgkmcnt(6)
    v_mfma_f32_32x32x16_bf16 v[192:207], v[40:43], v[8:11], v[192:207]
    ds_read_b64_tr_b16 v[56:57], v241 offset:12288
    ds_read_b64_tr_b16 v[58:59], v241 offset:13312
    s_waitcnt lgkmcnt(6)
    v_mfma_f32_32x32x16_bf16 v[208:223], v[44:47], v[8:11], v[208:223]
    ds_read_b64_tr_b16 v[60:61], v242 offset:12288
    ds_read_b64_tr_b16 v[62:63], v242 offset:13312
    s_waitcnt lgkmcnt(6)
    v_mfma_f32_32x32x16_bf16 v[224:239], v[48:51], v[8:11], v[224:239]
    ds_read_b64_tr_b16 v[32:33], v243 offset:12288
    ds_read_b64_tr_b16 v[34:35], v243 offset:13312
    buffer_load_dwordx4 v[8:11], v254, s[16:19], s13 offen offset:2048
    s_waitcnt vmcnt(12)
    s_waitcnt lgkmcnt(6)
    v_mfma_f32_32x32x16_bf16 v[128:143], v[52:55], v[12:15], v[128:143]
    ds_read_b64_tr_b16 v[36:37], v247 offset:20992
    ds_read_b64_tr_b16 v[38:39], v247 offset:21376
    s_cmp_lg_u32 s15, 0
    s_cbranch_scc1 H_kvs10a
    buffer_store_dwordx4 v[84:87], v244, s[16:19], s8 offen offset:1024
    s_branch H_kvs10b
H_kvs10a:
    buffer_store_dwordx4 v[84:87], v244, s[16:19], s8 offen offset:1024 sc1
H_kvs10b:
    s_waitcnt lgkmcnt(6)
    v_mfma_f32_32x32x16_bf16 v[144:159], v[56:59], v[12:15], v[144:159]
    ds_read_b64_tr_b16 v[40:41], v247 offset:21024
    ds_read_b64_tr_b16 v[42:43], v247 offset:21408
    s_waitcnt lgkmcnt(6)
    v_mfma_f32_32x32x16_bf16 v[160:175], v[60:63], v[12:15], v[160:175]
    ds_read_b64_tr_b16 v[44:45], v247 offset:21056
    ds_read_b64_tr_b16 v[46:47], v247 offset:21440
    s_cmp_lg_u32 s15, 0
    s_cbranch_scc1 H_kvs9a
    buffer_store_dwordx4 v[88:91], v244, s[16:19], s6 offen offset:1280
    s_branch H_kvs9b
H_kvs9a:
    buffer_store_dwordx4 v[88:91], v244, s[16:19], s6 offen offset:1280 sc1
H_kvs9b:
    s_waitcnt lgkmcnt(6)
    v_mfma_f32_32x32x16_bf16 v[176:191], v[32:35], v[12:15], v[176:191]
    s_barrier
    v_add_u32 v240, 32768, v240
    v_add_u32 v241, 32768, v241
    v_add_u32 v242, 32768, v242
    v_add_u32 v243, 32768, v243
    v_add_u32 v247, 32768, v247
    ds_read_b64_tr_b16 v[48:49], v240 offset:0
    ds_read_b64_tr_b16 v[50:51], v240 offset:1024
    s_waitcnt lgkmcnt(6)
    v_mfma_f32_32x32x16_bf16 v[192:207], v[36:39], v[12:15], v[192:207]
    ds_read_b64_tr_b16 v[52:53], v241 offset:0
    ds_read_b64_tr_b16 v[54:55], v241 offset:1024
    s_waitcnt lgkmcnt(6)
    v_mfma_f32_32x32x16_bf16 v[208:223], v[40:43], v[12:15], v[208:223]
    ds_read_b64_tr_b16 v[56:57], v242 offset:0
    ds_read_b64_tr_b16 v[58:59], v242 offset:1024
    s_waitcnt lgkmcnt(6)
    v_mfma_f32_32x32x16_bf16 v[224:239], v[44:47], v[12:15], v[224:239]
    ds_read_b64_tr_b16 v[60:61], v243 offset:0
    ds_read_b64_tr_b16 v[62:63], v243 offset:1024
    buffer_load_dwordx4 v[12:15], v254, s[16:19], s13 offen offset:3072
    s_add_u32 s13, s13, 4096
    s_waitcnt vmcnt(14)
    s_waitcnt lgkmcnt(6)
    v_mfma_f32_32x32x16_bf16 v[128:143], v[48:51], v[16:19], v[128:143]
    ds_read_b64_tr_b16 v[32:33], v247 offset:16384
    ds_read_b64_tr_b16 v[34:35], v247 offset:16768
    s_cmp_lg_u32 s15, 0
    s_cbranch_scc1 H_kvs8a
    buffer_store_dwordx4 v[92:95], v244, s[16:19], s8 offen offset:1280
    s_branch H_kvs8b
H_kvs8a:
    buffer_store_dwordx4 v[92:95], v244, s[16:19], s8 offen offset:1280 sc1
H_kvs8b:
    s_waitcnt lgkmcnt(6)
    v_mfma_f32_32x32x16_bf16 v[144:159], v[52:55], v[16:19], v[144:159]
    ds_read_b64_tr_b16 v[36:37], v247 offset:16416
    ds_read_b64_tr_b16 v[38:39], v247 offset:16800
    s_waitcnt lgkmcnt(6)
    v_mfma_f32_32x32x16_bf16 v[160:175], v[56:59], v[16:19], v[160:175]
    ds_read_b64_tr_b16 v[40:41], v247 offset:16448
    ds_read_b64_tr_b16 v[42:43], v247 offset:16832
    s_cmp_lg_u32 s15, 0
    s_cbranch_scc1 H_kvs7a
    buffer_store_dwordx4 v[96:99], v244, s[16:19], s6 offen offset:2048
    s_branch H_kvs7b
H_kvs7a:
    buffer_store_dwordx4 v[96:99], v244, s[16:19], s6 offen offset:2048 sc1
H_kvs7b:
    s_waitcnt lgkmcnt(6)
    v_mfma_f32_32x32x16_bf16 v[176:191], v[60:63], v[16:19], v[176:191]
    ds_read_b64_tr_b16 v[44:45], v240 offset:4096
    ds_read_b64_tr_b16 v[46:47], v240 offset:5120
    s_waitcnt lgkmcnt(6)
    v_mfma_f32_32x32x16_bf16 v[192:207], v[32:35], v[16:19], v[192:207]
    ds_read_b64_tr_b16 v[48:49], v241 offset:4096
    ds_read_b64_tr_b16 v[50:51], v241 offset:5120
    s_waitcnt lgkmcnt(6)
    v_mfma_f32_32x32x16_bf16 v[208:223], v[36:39], v[16:19], v[208:223]
    ds_read_b64_tr_b16 v[52:53], v242 offset:4096
    ds_read_b64_tr_b16 v[54:55], v242 offset:5120
    s_waitcnt lgkmcnt(6)
    v_mfma_f32_32x32x16_bf16 v[224:239], v[40:43], v[16:19], v[224:239]
    ds_read_b64_tr_b16 v[56:57], v243 offset:4096
    ds_read_b64_tr_b16 v[58:59], v243 offset:5120
    buffer_load_dwordx4 v[16:19], v254, s[16:19], s13 offen offset:0
    s_waitcnt vmcnt(16)
    s_waitcnt lgkmcnt(6)
    v_mfma_f32_32x32x16_bf16 v[128:143], v[44:47], v[20:23], v[128:143]
    ds_read_b64_tr_b16 v[60:61], v247 offset:17920
    ds_read_b64_tr_b16 v[62:63], v247 offset:18304
    s_cmp_lg_u32 s15, 0
    s_cbranch_scc1 H_kvs6a
    buffer_store_dwordx4 v[100:103], v244, s[16:19], s8 offen offset:2048
    s_branch H_kvs6b
H_kvs6a:
    buffer_store_dwordx4 v[100:103], v244, s[16:19], s8 offen offset:2048 sc1
H_kvs6b:
    s_waitcnt lgkmcnt(6)
    v_mfma_f32_32x32x16_bf16 v[144:159], v[48:51], v[20:23], v[144:159]
    ds_read_b64_tr_b16 v[32:33], v247 offset:17952
    ds_read_b64_tr_b16 v[34:35], v247 offset:18336
    s_waitcnt lgkmcnt(6)
    v_mfma_f32_32x32x16_bf16 v[160:175], v[52:55], v[20:23], v[160:175]
    ds_read_b64_tr_b16 v[36:37], v247 offset:17984
    ds_read_b64_tr_b16 v[38:39], v247 offset:18368
    s_cmp_lg_u32 s15, 0
    s_cbranch_scc1 H_kvs5a
    buffer_store_dwordx4 v[104:107], v244, s[16:19], s6 offen offset:2304
    s_branch H_kvs5b
H_kvs5a:
    buffer_store_dwordx4 v[104:107], v244, s[16:19], s6 offen offset:2304 sc1
H_kvs5b:
    s_waitcnt lgkmcnt(6)
    v_mfma_f32_32x32x16_bf16 v[176:191], v[56:59], v[20:23], v[176:191]
    ds_read_b64_tr_b16 v[40:41], v240 offset:8192
    ds_read_b64_tr_b16 v[42:43], v240 offset:9216
    s_waitcnt lgkmcnt(6)
    v_mfma_f32_32x32x16_bf16 v[192:207], v[60:63], v[20:23], v[192:207]
    ds_read_b64_tr_b16 v[44:45], v241 offset:8192
    ds_read_b64_tr_b16 v[46:47], v241 offset:9216
    s_waitcnt lgkmcnt(6)
    v_mfma_f32_32x32x16_bf16 v[208:223], v[32:35], v[20:23], v[208:223]
    ds_read_b64_tr_b16 v[48:49], v242 offset:8192
    ds_read_b64_tr_b16 v[50:51], v242 offset:9216
    s_waitcnt lgkmcnt(6)
    v_mfma_f32_32x32x16_bf16 v[224:239], v[36:39], v[20:23], v[224:239]
    ds_read_b64_tr_b16 v[52:53], v243 offset:8192
    ds_read_b64_tr_b16 v[54:55], v243 offset:9216
    buffer_load_dwordx4 v[20:23], v254, s[16:19], s13 offen offset:1024
    s_waitcnt vmcnt(18)
    s_waitcnt lgkmcnt(6)
    v_mfma_f32_32x32x16_bf16 v[128:143], v[40:43], v[24:27], v[128:143]
    ds_read_b64_tr_b16 v[56:57], v247 offset:19456
    ds_read_b64_tr_b16 v[58:59], v247 offset:19840
    s_cmp_lg_u32 s15, 0
    s_cbranch_scc1 H_kvs4a
    buffer_store_dwordx4 v[108:111], v244, s[16:19], s8 offen offset:2304
    s_branch H_kvs4b
H_kvs4a:
    buffer_store_dwordx4 v[108:111], v244, s[16:19], s8 offen offset:2304 sc1
H_kvs4b:
    s_waitcnt lgkmcnt(6)
    v_mfma_f32_32x32x16_bf16 v[144:159], v[44:47], v[24:27], v[144:159]
    ds_read_b64_tr_b16 v[60:61], v247 offset:19488
    ds_read_b64_tr_b16 v[62:63], v247 offset:19872
    s_waitcnt lgkmcnt(6)
    v_mfma_f32_32x32x16_bf16 v[160:175], v[48:51], v[24:27], v[160:175]
    ds_read_b64_tr_b16 v[32:33], v247 offset:19520
    ds_read_b64_tr_b16 v[34:35], v247 offset:19904
    s_cmp_lg_u32 s15, 0
    s_cbranch_scc1 H_kvs3a
    buffer_store_dwordx4 v[112:115], v244, s[16:19], s6 offen offset:3072
    s_branch H_kvs3b
H_kvs3a:
    buffer_store_dwordx4 v[112:115], v244, s[16:19], s6 offen offset:3072 sc1
H_kvs3b:
    s_waitcnt lgkmcnt(6)
    v_mfma_f32_32x32x16_bf16 v[176:191], v[52:55], v[24:27], v[176:191]
    ds_read_b64_tr_b16 v[36:37], v240 offset:12288
    ds_read_b64_tr_b16 v[38:39], v240 offset:13312
    s_waitcnt lgkmcnt(6)
    v_mfma_f32_32x32x16_bf16 v[192:207], v[56:59], v[24:27], v[192:207]
    ds_read_b64_tr_b16 v[40:41], v241 offset:12288
    ds_read_b64_tr_b16 v[42:43], v241 offset:13312
    s_waitcnt lgkmcnt(6)
    v_mfma_f32_32x32x16_bf16 v[208:223], v[60:63], v[24:27], v[208:223]
    ds_read_b64_tr_b16 v[44:45], v242 offset:12288
    ds_read_b64_tr_b16 v[46:47], v242 offset:13312
    s_waitcnt lgkmcnt(6)
    v_mfma_f32_32x32x16_bf16 v[224:239], v[32:35], v[24:27], v[224:239]
    ds_read_b64_tr_b16 v[48:49], v243 offset:12288
    ds_read_b64_tr_b16 v[50:51], v243 offset:13312
    buffer_load_dwordx4 v[24:27], v254, s[16:19], s13 offen offset:2048
    s_waitcnt vmcnt(20)
    s_waitcnt lgkmcnt(6)
    v_mfma_f32_32x32x16_bf16 v[128:143], v[36:39], v[28:31], v[128:143]
    ds_read_b64_tr_b16 v[52:53], v247 offset:20992
    ds_read_b64_tr_b16 v[54:55], v247 offset:21376
    s_cmp_lg_u32 s15, 0
    s_cbranch_scc1 H_kvs2a
    buffer_store_dwordx4 v[116:119], v244, s[16:19], s8 offen offset:3072
    s_branch H_kvs2b
H_kvs2a:
    buffer_store_dwordx4 v[116:119], v244, s[16:19], s8 offen offset:3072 sc1
H_kvs2b:
    s_waitcnt lgkmcnt(6)
    v_mfma_f32_32x32x16_bf16 v[144:159], v[40:43], v[28:31], v[144:159]
    ds_read_b64_tr_b16 v[56:57], v247 offset:21024
    ds_read_b64_tr_b16 v[58:59], v247 offset:21408
    s_waitcnt lgkmcnt(6)
    v_mfma_f32_32x32x16_bf16 v[160:175], v[44:47], v[28:31], v[160:175]
    ds_read_b64_tr_b16 v[60:61], v247 offset:21056
    ds_read_b64_tr_b16 v[62:63], v247 offset:21440
    s_cmp_lg_u32 s15, 0
    s_cbranch_scc1 H_kvs1a
    buffer_store_dwordx4 v[120:123], v244, s[16:19], s6 offen offset:3328
    s_branch H_kvs1b
H_kvs1a:
    buffer_store_dwordx4 v[120:123], v244, s[16:19], s6 offen offset:3328 sc1
H_kvs1b:
    s_waitcnt lgkmcnt(6)
    v_mfma_f32_32x32x16_bf16 v[176:191], v[48:51], v[28:31], v[176:191]
    s_barrier
    v_add_u32 v240, 32768, v240
    v_add_u32 v241, 32768, v241
    v_add_u32 v242, 32768, v242
    v_add_u32 v243, 32768, v243
    v_add_u32 v247, 32768, v247
    ds_read_b64_tr_b16 v[32:33], v240 offset:0
    ds_read_b64_tr_b16 v[34:35], v240 offset:1024
    s_waitcnt lgkmcnt(6)
    v_mfma_f32_32x32x16_bf16 v[192:207], v[52:55], v[28:31], v[192:207]
    ds_read_b64_tr_b16 v[36:37], v241 offset:0
    ds_read_b64_tr_b16 v[38:39], v241 offset:1024
    s_waitcnt lgkmcnt(6)
    v_mfma_f32_32x32x16_bf16 v[208:223], v[56:59], v[28:31], v[208:223]
    ds_read_b64_tr_b16 v[40:41], v242 offset:0
    ds_read_b64_tr_b16 v[42:43], v242 offset:1024
    s_waitcnt lgkmcnt(6)
    v_mfma_f32_32x32x16_bf16 v[224:239], v[60:63], v[28:31], v[224:239]
    ds_read_b64_tr_b16 v[44:45], v243 offset:0
    ds_read_b64_tr_b16 v[46:47], v243 offset:1024
    buffer_load_dwordx4 v[28:31], v254, s[16:19], s13 offen offset:3072
    s_add_u32 s13, s13, 4096
    s_waitcnt vmcnt(21)
    s_waitcnt lgkmcnt(6)
    v_mfma_f32_32x32x16_bf16 v[128:143], v[32:35], v[0:3], v[128:143]
    ds_read_b64_tr_b16 v[48:49], v247 offset:16384
    ds_read_b64_tr_b16 v[50:51], v247 offset:16768
    s_cmp_lg_u32 s15, 0
    s_cbranch_scc1 H_kvs0a
    buffer_store_dwordx4 v[124:127], v244, s[16:19], s8 offen offset:3328
    s_branch H_kvs0b
H_kvs0a:
    buffer_store_dwordx4 v[124:127], v244, s[16:19], s8 offen offset:3328 sc1
H_kvs0b:
    s_waitcnt lgkmcnt(6)
    v_mfma_f32_32x32x16_bf16 v[144:159], v[36:39], v[0:3], v[144:159]
    ds_read_b64_tr_b16 v[52:53], v247 offset:16416
    ds_read_b64_tr_b16 v[54:55], v247 offset:16800
    s_waitcnt lgkmcnt(6)
    v_mfma_f32_32x32x16_bf16 v[160:175], v[40:43], v[0:3], v[160:175]
    ds_read_b64_tr_b16 v[56:57], v247 offset:16448
    ds_read_b64_tr_b16 v[58:59], v247 offset:16832
    s_waitcnt lgkmcnt(6)
    v_mfma_f32_32x32x16_bf16 v[176:191], v[44:47], v[0:3], v[176:191]
    ds_read_b64_tr_b16 v[60:61], v240 offset:4096
    ds_read_b64_tr_b16 v[62:63], v240 offset:5120
    s_waitcnt lgkmcnt(6)
    v_mfma_f32_32x32x16_bf16 v[192:207], v[48:51], v[0:3], v[192:207]
    ds_read_b64_tr_b16 v[32:33], v241 offset:4096
    ds_read_b64_tr_b16 v[34:35], v241 offset:5120
    s_waitcnt lgkmcnt(6)
    v_mfma_f32_32x32x16_bf16 v[208:223], v[52:55], v[0:3], v[208:223]
    ds_read_b64_tr_b16 v[36:37], v242 offset:4096
    ds_read_b64_tr_b16 v[38:39], v242 offset:5120
    s_waitcnt lgkmcnt(6)
    v_mfma_f32_32x32x16_bf16 v[224:239], v[56:59], v[0:3], v[224:239]
    ds_read_b64_tr_b16 v[40:41], v243 offset:4096
    ds_read_b64_tr_b16 v[42:43], v243 offset:5120
    buffer_load_dwordx4 v[0:3], v254, s[16:19], s13 offen offset:0
    s_waitcnt vmcnt(20)
    s_waitcnt lgkmcnt(6)
    v_mfma_f32_32x32x16_bf16 v[128:143], v[60:63], v[4:7], v[128:143]
    ds_read_b64_tr_b16 v[44:45], v247 offset:17920
    ds_read_b64_tr_b16 v[46:47], v247 offset:18304
    s_waitcnt lgkmcnt(6)
    v_mfma_f32_32x32x16_bf16 v[144:159], v[32:35], v[4:7], v[144:159]
    ds_read_b64_tr_b16 v[48:49], v247 offset:17952
    ds_read_b64_tr_b16 v[50:51], v247 offset:18336
    s_waitcnt lgkmcnt(6)
    v_mfma_f32_32x32x16_bf16 v[160:175], v[36:39], v[4:7], v[160:175]
    ds_read_b64_tr_b16 v[52:53], v247 offset:17984
    ds_read_b64_tr_b16 v[54:55], v247 offset:18368
    s_waitcnt lgkmcnt(6)
    v_mfma_f32_32x32x16_bf16 v[176:191], v[40:43], v[4:7], v[176:191]
    ds_read_b64_tr_b16 v[56:57], v240 offset:8192
    ds_read_b64_tr_b16 v[58:59], v240 offset:9216
    s_waitcnt lgkmcnt(6)
    v_mfma_f32_32x32x16_bf16 v[192:207], v[44:47], v[4:7], v[192:207]
    ds_read_b64_tr_b16 v[60:61], v241 offset:8192
    ds_read_b64_tr_b16 v[62:63], v241 offset:9216
    s_waitcnt lgkmcnt(6)
    v_mfma_f32_32x32x16_bf16 v[208:223], v[48:51], v[4:7], v[208:223]
    ds_read_b64_tr_b16 v[32:33], v242 offset:8192
    ds_read_b64_tr_b16 v[34:35], v242 offset:9216
    s_waitcnt lgkmcnt(6)
    v_mfma_f32_32x32x16_bf16 v[224:239], v[52:55], v[4:7], v[224:239]
    ds_read_b64_tr_b16 v[36:37], v243 offset:8192
    ds_read_b64_tr_b16 v[38:39], v243 offset:9216
    buffer_load_dwordx4 v[4:7], v254, s[16:19], s13 offen offset:1024
    s_waitcnt vmcnt(18)
    s_waitcnt lgkmcnt(6)
    v_mfma_f32_32x32x16_bf16 v[128:143], v[56:59], v[8:11], v[128:143]
    ds_read_b64_tr_b16 v[40:41], v247 offset:19456
    ds_read_b64_tr_b16 v[42:43], v247 offset:19840
    s_waitcnt lgkmcnt(6)
    v_mfma_f32_32x32x16_bf16 v[144:159], v[60:63], v[8:11], v[144:159]
    ds_read_b64_tr_b16 v[44:45], v247 offset:19488
    ds_read_b64_tr_b16 v[46:47], v247 offset:19872
    s_waitcnt lgkmcnt(6)
    v_mfma_f32_32x32x16_bf16 v[160:175], v[32:35], v[8:11], v[160:175]
    ds_read_b64_tr_b16 v[48:49], v247 offset:19520
    ds_read_b64_tr_b16 v[50:51], v247 offset:19904
    s_waitcnt lgkmcnt(6)
    v_mfma_f32_32x32x16_bf16 v[176:191], v[36:39], v[8:11], v[176:191]
    ds_read_b64_tr_b16 v[52:53], v240 offset:12288
    ds_read_b64_tr_b16 v[54:55], v240 offset:13312
    s_waitcnt lgkmcnt(6)
    v_mfma_f32_32x32x16_bf16 v[192:207], v[40:43], v[8:11], v[192:207]
    ds_read_b64_tr_b16 v[56:57], v241 offset:12288
    ds_read_b64_tr_b16 v[58:59], v241 offset:13312
    s_waitcnt lgkmcnt(6)
    v_mfma_f32_32x32x16_bf16 v[208:223], v[44:47], v[8:11], v[208:223]
    ds_read_b64_tr_b16 v[60:61], v242 offset:12288
    ds_read_b64_tr_b16 v[62:63], v242 offset:13312
    s_waitcnt lgkmcnt(6)
    v_mfma_f32_32x32x16_bf16 v[224:239], v[48:51], v[8:11], v[224:239]
    ds_read_b64_tr_b16 v[32:33], v243 offset:12288
    ds_read_b64_tr_b16 v[34:35], v243 offset:13312
    buffer_load_dwordx4 v[8:11], v254, s[16:19], s13 offen offset:2048
    s_waitcnt vmcnt(16)
    s_waitcnt lgkmcnt(6)
    v_mfma_f32_32x32x16_bf16 v[128:143], v[52:55], v[12:15], v[128:143]
    ds_read_b64_tr_b16 v[36:37], v247 offset:20992
    ds_read_b64_tr_b16 v[38:39], v247 offset:21376
    s_waitcnt lgkmcnt(6)
    v_mfma_f32_32x32x16_bf16 v[144:159], v[56:59], v[12:15], v[144:159]
    ds_read_b64_tr_b16 v[40:41], v247 offset:21024
    ds_read_b64_tr_b16 v[42:43], v247 offset:21408
    s_waitcnt lgkmcnt(6)
    v_mfma_f32_32x32x16_bf16 v[160:175], v[60:63], v[12:15], v[160:175]
    ds_read_b64_tr_b16 v[44:45], v247 offset:21056
    ds_read_b64_tr_b16 v[46:47], v247 offset:21440
    s_waitcnt lgkmcnt(6)
    v_mfma_f32_32x32x16_bf16 v[176:191], v[32:35], v[12:15], v[176:191]
    s_barrier
    v_add_u32 v240, 32768, v240
    v_add_u32 v241, 32768, v241
    v_add_u32 v242, 32768, v242
    v_add_u32 v243, 32768, v243
    v_add_u32 v247, 32768, v247
    ds_read_b64_tr_b16 v[48:49], v240 offset:0
    ds_read_b64_tr_b16 v[50:51], v240 offset:1024
    s_waitcnt lgkmcnt(6)
    v_mfma_f32_32x32x16_bf16 v[192:207], v[36:39], v[12:15], v[192:207]
    ds_read_b64_tr_b16 v[52:53], v241 offset:0
    ds_read_b64_tr_b16 v[54:55], v241 offset:1024
    s_waitcnt lgkmcnt(6)
    v_mfma_f32_32x32x16_bf16 v[208:223], v[40:43], v[12:15], v[208:223]
    ds_read_b64_tr_b16 v[56:57], v242 offset:0
    ds_read_b64_tr_b16 v[58:59], v242 offset:1024
    s_waitcnt lgkmcnt(6)
    v_mfma_f32_32x32x16_bf16 v[224:239], v[44:47], v[12:15], v[224:239]
    ds_read_b64_tr_b16 v[60:61], v243 offset:0
    ds_read_b64_tr_b16 v[62:63], v243 offset:1024
    buffer_load_dwordx4 v[12:15], v254, s[16:19], s13 offen offset:3072
    s_add_u32 s13, s13, 4096
    s_waitcnt vmcnt(14)
    s_waitcnt lgkmcnt(6)
    v_mfma_f32_32x32x16_bf16 v[128:143], v[48:51], v[16:19], v[128:143]
    ds_read_b64_tr_b16 v[32:33], v247 offset:16384
    ds_read_b64_tr_b16 v[34:35], v247 offset:16768
    s_waitcnt lgkmcnt(6)
    v_mfma_f32_32x32x16_bf16 v[144:159], v[52:55], v[16:19], v[144:159]
    ds_read_b64_tr_b16 v[36:37], v247 offset:16416
    ds_read_b64_tr_b16 v[38:39], v247 offset:16800
    s_waitcnt lgkmcnt(6)
    v_mfma_f32_32x32x16_bf16 v[160:175], v[56:59], v[16:19], v[160:175]
    ds_read_b64_tr_b16 v[40:41], v247 offset:16448
    ds_read_b64_tr_b16 v[42:43], v247 offset:16832
    s_waitcnt lgkmcnt(6)
    v_mfma_f32_32x32x16_bf16 v[176:191], v[60:63], v[16:19], v[176:191]
    ds_read_b64_tr_b16 v[44:45], v240 offset:4096
    ds_read_b64_tr_b16 v[46:47], v240 offset:5120
    s_waitcnt lgkmcnt(6)
    v_mfma_f32_32x32x16_bf16 v[192:207], v[32:35], v[16:19], v[192:207]
    ds_read_b64_tr_b16 v[48:49], v241 offset:4096
    ds_read_b64_tr_b16 v[50:51], v241 offset:5120
    s_waitcnt lgkmcnt(6)
    v_mfma_f32_32x32x16_bf16 v[208:223], v[36:39], v[16:19], v[208:223]
    ds_read_b64_tr_b16 v[52:53], v242 offset:4096
    ds_read_b64_tr_b16 v[54:55], v242 offset:5120
    s_waitcnt lgkmcnt(6)
    v_mfma_f32_32x32x16_bf16 v[224:239], v[40:43], v[16:19], v[224:239]
    ds_read_b64_tr_b16 v[56:57], v243 offset:4096
    ds_read_b64_tr_b16 v[58:59], v243 offset:5120
    buffer_load_dwordx4 v[16:19], v254, s[16:19], s13 offen offset:0
    s_waitcnt vmcnt(12)
    s_waitcnt lgkmcnt(6)
    v_mfma_f32_32x32x16_bf16 v[128:143], v[44:47], v[20:23], v[128:143]
    ds_read_b64_tr_b16 v[60:61], v247 offset:17920
    ds_read_b64_tr_b16 v[62:63], v247 offset:18304
    s_waitcnt lgkmcnt(6)
    v_mfma_f32_32x32x16_bf16 v[144:159], v[48:51], v[20:23], v[144:159]
    ds_read_b64_tr_b16 v[32:33], v247 offset:17952
    ds_read_b64_tr_b16 v[34:35], v247 offset:18336
    s_waitcnt lgkmcnt(6)
    v_mfma_f32_32x32x16_bf16 v[160:175], v[52:55], v[20:23], v[160:175]
    ds_read_b64_tr_b16 v[36:37], v247 offset:17984
    ds_read_b64_tr_b16 v[38:39], v247 offset:18368
    s_waitcnt lgkmcnt(6)
    v_mfma_f32_32x32x16_bf16 v[176:191], v[56:59], v[20:23], v[176:191]
    ds_read_b64_tr_b16 v[40:41], v240 offset:8192
    ds_read_b64_tr_b16 v[42:43], v240 offset:9216
    s_waitcnt lgkmcnt(6)
    v_mfma_f32_32x32x16_bf16 v[192:207], v[60:63], v[20:23], v[192:207]
    ds_read_b64_tr_b16 v[44:45], v241 offset:8192
    ds_read_b64_tr_b16 v[46:47], v241 offset:9216
    s_waitcnt lgkmcnt(6)
    v_mfma_f32_32x32x16_bf16 v[208:223], v[32:35], v[20:23], v[208:223]
    ds_read_b64_tr_b16 v[48:49], v242 offset:8192
    ds_read_b64_tr_b16 v[50:51], v242 offset:9216
    s_waitcnt lgkmcnt(6)
    v_mfma_f32_32x32x16_bf16 v[224:239], v[36:39], v[20:23], v[224:239]
    ds_read_b64_tr_b16 v[52:53], v243 offset:8192
    ds_read_b64_tr_b16 v[54:55], v243 offset:9216
    buffer_load_dwordx4 v[20:23], v254, s[16:19], s13 offen offset:1024
    s_waitcnt vmcnt(10)
    s_waitcnt lgkmcnt(6)
    v_mfma_f32_32x32x16_bf16 v[128:143], v[40:43], v[24:27], v[128:143]
    ds_read_b64_tr_b16 v[56:57], v247 offset:19456
    ds_read_b64_tr_b16 v[58:59], v247 offset:19840
    s_waitcnt lgkmcnt(6)
    v_mfma_f32_32x32x16_bf16 v[144:159], v[44:47], v[24:27], v[144:159]
    ds_read_b64_tr_b16 v[60:61], v247 offset:19488
    ds_read_b64_tr_b16 v[62:63], v247 offset:19872
    s_waitcnt lgkmcnt(6)
    v_mfma_f32_32x32x16_bf16 v[160:175], v[48:51], v[24:27], v[160:175]
    ds_read_b64_tr_b16 v[32:33], v247 offset:19520
    ds_read_b64_tr_b16 v[34:35], v247 offset:19904
    s_waitcnt lgkmcnt(6)
    v_mfma_f32_32x32x16_bf16 v[176:191], v[52:55], v[24:27], v[176:191]
    ds_read_b64_tr_b16 v[36:37], v240 offset:12288
    ds_read_b64_tr_b16 v[38:39], v240 offset:13312
    s_waitcnt lgkmcnt(6)
    v_mfma_f32_32x32x16_bf16 v[192:207], v[56:59], v[24:27], v[192:207]
    ds_read_b64_tr_b16 v[40:41], v241 offset:12288
    ds_read_b64_tr_b16 v[42:43], v241 offset:13312
    s_waitcnt lgkmcnt(6)
    v_mfma_f32_32x32x16_bf16 v[208:223], v[60:63], v[24:27], v[208:223]
    ds_read_b64_tr_b16 v[44:45], v242 offset:12288
    ds_read_b64_tr_b16 v[46:47], v242 offset:13312
    s_waitcnt lgkmcnt(6)
    v_mfma_f32_32x32x16_bf16 v[224:239], v[32:35], v[24:27], v[224:239]
    ds_read_b64_tr_b16 v[48:49], v243 offset:12288
    ds_read_b64_tr_b16 v[50:51], v243 offset:13312
    buffer_load_dwordx4 v[24:27], v254, s[16:19], s13 offen offset:2048
    s_waitcnt vmcnt(8)
    s_waitcnt lgkmcnt(6)
    v_mfma_f32_32x32x16_bf16 v[128:143], v[36:39], v[28:31], v[128:143]
    ds_read_b64_tr_b16 v[52:53], v247 offset:20992
    ds_read_b64_tr_b16 v[54:55], v247 offset:21376
    s_waitcnt lgkmcnt(6)
    v_mfma_f32_32x32x16_bf16 v[144:159], v[40:43], v[28:31], v[144:159]
    ds_read_b64_tr_b16 v[56:57], v247 offset:21024
    ds_read_b64_tr_b16 v[58:59], v247 offset:21408
    s_waitcnt lgkmcnt(6)
    v_mfma_f32_32x32x16_bf16 v[160:175], v[44:47], v[28:31], v[160:175]
    ds_read_b64_tr_b16 v[60:61], v247 offset:21056
    ds_read_b64_tr_b16 v[62:63], v247 offset:21440
    s_waitcnt lgkmcnt(6)
    v_mfma_f32_32x32x16_bf16 v[176:191], v[48:51], v[28:31], v[176:191]
    s_barrier
    v_add_u32 v240, 32768, v240
    v_add_u32 v241, 32768, v241
    v_add_u32 v242, 32768, v242
    v_add_u32 v243, 32768, v243
    v_add_u32 v247, 32768, v247
    ds_read_b64_tr_b16 v[32:33], v240 offset:0
    ds_read_b64_tr_b16 v[34:35], v240 offset:1024
    s_waitcnt lgkmcnt(6)
    v_mfma_f32_32x32x16_bf16 v[192:207], v[52:55], v[28:31], v[192:207]
    ds_read_b64_tr_b16 v[36:37], v241 offset:0
    ds_read_b64_tr_b16 v[38:39], v241 offset:1024
    s_waitcnt lgkmcnt(6)
    v_mfma_f32_32x32x16_bf16 v[208:223], v[56:59], v[28:31], v[208:223]
    ds_read_b64_tr_b16 v[40:41], v242 offset:0
    ds_read_b64_tr_b16 v[42:43], v242 offset:1024
    s_waitcnt lgkmcnt(6)
    v_mfma_f32_32x32x16_bf16 v[224:239], v[60:63], v[28:31], v[224:239]
    ds_read_b64_tr_b16 v[44:45], v243 offset:0
    ds_read_b64_tr_b16 v[46:47], v243 offset:1024
    buffer_load_dwordx4 v[28:31], v254, s[16:19], s13 offen offset:3072
    s_add_u32 s13, s13, 4096
    s_waitcnt vmcnt(7)
    s_lshl_b32 s54, s48, 3
    s_add_u32 s54, s54, s49
    s_lshl_b32 s54, s54, 3
    s_add_u32 s54, s54, s50
    s_lshl_b32 s54, s54, 2
    s_add_u32 s54, s54, 58736640
    s_mov_b64 exec, 1
    buffer_store_dword v251, off, s[16:19], s54 sc1
    s_mov_b64 exec, -1
    s_waitcnt lgkmcnt(6)
    v_mfma_f32_32x32x16_bf16 v[128:143], v[32:35], v[0:3], v[128:143]
    ds_read_b64_tr_b16 v[48:49], v247 offset:16384
    ds_read_b64_tr_b16 v[50:51], v247 offset:16768
    v_mov_b32 v64, 0
    v_mov_b32 v65, 0
    v_mov_b32 v66, 0
    s_waitcnt lgkmcnt(6)
    v_mfma_f32_32x32x16_bf16 v[144:159], v[36:39], v[0:3], v[144:159]
    ds_read_b64_tr_b16 v[52:53], v247 offset:16416
    ds_read_b64_tr_b16 v[54:55], v247 offset:16800
    v_mov_b32 v67, 0
    v_mov_b32 v68, 0
    v_mov_b32 v69, 0
    s_waitcnt lgkmcnt(6)
    v_mfma_f32_32x32x16_bf16 v[160:175], v[40:43], v[0:3], v[160:175]
    ds_read_b64_tr_b16 v[56:57], v247 offset:16448
    ds_read_b64_tr_b16 v[58:59], v247 offset:16832
    v_mov_b32 v70, 0
    v_mov_b32 v71, 0
    v_mov_b32 v72, 0
    s_waitcnt lgkmcnt(6)
    v_mfma_f32_32x32x16_bf16 v[176:191], v[44:47], v[0:3], v[176:191]
    ds_read_b64_tr_b16 v[60:61], v240 offset:4096
    ds_read_b64_tr_b16 v[62:63], v240 offset:5120
    v_mov_b32 v73, 0
    v_mov_b32 v74, 0
    v_mov_b32 v75, 0
    s_waitcnt lgkmcnt(6)
    v_mfma_f32_32x32x16_bf16 v[192:207], v[48:51], v[0:3], v[192:207]
    ds_read_b64_tr_b16 v[32:33], v241 offset:4096
    ds_read_b64_tr_b16 v[34:35], v241 offset:5120
    v_mov_b32 v76, 0
    v_mov_b32 v77, 0
    v_mov_b32 v78, 0
    s_waitcnt lgkmcnt(6)
    v_mfma_f32_32x32x16_bf16 v[208:223], v[52:55], v[0:3], v[208:223]
    ds_read_b64_tr_b16 v[36:37], v242 offset:4096
    ds_read_b64_tr_b16 v[38:39], v242 offset:5120
    v_mov_b32 v79, 0
    v_mov_b32 v80, 0
    v_mov_b32 v81, 0
    s_waitcnt lgkmcnt(6)
    v_mfma_f32_32x32x16_bf16 v[224:239], v[56:59], v[0:3], v[224:239]
    ds_read_b64_tr_b16 v[40:41], v243 offset:4096
    ds_read_b64_tr_b16 v[42:43], v243 offset:5120
    buffer_load_dwordx4 v[0:3], v254, s[16:19], s13 offen offset:0
    v_mov_b32 v82, 0
    v_mov_b32 v83, 0
    v_mov_b32 v84, 0
    s_waitcnt vmcnt(8)
    s_waitcnt lgkmcnt(6)
    v_mfma_f32_32x32x16_bf16 v[128:143], v[60:63], v[4:7], v[128:143]
    ds_read_b64_tr_b16 v[44:45], v247 offset:17920
    ds_read_b64_tr_b16 v[46:47], v247 offset:18304
    v_mov_b32 v85, 0
    v_mov_b32 v86, 0
    v_mov_b32 v87, 0
    s_waitcnt lgkmcnt(6)
    v_mfma_f32_32x32x16_bf16 v[144:159], v[32:35], v[4:7], v[144:159]
    ds_read_b64_tr_b16 v[48:49], v247 offset:17952
    ds_read_b64_tr_b16 v[50:51], v247 offset:18336
    v_mov_b32 v88, 0
    v_mov_b32 v89, 0
    v_mov_b32 v90, 0
    s_waitcnt lgkmcnt(6)
    v_mfma_f32_32x32x16_bf16 v[160:175], v[36:39], v[4:7], v[160:175]
    ds_read_b64_tr_b16 v[52:53], v247 offset:17984
    ds_read_b64_tr_b16 v[54:55], v247 offset:18368
    v_mov_b32 v91, 0
    v_mov_b32 v92, 0
    v_mov_b32 v93, 0
    s_waitcnt lgkmcnt(6)
    v_mfma_f32_32x32x16_bf16 v[176:191], v[40:43], v[4:7], v[176:191]
    ds_read_b64_tr_b16 v[56:57], v240 offset:8192
    ds_read_b64_tr_b16 v[58:59], v240 offset:9216
    v_mov_b32 v94, 0
    v_mov_b32 v95, 0
    v_mov_b32 v96, 0
    s_waitcnt lgkmcnt(6)
    v_mfma_f32_32x32x16_bf16 v[192:207], v[44:47], v[4:7], v[192:207]
    ds_read_b64_tr_b16 v[60:61], v241 offset:8192
    ds_read_b64_tr_b16 v[62:63], v241 offset:9216
    v_mov_b32 v97, 0
    v_mov_b32 v98, 0
    v_mov_b32 v99, 0
    s_waitcnt lgkmcnt(6)
    v_mfma_f32_32x32x16_bf16 v[208:223], v[48:51], v[4:7], v[208:223]
    ds_read_b64_tr_b16 v[32:33], v242 offset:8192
    ds_read_b64_tr_b16 v[34:35], v242 offset:9216
    v_mov_b32 v100, 0
    v_mov_b32 v101, 0
    v_mov_b32 v102, 0
    s_waitcnt lgkmcnt(6)
    v_mfma_f32_32x32x16_bf16 v[224:239], v[52:55], v[4:7], v[224:239]
    ds_read_b64_tr_b16 v[36:37], v243 offset:8192
    ds_read_b64_tr_b16 v[38:39], v243 offset:9216
    buffer_load_dwordx4 v[4:7], v254, s[16:19], s13 offen offset:1024
    v_mov_b32 v103, 0
    v_mov_b32 v104, 0
    v_mov_b32 v105, 0
    s_waitcnt vmcnt(8)
    s_waitcnt lgkmcnt(6)
    v_mfma_f32_32x32x16_bf16 v[128:143], v[56:59], v[8:11], v[128:143]
    ds_read_b64_tr_b16 v[40:41], v247 offset:19456
    ds_read_b64_tr_b16 v[42:43], v247 offset:19840
    v_mov_b32 v106, 0
    v_mov_b32 v107, 0
    v_mov_b32 v108, 0
    s_waitcnt lgkmcnt(6)
    v_mfma_f32_32x32x16_bf16 v[144:159], v[60:63], v[8:11], v[144:159]
    ds_read_b64_tr_b16 v[44:45], v247 offset:19488
    ds_read_b64_tr_b16 v[46:47], v247 offset:19872
    v_mov_b32 v109, 0
    v_mov_b32 v110, 0
    v_mov_b32 v111, 0
    s_waitcnt lgkmcnt(6)
    v_mfma_f32_32x32x16_bf16 v[160:175], v[32:35], v[8:11], v[160:175]
    ds_read_b64_tr_b16 v[48:49], v247 offset:19520
    ds_read_b64_tr_b16 v[50:51], v247 offset:19904
    v_mov_b32 v112, 0
    v_mov_b32 v113, 0
    v_mov_b32 v114, 0
    s_waitcnt lgkmcnt(6)
    v_mfma_f32_32x32x16_bf16 v[176:191], v[36:39], v[8:11], v[176:191]
    ds_read_b64_tr_b16 v[52:53], v240 offset:12288
    ds_read_b64_tr_b16 v[54:55], v240 offset:13312
    v_mov_b32 v115, 0
    v_mov_b32 v116, 0
    v_mov_b32 v117, 0
    s_waitcnt lgkmcnt(6)
    v_mfma_f32_32x32x16_bf16 v[192:207], v[40:43], v[8:11], v[192:207]
    ds_read_b64_tr_b16 v[56:57], v241 offset:12288
    ds_read_b64_tr_b16 v[58:59], v241 offset:13312
    v_mov_b32 v118, 0
    v_mov_b32 v119, 0
    v_mov_b32 v120, 0
    s_waitcnt lgkmcnt(6)
    v_mfma_f32_32x32x16_bf16 v[208:223], v[44:47], v[8:11], v[208:223]
    ds_read_b64_tr_b16 v[60:61], v242 offset:12288
    ds_read_b64_tr_b16 v[62:63], v242 offset:13312
    v_mov_b32 v121, 0
    v_mov_b32 v122, 0
    v_mov_b32 v123, 0
    s_waitcnt lgkmcnt(6)
    v_mfma_f32_32x32x16_bf16 v[224:239], v[48:51], v[8:11], v[224:239]
    ds_read_b64_tr_b16 v[32:33], v243 offset:12288
    ds_read_b64_tr_b16 v[34:35], v243 offset:13312
    buffer_load_dwordx4 v[8:11], v254, s[16:19], s13 offen offset:2048
    v_mov_b32 v124, 0
    v_mov_b32 v125, 0
    v_mov_b32 v126, 0
    s_waitcnt vmcnt(8)
    s_waitcnt lgkmcnt(6)
    v_mfma_f32_32x32x16_bf16 v[128:143], v[52:55], v[12:15], v[128:143]
    ds_read_b64_tr_b16 v[36:37], v247 offset:20992
    ds_read_b64_tr_b16 v[38:39], v247 offset:21376
    v_mov_b32 v127, 0
    s_waitcnt lgkmcnt(6)
    v_mfma_f32_32x32x16_bf16 v[144:159], v[56:59], v[12:15], v[144:159]
    ds_read_b64_tr_b16 v[40:41], v247 offset:21024
    ds_read_b64_tr_b16 v[42:43], v247 offset:21408
    s_waitcnt lgkmcnt(6)
    v_mfma_f32_32x32x16_bf16 v[160:175], v[60:63], v[12:15], v[160:175]
    ds_read_b64_tr_b16 v[44:45], v247 offset:21056
    ds_read_b64_tr_b16 v[46:47], v247 offset:21440
    s_waitcnt lgkmcnt(6)
    v_mfma_f32_32x32x16_bf16 v[176:191], v[32:35], v[12:15], v[176:191]
    s_barrier
    v_add_u32 v240, 4294836224, v240
    v_add_u32 v241, 4294836224, v241
    v_add_u32 v242, 4294836224, v242
    v_add_u32 v243, 4294836224, v243
    v_add_u32 v247, 4294836224, v247
    ds_read_b64_tr_b16 v[48:49], v240 offset:0
    ds_read_b64_tr_b16 v[50:51], v240 offset:1024
    s_waitcnt lgkmcnt(6)
    v_mfma_f32_32x32x16_bf16 v[192:207], v[36:39], v[12:15], v[192:207]
    ds_read_b64_tr_b16 v[52:53], v241 offset:0
    ds_read_b64_tr_b16 v[54:55], v241 offset:1024
    s_waitcnt lgkmcnt(6)
    v_mfma_f32_32x32x16_bf16 v[208:223], v[40:43], v[12:15], v[208:223]
    ds_read_b64_tr_b16 v[56:57], v242 offset:0
    ds_read_b64_tr_b16 v[58:59], v242 offset:1024
    s_waitcnt lgkmcnt(6)
    v_mfma_f32_32x32x16_bf16 v[224:239], v[44:47], v[12:15], v[224:239]
    ds_read_b64_tr_b16 v[60:61], v243 offset:0
    ds_read_b64_tr_b16 v[62:63], v243 offset:1024
    buffer_load_dwordx4 v[12:15], v254, s[16:19], s13 offen offset:3072
    s_add_u32 s13, s13, 4096
    s_waitcnt vmcnt(8)
    s_waitcnt lgkmcnt(6)
    v_mfma_f32_32x32x16_bf16 v[128:143], v[48:51], v[16:19], v[128:143]
    ds_read_b64_tr_b16 v[32:33], v247 offset:16384
    ds_read_b64_tr_b16 v[34:35], v247 offset:16768
    s_waitcnt lgkmcnt(6)
    v_mfma_f32_32x32x16_bf16 v[144:159], v[52:55], v[16:19], v[144:159]
    ds_read_b64_tr_b16 v[36:37], v247 offset:16416
    ds_read_b64_tr_b16 v[38:39], v247 offset:16800
    s_waitcnt lgkmcnt(6)
    v_mfma_f32_32x32x16_bf16 v[160:175], v[56:59], v[16:19], v[160:175]
    ds_read_b64_tr_b16 v[40:41], v247 offset:16448
    ds_read_b64_tr_b16 v[42:43], v247 offset:16832
    s_waitcnt lgkmcnt(6)
    v_mfma_f32_32x32x16_bf16 v[176:191], v[60:63], v[16:19], v[176:191]
    ds_read_b64_tr_b16 v[44:45], v240 offset:4096
    ds_read_b64_tr_b16 v[46:47], v240 offset:5120
    s_waitcnt lgkmcnt(6)
    v_mfma_f32_32x32x16_bf16 v[192:207], v[32:35], v[16:19], v[192:207]
    ds_read_b64_tr_b16 v[48:49], v241 offset:4096
    ds_read_b64_tr_b16 v[50:51], v241 offset:5120
    s_waitcnt lgkmcnt(6)
    v_mfma_f32_32x32x16_bf16 v[208:223], v[36:39], v[16:19], v[208:223]
    ds_read_b64_tr_b16 v[52:53], v242 offset:4096
    ds_read_b64_tr_b16 v[54:55], v242 offset:5120
    s_waitcnt lgkmcnt(6)
    v_mfma_f32_32x32x16_bf16 v[224:239], v[40:43], v[16:19], v[224:239]
    ds_read_b64_tr_b16 v[56:57], v243 offset:4096
    ds_read_b64_tr_b16 v[58:59], v243 offset:5120
    buffer_load_dwordx4 v[16:19], v254, s[16:19], s13 offen offset:0
    s_waitcnt vmcnt(8)
    s_waitcnt lgkmcnt(6)
    v_mfma_f32_32x32x16_bf16 v[128:143], v[44:47], v[20:23], v[128:143]
    ds_read_b64_tr_b16 v[60:61], v247 offset:17920
    ds_read_b64_tr_b16 v[62:63], v247 offset:18304
    s_waitcnt lgkmcnt(6)
    v_mfma_f32_32x32x16_bf16 v[144:159], v[48:51], v[20:23], v[144:159]
    ds_read_b64_tr_b16 v[32:33], v247 offset:17952
    ds_read_b64_tr_b16 v[34:35], v247 offset:18336
    s_waitcnt lgkmcnt(6)
    v_mfma_f32_32x32x16_bf16 v[160:175], v[52:55], v[20:23], v[160:175]
    ds_read_b64_tr_b16 v[36:37], v247 offset:17984
    ds_read_b64_tr_b16 v[38:39], v247 offset:18368
    s_waitcnt lgkmcnt(6)
    v_mfma_f32_32x32x16_bf16 v[176:191], v[56:59], v[20:23], v[176:191]
    ds_read_b64_tr_b16 v[40:41], v240 offset:8192
    ds_read_b64_tr_b16 v[42:43], v240 offset:9216
    s_waitcnt lgkmcnt(6)
    v_mfma_f32_32x32x16_bf16 v[192:207], v[60:63], v[20:23], v[192:207]
    ds_read_b64_tr_b16 v[44:45], v241 offset:8192
    ds_read_b64_tr_b16 v[46:47], v241 offset:9216
    s_waitcnt lgkmcnt(6)
    v_mfma_f32_32x32x16_bf16 v[208:223], v[32:35], v[20:23], v[208:223]
    ds_read_b64_tr_b16 v[48:49], v242 offset:8192
    ds_read_b64_tr_b16 v[50:51], v242 offset:9216
    s_waitcnt lgkmcnt(6)
    v_mfma_f32_32x32x16_bf16 v[224:239], v[36:39], v[20:23], v[224:239]
    ds_read_b64_tr_b16 v[52:53], v243 offset:8192
    ds_read_b64_tr_b16 v[54:55], v243 offset:9216
    buffer_load_dwordx4 v[20:23], v254, s[16:19], s13 offen offset:1024
    s_waitcnt vmcnt(8)
    s_waitcnt lgkmcnt(6)
    v_mfma_f32_32x32x16_bf16 v[128:143], v[40:43], v[24:27], v[128:143]
    ds_read_b64_tr_b16 v[56:57], v247 offset:19456
    ds_read_b64_tr_b16 v[58:59], v247 offset:19840
    s_waitcnt lgkmcnt(6)
    v_mfma_f32_32x32x16_bf16 v[144:159], v[44:47], v[24:27], v[144:159]
    ds_read_b64_tr_b16 v[60:61], v247 offset:19488
    ds_read_b64_tr_b16 v[62:63], v247 offset:19872
    s_waitcnt lgkmcnt(6)
    v_mfma_f32_32x32x16_bf16 v[160:175], v[48:51], v[24:27], v[160:175]
    ds_read_b64_tr_b16 v[32:33], v247 offset:19520
    ds_read_b64_tr_b16 v[34:35], v247 offset:19904
    s_waitcnt lgkmcnt(6)
    v_mfma_f32_32x32x16_bf16 v[176:191], v[52:55], v[24:27], v[176:191]
    ds_read_b64_tr_b16 v[36:37], v240 offset:12288
    ds_read_b64_tr_b16 v[38:39], v240 offset:13312
    s_waitcnt lgkmcnt(6)
    v_mfma_f32_32x32x16_bf16 v[192:207], v[56:59], v[24:27], v[192:207]
    ds_read_b64_tr_b16 v[40:41], v241 offset:12288
    ds_read_b64_tr_b16 v[42:43], v241 offset:13312
    s_waitcnt lgkmcnt(6)
    v_mfma_f32_32x32x16_bf16 v[208:223], v[60:63], v[24:27], v[208:223]
    ds_read_b64_tr_b16 v[44:45], v242 offset:12288
    ds_read_b64_tr_b16 v[46:47], v242 offset:13312
    s_waitcnt lgkmcnt(6)
    v_mfma_f32_32x32x16_bf16 v[224:239], v[32:35], v[24:27], v[224:239]
    ds_read_b64_tr_b16 v[48:49], v243 offset:12288
    ds_read_b64_tr_b16 v[50:51], v243 offset:13312
    buffer_load_dwordx4 v[24:27], v254, s[16:19], s13 offen offset:2048
    s_waitcnt vmcnt(8)
    s_waitcnt lgkmcnt(6)
    v_mfma_f32_32x32x16_bf16 v[128:143], v[36:39], v[28:31], v[128:143]
    ds_read_b64_tr_b16 v[52:53], v247 offset:20992
    ds_read_b64_tr_b16 v[54:55], v247 offset:21376
    s_waitcnt lgkmcnt(6)
    v_mfma_f32_32x32x16_bf16 v[144:159], v[40:43], v[28:31], v[144:159]
    ds_read_b64_tr_b16 v[56:57], v247 offset:21024
    ds_read_b64_tr_b16 v[58:59], v247 offset:21408
    s_waitcnt lgkmcnt(6)
    v_mfma_f32_32x32x16_bf16 v[160:175], v[44:47], v[28:31], v[160:175]
    ds_read_b64_tr_b16 v[60:61], v247 offset:21056
    ds_read_b64_tr_b16 v[62:63], v247 offset:21440
    s_waitcnt lgkmcnt(6)
    v_mfma_f32_32x32x16_bf16 v[176:191], v[48:51], v[28:31], v[176:191]
    s_barrier
    v_add_u32 v240, 32768, v240
    v_add_u32 v241, 32768, v241
    v_add_u32 v242, 32768, v242
    v_add_u32 v243, 32768, v243
    v_add_u32 v247, 32768, v247
    ds_read_b64_tr_b16 v[32:33], v240 offset:0
    ds_read_b64_tr_b16 v[34:35], v240 offset:1024
    s_waitcnt lgkmcnt(6)
    v_mfma_f32_32x32x16_bf16 v[192:207], v[52:55], v[28:31], v[192:207]
    ds_read_b64_tr_b16 v[36:37], v241 offset:0
    ds_read_b64_tr_b16 v[38:39], v241 offset:1024
    s_waitcnt lgkmcnt(6)
    v_mfma_f32_32x32x16_bf16 v[208:223], v[56:59], v[28:31], v[208:223]
    ds_read_b64_tr_b16 v[40:41], v242 offset:0
    ds_read_b64_tr_b16 v[42:43], v242 offset:1024
    s_waitcnt lgkmcnt(6)
    v_mfma_f32_32x32x16_bf16 v[224:239], v[60:63], v[28:31], v[224:239]
    ds_read_b64_tr_b16 v[44:45], v243 offset:0
    ds_read_b64_tr_b16 v[46:47], v243 offset:1024
    buffer_load_dwordx4 v[28:31], v254, s[16:19], s13 offen offset:3072
    s_add_u32 s13, s13, 4096
    s_waitcnt vmcnt(7)
    s_waitcnt lgkmcnt(6)
    v_mfma_f32_32x32x16_bf16 v[128:143], v[32:35], v[0:3], v[128:143]
    ds_read_b64_tr_b16 v[48:49], v247 offset:16384
    ds_read_b64_tr_b16 v[50:51], v247 offset:16768
    s_waitcnt lgkmcnt(6)
    v_mfma_f32_32x32x16_bf16 v[144:159], v[36:39], v[0:3], v[144:159]
    ds_read_b64_tr_b16 v[52:53], v247 offset:16416
    ds_read_b64_tr_b16 v[54:55], v247 offset:16800
    s_waitcnt lgkmcnt(6)
    v_mfma_f32_32x32x16_bf16 v[160:175], v[40:43], v[0:3], v[160:175]
    ds_read_b64_tr_b16 v[56:57], v247 offset:16448
    ds_read_b64_tr_b16 v[58:59], v247 offset:16832
    s_waitcnt lgkmcnt(6)
    v_mfma_f32_32x32x16_bf16 v[176:191], v[44:47], v[0:3], v[176:191]
    ds_read_b64_tr_b16 v[60:61], v240 offset:4096
    ds_read_b64_tr_b16 v[62:63], v240 offset:5120
    s_waitcnt lgkmcnt(6)
    v_mfma_f32_32x32x16_bf16 v[192:207], v[48:51], v[0:3], v[192:207]
    ds_read_b64_tr_b16 v[32:33], v241 offset:4096
    ds_read_b64_tr_b16 v[34:35], v241 offset:5120
    v_lshlrev_b32 v244, 2, v255
    s_lshl_b32 s61, s48, 8
    s_add_u32 s61, s61, 58736640
    buffer_load_dword v249, v244, s[16:19], s61 offen sc1
    s_waitcnt lgkmcnt(6)
    v_mfma_f32_32x32x16_bf16 v[208:223], v[52:55], v[0:3], v[208:223]
    ds_read_b64_tr_b16 v[36:37], v242 offset:4096
    ds_read_b64_tr_b16 v[38:39], v242 offset:5120
    s_waitcnt lgkmcnt(6)
    v_mfma_f32_32x32x16_bf16 v[224:239], v[56:59], v[0:3], v[224:239]
    ds_read_b64_tr_b16 v[40:41], v243 offset:4096
    ds_read_b64_tr_b16 v[42:43], v243 offset:5120
    s_waitcnt vmcnt(7)
    s_waitcnt lgkmcnt(6)
    v_mfma_f32_32x32x16_bf16 v[128:143], v[60:63], v[4:7], v[128:143]
    ds_read_b64_tr_b16 v[44:45], v247 offset:17920
    ds_read_b64_tr_b16 v[46:47], v247 offset:18304
    s_waitcnt lgkmcnt(6)
    v_mfma_f32_32x32x16_bf16 v[144:159], v[32:35], v[4:7], v[144:159]
    ds_read_b64_tr_b16 v[48:49], v247 offset:17952
    ds_read_b64_tr_b16 v[50:51], v247 offset:18336
    s_waitcnt lgkmcnt(6)
    v_mfma_f32_32x32x16_bf16 v[160:175], v[36:39], v[4:7], v[160:175]
    ds_read_b64_tr_b16 v[52:53], v247 offset:17984
    ds_read_b64_tr_b16 v[54:55], v247 offset:18368
    s_waitcnt lgkmcnt(6)
    v_mfma_f32_32x32x16_bf16 v[176:191], v[40:43], v[4:7], v[176:191]
    ds_read_b64_tr_b16 v[56:57], v240 offset:8192
    ds_read_b64_tr_b16 v[58:59], v240 offset:9216
    s_waitcnt lgkmcnt(6)
    v_mfma_f32_32x32x16_bf16 v[192:207], v[44:47], v[4:7], v[192:207]
    ds_read_b64_tr_b16 v[60:61], v241 offset:8192
    ds_read_b64_tr_b16 v[62:63], v241 offset:9216
    s_waitcnt lgkmcnt(6)
    v_mfma_f32_32x32x16_bf16 v[208:223], v[48:51], v[4:7], v[208:223]
    ds_read_b64_tr_b16 v[32:33], v242 offset:8192
    ds_read_b64_tr_b16 v[34:35], v242 offset:9216
    s_waitcnt lgkmcnt(6)
    v_mfma_f32_32x32x16_bf16 v[224:239], v[52:55], v[4:7], v[224:239]
    ds_read_b64_tr_b16 v[36:37], v243 offset:8192
    ds_read_b64_tr_b16 v[38:39], v243 offset:9216
    s_waitcnt vmcnt(6)
    s_waitcnt lgkmcnt(6)
    v_mfma_f32_32x32x16_bf16 v[128:143], v[56:59], v[8:11], v[128:143]
    ds_read_b64_tr_b16 v[40:41], v247 offset:19456
    ds_read_b64_tr_b16 v[42:43], v247 offset:19840
    s_waitcnt lgkmcnt(6)
    v_mfma_f32_32x32x16_bf16 v[144:159], v[60:63], v[8:11], v[144:159]
    ds_read_b64_tr_b16 v[44:45], v247 offset:19488
    ds_read_b64_tr_b16 v[46:47], v247 offset:19872
    s_waitcnt lgkmcnt(6)
    v_mfma_f32_32x32x16_bf16 v[160:175], v[32:35], v[8:11], v[160:175]
    ds_read_b64_tr_b16 v[48:49], v247 offset:19520
    ds_read_b64_tr_b16 v[50:51], v247 offset:19904
    s_waitcnt lgkmcnt(6)
    v_mfma_f32_32x32x16_bf16 v[176:191], v[36:39], v[8:11], v[176:191]
    ds_read_b64_tr_b16 v[52:53], v240 offset:12288
    ds_read_b64_tr_b16 v[54:55], v240 offset:13312
    s_waitcnt lgkmcnt(6)
    v_mfma_f32_32x32x16_bf16 v[192:207], v[40:43], v[8:11], v[192:207]
    ds_read_b64_tr_b16 v[56:57], v241 offset:12288
    ds_read_b64_tr_b16 v[58:59], v241 offset:13312
    s_waitcnt lgkmcnt(6)
    v_mfma_f32_32x32x16_bf16 v[208:223], v[44:47], v[8:11], v[208:223]
    ds_read_b64_tr_b16 v[60:61], v242 offset:12288
    ds_read_b64_tr_b16 v[62:63], v242 offset:13312
    s_waitcnt lgkmcnt(6)
    v_mfma_f32_32x32x16_bf16 v[224:239], v[48:51], v[8:11], v[224:239]
    ds_read_b64_tr_b16 v[32:33], v243 offset:12288
    ds_read_b64_tr_b16 v[34:35], v243 offset:13312
    s_waitcnt vmcnt(5)
    s_waitcnt lgkmcnt(6)
    v_mfma_f32_32x32x16_bf16 v[128:143], v[52:55], v[12:15], v[128:143]
    ds_read_b64_tr_b16 v[36:37], v247 offset:20992
    ds_read_b64_tr_b16 v[38:39], v247 offset:21376
    s_waitcnt lgkmcnt(6)
    v_mfma_f32_32x32x16_bf16 v[144:159], v[56:59], v[12:15], v[144:159]
    ds_read_b64_tr_b16 v[40:41], v247 offset:21024
    ds_read_b64_tr_b16 v[42:43], v247 offset:21408
    s_waitcnt lgkmcnt(6)
    v_mfma_f32_32x32x16_bf16 v[160:175], v[60:63], v[12:15], v[160:175]
    ds_read_b64_tr_b16 v[44:45], v247 offset:21056
    ds_read_b64_tr_b16 v[46:47], v247 offset:21440
    s_waitcnt lgkmcnt(6)
    v_mfma_f32_32x32x16_bf16 v[176:191], v[32:35], v[12:15], v[176:191]
    s_waitcnt vmcnt(0)
    v_cmp_ne_u32 vcc, s51, v249
    s_cbranch_vccz H_pkv_ok
    s_mov_b32 s57, 0x40000
H_pkv:
    s_sleep 4
    buffer_load_dword v249, v244, s[16:19], s61 offen sc1
    s_waitcnt vmcnt(0)
    v_cmp_ne_u32 vcc, s51, v249
    s_sub_u32 s57, s57, 1
    s_cbranch_scc1 H_pkv_ok
    s_cbranch_vccnz H_pkv
H_pkv_ok:
    s_barrier
    v_add_u32 v240, 32768, v240
    v_add_u32 v241, 32768, v241
    v_add_u32 v242, 32768, v242
    v_add_u32 v243, 32768, v243
    v_add_u32 v247, 32768, v247
    ds_read_b64_tr_b16 v[48:49], v247 offset:16384
    ds_read_b64_tr_b16 v[50:51], v247 offset:16768
    s_waitcnt lgkmcnt(6)
    v_mfma_f32_32x32x16_bf16 v[192:207], v[36:39], v[12:15], v[192:207]
    ds_read_b64_tr_b16 v[52:53], v247 offset:16416
    ds_read_b64_tr_b16 v[54:55], v247 offset:16800
    s_waitcnt lgkmcnt(6)
    v_mfma_f32_32x32x16_bf16 v[208:223], v[40:43], v[12:15], v[208:223]
    ds_read_b64_tr_b16 v[56:57], v247 offset:16448
    ds_read_b64_tr_b16 v[58:59], v247 offset:16832
    s_waitcnt lgkmcnt(6)
    v_mfma_f32_32x32x16_bf16 v[224:239], v[44:47], v[12:15], v[224:239]
    ds_read_b64_tr_b16 v[60:61], v247 offset:17920
    ds_read_b64_tr_b16 v[62:63], v247 offset:18304
    s_waitcnt lgkmcnt(6)
    v_mfma_f32_32x32x16_bf16 v[192:207], v[48:51], v[16:19], v[192:207]
    ds_read_b64_tr_b16 v[32:33], v247 offset:17952
    ds_read_b64_tr_b16 v[34:35], v247 offset:18336
    s_waitcnt lgkmcnt(6)
    v_mfma_f32_32x32x16_bf16 v[208:223], v[52:55], v[16:19], v[208:223]
    ds_read_b64_tr_b16 v[36:37], v247 offset:17984
    ds_read_b64_tr_b16 v[38:39], v247 offset:18368
    s_waitcnt lgkmcnt(6)
    v_mfma_f32_32x32x16_bf16 v[224:239], v[56:59], v[16:19], v[224:239]
    ds_read_b64_tr_b16 v[40:41], v247 offset:19456
    ds_read_b64_tr_b16 v[42:43], v247 offset:19840
    s_waitcnt lgkmcnt(6)
    v_mfma_f32_32x32x16_bf16 v[192:207], v[60:63], v[20:23], v[192:207]
    ds_read_b64_tr_b16 v[44:45], v247 offset:19488
    ds_read_b64_tr_b16 v[46:47], v247 offset:19872
    s_waitcnt lgkmcnt(6)
    v_mfma_f32_32x32x16_bf16 v[208:223], v[32:35], v[20:23], v[208:223]
    ds_read_b64_tr_b16 v[48:49], v247 offset:19520
    ds_read_b64_tr_b16 v[50:51], v247 offset:19904
    s_waitcnt lgkmcnt(6)
    v_mfma_f32_32x32x16_bf16 v[224:239], v[36:39], v[20:23], v[224:239]
    ds_read_b64_tr_b16 v[52:53], v247 offset:20992
    ds_read_b64_tr_b16 v[54:55], v247 offset:21376
    s_waitcnt lgkmcnt(6)
    v_mfma_f32_32x32x16_bf16 v[192:207], v[40:43], v[24:27], v[192:207]
    ds_read_b64_tr_b16 v[56:57], v247 offset:21024
    ds_read_b64_tr_b16 v[58:59], v247 offset:21408
    s_waitcnt lgkmcnt(6)
    v_mfma_f32_32x32x16_bf16 v[208:223], v[44:47], v[24:27], v[208:223]
    ds_read_b64_tr_b16 v[60:61], v247 offset:21056
    ds_read_b64_tr_b16 v[62:63], v247 offset:21440
    s_waitcnt lgkmcnt(6)
    v_mfma_f32_32x32x16_bf16 v[224:239], v[48:51], v[24:27], v[224:239]
    ds_read_b64_tr_b16 v[32:33], v240 offset:0
    ds_read_b64_tr_b16 v[34:35], v240 offset:1024
    s_waitcnt lgkmcnt(6)
    v_mfma_f32_32x32x16_bf16 v[192:207], v[52:55], v[28:31], v[192:207]
    ds_read_b64_tr_b16 v[36:37], v241 offset:0
    ds_read_b64_tr_b16 v[38:39], v241 offset:1024
    s_waitcnt lgkmcnt(6)
    v_mfma_f32_32x32x16_bf16 v[208:223], v[56:59], v[28:31], v[208:223]
    ds_read_b64_tr_b16 v[40:41], v242 offset:0
    ds_read_b64_tr_b16 v[42:43], v242 offset:1024
    s_waitcnt lgkmcnt(6)
    v_mfma_f32_32x32x16_bf16 v[224:239], v[60:63], v[28:31], v[224:239]
    ds_read_b64_tr_b16 v[44:45], v243 offset:0
    ds_read_b64_tr_b16 v[46:47], v243 offset:1024
    s_waitcnt lgkmcnt(6)
    v_mfma_f32_32x32x16_bf16 v[128:143], v[32:35], v[16:19], v[128:143]
    ds_read_b64_tr_b16 v[48:49], v240 offset:4096
    ds_read_b64_tr_b16 v[50:51], v240 offset:5120
    s_waitcnt lgkmcnt(6)
    v_mfma_f32_32x32x16_bf16 v[144:159], v[36:39], v[16:19], v[144:159]
    ds_read_b64_tr_b16 v[52:53], v241 offset:4096
    ds_read_b64_tr_b16 v[54:55], v241 offset:5120
    v_max_f32 v192, 0, v192
    v_mul_f32 v192, v192, v200
    v_max_f32 v193, 0, v193
    v_mul_f32 v193, v193, v201
    v_max_f32 v194, 0, v194
    s_waitcnt lgkmcnt(6)
    v_mfma_f32_32x32x16_bf16 v[160:175], v[40:43], v[16:19], v[160:175]
    ds_read_b64_tr_b16 v[56:57], v242 offset:4096
    ds_read_b64_tr_b16 v[58:59], v242 offset:5120
    v_mul_f32 v194, v194, v202
    v_max_f32 v195, 0, v195
    v_mul_f32 v195, v195, v203
    v_max_f32 v196, 0, v196
    v_mul_f32 v196, v196, v204
    s_waitcnt lgkmcnt(6)
    v_mfma_f32_32x32x16_bf16 v[176:191], v[44:47], v[16:19], v[176:191]
    ds_read_b64_tr_b16 v[60:61], v243 offset:4096
    ds_read_b64_tr_b16 v[62:63], v243 offset:5120
    v_max_f32 v197, 0, v197
    v_mul_f32 v197, v197, v205
    v_max_f32 v198, 0, v198
    v_mul_f32 v198, v198, v206
    v_max_f32 v199, 0, v199
    s_waitcnt lgkmcnt(6)
    v_mfma_f32_32x32x16_bf16 v[128:143], v[48:51], v[20:23], v[128:143]
    ds_read_b64_tr_b16 v[32:33], v240 offset:8192
    ds_read_b64_tr_b16 v[34:35], v240 offset:9216
    v_mul_f32 v199, v199, v207
    v_cvt_pk_bf16_f32 v192, v192, v193
    v_cvt_pk_bf16_f32 v193, v194, v195
    v_cvt_pk_bf16_f32 v194, v196, v197
    v_cvt_pk_bf16_f32 v195, v198, v199
    s_waitcnt lgkmcnt(6)
    v_mfma_f32_32x32x16_bf16 v[144:159], v[52:55], v[20:23], v[144:159]
    ds_read_b64_tr_b16 v[36:37], v241 offset:8192
    ds_read_b64_tr_b16 v[38:39], v241 offset:9216
    buffer_store_dwordx4 v[192:195], v253, s[16:19], s99 offen sc1
    s_waitcnt lgkmcnt(6)
    v_mfma_f32_32x32x16_bf16 v[160:175], v[56:59], v[20:23], v[160:175]
    ds_read_b64_tr_b16 v[40:41], v242 offset:8192
    ds_read_b64_tr_b16 v[42:43], v242 offset:9216
    v_max_f32 v208, 0, v208
    v_mul_f32 v208, v208, v216
    v_max_f32 v209, 0, v209
    v_mul_f32 v209, v209, v217
    v_max_f32 v210, 0, v210
    s_waitcnt lgkmcnt(6)
    v_mfma_f32_32x32x16_bf16 v[176:191], v[60:63], v[20:23], v[176:191]
    ds_read_b64_tr_b16 v[44:45], v243 offset:8192
    ds_read_b64_tr_b16 v[46:47], v243 offset:9216
    v_mul_f32 v210, v210, v218
    v_max_f32 v211, 0, v211
    v_mul_f32 v211, v211, v219
    v_max_f32 v212, 0, v212
    v_mul_f32 v212, v212, v220
    s_waitcnt lgkmcnt(6)
    v_mfma_f32_32x32x16_bf16 v[128:143], v[32:35], v[24:27], v[128:143]
    ds_read_b64_tr_b16 v[48:49], v240 offset:12288
    ds_read_b64_tr_b16 v[50:51], v240 offset:13312
    v_max_f32 v213, 0, v213
    v_mul_f32 v213, v213, v221
    v_max_f32 v214, 0, v214
    v_mul_f32 v214, v214, v222
    v_max_f32 v215, 0, v215
    s_waitcnt lgkmcnt(6)
    v_mfma_f32_32x32x16_bf16 v[144:159], v[36:39], v[24:27], v[144:159]
    ds_read_b64_tr_b16 v[52:53], v241 offset:12288
    ds_read_b64_tr_b16 v[54:55], v241 offset:13312
    v_mul_f32 v215, v215, v223
    v_cvt_pk_bf16_f32 v208, v208, v209
    v_cvt_pk_bf16_f32 v209, v210, v211
    v_cvt_pk_bf16_f32 v210, v212, v213
    v_cvt_pk_bf16_f32 v211, v214, v215
    s_waitcnt lgkmcnt(6)
    v_mfma_f32_32x32x16_bf16 v[160:175], v[40:43], v[24:27], v[160:175]
    ds_read_b64_tr_b16 v[56:57], v242 offset:12288
    ds_read_b64_tr_b16 v[58:59], v242 offset:13312
    buffer_store_dwordx4 v[208:211], v253, s[16:19], s100 offen sc1
    s_waitcnt lgkmcnt(6)
    v_mfma_f32_32x32x16_bf16 v[176:191], v[44:47], v[24:27], v[176:191]
    ds_read_b64_tr_b16 v[60:61], v243 offset:12288
    ds_read_b64_tr_b16 v[62:63], v243 offset:13312
    v_max_f32 v224, 0, v224
    v_mul_f32 v224, v224, v232
    v_max_f32 v225, 0, v225
    v_mul_f32 v225, v225, v233
    v_max_f32 v226, 0, v226
    s_waitcnt lgkmcnt(6)
    v_mfma_f32_32x32x16_bf16 v[128:143], v[48:51], v[28:31], v[128:143]
    v_mul_f32 v226, v226, v234
    v_max_f32 v227, 0, v227
    v_mul_f32 v227, v227, v235
    v_max_f32 v228, 0, v228
    v_mul_f32 v228, v228, v236
    s_waitcnt lgkmcnt(4)
    v_mfma_f32_32x32x16_bf16 v[144:159], v[52:55], v[28:31], v[144:159]
    v_max_f32 v229, 0, v229
    v_mul_f32 v229, v229, v237
    v_max_f32 v230, 0, v230
    v_mul_f32 v230, v230, v238
    v_max_f32 v231, 0, v231
    s_waitcnt lgkmcnt(2)
    v_mfma_f32_32x32x16_bf16 v[160:175], v[56:59], v[28:31], v[160:175]
    v_mul_f32 v231, v231, v239
    v_cvt_pk_bf16_f32 v224, v224, v225
    v_cvt_pk_bf16_f32 v225, v226, v227
    v_cvt_pk_bf16_f32 v226, v228, v229
    v_cvt_pk_bf16_f32 v227, v230, v231
    s_waitcnt lgkmcnt(0)
    v_mfma_f32_32x32x16_bf16 v[176:191], v[60:63], v[28:31], v[176:191]
    buffer_store_dwordx4 v[224:227], v253, s[16:19], s101 offen sc1
    s_mov_b32 s55, 0x3e0293ee
    s_sub_u32 s9, s52, 1
    s_lshr_b32 s9, s9, 1
    s_lshr_b32 s8, s52, 1
    s_add_u32 s8, s8, 2
    s_mov_b32 s10, 0x43800000
    s_mov_b32 s12, 0
    s_mov_b32 s62, 0x3f803f80
    s_mov_b32 s4, 98304
    v_add_u32 v252, s4, v254
    v_mov_b32 v32, 0
    v_mov_b32 v33, 0
    v_mov_b32 v34, 0
    v_mov_b32 v35, 0
    v_mov_b32 v36, 0
    v_mov_b32 v37, 0
    v_mov_b32 v38, 0
    v_mov_b32 v39, 0
    v_mov_b32 v40, 0
    v_mov_b32 v41, 0
    v_mov_b32 v42, 0
    v_mov_b32 v43, 0
    v_mov_b32 v44, 0
    v_mov_b32 v45, 0
    v_mov_b32 v46, 0
    v_mov_b32 v47, 0
    v_mul_f32 v128, s55, v128
    v_mul_f32 v129, s55, v129
    v_cvt_pk_bf16_f32 v128, v128, v129
    v_mul_f32 v130, s55, v130
    v_mul_f32 v131, s55, v131
    v_cvt_pk_bf16_f32 v129, v130, v131
    v_mul_f32 v132, s55, v132
    v_mul_f32 v133, s55, v133
    v_cvt_pk_bf16_f32 v132, v132, v133
    v_mul_f32 v134, s55, v134
    v_mul_f32 v135, s55, v135
    v_cvt_pk_bf16_f32 v133, v134, v135
    v_mul_f32 v136, s55, v136
    v_mul_f32 v137, s55, v137
    v_cvt_pk_bf16_f32 v130, v136, v137
    v_mul_f32 v138, s55, v138
    v_mul_f32 v139, s55, v139
    v_cvt_pk_bf16_f32 v131, v138, v139
    v_mul_f32 v140, s55, v140
    v_mul_f32 v141, s55, v141
    v_cvt_pk_bf16_f32 v134, v140, v141
    v_mul_f32 v142, s55, v142
    v_mul_f32 v143, s55, v143
    v_cvt_pk_bf16_f32 v135, v142, v143
    v_mul_f32 v144, s55, v144
    v_mul_f32 v145, s55, v145
    v_cvt_pk_bf16_f32 v136, v144, v145
    v_mul_f32 v146, s55, v146
    v_mul_f32 v147, s55, v147
    v_cvt_pk_bf16_f32 v137, v146, v147
    v_mul_f32 v148, s55, v148
    v_mul_f32 v149, s55, v149
    v_cvt_pk_bf16_f32 v140, v148, v149
    v_mul_f32 v150, s55, v150
    v_mul_f32 v151, s55, v151
    v_cvt_pk_bf16_f32 v141, v150, v151
    v_mul_f32 v152, s55, v152
    v_mul_f32 v153, s55, v153
    v_cvt_pk_bf16_f32 v138, v152, v153
    v_mul_f32 v154, s55, v154
    v_mul_f32 v155, s55, v155
    v_cvt_pk_bf16_f32 v139, v154, v155
    v_mul_f32 v156, s55, v156
    v_mul_f32 v157, s55, v157
    v_cvt_pk_bf16_f32 v142, v156, v157
    v_mul_f32 v158, s55, v158
    v_mul_f32 v159, s55, v159
    v_cvt_pk_bf16_f32 v143, v158, v159
    v_mul_f32 v160, s55, v160
    v_mul_f32 v161, s55, v161
    v_cvt_pk_bf16_f32 v144, v160, v161
    v_mul_f32 v162, s55, v162
    v_mul_f32 v163, s55, v163
    v_cvt_pk_bf16_f32 v145, v162, v163
    v_mul_f32 v164, s55, v164
    v_mul_f32 v165, s55, v165
    v_cvt_pk_bf16_f32 v148, v164, v165
    v_mul_f32 v166, s55, v166
    v_mul_f32 v167, s55, v167
    v_cvt_pk_bf16_f32 v149, v166, v167
    v_mul_f32 v168, s55, v168
    v_mul_f32 v169, s55, v169
    v_cvt_pk_bf16_f32 v146, v168, v169
    v_mul_f32 v170, s55, v170
    v_mul_f32 v171, s55, v171
    v_cvt_pk_bf16_f32 v147, v170, v171
    v_mul_f32 v172, s55, v172
    v_mul_f32 v173, s55, v173
    v_cvt_pk_bf16_f32 v150, v172, v173
    v_mul_f32 v174, s55, v174
    v_mul_f32 v175, s55, v175
    v_cvt_pk_bf16_f32 v151, v174, v175
    v_mul_f32 v176, s55, v176
    v_mul_f32 v177, s55, v177
    v_cvt_pk_bf16_f32 v152, v176, v177
    v_mul_f32 v178, s55, v178
    v_mul_f32 v179, s55, v179
    v_cvt_pk_bf16_f32 v153, v178, v179
    v_mul_f32 v180, s55, v180
    v_mul_f32 v181, s55, v181
    v_cvt_pk_bf16_f32 v156, v180, v181
    v_mul_f32 v182, s55, v182
    v_mul_f32 v183, s55, v183
    v_cvt_pk_bf16_f32 v157, v182, v183
    v_mul_f32 v184, s55, v184
    v_mul_f32 v185, s55, v185
    v_cvt_pk_bf16_f32 v154, v184, v185
    v_mul_f32 v186, s55, v186
    v_mul_f32 v187, s55, v187
    v_cvt_pk_bf16_f32 v155, v186, v187
    v_mul_f32 v188, s55, v188
    v_mul_f32 v189, s55, v189
    v_cvt_pk_bf16_f32 v158, v188, v189
    v_mul_f32 v190, s55, v190
    v_mul_f32 v191, s55, v191
    v_cvt_pk_bf16_f32 v159, v190, v191
    v_and_b32 v212, 31, v255
    v_lshrrev_b32 v213, 5, v255
    v_lshlrev_b32 v213, 2, v213
    v_sub_u32 v212, v212, v213
    s_barrier
    ds_read_b128 v[160:163], v252 offset:0
    ds_read_b128 v[164:167], v252 offset:1024
    ds_read_b128 v[168:171], v252 offset:2048
    ds_read_b128 v[172:175], v252 offset:3072
    ds_read_b128 v[176:179], v252 offset:4096
    ds_read_b128 v[180:183], v252 offset:5120
    s_cmp_eq_u32 s52, 0
    s_cbranch_scc1 H_F0d
H_F0:
    s_waitcnt lgkmcnt(4)
    v_mfma_f32_32x32x16_bf16 v[0:15], v[160:163], v[128:131], v[32:47]
    ds_read_b128 v[184:187], v252 offset:6144
    v_mfma_f32_32x32x16_bf16 v[0:15], v[164:167], v[132:135], v[0:15]
    ds_read_b128 v[188:191], v252 offset:7168
    s_waitcnt lgkmcnt(4)
    v_mfma_f32_32x32x16_bf16 v[0:15], v[168:171], v[136:139], v[0:15]
    ds_read_b128 v[160:163], v252 offset:8192
    v_mfma_f32_32x32x16_bf16 v[0:15], v[172:175], v[140:143], v[0:15]
    ds_read_b128 v[164:167], v252 offset:9216
    s_waitcnt lgkmcnt(4)
    v_mfma_f32_32x32x16_bf16 v[0:15], v[176:179], v[144:147], v[0:15]
    ds_read_b128 v[168:171], v252 offset:10240
    v_mfma_f32_32x32x16_bf16 v[0:15], v[180:183], v[148:151], v[0:15]
    ds_read_b128 v[172:175], v252 offset:11264
    s_waitcnt lgkmcnt(4)
    v_mfma_f32_32x32x16_bf16 v[0:15], v[184:187], v[152:155], v[0:15]
    ds_read_b128 v[176:179], v252 offset:12288
    v_mfma_f32_32x32x16_bf16 v[0:15], v[188:191], v[156:159], v[0:15]
    ds_read_b128 v[180:183], v252 offset:13312
    s_nop 7
    s_nop 3
    v_max3_f32 v200, v0, v1, v2
    v_max3_f32 v200, v200, v3, v4
    v_max3_f32 v200, v200, v5, v6
    v_max3_f32 v200, v200, v7, v8
    v_max3_f32 v200, v200, v9, v10
    v_max3_f32 v200, v200, v11, v12
    v_max3_f32 v200, v200, v13, v14
    v_max_f32 v200, v200, v15
    v_mov_b32 v201, v200
    s_nop 1
    v_permlane32_swap_b32 v200, v201
    v_max_f32 v200, v200, v201
    v_sub_f32 v32, 0, v200
    v_sub_f32 v33, 0, v200
    v_sub_f32 v34, 0, v200
    v_sub_f32 v35, 0, v200
    v_sub_f32 v36, 0, v200
    v_sub_f32 v37, 0, v200
    v_sub_f32 v38, 0, v200
    v_sub_f32 v39, 0, v200
    v_sub_f32 v40, 0, v200
    v_sub_f32 v41, 0, v200
    v_sub_f32 v42, 0, v200
    v_sub_f32 v43, 0, v200
    v_sub_f32 v44, 0, v200
    v_sub_f32 v45, 0, v200
    v_sub_f32 v46, 0, v200
    v_sub_f32 v47, 0, v200
    s_waitcnt lgkmcnt(4)
    s_nop 0
    v_mfma_f32_32x32x16_bf16 v[16:31], v[160:163], v[128:131], v[32:47]
    ds_read_b128 v[184:187], v252 offset:14336
    v_sub_f32 v0, v0, v200
    v_sub_f32 v1, v1, v200
    v_sub_f32 v2, v2, v200
    v_sub_f32 v3, v3, v200
    v_sub_f32 v4, v4, v200
    v_sub_f32 v5, v5, v200
    v_sub_f32 v6, v6, v200
    v_sub_f32 v7, v7, v200
    v_sub_f32 v8, v8, v200
    v_mfma_f32_32x32x16_bf16 v[16:31], v[164:167], v[132:135], v[16:31]
    ds_read_b128 v[188:191], v252 offset:15360
    v_sub_f32 v9, v9, v200
    v_sub_f32 v10, v10, v200
    v_sub_f32 v11, v11, v200
    v_sub_f32 v12, v12, v200
    v_sub_f32 v13, v13, v200
    v_sub_f32 v14, v14, v200
    v_sub_f32 v15, v15, v200
    v_exp_f32 v192, v0
    s_waitcnt lgkmcnt(4)
    v_mfma_f32_32x32x16_bf16 v[16:31], v[168:171], v[136:139], v[16:31]
    s_barrier
    s_add_u32 s4, s4, 32768
    s_cmp_eq_u32 s4, 163840
    s_cselect_b32 s4, 0, s4
    v_add_u32 v252, s4, v254
    ds_read_b128 v[160:163], v252 offset:0
    v_exp_f32 v193, v1
    v_exp_f32 v194, v2
    v_exp_f32 v195, v3
    v_cvt_pk_bf16_f32 v48, v192, v193
    v_exp_f32 v196, v4
    v_mfma_f32_32x32x16_bf16 v[16:31], v[172:175], v[140:143], v[16:31]
    ds_read_b128 v[164:167], v252 offset:16384
    v_add_f32 v242, v192, v194
    v_exp_f32 v197, v5
    v_add_f32 v243, v193, v195
    v_cvt_pk_bf16_f32 v49, v194, v195
    v_exp_f32 v198, v6
    v_add_f32 v242, v242, v196
    s_waitcnt lgkmcnt(4)
    v_mfma_f32_32x32x16_bf16 v[16:31], v[176:179], v[144:147], v[16:31]
    ds_read_b128 v[168:171], v252 offset:1024
    v_exp_f32 v199, v7
    v_add_f32 v243, v243, v197
    v_cvt_pk_bf16_f32 v52, v196, v197
    v_exp_f32 v192, v8
    v_add_f32 v242, v242, v198
    v_exp_f32 v193, v9
    v_mfma_f32_32x32x16_bf16 v[16:31], v[180:183], v[148:151], v[16:31]
    ds_read_b128 v[172:175], v252 offset:17408
    v_add_f32 v243, v243, v199
    v_cvt_pk_bf16_f32 v53, v198, v199
    v_exp_f32 v194, v10
    v_add_f32 v242, v242, v192
    v_exp_f32 v195, v11
    v_add_f32 v243, v243, v193
    v_cvt_pk_bf16_f32 v50, v192, v193
    s_waitcnt lgkmcnt(4)
    v_mfma_f32_32x32x16_bf16 v[16:31], v[184:187], v[152:155], v[16:31]
    ds_read_b128 v[176:179], v252 offset:2048
    v_exp_f32 v196, v12
    v_add_f32 v242, v242, v194
    v_exp_f32 v197, v13
    v_add_f32 v243, v243, v195
    v_cvt_pk_bf16_f32 v51, v194, v195
    v_exp_f32 v198, v14
    v_mfma_f32_32x32x16_bf16 v[16:31], v[188:191], v[156:159], v[16:31]
    ds_read_b128 v[180:183], v252 offset:18432
    v_add_f32 v242, v242, v196
    v_exp_f32 v199, v15
    v_add_f32 v243, v243, v197
    v_cvt_pk_bf16_f32 v54, v196, v197
    v_add_f32 v242, v242, v198
    v_add_f32 v243, v243, v199
    v_cvt_pk_bf16_f32 v55, v198, v199
    v_add_f32 v242, v242, v243
    v_mov_b32 v240, v242
    s_nop 3
    s_waitcnt vmcnt(0)
    s_lshl_b32 s54, s52, 5
    s_add_u32 s54, s54, s48
    s_lshl_b32 s54, s54, 2
    s_add_u32 s54, s54, 58753024
    s_mov_b64 exec, 1
    buffer_store_dword v251, off, s[16:19], s54 sc1
    s_mov_b64 exec, -1
    s_load_dwordx2 s[96:97], s[0:1], 40
    s_load_dwordx2 s[98:99], s[0:1], 72
    s_load_dwordx2 s[100:101], s[0:1], 80
    s_and_b32 s15, s2, 3
    s_bfe_u32 s13, s2, 0x10002
    s_lshl_b32 s13, s13, 3
    s_lshr_b32 s54, s2, 5
    s_add_u32 s13, s13, s54
    s_bfe_u32 s14, s2, 0x20003
    s_waitcnt lgkmcnt(0)
    s_mov_b32 s20, s96
    s_and_b32 s21, s97, 0xffff
    s_mov_b32 s22, 4194304
    s_mov_b32 s23, 0x20000
    s_mov_b32 s24, s98
    s_and_b32 s25, s99, 0xffff
    s_mov_b32 s26, 0
    s_mov_b32 s27, 0x20000
    s_mov_b32 s28, s100
    s_and_b32 s29, s101, 0xffff
    s_mov_b32 s30, 2097152
    s_mov_b32 s31, 0x20000
    s_lshl_b32 s101, s13, 2
    s_add_u32 s101, s101, s14
    s_mul_i32 s54, s15, 11
    s_add_u32 s55, s54, 11
    s_min_u32 s55, s55, 43
    s_lshl_b32 s26, s55, 15
    s_lshl_b32 s97, s54, 15
    s_lshl_b32 s96, s13, 3
    s_add_u32 s96, s96, s50
    s_mul_i32 s96, s96, 171
    s_lshl_b32 s96, s96, 10
    s_add_u32 s99, s96, 35651584
    s_add_u32 s98, s99, 173056
    s_add_u32 s54, s54, 128
    s_lshl_b32 s54, s54, 10
    s_add_u32 s96, s99, s54
    s_add_u32 s54, s53, 29
    s_mul_i32 s55, s54, 205
    s_lshr_b32 s55, s55, 10
    s_mul_i32 s55, s55, 5
    s_sub_u32 s54, s54, s55
    s_lshl_b32 s100, s54, 15
    v_lshrrev_b32 v228, 4, v255
    v_and_b32 v229, 15, v255
    v_lshlrev_b32 v230, 1, v228
    v_xor_b32 v229, v229, v230
    v_mov_b32 v230, s50
    v_lshl_add_u32 v228, v230, 3, v228
    v_lshlrev_b32 v228, 10, v228
    s_lshl_b32 s54, s14, 8
    v_add_u32 v228, s54, v228
    v_lshl_add_u32 v214, v229, 4, v228
    v_xor_b32 v229, 8, v229
    v_lshl_add_u32 v215, v229, 4, v228
    v_add_u32 v215, 3072, v215
    s_and_b32 s54, s50, 1
    s_lshl_b32 s54, s54, 13
    s_lshr_b32 s55, s50, 2
    s_lshl_b32 s55, s55, 10
    s_add_u32 s54, s54, s55
    s_add_u32 s54, s54, s100
    v_add_u32 v216, s54, v254
    v_bfe_u32 v228, v255, 2, 3
    v_lshrrev_b32 v229, 5, v255
    v_lshl_add_u32 v229, v229, 4, v228
    v_lshlrev_b32 v229, 8, v229
    v_and_b32 v230, 3, v255
    v_lshl_add_u32 v229, v230, 3, v229
    s_lshl_b32 s55, s55, 3
    s_add_u32 s55, s55, 16384
    s_add_u32 s55, s55, s100
    v_add_u32 v229, s55, v229
    s_bfe_u32 s54, s50, 0x10001
    s_lshl_b32 s54, s54, 2
    v_xor_b32 v228, s54, v228
    v_xor_b32 v218, 0, v228
    v_lshl_add_u32 v218, v218, 5, v229
    v_xor_b32 v219, 1, v228
    v_lshl_add_u32 v219, v219, 5, v229
    v_xor_b32 v220, 2, v228
    v_lshl_add_u32 v220, v220, 5, v229
    v_xor_b32 v221, 3, v228
    v_lshl_add_u32 v221, v221, 5, v229
    v_and_b32 v228, 15, v255
    v_lshlrev_b32 v228, 10, v228
    v_lshrrev_b32 v229, 4, v255
    v_lshl_add_u32 v234, v229, 3, v228
    s_lshl_b32 s61, s13, 17
    s_and_b32 s54, s50, 1
    s_lshl_b32 s54, s54, 16
    s_add_u32 s61, s61, s54
    s_lshl_b32 s54, s15, 14
    s_add_u32 s61, s61, s54
    s_lshl_b32 s54, s14, 8
    s_add_u32 s61, s61, s54
    s_bfe_u32 s54, s50, 0x10001
    s_lshl_b32 s54, s54, 7
    s_add_u32 s61, s61, s54
    s_lshr_b32 s54, s50, 2
    s_lshl_b32 s54, s54, 6
    s_add_u32 s61, s61, s54
    v_add_u32 v234, s61, v234
    buffer_load_dwordx2 v[222:223], v234, s[32:35], 0 offen
    buffer_load_dwordx2 v[224:225], v234, s[32:35], 0 offen offset:32
    s_lshr_b32 s54, s2, 3
    s_lshl_b32 s54, s54, 2
    s_and_b32 s55, s50, 3
    s_add_u32 s54, s54, s55
    v_lshlrev_b32 v208, 7, v255
    s_lshl_b32 s6, s15, 20
    s_lshl_b32 s55, s54, 13
    s_add_u32 s6, s6, s55
    s_mul_i32 s7, s15, 360448
    s_mul_i32 s55, s54, 3072
    s_add_u32 s7, s7, s55
    s_cmp_eq_u32 s9, 0
    s_cbranch_scc1 H_tail
H_FULL:
    s_waitcnt lgkmcnt(4)
    v_mfma_f32_32x32x16_bf16 v[0:15], v[160:163], v[128:131], v[32:47]
    ds_read_b128 v[184:187], v252 offset:3072
    v_mfma_f32_32x32x16_bf16 v[64:79], v[164:167], v[48:51], v[64:79]
    ds_read_b128 v[188:191], v252 offset:19456
    v_exp_f32 v192, v16
    v_exp_f32 v193, v17
    s_waitcnt lgkmcnt(4)
    v_mfma_f32_32x32x16_bf16 v[0:15], v[168:171], v[132:135], v[0:15]
    ds_read_b128 v[160:163], v252 offset:4096
    v_exp_f32 v194, v18
    v_exp_f32 v195, v19
    v_mfma_f32_32x32x16_bf16 v[80:95], v[172:175], v[48:51], v[80:95]
    ds_read_b128 v[164:167], v252 offset:20480
    v_cvt_pk_bf16_f32 v56, v192, v193
    v_exp_f32 v196, v20
    v_add_f32 v242, v192, v194
    s_waitcnt lgkmcnt(4)
    v_mfma_f32_32x32x16_bf16 v[0:15], v[176:179], v[136:139], v[0:15]
    ds_read_b128 v[168:171], v252 offset:5120
    v_exp_f32 v197, v21
    v_add_f32 v243, v193, v195
    v_cvt_pk_bf16_f32 v57, v194, v195
    v_mfma_f32_32x32x16_bf16 v[96:111], v[180:183], v[48:51], v[96:111]
    ds_read_b128 v[172:175], v252 offset:21504
    v_exp_f32 v198, v22
    v_add_f32 v242, v242, v196
    v_exp_f32 v199, v23
    s_waitcnt lgkmcnt(4)
    v_mfma_f32_32x32x16_bf16 v[0:15], v[184:187], v[140:143], v[0:15]
    ds_read_b128 v[176:179], v252 offset:6144
    v_add_f32 v243, v243, v197
    v_cvt_pk_bf16_f32 v60, v196, v197
    v_exp_f32 v192, v24
    v_mfma_f32_32x32x16_bf16 v[112:127], v[188:191], v[48:51], v[112:127]
    ds_read_b128 v[180:183], v252 offset:22528
    v_add_f32 v242, v242, v198
    v_exp_f32 v193, v25
    s_waitcnt lgkmcnt(4)
    v_mfma_f32_32x32x16_bf16 v[0:15], v[160:163], v[144:147], v[0:15]
    ds_read_b128 v[184:187], v252 offset:7168
    v_add_f32 v243, v243, v199
    v_cvt_pk_bf16_f32 v61, v198, v199
    v_exp_f32 v194, v26
    v_mfma_f32_32x32x16_bf16 v[64:79], v[164:167], v[52:55], v[64:79]
    ds_read_b128 v[188:191], v252 offset:23552
    v_add_f32 v242, v242, v192
    v_exp_f32 v195, v27
    v_add_f32 v243, v243, v193
    s_waitcnt lgkmcnt(4)
    v_mfma_f32_32x32x16_bf16 v[0:15], v[168:171], v[148:151], v[0:15]
    ds_read_b128 v[160:163], v252 offset:8192
    v_cvt_pk_bf16_f32 v58, v192, v193
    v_exp_f32 v196, v28
    v_add_f32 v242, v242, v194
    v_mfma_f32_32x32x16_bf16 v[80:95], v[172:175], v[52:55], v[80:95]
    ds_read_b128 v[164:167], v252 offset:24576
    v_exp_f32 v197, v29
    v_add_f32 v243, v243, v195
    v_cvt_pk_bf16_f32 v59, v194, v195
    s_waitcnt lgkmcnt(4)
    v_mfma_f32_32x32x16_bf16 v[0:15], v[176:179], v[152:155], v[0:15]
    ds_read_b128 v[168:171], v252 offset:9216
    v_exp_f32 v198, v30
    v_add_f32 v242, v242, v196
    v_exp_f32 v199, v31
    v_mfma_f32_32x32x16_bf16 v[96:111], v[180:183], v[52:55], v[96:111]
    ds_read_b128 v[172:175], v252 offset:25600
    v_add_f32 v243, v243, v197
    v_cvt_pk_bf16_f32 v62, v196, v197
    v_add_f32 v242, v242, v198
    s_waitcnt lgkmcnt(4)
    v_mfma_f32_32x32x16_bf16 v[0:15], v[184:187], v[156:159], v[0:15]
    ds_read_b128 v[176:179], v252 offset:10240
    v_add_f32 v243, v243, v199
    v_cvt_pk_bf16_f32 v63, v198, v199
    v_add_f32 v242, v242, v243
    v_cmp_lt_f32 vcc, s10, v242
    v_mfma_f32_32x32x16_bf16 v[112:127], v[188:191], v[52:55], v[112:127]
    ds_read_b128 v[180:183], v252 offset:26624
    s_cbranch_vccnz H_FULL_slow0
H_FULL_ret0:
    v_add_f32 v240, v240, v242
    s_waitcnt lgkmcnt(4)
    v_mfma_f32_32x32x16_bf16 v[16:31], v[160:163], v[128:131], v[32:47]
    ds_read_b128 v[184:187], v252 offset:11264
    v_mfma_f32_32x32x16_bf16 v[64:79], v[164:167], v[56:59], v[64:79]
    ds_read_b128 v[188:191], v252 offset:27648
    v_exp_f32 v192, v0
    v_exp_f32 v193, v1
    s_waitcnt lgkmcnt(4)
    v_mfma_f32_32x32x16_bf16 v[16:31], v[168:171], v[132:135], v[16:31]
    ds_read_b128 v[160:163], v252 offset:12288
    v_exp_f32 v194, v2
    v_exp_f32 v195, v3
    v_mfma_f32_32x32x16_bf16 v[80:95], v[172:175], v[56:59], v[80:95]
    ds_read_b128 v[164:167], v252 offset:28672
    v_cvt_pk_bf16_f32 v48, v192, v193
    v_exp_f32 v196, v4
    v_add_f32 v242, v192, v194
    s_waitcnt lgkmcnt(4)
    v_mfma_f32_32x32x16_bf16 v[16:31], v[176:179], v[136:139], v[16:31]
    ds_read_b128 v[168:171], v252 offset:13312
    v_exp_f32 v197, v5
    v_add_f32 v243, v193, v195
    v_cvt_pk_bf16_f32 v49, v194, v195
    v_mfma_f32_32x32x16_bf16 v[96:111], v[180:183], v[56:59], v[96:111]
    ds_read_b128 v[172:175], v252 offset:29696
    v_exp_f32 v198, v6
    v_add_f32 v242, v242, v196
    v_exp_f32 v199, v7
    s_waitcnt lgkmcnt(4)
    v_mfma_f32_32x32x16_bf16 v[16:31], v[184:187], v[140:143], v[16:31]
    ds_read_b128 v[176:179], v252 offset:14336
    v_add_f32 v243, v243, v197
    v_cvt_pk_bf16_f32 v52, v196, v197
    v_exp_f32 v192, v8
    v_mfma_f32_32x32x16_bf16 v[112:127], v[188:191], v[56:59], v[112:127]
    ds_read_b128 v[180:183], v252 offset:30720
    v_add_f32 v242, v242, v198
    v_exp_f32 v193, v9
    s_waitcnt lgkmcnt(4)
    v_mfma_f32_32x32x16_bf16 v[16:31], v[160:163], v[144:147], v[16:31]
    ds_read_b128 v[184:187], v252 offset:15360
    v_add_f32 v243, v243, v199
    v_cvt_pk_bf16_f32 v53, v198, v199
    v_exp_f32 v194, v10
    v_mfma_f32_32x32x16_bf16 v[64:79], v[164:167], v[60:63], v[64:79]
    ds_read_b128 v[188:191], v252 offset:31744
    v_add_f32 v242, v242, v192
    v_exp_f32 v195, v11
    v_add_f32 v243, v243, v193
    s_waitcnt lgkmcnt(4)
    v_mfma_f32_32x32x16_bf16 v[16:31], v[168:171], v[148:151], v[16:31]
    s_barrier
    s_add_u32 s4, s4, 32768
    s_cmp_eq_u32 s4, 163840
    s_cselect_b32 s4, 0, s4
    v_add_u32 v252, s4, v254
    ds_read_b128 v[160:163], v252 offset:0
    v_cvt_pk_bf16_f32 v50, v192, v193
    v_exp_f32 v196, v12
    v_add_f32 v242, v242, v194
    v_mfma_f32_32x32x16_bf16 v[80:95], v[172:175], v[60:63], v[80:95]
    ds_read_b128 v[164:167], v252 offset:16384
    v_exp_f32 v197, v13
    v_add_f32 v243, v243, v195
    v_cvt_pk_bf16_f32 v51, v194, v195
    s_waitcnt lgkmcnt(4)
    v_mfma_f32_32x32x16_bf16 v[16:31], v[176:179], v[152:155], v[16:31]
    ds_read_b128 v[168:171], v252 offset:1024
    v_exp_f32 v198, v14
    v_add_f32 v242, v242, v196
    v_exp_f32 v199, v15
    v_mfma_f32_32x32x16_bf16 v[96:111], v[180:183], v[60:63], v[96:111]
    ds_read_b128 v[172:175], v252 offset:17408
    v_add_f32 v243, v243, v197
    v_cvt_pk_bf16_f32 v54, v196, v197
    v_add_f32 v242, v242, v198
    s_waitcnt lgkmcnt(4)
    v_mfma_f32_32x32x16_bf16 v[16:31], v[184:187], v[156:159], v[16:31]
    ds_read_b128 v[176:179], v252 offset:2048
    v_add_f32 v243, v243, v199
    v_cvt_pk_bf16_f32 v55, v198, v199
    v_add_f32 v242, v242, v243
    v_cmp_lt_f32 vcc, s10, v242
    v_mfma_f32_32x32x16_bf16 v[112:127], v[188:191], v[60:63], v[112:127]
    ds_read_b128 v[180:183], v252 offset:18432
    s_cbranch_vccnz H_FULL_slow1
H_FULL_ret1:
    v_add_f32 v240, v240, v242
    s_sub_u32 s9, s9, 1
    s_cmp_lg_u32 s9, 4
    s_cbranch_scc1 H_nowpf
    buffer_load_dword v248, v208, s[20:23], s6 offen
    s_mov_b64 exec, 0xffffff
    buffer_load_dword v248, v208, s[24:27], s7 offen
    s_mov_b64 exec, -1
H_nowpf:
    s_cmp_lg_u32 s9, 0
    s_cbranch_scc1 H_FULL
H_tail:
    s_bitcmp1_b32 s52, 0
    s_cbranch_scc1 H_E2
H_E1:
    s_waitcnt lgkmcnt(4)
    v_mfma_f32_32x32x16_bf16 v[0:15], v[160:163], v[128:131], v[32:47]
    ds_read_b128 v[184:187], v252 offset:3072
    v_mfma_f32_32x32x16_bf16 v[64:79], v[164:167], v[48:51], v[64:79]
    ds_read_b128 v[188:191], v252 offset:19456
    v_exp_f32 v192, v16
    v_exp_f32 v193, v17
    s_waitcnt lgkmcnt(4)
    v_mfma_f32_32x32x16_bf16 v[0:15], v[168:171], v[132:135], v[0:15]
    ds_read_b128 v[160:163], v252 offset:4096
    v_exp_f32 v194, v18
    v_exp_f32 v195, v19
    v_mfma_f32_32x32x16_bf16 v[80:95], v[172:175], v[48:51], v[80:95]
    ds_read_b128 v[164:167], v252 offset:20480
    v_cvt_pk_bf16_f32 v56, v192, v193
    v_exp_f32 v196, v20
    v_add_f32 v242, v192, v194
    s_waitcnt lgkmcnt(4)
    v_mfma_f32_32x32x16_bf16 v[0:15], v[176:179], v[136:139], v[0:15]
    ds_read_b128 v[168:171], v252 offset:5120
    v_exp_f32 v197, v21
    v_add_f32 v243, v193, v195
    v_cvt_pk_bf16_f32 v57, v194, v195
    v_mfma_f32_32x32x16_bf16 v[96:111], v[180:183], v[48:51], v[96:111]
    ds_read_b128 v[172:175], v252 offset:21504
    v_exp_f32 v198, v22
    v_add_f32 v242, v242, v196
    v_exp_f32 v199, v23
    s_waitcnt lgkmcnt(4)
    v_mfma_f32_32x32x16_bf16 v[0:15], v[184:187], v[140:143], v[0:15]
    ds_read_b128 v[176:179], v252 offset:6144
    v_add_f32 v243, v243, v197
    v_cvt_pk_bf16_f32 v60, v196, v197
    v_exp_f32 v192, v24
    v_mfma_f32_32x32x16_bf16 v[112:127], v[188:191], v[48:51], v[112:127]
    ds_read_b128 v[180:183], v252 offset:22528
    v_add_f32 v242, v242, v198
    v_exp_f32 v193, v25
    s_waitcnt lgkmcnt(4)
    v_mfma_f32_32x32x16_bf16 v[0:15], v[160:163], v[144:147], v[0:15]
    ds_read_b128 v[184:187], v252 offset:7168
    v_add_f32 v243, v243, v199
    v_cvt_pk_bf16_f32 v61, v198, v199
    v_exp_f32 v194, v26
    v_mfma_f32_32x32x16_bf16 v[64:79], v[164:167], v[52:55], v[64:79]
    ds_read_b128 v[188:191], v252 offset:23552
    v_add_f32 v242, v242, v192
    v_exp_f32 v195, v27
    v_add_f32 v243, v243, v193
    s_waitcnt lgkmcnt(4)
    v_mfma_f32_32x32x16_bf16 v[0:15], v[168:171], v[148:151], v[0:15]
    ds_read_b128 v[160:163], v252 offset:24576
    v_cvt_pk_bf16_f32 v58, v192, v193
    v_exp_f32 v196, v28
    v_add_f32 v242, v242, v194
    v_mfma_f32_32x32x16_bf16 v[80:95], v[172:175], v[52:55], v[80:95]
    ds_read_b128 v[164:167], v252 offset:25600
    v_exp_f32 v197, v29
    v_add_f32 v243, v243, v195
    v_cvt_pk_bf16_f32 v59, v194, v195
    s_waitcnt lgkmcnt(4)
    v_mfma_f32_32x32x16_bf16 v[0:15], v[176:179], v[152:155], v[0:15]
    ds_read_b128 v[168:171], v252 offset:26624
    v_exp_f32 v198, v30
    v_add_f32 v242, v242, v196
    v_exp_f32 v199, v31
    v_mfma_f32_32x32x16_bf16 v[96:111], v[180:183], v[52:55], v[96:111]
    ds_read_b128 v[172:175], v252 offset:27648
    v_add_f32 v243, v243, v197
    v_cvt_pk_bf16_f32 v62, v196, v197
    v_add_f32 v242, v242, v198
    s_waitcnt lgkmcnt(4)
    v_mfma_f32_32x32x16_bf16 v[0:15], v[184:187], v[156:159], v[0:15]
    ds_read_b128 v[176:179], v252 offset:28672
    v_add_f32 v243, v243, v199
    v_cvt_pk_bf16_f32 v63, v198, v199
    v_add_f32 v242, v242, v243
    v_cmp_lt_f32 vcc, s10, v242
    v_mfma_f32_32x32x16_bf16 v[112:127], v[188:191], v[52:55], v[112:127]
    ds_read_b128 v[180:183], v252 offset:29696
    s_cbranch_vccnz H_E1_slow0
H_E1_ret0:
    v_add_f32 v240, v240, v242
    s_waitcnt lgkmcnt(4)
    v_mfma_f32_32x32x16_bf16 v[64:79], v[160:163], v[56:59], v[64:79]
    ds_read_b128 v[184:187], v252 offset:30720
    v_mov_b32 v207, 0xff800000
    v_cmp_le_i32 vcc, 0, v212
    s_nop 1
    v_cndmask_b32 v0, v207, v0, vcc
    v_cmp_le_i32 vcc, 1, v212
    s_nop 1
    v_cndmask_b32 v1, v207, v1, vcc
    v_cmp_le_i32 vcc, 2, v212
    s_nop 1
    v_cndmask_b32 v2, v207, v2, vcc
    v_cmp_le_i32 vcc, 3, v212
    s_nop 1
    v_cndmask_b32 v3, v207, v3, vcc
    v_cmp_le_i32 vcc, 8, v212
    s_nop 1
    v_cndmask_b32 v4, v207, v4, vcc
    v_mfma_f32_32x32x16_bf16 v[80:95], v[164:167], v[56:59], v[80:95]
    ds_read_b128 v[188:191], v252 offset:31744
    v_cmp_le_i32 vcc, 9, v212
    s_nop 1
    v_cndmask_b32 v5, v207, v5, vcc
    v_cmp_le_i32 vcc, 10, v212
    s_nop 1
    v_cndmask_b32 v6, v207, v6, vcc
    v_cmp_le_i32 vcc, 11, v212
    s_nop 1
    v_cndmask_b32 v7, v207, v7, vcc
    v_cmp_le_i32 vcc, 16, v212
    s_nop 1
    v_cndmask_b32 v8, v207, v8, vcc
    v_cmp_le_i32 vcc, 17, v212
    s_nop 1
    v_cndmask_b32 v9, v207, v9, vcc
    v_cmp_le_i32 vcc, 18, v212
    s_waitcnt lgkmcnt(4)
    v_mfma_f32_32x32x16_bf16 v[96:111], v[168:171], v[56:59], v[96:111]
    s_barrier
    s_add_u32 s4, s4, 32768
    s_cmp_eq_u32 s4, 163840
    s_cselect_b32 s4, 0, s4
    v_add_u32 v252, s4, v254
    ds_read_b128 v[160:163], v252 offset:0
    v_cndmask_b32 v10, v207, v10, vcc
    v_cmp_le_i32 vcc, 19, v212
    s_nop 1
    v_cndmask_b32 v11, v207, v11, vcc
    v_cmp_le_i32 vcc, 24, v212
    s_nop 1
    v_cndmask_b32 v12, v207, v12, vcc
    v_cmp_le_i32 vcc, 25, v212
    s_nop 1
    v_cndmask_b32 v13, v207, v13, vcc
    v_cmp_le_i32 vcc, 26, v212
    s_nop 1
    v_cndmask_b32 v14, v207, v14, vcc
    v_cmp_le_i32 vcc, 27, v212
    s_nop 1
    v_cndmask_b32 v15, v207, v15, vcc
    v_mfma_f32_32x32x16_bf16 v[112:127], v[172:175], v[56:59], v[112:127]
    ds_read_b128 v[164:167], v252 offset:16384
    v_exp_f32 v192, v0
    v_exp_f32 v193, v1
    v_exp_f32 v194, v2
    v_exp_f32 v195, v3
    v_cvt_pk_bf16_f32 v48, v192, v193
    v_exp_f32 v196, v4
    v_add_f32 v242, v192, v194
    s_waitcnt lgkmcnt(4)
    v_mfma_f32_32x32x16_bf16 v[64:79], v[176:179], v[60:63], v[64:79]
    ds_read_b128 v[168:171], v252 offset:1024
    v_exp_f32 v197, v5
    v_add_f32 v243, v193, v195
    v_cvt_pk_bf16_f32 v49, v194, v195
    v_exp_f32 v198, v6
    v_add_f32 v242, v242, v196
    v_exp_f32 v199, v7
    v_add_f32 v243, v243, v197
    v_cvt_pk_bf16_f32 v52, v196, v197
    v_mfma_f32_32x32x16_bf16 v[80:95], v[180:183], v[60:63], v[80:95]
    ds_read_b128 v[172:175], v252 offset:17408
    v_exp_f32 v192, v8
    v_add_f32 v242, v242, v198
    v_exp_f32 v193, v9
    v_add_f32 v243, v243, v199
    v_cvt_pk_bf16_f32 v53, v198, v199
    v_exp_f32 v194, v10
    v_add_f32 v242, v242, v192
    s_waitcnt lgkmcnt(4)
    v_mfma_f32_32x32x16_bf16 v[96:111], v[184:187], v[60:63], v[96:111]
    ds_read_b128 v[176:179], v252 offset:2048
    v_exp_f32 v195, v11
    v_add_f32 v243, v243, v193
    v_cvt_pk_bf16_f32 v50, v192, v193
    v_exp_f32 v196, v12
    v_add_f32 v242, v242, v194
    v_exp_f32 v197, v13
    v_add_f32 v243, v243, v195
    v_cvt_pk_bf16_f32 v51, v194, v195
    v_mfma_f32_32x32x16_bf16 v[112:127], v[188:191], v[60:63], v[112:127]
    ds_read_b128 v[180:183], v252 offset:18432
    v_exp_f32 v198, v14
    v_add_f32 v242, v242, v196
    v_exp_f32 v199, v15
    v_add_f32 v243, v243, v197
    v_cvt_pk_bf16_f32 v54, v196, v197
    v_add_f32 v242, v242, v198
    v_add_f32 v243, v243, v199
    v_cvt_pk_bf16_f32 v55, v198, v199
    v_add_f32 v242, v242, v243
    v_cmp_lt_f32 vcc, s10, v242
    s_cbranch_vccnz H_E1_slow1
H_E1_ret1:
    v_add_f32 v240, v240, v242
H_E3:
    ds_read_b128 v[184:187], v252 offset:16384
    ds_read_b128 v[188:191], v252 offset:17408
    ds_read_b128 v[160:163], v252 offset:18432
    ds_read_b128 v[164:167], v252 offset:19456
    ds_read_b128 v[168:171], v252 offset:20480
    ds_read_b128 v[172:175], v252 offset:21504
    s_waitcnt lgkmcnt(4)
    v_mfma_f32_32x32x16_bf16 v[64:79], v[184:187], v[48:51], v[64:79]
    ds_read_b128 v[176:179], v252 offset:22528
    v_mfma_f32_32x32x16_bf16 v[80:95], v[188:191], v[48:51], v[80:95]
    ds_read_b128 v[180:183], v252 offset:23552
    s_waitcnt lgkmcnt(4)
    v_mfma_f32_32x32x16_bf16 v[96:111], v[160:163], v[48:51], v[96:111]
    v_mfma_f32_32x32x16_bf16 v[112:127], v[164:167], v[48:51], v[112:127]
    s_waitcnt lgkmcnt(2)
    v_mfma_f32_32x32x16_bf16 v[64:79], v[168:171], v[52:55], v[64:79]
    v_mfma_f32_32x32x16_bf16 v[80:95], v[172:175], v[52:55], v[80:95]
    s_waitcnt lgkmcnt(0)
    v_mfma_f32_32x32x16_bf16 v[96:111], v[176:179], v[52:55], v[96:111]
    v_mfma_f32_32x32x16_bf16 v[112:127], v[180:183], v[52:55], v[112:127]
H_epi:
    s_nop 7
    v_mov_b32 v201, v240
    v_mov_b32 v200, v240
    s_nop 1
    v_permlane32_swap_b32 v200, v201
    v_add_f32 v200, v200, v201
    v_rcp_f32 v200, v200
    s_mul_i32 s55, s52, 350208
    s_lshl_b32 s54, s48, 12
    s_add_u32 s55, s55, s54
    s_add_u32 s9, s55, 35651584
    v_mul_f32 v64, v64, v200
    v_mul_f32 v65, v65, v200
    v_mul_f32 v66, v66, v200
    v_mul_f32 v67, v67, v200
    v_mul_f32 v68, v68, v200
    v_mul_f32 v69, v69, v200
    v_mul_f32 v70, v70, v200
    v_mul_f32 v71, v71, v200
    v_cvt_pk_bf16_f32 v64, v64, v65
    v_cvt_pk_bf16_f32 v65, v66, v67
    v_cvt_pk_bf16_f32 v66, v68, v69
    v_cvt_pk_bf16_f32 v67, v70, v71
    buffer_store_dwordx4 v[64:67], v253, s[16:19], s9 offen offset:0 sc1
    v_mul_f32 v72, v72, v200
    v_mul_f32 v73, v73, v200
    v_mul_f32 v74, v74, v200
    v_mul_f32 v75, v75, v200
    v_mul_f32 v76, v76, v200
    v_mul_f32 v77, v77, v200
    v_mul_f32 v78, v78, v200
    v_mul_f32 v79, v79, v200
    v_cvt_pk_bf16_f32 v72, v72, v73
    v_cvt_pk_bf16_f32 v73, v74, v75
    v_cvt_pk_bf16_f32 v74, v76, v77
    v_cvt_pk_bf16_f32 v75, v78, v79
    buffer_store_dwordx4 v[72:75], v253, s[16:19], s9 offen offset:512 sc1
    v_mul_f32 v80, v80, v200
    v_mul_f32 v81, v81, v200
    v_mul_f32 v82, v82, v200
    v_mul_f32 v83, v83, v200
    v_mul_f32 v84, v84, v200
    v_mul_f32 v85, v85, v200
    v_mul_f32 v86, v86, v200
    v_mul_f32 v87, v87, v200
    v_cvt_pk_bf16_f32 v80, v80, v81
    v_cvt_pk_bf16_f32 v81, v82, v83
    v_cvt_pk_bf16_f32 v82, v84, v85
    v_cvt_pk_bf16_f32 v83, v86, v87
    buffer_store_dwordx4 v[80:83], v253, s[16:19], s9 offen offset:1024 sc1
    v_mul_f32 v88, v88, v200
    v_mul_f32 v89, v89, v200
    v_mul_f32 v90, v90, v200
    v_mul_f32 v91, v91, v200
    v_mul_f32 v92, v92, v200
    v_mul_f32 v93, v93, v200
    v_mul_f32 v94, v94, v200
    v_mul_f32 v95, v95, v200
    v_cvt_pk_bf16_f32 v88, v88, v89
    v_cvt_pk_bf16_f32 v89, v90, v91
    v_cvt_pk_bf16_f32 v90, v92, v93
    v_cvt_pk_bf16_f32 v91, v94, v95
    buffer_store_dwordx4 v[88:91], v253, s[16:19], s9 offen offset:1536 sc1
    v_mul_f32 v96, v96, v200
    v_mul_f32 v97, v97, v200
    v_mul_f32 v98, v98, v200
    v_mul_f32 v99, v99, v200
    v_mul_f32 v100, v100, v200
    v_mul_f32 v101, v101, v200
    v_mul_f32 v102, v102, v200
    v_mul_f32 v103, v103, v200
    v_cvt_pk_bf16_f32 v96, v96, v97
    v_cvt_pk_bf16_f32 v97, v98, v99
    v_cvt_pk_bf16_f32 v98, v100, v101
    v_cvt_pk_bf16_f32 v99, v102, v103
    buffer_store_dwordx4 v[96:99], v253, s[16:19], s9 offen offset:2048 sc1
    v_mul_f32 v104, v104, v200
    v_mul_f32 v105, v105, v200
    v_mul_f32 v106, v106, v200
    v_mul_f32 v107, v107, v200
    v_mul_f32 v108, v108, v200
    v_mul_f32 v109, v109, v200
    v_mul_f32 v110, v110, v200
    v_mul_f32 v111, v111, v200
    v_cvt_pk_bf16_f32 v104, v104, v105
    v_cvt_pk_bf16_f32 v105, v106, v107
    v_cvt_pk_bf16_f32 v106, v108, v109
    v_cvt_pk_bf16_f32 v107, v110, v111
    buffer_store_dwordx4 v[104:107], v253, s[16:19], s9 offen offset:2560 sc1
    v_mul_f32 v112, v112, v200
    v_mul_f32 v113, v113, v200
    v_mul_f32 v114, v114, v200
    v_mul_f32 v115, v115, v200
    v_mul_f32 v116, v116, v200
    v_mul_f32 v117, v117, v200
    v_mul_f32 v118, v118, v200
    v_mul_f32 v119, v119, v200
    v_cvt_pk_bf16_f32 v112, v112, v113
    v_cvt_pk_bf16_f32 v113, v114, v115
    v_cvt_pk_bf16_f32 v114, v116, v117
    v_cvt_pk_bf16_f32 v115, v118, v119
    buffer_store_dwordx4 v[112:115], v253, s[16:19], s9 offen offset:3072 sc1
    v_mul_f32 v120, v120, v200
    v_mul_f32 v121, v121, v200
    v_mul_f32 v122, v122, v200
    v_mul_f32 v123, v123, v200
    v_mul_f32 v124, v124, v200
    v_mul_f32 v125, v125, v200
    v_mul_f32 v126, v126, v200
    v_mul_f32 v127, v127, v200
    v_cvt_pk_bf16_f32 v120, v120, v121
    v_cvt_pk_bf16_f32 v121, v122, v123
    v_cvt_pk_bf16_f32 v122, v124, v125
    v_cvt_pk_bf16_f32 v123, v126, v127
    buffer_store_dwordx4 v[120:123], v253, s[16:19], s9 offen offset:3584 sc1
    s_barrier
    s_cmp_gt_u32 s8, s53
    s_cbranch_scc1 H_p4
    s_barrier
H_p4:
    s_add_u32 s54, s53, 29
    s_mul_i32 s55, s54, 205
    s_lshr_b32 s55, s55, 10
    s_mul_i32 s55, s55, 5
    s_sub_u32 s54, s54, s55
    s_lshl_b32 s4, s54, 15
    v_bfe_u32 v228, v255, 3, 2
    v_lshlrev_b32 v228, 7, v228
    v_and_b32 v229, 7, v255
    v_lshl_add_u32 v236, v229, 2, v228
    s_lshl_b32 s5, s13, 9
    s_lshl_b32 s54, s15, 5
    s_add_u32 s5, s5, s54
    s_add_u32 s5, s5, 58769408
    ds_read_b128 v[128:131], v216 offset:0
    ds_read_b64_tr_b16 v[160:161], v218 offset:0
    ds_read_b64_tr_b16 v[162:163], v218 offset:2048
    ds_read_b128 v[132:135], v216 offset:2048
    ds_read_b128 v[136:139], v216 offset:4096
    ds_read_b128 v[140:143], v216 offset:6144
    ds_read_b64_tr_b16 v[164:165], v219 offset:0
    ds_read_b64_tr_b16 v[166:167], v219 offset:2048
    ds_read_b64_tr_b16 v[168:169], v220 offset:0
    ds_read_b64_tr_b16 v[170:171], v220 offset:2048
    ds_read_b64_tr_b16 v[172:173], v221 offset:0
    ds_read_b64_tr_b16 v[174:175], v221 offset:2048
    s_waitcnt lgkmcnt(9)
    v_mfma_f32_16x16x32_bf16 v[0:3], v[160:163], v[128:131], 0
    s_waitcnt lgkmcnt(8)
    v_mfma_f32_16x16x32_bf16 v[4:7], v[160:163], v[132:135], 0
    s_waitcnt lgkmcnt(7)
    v_mfma_f32_16x16x32_bf16 v[8:11], v[160:163], v[136:139], 0
    s_barrier
    s_add_u32 s54, s4, 32768
    s_cmp_eq_u32 s54, 163840
    s_cselect_b32 s54, 0, s54
    s_sub_u32 s55, s54, s4
    s_mov_b32 s4, s54
    v_add_u32 v216, s55, v216
    v_add_u32 v218, s55, v218
    v_add_u32 v219, s55, v219
    v_add_u32 v220, s55, v220
    v_add_u32 v221, s55, v221
    ds_read_b128 v[144:147], v216 offset:0
    s_waitcnt lgkmcnt(7)
    v_mfma_f32_16x16x32_bf16 v[12:15], v[160:163], v[140:143], 0
    ds_read_b64_tr_b16 v[176:177], v218 offset:0
    s_waitcnt lgkmcnt(6)
    v_mfma_f32_16x16x32_bf16 v[16:19], v[164:167], v[128:131], 0
    ds_read_b64_tr_b16 v[178:179], v218 offset:2048
    v_mfma_f32_16x16x32_bf16 v[20:23], v[164:167], v[132:135], 0
    ds_read_b128 v[148:151], v216 offset:2048
    v_mfma_f32_16x16x32_bf16 v[24:27], v[164:167], v[136:139], 0
    ds_read_b128 v[152:155], v216 offset:4096
    v_mfma_f32_16x16x32_bf16 v[28:31], v[164:167], v[140:143], 0
    ds_read_b128 v[156:159], v216 offset:6144
    s_waitcnt lgkmcnt(8)
    v_mfma_f32_16x16x32_bf16 v[32:35], v[168:171], v[128:131], 0
    ds_read_b64_tr_b16 v[180:181], v219 offset:0
    v_mfma_f32_16x16x32_bf16 v[36:39], v[168:171], v[132:135], 0
    ds_read_b64_tr_b16 v[182:183], v219 offset:2048
    v_mfma_f32_16x16x32_bf16 v[40:43], v[168:171], v[136:139], 0
    ds_read_b64_tr_b16 v[184:185], v220 offset:0
    v_mfma_f32_16x16x32_bf16 v[44:47], v[168:171], v[140:143], 0
    ds_read_b64_tr_b16 v[186:187], v220 offset:2048
    s_waitcnt lgkmcnt(10)
    v_mfma_f32_16x16x32_bf16 v[48:51], v[172:175], v[128:131], 0
    ds_read_b64_tr_b16 v[188:189], v221 offset:0
    v_mfma_f32_16x16x32_bf16 v[52:55], v[172:175], v[132:135], 0
    ds_read_b64_tr_b16 v[190:191], v221 offset:2048
    v_mfma_f32_16x16x32_bf16 v[56:59], v[172:175], v[136:139], 0
    v_mfma_f32_16x16x32_bf16 v[60:63], v[172:175], v[140:143], 0
    s_waitcnt lgkmcnt(9)
    v_mfma_f32_16x16x32_bf16 v[0:3], v[176:179], v[144:147], v[0:3]
    s_waitcnt lgkmcnt(8)
    v_mfma_f32_16x16x32_bf16 v[4:7], v[176:179], v[148:151], v[4:7]
    s_waitcnt lgkmcnt(7)
    v_mfma_f32_16x16x32_bf16 v[8:11], v[176:179], v[152:155], v[8:11]
    s_barrier
    s_add_u32 s54, s4, 32768
    s_cmp_eq_u32 s54, 163840
    s_cselect_b32 s54, 0, s54
    s_sub_u32 s55, s54, s4
    s_mov_b32 s4, s54
    v_add_u32 v216, s55, v216
    v_add_u32 v218, s55, v218
    v_add_u32 v219, s55, v219
    v_add_u32 v220, s55, v220
    v_add_u32 v221, s55, v221
    s_waitcnt vmcnt(0)
    s_lshl_b32 s54, s52, 5
    s_add_u32 s54, s54, s48
    s_lshl_b32 s54, s54, 2
    s_add_u32 s54, s54, 58769408
    s_mov_b64 exec, 1
    buffer_store_dword v251, off, s[16:19], s54 sc1
    s_mov_b64 exec, -1
    ds_read_b128 v[128:131], v216 offset:0
    s_waitcnt lgkmcnt(7)
    v_mfma_f32_16x16x32_bf16 v[12:15], v[176:179], v[156:159], v[12:15]
    ds_read_b64_tr_b16 v[160:161], v218 offset:0
    s_waitcnt lgkmcnt(6)
    v_mfma_f32_16x16x32_bf16 v[16:19], v[180:183], v[144:147], v[16:19]
    ds_read_b64_tr_b16 v[162:163], v218 offset:2048
    v_mfma_f32_16x16x32_bf16 v[20:23], v[180:183], v[148:151], v[20:23]
    ds_read_b128 v[132:135], v216 offset:2048
    v_mfma_f32_16x16x32_bf16 v[24:27], v[180:183], v[152:155], v[24:27]
    ds_read_b128 v[136:139], v216 offset:4096
    v_mfma_f32_16x16x32_bf16 v[28:31], v[180:183], v[156:159], v[28:31]
    ds_read_b128 v[140:143], v216 offset:6144
    s_waitcnt lgkmcnt(8)
    v_mfma_f32_16x16x32_bf16 v[32:35], v[184:187], v[144:147], v[32:35]
    ds_read_b64_tr_b16 v[164:165], v219 offset:0
    v_mfma_f32_16x16x32_bf16 v[36:39], v[184:187], v[148:151], v[36:39]
    ds_read_b64_tr_b16 v[166:167], v219 offset:2048
    v_mfma_f32_16x16x32_bf16 v[40:43], v[184:187], v[152:155], v[40:43]
    ds_read_b64_tr_b16 v[168:169], v220 offset:0
    v_mfma_f32_16x16x32_bf16 v[44:47], v[184:187], v[156:159], v[44:47]
    ds_read_b64_tr_b16 v[170:171], v220 offset:2048
    s_waitcnt lgkmcnt(10)
    v_mfma_f32_16x16x32_bf16 v[48:51], v[188:191], v[144:147], v[48:51]
    ds_read_b64_tr_b16 v[172:173], v221 offset:0
    v_mfma_f32_16x16x32_bf16 v[52:55], v[188:191], v[148:151], v[52:55]
    ds_read_b64_tr_b16 v[174:175], v221 offset:2048
    v_mfma_f32_16x16x32_bf16 v[56:59], v[188:191], v[152:155], v[56:59]
    v_mfma_f32_16x16x32_bf16 v[60:63], v[188:191], v[156:159], v[60:63]
    s_waitcnt lgkmcnt(9)
    v_mfma_f32_16x16x32_bf16 v[0:3], v[160:163], v[128:131], v[0:3]
    s_waitcnt lgkmcnt(8)
    v_mfma_f32_16x16x32_bf16 v[4:7], v[160:163], v[132:135], v[4:7]
    s_waitcnt lgkmcnt(7)
    v_mfma_f32_16x16x32_bf16 v[8:11], v[160:163], v[136:139], v[8:11]
    s_barrier
    s_add_u32 s54, s4, 32768
    s_cmp_eq_u32 s54, 163840
    s_cselect_b32 s54, 0, s54
    s_sub_u32 s55, s54, s4
    s_mov_b32 s4, s54
    v_add_u32 v216, s55, v216
    v_add_u32 v218, s55, v218
    v_add_u32 v219, s55, v219
    v_add_u32 v220, s55, v220
    v_add_u32 v221, s55, v221
    ds_read_b128 v[144:147], v216 offset:0
    s_waitcnt lgkmcnt(7)
    v_mfma_f32_16x16x32_bf16 v[12:15], v[160:163], v[140:143], v[12:15]
    ds_read_b64_tr_b16 v[176:177], v218 offset:0
    s_waitcnt lgkmcnt(6)
    v_mfma_f32_16x16x32_bf16 v[16:19], v[164:167], v[128:131], v[16:19]
    ds_read_b64_tr_b16 v[178:179], v218 offset:2048
    v_mfma_f32_16x16x32_bf16 v[20:23], v[164:167], v[132:135], v[20:23]
    ds_read_b128 v[148:151], v216 offset:2048
    v_mfma_f32_16x16x32_bf16 v[24:27], v[164:167], v[136:139], v[24:27]
    ds_read_b128 v[152:155], v216 offset:4096
    v_mfma_f32_16x16x32_bf16 v[28:31], v[164:167], v[140:143], v[28:31]
    ds_read_b128 v[156:159], v216 offset:6144
    s_waitcnt lgkmcnt(8)
    v_mfma_f32_16x16x32_bf16 v[32:35], v[168:171], v[128:131], v[32:35]
    ds_read_b64_tr_b16 v[180:181], v219 offset:0
    v_mfma_f32_16x16x32_bf16 v[36:39], v[168:171], v[132:135], v[36:39]
    ds_read_b64_tr_b16 v[182:183], v219 offset:2048
    v_mfma_f32_16x16x32_bf16 v[40:43], v[168:171], v[136:139], v[40:43]
    ds_read_b64_tr_b16 v[184:185], v220 offset:0
    v_mfma_f32_16x16x32_bf16 v[44:47], v[168:171], v[140:143], v[44:47]
    ds_read_b64_tr_b16 v[186:187], v220 offset:2048
    s_waitcnt lgkmcnt(10)
    v_mfma_f32_16x16x32_bf16 v[48:51], v[172:175], v[128:131], v[48:51]
    ds_read_b64_tr_b16 v[188:189], v221 offset:0
    v_mfma_f32_16x16x32_bf16 v[52:55], v[172:175], v[132:135], v[52:55]
    ds_read_b64_tr_b16 v[190:191], v221 offset:2048
    v_mfma_f32_16x16x32_bf16 v[56:59], v[172:175], v[136:139], v[56:59]
    v_mfma_f32_16x16x32_bf16 v[60:63], v[172:175], v[140:143], v[60:63]
    s_waitcnt lgkmcnt(9)
    v_mfma_f32_16x16x32_bf16 v[0:3], v[176:179], v[144:147], v[0:3]
    s_waitcnt lgkmcnt(8)
    v_mfma_f32_16x16x32_bf16 v[4:7], v[176:179], v[148:151], v[4:7]
    s_waitcnt lgkmcnt(7)
    v_mfma_f32_16x16x32_bf16 v[8:11], v[176:179], v[152:155], v[8:11]
    s_barrier
    s_add_u32 s54, s4, 32768
    s_cmp_eq_u32 s54, 163840
    s_cselect_b32 s54, 0, s54
    s_sub_u32 s55, s54, s4
    s_mov_b32 s4, s54
    v_add_u32 v216, s55, v216
    v_add_u32 v218, s55, v218
    v_add_u32 v219, s55, v219
    v_add_u32 v220, s55, v220
    v_add_u32 v221, s55, v221
    s_and_b32 s54, s50, 3
    s_lshl_b32 s54, s54, 13
    s_lshl_b32 s55, s15, 15
    s_add_u32 s54, s54, s55
    s_lshl_b32 s55, s13, 3
    s_lshl_b32 s56, s14, 1
    s_add_u32 s55, s55, s56
    s_mul_i32 s55, s55, 175104
    s_add_u32 s54, s54, s55
    s_add_u32 s54, s54, 35651584
    s_add_u32 s55, s54, 175104
    v_lshlrev_b32 v228, 7, v255
    buffer_load_dword v238, v228, s[16:19], s54 offen
    buffer_load_dword v238, v228, s[16:19], s55 offen
    ds_read_b128 v[128:131], v216 offset:0
    s_waitcnt lgkmcnt(7)
    v_mfma_f32_16x16x32_bf16 v[12:15], v[176:179], v[156:159], v[12:15]
    ds_read_b64_tr_b16 v[160:161], v218 offset:0
    s_waitcnt lgkmcnt(6)
    v_mfma_f32_16x16x32_bf16 v[16:19], v[180:183], v[144:147], v[16:19]
    ds_read_b64_tr_b16 v[162:163], v218 offset:2048
    v_mfma_f32_16x16x32_bf16 v[20:23], v[180:183], v[148:151], v[20:23]
    ds_read_b128 v[132:135], v216 offset:2048
    v_mfma_f32_16x16x32_bf16 v[24:27], v[180:183], v[152:155], v[24:27]
    ds_read_b128 v[136:139], v216 offset:4096
    v_mfma_f32_16x16x32_bf16 v[28:31], v[180:183], v[156:159], v[28:31]
    ds_read_b128 v[140:143], v216 offset:6144
    s_waitcnt lgkmcnt(8)
    v_mfma_f32_16x16x32_bf16 v[32:35], v[184:187], v[144:147], v[32:35]
    ds_read_b64_tr_b16 v[164:165], v219 offset:0
    v_mfma_f32_16x16x32_bf16 v[36:39], v[184:187], v[148:151], v[36:39]
    ds_read_b64_tr_b16 v[166:167], v219 offset:2048
    v_mfma_f32_16x16x32_bf16 v[40:43], v[184:187], v[152:155], v[40:43]
    ds_read_b64_tr_b16 v[168:169], v220 offset:0
    v_mfma_f32_16x16x32_bf16 v[44:47], v[184:187], v[156:159], v[44:47]
    ds_read_b64_tr_b16 v[170:171], v220 offset:2048
    s_waitcnt lgkmcnt(10)
    v_mfma_f32_16x16x32_bf16 v[48:51], v[188:191], v[144:147], v[48:51]
    ds_read_b64_tr_b16 v[172:173], v221 offset:0
    v_mfma_f32_16x16x32_bf16 v[52:55], v[188:191], v[148:151], v[52:55]
    ds_read_b64_tr_b16 v[174:175], v221 offset:2048
    v_mfma_f32_16x16x32_bf16 v[56:59], v[188:191], v[152:155], v[56:59]
    v_mfma_f32_16x16x32_bf16 v[60:63], v[188:191], v[156:159], v[60:63]
    s_waitcnt lgkmcnt(9)
    v_mfma_f32_16x16x32_bf16 v[0:3], v[160:163], v[128:131], v[0:3]
    s_waitcnt lgkmcnt(8)
    v_mfma_f32_16x16x32_bf16 v[4:7], v[160:163], v[132:135], v[4:7]
    s_waitcnt lgkmcnt(7)
    v_mfma_f32_16x16x32_bf16 v[8:11], v[160:163], v[136:139], v[8:11]
    s_barrier
    s_add_u32 s54, s4, 32768
    s_cmp_eq_u32 s54, 163840
    s_cselect_b32 s54, 0, s54
    s_sub_u32 s55, s54, s4
    s_mov_b32 s4, s54
    v_add_u32 v216, s55, v216
    v_add_u32 v218, s55, v218
    v_add_u32 v219, s55, v219
    v_add_u32 v220, s55, v220
    v_add_u32 v221, s55, v221
    ds_read_b128 v[144:147], v216 offset:0
    s_waitcnt lgkmcnt(7)
    v_mfma_f32_16x16x32_bf16 v[12:15], v[160:163], v[140:143], v[12:15]
    ds_read_b64_tr_b16 v[176:177], v218 offset:0
    s_waitcnt lgkmcnt(6)
    v_mfma_f32_16x16x32_bf16 v[16:19], v[164:167], v[128:131], v[16:19]
    ds_read_b64_tr_b16 v[178:179], v218 offset:2048
    v_mfma_f32_16x16x32_bf16 v[20:23], v[164:167], v[132:135], v[20:23]
    ds_read_b128 v[148:151], v216 offset:2048
    v_mfma_f32_16x16x32_bf16 v[24:27], v[164:167], v[136:139], v[24:27]
    ds_read_b128 v[152:155], v216 offset:4096
    v_mfma_f32_16x16x32_bf16 v[28:31], v[164:167], v[140:143], v[28:31]
    ds_read_b128 v[156:159], v216 offset:6144
    s_waitcnt lgkmcnt(8)
    v_mfma_f32_16x16x32_bf16 v[32:35], v[168:171], v[128:131], v[32:35]
    ds_read_b64_tr_b16 v[180:181], v219 offset:0
    v_mfma_f32_16x16x32_bf16 v[36:39], v[168:171], v[132:135], v[36:39]
    ds_read_b64_tr_b16 v[182:183], v219 offset:2048
    v_mfma_f32_16x16x32_bf16 v[40:43], v[168:171], v[136:139], v[40:43]
    ds_read_b64_tr_b16 v[184:185], v220 offset:0
    v_mfma_f32_16x16x32_bf16 v[44:47], v[168:171], v[140:143], v[44:47]
    ds_read_b64_tr_b16 v[186:187], v220 offset:2048
    s_waitcnt lgkmcnt(10)
    v_mfma_f32_16x16x32_bf16 v[48:51], v[172:175], v[128:131], v[48:51]
    ds_read_b64_tr_b16 v[188:189], v221 offset:0
    v_mfma_f32_16x16x32_bf16 v[52:55], v[172:175], v[132:135], v[52:55]
    ds_read_b64_tr_b16 v[190:191], v221 offset:2048
    v_mfma_f32_16x16x32_bf16 v[56:59], v[172:175], v[136:139], v[56:59]
    v_mfma_f32_16x16x32_bf16 v[60:63], v[172:175], v[140:143], v[60:63]
    s_waitcnt lgkmcnt(9)
    v_mfma_f32_16x16x32_bf16 v[0:3], v[176:179], v[144:147], v[0:3]
    s_waitcnt lgkmcnt(8)
    v_mfma_f32_16x16x32_bf16 v[4:7], v[176:179], v[148:151], v[4:7]
    s_waitcnt lgkmcnt(7)
    v_mfma_f32_16x16x32_bf16 v[8:11], v[176:179], v[152:155], v[8:11]
    s_barrier
    s_add_u32 s54, s4, 32768
    s_cmp_eq_u32 s54, 163840
    s_cselect_b32 s54, 0, s54
    s_sub_u32 s55, s54, s4
    s_mov_b32 s4, s54
    v_add_u32 v216, s55, v216
    v_add_u32 v218, s55, v218
    v_add_u32 v219, s55, v219
    v_add_u32 v220, s55, v220
    v_add_u32 v221, s55, v221
    ds_read_b128 v[128:131], v216 offset:0
    s_waitcnt lgkmcnt(7)
    v_mfma_f32_16x16x32_bf16 v[12:15], v[176:179], v[156:159], v[12:15]
    ds_read_b64_tr_b16 v[160:161], v218 offset:0
    s_waitcnt lgkmcnt(6)
    v_mfma_f32_16x16x32_bf16 v[16:19], v[180:183], v[144:147], v[16:19]
    ds_read_b64_tr_b16 v[162:163], v218 offset:2048
    v_mfma_f32_16x16x32_bf16 v[20:23], v[180:183], v[148:151], v[20:23]
    ds_read_b128 v[132:135], v216 offset:2048
    v_mfma_f32_16x16x32_bf16 v[24:27], v[180:183], v[152:155], v[24:27]
    ds_read_b128 v[136:139], v216 offset:4096
    v_mfma_f32_16x16x32_bf16 v[28:31], v[180:183], v[156:159], v[28:31]
    ds_read_b128 v[140:143], v216 offset:6144
    s_waitcnt lgkmcnt(8)
    v_mfma_f32_16x16x32_bf16 v[32:35], v[184:187], v[144:147], v[32:35]
    ds_read_b64_tr_b16 v[164:165], v219 offset:0
    v_mfma_f32_16x16x32_bf16 v[36:39], v[184:187], v[148:151], v[36:39]
    ds_read_b64_tr_b16 v[166:167], v219 offset:2048
    v_mfma_f32_16x16x32_bf16 v[40:43], v[184:187], v[152:155], v[40:43]
    ds_read_b64_tr_b16 v[168:169], v220 offset:0
    v_mfma_f32_16x16x32_bf16 v[44:47], v[184:187], v[156:159], v[44:47]
    ds_read_b64_tr_b16 v[170:171], v220 offset:2048
    s_waitcnt lgkmcnt(10)
    v_mfma_f32_16x16x32_bf16 v[48:51], v[188:191], v[144:147], v[48:51]
    ds_read_b64_tr_b16 v[172:173], v221 offset:0
    v_mfma_f32_16x16x32_bf16 v[52:55], v[188:191], v[148:151], v[52:55]
    ds_read_b64_tr_b16 v[174:175], v221 offset:2048
    v_mfma_f32_16x16x32_bf16 v[56:59], v[188:191], v[152:155], v[56:59]
    v_mfma_f32_16x16x32_bf16 v[60:63], v[188:191], v[156:159], v[60:63]
    s_waitcnt lgkmcnt(9)
    v_mfma_f32_16x16x32_bf16 v[0:3], v[160:163], v[128:131], v[0:3]
    s_waitcnt lgkmcnt(8)
    v_mfma_f32_16x16x32_bf16 v[4:7], v[160:163], v[132:135], v[4:7]
    s_waitcnt lgkmcnt(7)
    v_mfma_f32_16x16x32_bf16 v[8:11], v[160:163], v[136:139], v[8:11]
    s_barrier
    s_add_u32 s54, s4, 32768
    s_cmp_eq_u32 s54, 163840
    s_cselect_b32 s54, 0, s54
    s_sub_u32 s55, s54, s4
    s_mov_b32 s4, s54
    v_add_u32 v216, s55, v216
    v_add_u32 v218, s55, v218
    v_add_u32 v219, s55, v219
    v_add_u32 v220, s55, v220
    v_add_u32 v221, s55, v221
    ds_read_b128 v[144:147], v216 offset:0
    s_waitcnt lgkmcnt(7)
    v_mfma_f32_16x16x32_bf16 v[12:15], v[160:163], v[140:143], v[12:15]
    ds_read_b64_tr_b16 v[176:177], v218 offset:0
    s_waitcnt lgkmcnt(6)
    v_mfma_f32_16x16x32_bf16 v[16:19], v[164:167], v[128:131], v[16:19]
    ds_read_b64_tr_b16 v[178:179], v218 offset:2048
    v_mfma_f32_16x16x32_bf16 v[20:23], v[164:167], v[132:135], v[20:23]
    ds_read_b128 v[148:151], v216 offset:2048
    v_mfma_f32_16x16x32_bf16 v[24:27], v[164:167], v[136:139], v[24:27]
    ds_read_b128 v[152:155], v216 offset:4096
    v_mfma_f32_16x16x32_bf16 v[28:31], v[164:167], v[140:143], v[28:31]
    ds_read_b128 v[156:159], v216 offset:6144
    s_waitcnt lgkmcnt(8)
    v_mfma_f32_16x16x32_bf16 v[32:35], v[168:171], v[128:131], v[32:35]
    ds_read_b64_tr_b16 v[180:181], v219 offset:0
    v_mfma_f32_16x16x32_bf16 v[36:39], v[168:171], v[132:135], v[36:39]
    ds_read_b64_tr_b16 v[182:183], v219 offset:2048
    v_mfma_f32_16x16x32_bf16 v[40:43], v[168:171], v[136:139], v[40:43]
    ds_read_b64_tr_b16 v[184:185], v220 offset:0
    v_mfma_f32_16x16x32_bf16 v[44:47], v[168:171], v[140:143], v[44:47]
    ds_read_b64_tr_b16 v[186:187], v220 offset:2048
    s_waitcnt lgkmcnt(10)
    v_mfma_f32_16x16x32_bf16 v[48:51], v[172:175], v[128:131], v[48:51]
    ds_read_b64_tr_b16 v[188:189], v221 offset:0
    v_mfma_f32_16x16x32_bf16 v[52:55], v[172:175], v[132:135], v[52:55]
    ds_read_b64_tr_b16 v[190:191], v221 offset:2048
    v_mfma_f32_16x16x32_bf16 v[56:59], v[172:175], v[136:139], v[56:59]
    v_mfma_f32_16x16x32_bf16 v[60:63], v[172:175], v[140:143], v[60:63]
    s_waitcnt lgkmcnt(9)
    v_mfma_f32_16x16x32_bf16 v[0:3], v[176:179], v[144:147], v[0:3]
    s_waitcnt lgkmcnt(8)
    v_mfma_f32_16x16x32_bf16 v[4:7], v[176:179], v[148:151], v[4:7]
    s_waitcnt lgkmcnt(7)
    v_mfma_f32_16x16x32_bf16 v[8:11], v[176:179], v[152:155], v[8:11]
    s_barrier
    s_add_u32 s54, s4, 32768
    s_cmp_eq_u32 s54, 163840
    s_cselect_b32 s54, 0, s54
    s_sub_u32 s55, s54, s4
    s_mov_b32 s4, s54
    v_add_u32 v216, s55, v216
    v_add_u32 v218, s55, v218
    v_add_u32 v219, s55, v219
    v_add_u32 v220, s55, v220
    v_add_u32 v221, s55, v221
    ds_read_b128 v[128:131], v216 offset:0
    s_waitcnt lgkmcnt(7)
    v_mfma_f32_16x16x32_bf16 v[12:15], v[176:179], v[156:159], v[12:15]
    ds_read_b64_tr_b16 v[160:161], v218 offset:0
    s_waitcnt lgkmcnt(6)
    v_mfma_f32_16x16x32_bf16 v[16:19], v[180:183], v[144:147], v[16:19]
    ds_read_b64_tr_b16 v[162:163], v218 offset:2048
    v_mfma_f32_16x16x32_bf16 v[20:23], v[180:183], v[148:151], v[20:23]
    ds_read_b128 v[132:135], v216 offset:2048
    v_mfma_f32_16x16x32_bf16 v[24:27], v[180:183], v[152:155], v[24:27]
    ds_read_b128 v[136:139], v216 offset:4096
    v_mfma_f32_16x16x32_bf16 v[28:31], v[180:183], v[156:159], v[28:31]
    ds_read_b128 v[140:143], v216 offset:6144
    s_waitcnt lgkmcnt(8)
    v_mfma_f32_16x16x32_bf16 v[32:35], v[184:187], v[144:147], v[32:35]
    ds_read_b64_tr_b16 v[164:165], v219 offset:0
    v_mfma_f32_16x16x32_bf16 v[36:39], v[184:187], v[148:151], v[36:39]
    ds_read_b64_tr_b16 v[166:167], v219 offset:2048
    v_mfma_f32_16x16x32_bf16 v[40:43], v[184:187], v[152:155], v[40:43]
    ds_read_b64_tr_b16 v[168:169], v220 offset:0
    v_mfma_f32_16x16x32_bf16 v[44:47], v[184:187], v[156:159], v[44:47]
    ds_read_b64_tr_b16 v[170:171], v220 offset:2048
    s_waitcnt lgkmcnt(10)
    v_mfma_f32_16x16x32_bf16 v[48:51], v[188:191], v[144:147], v[48:51]
    ds_read_b64_tr_b16 v[172:173], v221 offset:0
    v_mfma_f32_16x16x32_bf16 v[52:55], v[188:191], v[148:151], v[52:55]
    ds_read_b64_tr_b16 v[174:175], v221 offset:2048
    v_mfma_f32_16x16x32_bf16 v[56:59], v[188:191], v[152:155], v[56:59]
    v_mfma_f32_16x16x32_bf16 v[60:63], v[188:191], v[156:159], v[60:63]
    s_waitcnt lgkmcnt(9)
    v_mfma_f32_16x16x32_bf16 v[0:3], v[160:163], v[128:131], v[0:3]
    s_waitcnt lgkmcnt(8)
    v_mfma_f32_16x16x32_bf16 v[4:7], v[160:163], v[132:135], v[4:7]
    s_waitcnt lgkmcnt(7)
    v_mfma_f32_16x16x32_bf16 v[8:11], v[160:163], v[136:139], v[8:11]
    s_barrier
    s_add_u32 s54, s4, 32768
    s_cmp_eq_u32 s54, 163840
    s_cselect_b32 s54, 0, s54
    s_sub_u32 s55, s54, s4
    s_mov_b32 s4, s54
    v_add_u32 v216, s55, v216
    v_add_u32 v218, s55, v218
    v_add_u32 v219, s55, v219
    v_add_u32 v220, s55, v220
    v_add_u32 v221, s55, v221
    ds_read_b128 v[144:147], v216 offset:0
    s_waitcnt lgkmcnt(7)
    v_mfma_f32_16x16x32_bf16 v[12:15], v[160:163], v[140:143], v[12:15]
    ds_read_b64_tr_b16 v[176:177], v218 offset:0
    s_waitcnt lgkmcnt(6)
    v_mfma_f32_16x16x32_bf16 v[16:19], v[164:167], v[128:131], v[16:19]
    ds_read_b64_tr_b16 v[178:179], v218 offset:2048
    v_mfma_f32_16x16x32_bf16 v[20:23], v[164:167], v[132:135], v[20:23]
    ds_read_b128 v[148:151], v216 offset:2048
    v_mfma_f32_16x16x32_bf16 v[24:27], v[164:167], v[136:139], v[24:27]
    ds_read_b128 v[152:155], v216 offset:4096
    v_mfma_f32_16x16x32_bf16 v[28:31], v[164:167], v[140:143], v[28:31]
    ds_read_b128 v[156:159], v216 offset:6144
    s_waitcnt lgkmcnt(8)
    v_mfma_f32_16x16x32_bf16 v[32:35], v[168:171], v[128:131], v[32:35]
    ds_read_b64_tr_b16 v[180:181], v219 offset:0
    v_mfma_f32_16x16x32_bf16 v[36:39], v[168:171], v[132:135], v[36:39]
    ds_read_b64_tr_b16 v[182:183], v219 offset:2048
    v_mfma_f32_16x16x32_bf16 v[40:43], v[168:171], v[136:139], v[40:43]
    ds_read_b64_tr_b16 v[184:185], v220 offset:0
    v_mfma_f32_16x16x32_bf16 v[44:47], v[168:171], v[140:143], v[44:47]
    ds_read_b64_tr_b16 v[186:187], v220 offset:2048
    s_waitcnt lgkmcnt(10)
    v_mfma_f32_16x16x32_bf16 v[48:51], v[172:175], v[128:131], v[48:51]
    ds_read_b64_tr_b16 v[188:189], v221 offset:0
    v_mfma_f32_16x16x32_bf16 v[52:55], v[172:175], v[132:135], v[52:55]
    ds_read_b64_tr_b16 v[190:191], v221 offset:2048
    v_mfma_f32_16x16x32_bf16 v[56:59], v[172:175], v[136:139], v[56:59]
    v_mfma_f32_16x16x32_bf16 v[60:63], v[172:175], v[140:143], v[60:63]
    s_waitcnt lgkmcnt(9)
    v_mfma_f32_16x16x32_bf16 v[0:3], v[176:179], v[144:147], v[0:3]
    s_waitcnt lgkmcnt(8)
    v_mfma_f32_16x16x32_bf16 v[4:7], v[176:179], v[148:151], v[4:7]
    s_waitcnt lgkmcnt(7)
    v_mfma_f32_16x16x32_bf16 v[8:11], v[176:179], v[152:155], v[8:11]
    s_barrier
    s_add_u32 s54, s4, 32768
    s_cmp_eq_u32 s54, 163840
    s_cselect_b32 s54, 0, s54
    s_sub_u32 s55, s54, s4
    s_mov_b32 s4, s54
    v_add_u32 v216, s55, v216
    v_add_u32 v218, s55, v218
    v_add_u32 v219, s55, v219
    v_add_u32 v220, s55, v220
    v_add_u32 v221, s55, v221
    ds_read_b128 v[128:131], v216 offset:0
    s_waitcnt lgkmcnt(7)
    v_mfma_f32_16x16x32_bf16 v[12:15], v[176:179], v[156:159], v[12:15]
    ds_read_b64_tr_b16 v[160:161], v218 offset:0
    s_waitcnt lgkmcnt(6)
    v_mfma_f32_16x16x32_bf16 v[16:19], v[180:183], v[144:147], v[16:19]
    ds_read_b64_tr_b16 v[162:163], v218 offset:2048
    v_mfma_f32_16x16x32_bf16 v[20:23], v[180:183], v[148:151], v[20:23]
    ds_read_b128 v[132:135], v216 offset:2048
    v_mfma_f32_16x16x32_bf16 v[24:27], v[180:183], v[152:155], v[24:27]
    ds_read_b128 v[136:139], v216 offset:4096
    v_mfma_f32_16x16x32_bf16 v[28:31], v[180:183], v[156:159], v[28:31]
    ds_read_b128 v[140:143], v216 offset:6144
    s_waitcnt lgkmcnt(8)
    v_mfma_f32_16x16x32_bf16 v[32:35], v[184:187], v[144:147], v[32:35]
    ds_read_b64_tr_b16 v[164:165], v219 offset:0
    v_mfma_f32_16x16x32_bf16 v[36:39], v[184:187], v[148:151], v[36:39]
    ds_read_b64_tr_b16 v[166:167], v219 offset:2048
    v_mfma_f32_16x16x32_bf16 v[40:43], v[184:187], v[152:155], v[40:43]
    ds_read_b64_tr_b16 v[168:169], v220 offset:0
    v_mfma_f32_16x16x32_bf16 v[44:47], v[184:187], v[156:159], v[44:47]
    ds_read_b64_tr_b16 v[170:171], v220 offset:2048
    s_waitcnt lgkmcnt(10)
    v_mfma_f32_16x16x32_bf16 v[48:51], v[188:191], v[144:147], v[48:51]
    ds_read_b64_tr_b16 v[172:173], v221 offset:0
    v_mfma_f32_16x16x32_bf16 v[52:55], v[188:191], v[148:151], v[52:55]
    ds_read_b64_tr_b16 v[174:175], v221 offset:2048
    v_mfma_f32_16x16x32_bf16 v[56:59], v[188:191], v[152:155], v[56:59]
    v_mfma_f32_16x16x32_bf16 v[60:63], v[188:191], v[156:159], v[60:63]
    s_waitcnt lgkmcnt(9)
    v_mfma_f32_16x16x32_bf16 v[0:3], v[160:163], v[128:131], v[0:3]
    s_waitcnt lgkmcnt(8)
    v_mfma_f32_16x16x32_bf16 v[4:7], v[160:163], v[132:135], v[4:7]
    s_waitcnt lgkmcnt(7)
    v_mfma_f32_16x16x32_bf16 v[8:11], v[160:163], v[136:139], v[8:11]
    s_barrier
    s_add_u32 s54, s4, 32768
    s_cmp_eq_u32 s54, 163840
    s_cselect_b32 s54, 0, s54
    s_sub_u32 s55, s54, s4
    s_mov_b32 s4, s54
    v_add_u32 v216, s55, v216
    v_add_u32 v218, s55, v218
    v_add_u32 v219, s55, v219
    v_add_u32 v220, s55, v220
    v_add_u32 v221, s55, v221
    ds_read_b128 v[144:147], v216 offset:0
    s_waitcnt lgkmcnt(7)
    v_mfma_f32_16x16x32_bf16 v[12:15], v[160:163], v[140:143], v[12:15]
    ds_read_b64_tr_b16 v[176:177], v218 offset:0
    s_waitcnt lgkmcnt(6)
    v_mfma_f32_16x16x32_bf16 v[16:19], v[164:167], v[128:131], v[16:19]
    ds_read_b64_tr_b16 v[178:179], v218 offset:2048
    v_mfma_f32_16x16x32_bf16 v[20:23], v[164:167], v[132:135], v[20:23]
    ds_read_b128 v[148:151], v216 offset:2048
    v_mfma_f32_16x16x32_bf16 v[24:27], v[164:167], v[136:139], v[24:27]
    ds_read_b128 v[152:155], v216 offset:4096
    v_mfma_f32_16x16x32_bf16 v[28:31], v[164:167], v[140:143], v[28:31]
    ds_read_b128 v[156:159], v216 offset:6144
    s_waitcnt lgkmcnt(8)
    v_mfma_f32_16x16x32_bf16 v[32:35], v[168:171], v[128:131], v[32:35]
    ds_read_b64_tr_b16 v[180:181], v219 offset:0
    v_mfma_f32_16x16x32_bf16 v[36:39], v[168:171], v[132:135], v[36:39]
    ds_read_b64_tr_b16 v[182:183], v219 offset:2048
    v_mfma_f32_16x16x32_bf16 v[40:43], v[168:171], v[136:139], v[40:43]
    ds_read_b64_tr_b16 v[184:185], v220 offset:0
    v_mfma_f32_16x16x32_bf16 v[44:47], v[168:171], v[140:143], v[44:47]
    ds_read_b64_tr_b16 v[186:187], v220 offset:2048
    s_waitcnt lgkmcnt(10)
    v_mfma_f32_16x16x32_bf16 v[48:51], v[172:175], v[128:131], v[48:51]
    ds_read_b64_tr_b16 v[188:189], v221 offset:0
    v_mfma_f32_16x16x32_bf16 v[52:55], v[172:175], v[132:135], v[52:55]
    ds_read_b64_tr_b16 v[190:191], v221 offset:2048
    v_mfma_f32_16x16x32_bf16 v[56:59], v[172:175], v[136:139], v[56:59]
    v_mfma_f32_16x16x32_bf16 v[60:63], v[172:175], v[140:143], v[60:63]
    s_waitcnt lgkmcnt(9)
    v_mfma_f32_16x16x32_bf16 v[0:3], v[176:179], v[144:147], v[0:3]
    s_waitcnt lgkmcnt(8)
    v_mfma_f32_16x16x32_bf16 v[4:7], v[176:179], v[148:151], v[4:7]
    s_waitcnt lgkmcnt(7)
    v_mfma_f32_16x16x32_bf16 v[8:11], v[176:179], v[152:155], v[8:11]
    s_barrier
    s_add_u32 s54, s4, 32768
    s_cmp_eq_u32 s54, 163840
    s_cselect_b32 s54, 0, s54
    s_sub_u32 s55, s54, s4
    s_mov_b32 s4, s54
    v_add_u32 v216, s55, v216
    v_add_u32 v218, s55, v218
    v_add_u32 v219, s55, v219
    v_add_u32 v220, s55, v220
    v_add_u32 v221, s55, v221
    ds_read_b128 v[128:131], v216 offset:0
    s_waitcnt lgkmcnt(7)
    v_mfma_f32_16x16x32_bf16 v[12:15], v[176:179], v[156:159], v[12:15]
    ds_read_b64_tr_b16 v[160:161], v218 offset:0
    s_waitcnt lgkmcnt(6)
    v_mfma_f32_16x16x32_bf16 v[16:19], v[180:183], v[144:147], v[16:19]
    ds_read_b64_tr_b16 v[162:163], v218 offset:2048
    v_mfma_f32_16x16x32_bf16 v[20:23], v[180:183], v[148:151], v[20:23]
    ds_read_b128 v[132:135], v216 offset:2048
    v_mfma_f32_16x16x32_bf16 v[24:27], v[180:183], v[152:155], v[24:27]
    ds_read_b128 v[136:139], v216 offset:4096
    v_mfma_f32_16x16x32_bf16 v[28:31], v[180:183], v[156:159], v[28:31]
    ds_read_b128 v[140:143], v216 offset:6144
    s_waitcnt lgkmcnt(8)
    v_mfma_f32_16x16x32_bf16 v[32:35], v[184:187], v[144:147], v[32:35]
    ds_read_b64_tr_b16 v[164:165], v219 offset:0
    v_mfma_f32_16x16x32_bf16 v[36:39], v[184:187], v[148:151], v[36:39]
    ds_read_b64_tr_b16 v[166:167], v219 offset:2048
    v_mfma_f32_16x16x32_bf16 v[40:43], v[184:187], v[152:155], v[40:43]
    ds_read_b64_tr_b16 v[168:169], v220 offset:0
    v_mfma_f32_16x16x32_bf16 v[44:47], v[184:187], v[156:159], v[44:47]
    ds_read_b64_tr_b16 v[170:171], v220 offset:2048
    s_waitcnt lgkmcnt(10)
    v_mfma_f32_16x16x32_bf16 v[48:51], v[188:191], v[144:147], v[48:51]
    ds_read_b64_tr_b16 v[172:173], v221 offset:0
    v_mfma_f32_16x16x32_bf16 v[52:55], v[188:191], v[148:151], v[52:55]
    ds_read_b64_tr_b16 v[174:175], v221 offset:2048
    v_mfma_f32_16x16x32_bf16 v[56:59], v[188:191], v[152:155], v[56:59]
    v_mfma_f32_16x16x32_bf16 v[60:63], v[188:191], v[156:159], v[60:63]
    s_waitcnt lgkmcnt(9)
    v_mfma_f32_16x16x32_bf16 v[0:3], v[160:163], v[128:131], v[0:3]
    s_waitcnt lgkmcnt(8)
    v_mfma_f32_16x16x32_bf16 v[4:7], v[160:163], v[132:135], v[4:7]
    s_waitcnt lgkmcnt(7)
    v_mfma_f32_16x16x32_bf16 v[8:11], v[160:163], v[136:139], v[8:11]
    s_barrier
    s_add_u32 s54, s4, 32768
    s_cmp_eq_u32 s54, 163840
    s_cselect_b32 s54, 0, s54
    s_sub_u32 s55, s54, s4
    s_mov_b32 s4, s54
    v_add_u32 v216, s55, v216
    v_add_u32 v218, s55, v218
    v_add_u32 v219, s55, v219
    v_add_u32 v220, s55, v220
    v_add_u32 v221, s55, v221
    ds_read_b128 v[144:147], v216 offset:0
    s_waitcnt lgkmcnt(7)
    v_mfma_f32_16x16x32_bf16 v[12:15], v[160:163], v[140:143], v[12:15]
    ds_read_b64_tr_b16 v[176:177], v218 offset:0
    s_waitcnt lgkmcnt(6)
    v_mfma_f32_16x16x32_bf16 v[16:19], v[164:167], v[128:131], v[16:19]
    ds_read_b64_tr_b16 v[178:179], v218 offset:2048
    v_mfma_f32_16x16x32_bf16 v[20:23], v[164:167], v[132:135], v[20:23]
    ds_read_b128 v[148:151], v216 offset:2048
    v_mfma_f32_16x16x32_bf16 v[24:27], v[164:167], v[136:139], v[24:27]
    ds_read_b128 v[152:155], v216 offset:4096
    v_mfma_f32_16x16x32_bf16 v[28:31], v[164:167], v[140:143], v[28:31]
    ds_read_b128 v[156:159], v216 offset:6144
    s_waitcnt lgkmcnt(8)
    v_mfma_f32_16x16x32_bf16 v[32:35], v[168:171], v[128:131], v[32:35]
    ds_read_b64_tr_b16 v[180:181], v219 offset:0
    v_mfma_f32_16x16x32_bf16 v[36:39], v[168:171], v[132:135], v[36:39]
    ds_read_b64_tr_b16 v[182:183], v219 offset:2048
    v_mfma_f32_16x16x32_bf16 v[40:43], v[168:171], v[136:139], v[40:43]
    ds_read_b64_tr_b16 v[184:185], v220 offset:0
    v_mfma_f32_16x16x32_bf16 v[44:47], v[168:171], v[140:143], v[44:47]
    ds_read_b64_tr_b16 v[186:187], v220 offset:2048
    s_waitcnt lgkmcnt(10)
    v_mfma_f32_16x16x32_bf16 v[48:51], v[172:175], v[128:131], v[48:51]
    ds_read_b64_tr_b16 v[188:189], v221 offset:0
    v_mfma_f32_16x16x32_bf16 v[52:55], v[172:175], v[132:135], v[52:55]
    ds_read_b64_tr_b16 v[190:191], v221 offset:2048
    v_mfma_f32_16x16x32_bf16 v[56:59], v[172:175], v[136:139], v[56:59]
    v_mfma_f32_16x16x32_bf16 v[60:63], v[172:175], v[140:143], v[60:63]
    s_waitcnt lgkmcnt(9)
    v_mfma_f32_16x16x32_bf16 v[0:3], v[176:179], v[144:147], v[0:3]
    s_waitcnt lgkmcnt(8)
    v_mfma_f32_16x16x32_bf16 v[4:7], v[176:179], v[148:151], v[4:7]
    s_waitcnt lgkmcnt(7)
    v_mfma_f32_16x16x32_bf16 v[8:11], v[176:179], v[152:155], v[8:11]
    s_barrier
    s_add_u32 s54, s4, 32768
    s_cmp_eq_u32 s54, 163840
    s_cselect_b32 s54, 0, s54
    s_sub_u32 s55, s54, s4
    s_mov_b32 s4, s54
    v_add_u32 v216, s55, v216
    v_add_u32 v218, s55, v218
    v_add_u32 v219, s55, v219
    v_add_u32 v220, s55, v220
    v_add_u32 v221, s55, v221
    ds_read_b128 v[128:131], v216 offset:0
    s_waitcnt lgkmcnt(7)
    v_mfma_f32_16x16x32_bf16 v[12:15], v[176:179], v[156:159], v[12:15]
    ds_read_b64_tr_b16 v[160:161], v218 offset:0
    s_waitcnt lgkmcnt(6)
    v_mfma_f32_16x16x32_bf16 v[16:19], v[180:183], v[144:147], v[16:19]
    ds_read_b64_tr_b16 v[162:163], v218 offset:2048
    v_mfma_f32_16x16x32_bf16 v[20:23], v[180:183], v[148:151], v[20:23]
    ds_read_b128 v[132:135], v216 offset:2048
    v_mfma_f32_16x16x32_bf16 v[24:27], v[180:183], v[152:155], v[24:27]
    ds_read_b128 v[136:139], v216 offset:4096
    v_mfma_f32_16x16x32_bf16 v[28:31], v[180:183], v[156:159], v[28:31]
    ds_read_b128 v[140:143], v216 offset:6144
    s_waitcnt lgkmcnt(8)
    v_mfma_f32_16x16x32_bf16 v[32:35], v[184:187], v[144:147], v[32:35]
    ds_read_b64_tr_b16 v[164:165], v219 offset:0
    v_mfma_f32_16x16x32_bf16 v[36:39], v[184:187], v[148:151], v[36:39]
    ds_read_b64_tr_b16 v[166:167], v219 offset:2048
    v_mfma_f32_16x16x32_bf16 v[40:43], v[184:187], v[152:155], v[40:43]
    ds_read_b64_tr_b16 v[168:169], v220 offset:0
    v_mfma_f32_16x16x32_bf16 v[44:47], v[184:187], v[156:159], v[44:47]
    ds_read_b64_tr_b16 v[170:171], v220 offset:2048
    s_waitcnt lgkmcnt(10)
    v_mfma_f32_16x16x32_bf16 v[48:51], v[188:191], v[144:147], v[48:51]
    ds_read_b64_tr_b16 v[172:173], v221 offset:0
    v_mfma_f32_16x16x32_bf16 v[52:55], v[188:191], v[148:151], v[52:55]
    ds_read_b64_tr_b16 v[174:175], v221 offset:2048
    v_mfma_f32_16x16x32_bf16 v[56:59], v[188:191], v[152:155], v[56:59]
    v_mfma_f32_16x16x32_bf16 v[60:63], v[188:191], v[156:159], v[60:63]
    s_waitcnt lgkmcnt(9)
    v_mfma_f32_16x16x32_bf16 v[0:3], v[160:163], v[128:131], v[0:3]
    s_waitcnt lgkmcnt(8)
    v_mfma_f32_16x16x32_bf16 v[4:7], v[160:163], v[132:135], v[4:7]
    s_waitcnt lgkmcnt(7)
    v_mfma_f32_16x16x32_bf16 v[8:11], v[160:163], v[136:139], v[8:11]
    s_barrier
    s_add_u32 s54, s4, 32768
    s_cmp_eq_u32 s54, 163840
    s_cselect_b32 s54, 0, s54
    s_sub_u32 s55, s54, s4
    s_mov_b32 s4, s54
    v_add_u32 v216, s55, v216
    v_add_u32 v218, s55, v218
    v_add_u32 v219, s55, v219
    v_add_u32 v220, s55, v220
    v_add_u32 v221, s55, v221
    ds_read_b128 v[144:147], v216 offset:0
    s_waitcnt lgkmcnt(7)
    v_mfma_f32_16x16x32_bf16 v[12:15], v[160:163], v[140:143], v[12:15]
    ds_read_b64_tr_b16 v[176:177], v218 offset:0
    s_waitcnt lgkmcnt(6)
    v_mfma_f32_16x16x32_bf16 v[16:19], v[164:167], v[128:131], v[16:19]
    ds_read_b64_tr_b16 v[178:179], v218 offset:2048
    v_mfma_f32_16x16x32_bf16 v[20:23], v[164:167], v[132:135], v[20:23]
    ds_read_b128 v[148:151], v216 offset:2048
    v_mfma_f32_16x16x32_bf16 v[24:27], v[164:167], v[136:139], v[24:27]
    ds_read_b128 v[152:155], v216 offset:4096
    v_mfma_f32_16x16x32_bf16 v[28:31], v[164:167], v[140:143], v[28:31]
    ds_read_b128 v[156:159], v216 offset:6144
    s_waitcnt lgkmcnt(8)
    v_mfma_f32_16x16x32_bf16 v[32:35], v[168:171], v[128:131], v[32:35]
    ds_read_b64_tr_b16 v[180:181], v219 offset:0
    v_mfma_f32_16x16x32_bf16 v[36:39], v[168:171], v[132:135], v[36:39]
    ds_read_b64_tr_b16 v[182:183], v219 offset:2048
    v_mfma_f32_16x16x32_bf16 v[40:43], v[168:171], v[136:139], v[40:43]
    ds_read_b64_tr_b16 v[184:185], v220 offset:0
    v_mfma_f32_16x16x32_bf16 v[44:47], v[168:171], v[140:143], v[44:47]
    ds_read_b64_tr_b16 v[186:187], v220 offset:2048
    s_waitcnt lgkmcnt(10)
    v_mfma_f32_16x16x32_bf16 v[48:51], v[172:175], v[128:131], v[48:51]
    ds_read_b64_tr_b16 v[188:189], v221 offset:0
    v_mfma_f32_16x16x32_bf16 v[52:55], v[172:175], v[132:135], v[52:55]
    ds_read_b64_tr_b16 v[190:191], v221 offset:2048
    v_mfma_f32_16x16x32_bf16 v[56:59], v[172:175], v[136:139], v[56:59]
    v_mfma_f32_16x16x32_bf16 v[60:63], v[172:175], v[140:143], v[60:63]
    s_waitcnt lgkmcnt(9)
    v_mfma_f32_16x16x32_bf16 v[0:3], v[176:179], v[144:147], v[0:3]
    s_waitcnt lgkmcnt(8)
    v_mfma_f32_16x16x32_bf16 v[4:7], v[176:179], v[148:151], v[4:7]
    s_waitcnt lgkmcnt(7)
    v_mfma_f32_16x16x32_bf16 v[8:11], v[176:179], v[152:155], v[8:11]
    s_barrier
    s_add_u32 s54, s4, 32768
    s_cmp_eq_u32 s54, 163840
    s_cselect_b32 s54, 0, s54
    s_sub_u32 s55, s54, s4
    s_mov_b32 s4, s54
    v_add_u32 v216, s55, v216
    v_add_u32 v218, s55, v218
    v_add_u32 v219, s55, v219
    v_add_u32 v220, s55, v220
    v_add_u32 v221, s55, v221
    ds_read_b128 v[128:131], v216 offset:0
    s_waitcnt lgkmcnt(7)
    v_mfma_f32_16x16x32_bf16 v[12:15], v[176:179], v[156:159], v[12:15]
    ds_read_b64_tr_b16 v[160:161], v218 offset:0
    s_waitcnt lgkmcnt(6)
    v_mfma_f32_16x16x32_bf16 v[16:19], v[180:183], v[144:147], v[16:19]
    ds_read_b64_tr_b16 v[162:163], v218 offset:2048
    v_mfma_f32_16x16x32_bf16 v[20:23], v[180:183], v[148:151], v[20:23]
    ds_read_b128 v[132:135], v216 offset:2048
    v_mfma_f32_16x16x32_bf16 v[24:27], v[180:183], v[152:155], v[24:27]
    ds_read_b128 v[136:139], v216 offset:4096
    v_mfma_f32_16x16x32_bf16 v[28:31], v[180:183], v[156:159], v[28:31]
    ds_read_b128 v[140:143], v216 offset:6144
    s_waitcnt lgkmcnt(8)
    v_mfma_f32_16x16x32_bf16 v[32:35], v[184:187], v[144:147], v[32:35]
    ds_read_b64_tr_b16 v[164:165], v219 offset:0
    v_mfma_f32_16x16x32_bf16 v[36:39], v[184:187], v[148:151], v[36:39]
    ds_read_b64_tr_b16 v[166:167], v219 offset:2048
    v_mfma_f32_16x16x32_bf16 v[40:43], v[184:187], v[152:155], v[40:43]
    ds_read_b64_tr_b16 v[168:169], v220 offset:0
    v_mfma_f32_16x16x32_bf16 v[44:47], v[184:187], v[156:159], v[44:47]
    ds_read_b64_tr_b16 v[170:171], v220 offset:2048
    s_waitcnt lgkmcnt(10)
    v_mfma_f32_16x16x32_bf16 v[48:51], v[188:191], v[144:147], v[48:51]
    ds_read_b64_tr_b16 v[172:173], v221 offset:0
    v_mfma_f32_16x16x32_bf16 v[52:55], v[188:191], v[148:151], v[52:55]
    ds_read_b64_tr_b16 v[174:175], v221 offset:2048
    v_mfma_f32_16x16x32_bf16 v[56:59], v[188:191], v[152:155], v[56:59]
    v_mfma_f32_16x16x32_bf16 v[60:63], v[188:191], v[156:159], v[60:63]
    s_waitcnt lgkmcnt(9)
    v_mfma_f32_16x16x32_bf16 v[0:3], v[160:163], v[128:131], v[0:3]
    s_waitcnt lgkmcnt(8)
    v_mfma_f32_16x16x32_bf16 v[4:7], v[160:163], v[132:135], v[4:7]
    s_waitcnt lgkmcnt(7)
    v_mfma_f32_16x16x32_bf16 v[8:11], v[160:163], v[136:139], v[8:11]
    s_barrier
    s_add_u32 s54, s4, 32768
    s_cmp_eq_u32 s54, 163840
    s_cselect_b32 s54, 0, s54
    s_sub_u32 s55, s54, s4
    s_mov_b32 s4, s54
    v_add_u32 v216, s55, v216
    v_add_u32 v218, s55, v218
    v_add_u32 v219, s55, v219
    v_add_u32 v220, s55, v220
    v_add_u32 v221, s55, v221
    ds_read_b128 v[144:147], v216 offset:0
    s_waitcnt lgkmcnt(7)
    v_mfma_f32_16x16x32_bf16 v[12:15], v[160:163], v[140:143], v[12:15]
    ds_read_b64_tr_b16 v[176:177], v218 offset:0
    s_waitcnt lgkmcnt(6)
    v_mfma_f32_16x16x32_bf16 v[16:19], v[164:167], v[128:131], v[16:19]
    ds_read_b64_tr_b16 v[178:179], v218 offset:2048
    v_mfma_f32_16x16x32_bf16 v[20:23], v[164:167], v[132:135], v[20:23]
    ds_read_b128 v[148:151], v216 offset:2048
    v_mfma_f32_16x16x32_bf16 v[24:27], v[164:167], v[136:139], v[24:27]
    ds_read_b128 v[152:155], v216 offset:4096
    v_mfma_f32_16x16x32_bf16 v[28:31], v[164:167], v[140:143], v[28:31]
    ds_read_b128 v[156:159], v216 offset:6144
    s_waitcnt lgkmcnt(8)
    v_mfma_f32_16x16x32_bf16 v[32:35], v[168:171], v[128:131], v[32:35]
    ds_read_b64_tr_b16 v[180:181], v219 offset:0
    v_mfma_f32_16x16x32_bf16 v[36:39], v[168:171], v[132:135], v[36:39]
    ds_read_b64_tr_b16 v[182:183], v219 offset:2048
    v_mfma_f32_16x16x32_bf16 v[40:43], v[168:171], v[136:139], v[40:43]
    ds_read_b64_tr_b16 v[184:185], v220 offset:0
    v_mfma_f32_16x16x32_bf16 v[44:47], v[168:171], v[140:143], v[44:47]
    ds_read_b64_tr_b16 v[186:187], v220 offset:2048
    s_waitcnt lgkmcnt(10)
    v_mfma_f32_16x16x32_bf16 v[48:51], v[172:175], v[128:131], v[48:51]
    ds_read_b64_tr_b16 v[188:189], v221 offset:0
    v_mfma_f32_16x16x32_bf16 v[52:55], v[172:175], v[132:135], v[52:55]
    ds_read_b64_tr_b16 v[190:191], v221 offset:2048
    v_mfma_f32_16x16x32_bf16 v[56:59], v[172:175], v[136:139], v[56:59]
    v_mfma_f32_16x16x32_bf16 v[60:63], v[172:175], v[140:143], v[60:63]
    s_waitcnt lgkmcnt(9)
    v_mfma_f32_16x16x32_bf16 v[0:3], v[176:179], v[144:147], v[0:3]
    s_waitcnt lgkmcnt(8)
    v_mfma_f32_16x16x32_bf16 v[4:7], v[176:179], v[148:151], v[4:7]
    s_waitcnt lgkmcnt(7)
    v_mfma_f32_16x16x32_bf16 v[8:11], v[176:179], v[152:155], v[8:11]
    s_barrier
    s_add_u32 s54, s4, 32768
    s_cmp_eq_u32 s54, 163840
    s_cselect_b32 s54, 0, s54
    s_sub_u32 s55, s54, s4
    s_mov_b32 s4, s54
    v_add_u32 v216, s55, v216
    v_add_u32 v218, s55, v218
    v_add_u32 v219, s55, v219
    v_add_u32 v220, s55, v220
    v_add_u32 v221, s55, v221
    ds_read_b128 v[128:131], v216 offset:0
    s_waitcnt lgkmcnt(7)
    v_mfma_f32_16x16x32_bf16 v[12:15], v[176:179], v[156:159], v[12:15]
    ds_read_b64_tr_b16 v[160:161], v218 offset:0
    s_waitcnt lgkmcnt(6)
    v_mfma_f32_16x16x32_bf16 v[16:19], v[180:183], v[144:147], v[16:19]
    ds_read_b64_tr_b16 v[162:163], v218 offset:2048
    v_mfma_f32_16x16x32_bf16 v[20:23], v[180:183], v[148:151], v[20:23]
    ds_read_b128 v[132:135], v216 offset:2048
    v_mfma_f32_16x16x32_bf16 v[24:27], v[180:183], v[152:155], v[24:27]
    ds_read_b128 v[136:139], v216 offset:4096
    v_mfma_f32_16x16x32_bf16 v[28:31], v[180:183], v[156:159], v[28:31]
    ds_read_b128 v[140:143], v216 offset:6144
    s_waitcnt lgkmcnt(8)
    v_mfma_f32_16x16x32_bf16 v[32:35], v[184:187], v[144:147], v[32:35]
    ds_read_b64_tr_b16 v[164:165], v219 offset:0
    v_mfma_f32_16x16x32_bf16 v[36:39], v[184:187], v[148:151], v[36:39]
    ds_read_b64_tr_b16 v[166:167], v219 offset:2048
    v_mfma_f32_16x16x32_bf16 v[40:43], v[184:187], v[152:155], v[40:43]
    ds_read_b64_tr_b16 v[168:169], v220 offset:0
    v_mfma_f32_16x16x32_bf16 v[44:47], v[184:187], v[156:159], v[44:47]
    ds_read_b64_tr_b16 v[170:171], v220 offset:2048
    s_waitcnt lgkmcnt(10)
    v_mfma_f32_16x16x32_bf16 v[48:51], v[188:191], v[144:147], v[48:51]
    ds_read_b64_tr_b16 v[172:173], v221 offset:0
    v_mfma_f32_16x16x32_bf16 v[52:55], v[188:191], v[148:151], v[52:55]
    ds_read_b64_tr_b16 v[174:175], v221 offset:2048
    v_mfma_f32_16x16x32_bf16 v[56:59], v[188:191], v[152:155], v[56:59]
    v_mfma_f32_16x16x32_bf16 v[60:63], v[188:191], v[156:159], v[60:63]
    s_waitcnt lgkmcnt(9)
    v_mfma_f32_16x16x32_bf16 v[0:3], v[160:163], v[128:131], v[0:3]
    s_waitcnt lgkmcnt(8)
    v_mfma_f32_16x16x32_bf16 v[4:7], v[160:163], v[132:135], v[4:7]
    s_waitcnt lgkmcnt(7)
    v_mfma_f32_16x16x32_bf16 v[8:11], v[160:163], v[136:139], v[8:11]
    s_barrier
    s_add_u32 s54, s4, 32768
    s_cmp_eq_u32 s54, 163840
    s_cselect_b32 s54, 0, s54
    s_sub_u32 s55, s54, s4
    s_mov_b32 s4, s54
    v_add_u32 v216, s55, v216
    v_add_u32 v218, s55, v218
    v_add_u32 v219, s55, v219
    v_add_u32 v220, s55, v220
    v_add_u32 v221, s55, v221
    ds_read_b128 v[144:147], v216 offset:0
    s_waitcnt lgkmcnt(7)
    v_mfma_f32_16x16x32_bf16 v[12:15], v[160:163], v[140:143], v[12:15]
    ds_read_b64_tr_b16 v[176:177], v218 offset:0
    s_waitcnt lgkmcnt(6)
    v_mfma_f32_16x16x32_bf16 v[16:19], v[164:167], v[128:131], v[16:19]
    ds_read_b64_tr_b16 v[178:179], v218 offset:2048
    v_mfma_f32_16x16x32_bf16 v[20:23], v[164:167], v[132:135], v[20:23]
    ds_read_b128 v[148:151], v216 offset:2048
    v_mfma_f32_16x16x32_bf16 v[24:27], v[164:167], v[136:139], v[24:27]
    ds_read_b128 v[152:155], v216 offset:4096
    v_mfma_f32_16x16x32_bf16 v[28:31], v[164:167], v[140:143], v[28:31]
    ds_read_b128 v[156:159], v216 offset:6144
    s_waitcnt lgkmcnt(8)
    v_mfma_f32_16x16x32_bf16 v[32:35], v[168:171], v[128:131], v[32:35]
    ds_read_b64_tr_b16 v[180:181], v219 offset:0
    v_mfma_f32_16x16x32_bf16 v[36:39], v[168:171], v[132:135], v[36:39]
    ds_read_b64_tr_b16 v[182:183], v219 offset:2048
    v_mfma_f32_16x16x32_bf16 v[40:43], v[168:171], v[136:139], v[40:43]
    ds_read_b64_tr_b16 v[184:185], v220 offset:0
    v_mfma_f32_16x16x32_bf16 v[44:47], v[168:171], v[140:143], v[44:47]
    ds_read_b64_tr_b16 v[186:187], v220 offset:2048
    s_waitcnt lgkmcnt(10)
    v_mfma_f32_16x16x32_bf16 v[48:51], v[172:175], v[128:131], v[48:51]
    ds_read_b64_tr_b16 v[188:189], v221 offset:0
    v_mfma_f32_16x16x32_bf16 v[52:55], v[172:175], v[132:135], v[52:55]
    ds_read_b64_tr_b16 v[190:191], v221 offset:2048
    v_mfma_f32_16x16x32_bf16 v[56:59], v[172:175], v[136:139], v[56:59]
    v_mfma_f32_16x16x32_bf16 v[60:63], v[172:175], v[140:143], v[60:63]
    s_waitcnt lgkmcnt(9)
    v_mfma_f32_16x16x32_bf16 v[0:3], v[176:179], v[144:147], v[0:3]
    s_waitcnt lgkmcnt(8)
    v_mfma_f32_16x16x32_bf16 v[4:7], v[176:179], v[148:151], v[4:7]
    s_waitcnt lgkmcnt(7)
    v_mfma_f32_16x16x32_bf16 v[8:11], v[176:179], v[152:155], v[8:11]
    s_barrier
    s_add_u32 s54, s4, 32768
    s_cmp_eq_u32 s54, 163840
    s_cselect_b32 s54, 0, s54
    s_sub_u32 s55, s54, s4
    s_mov_b32 s4, s54
    v_add_u32 v216, s55, v216
    v_add_u32 v218, s55, v218
    v_add_u32 v219, s55, v219
    v_add_u32 v220, s55, v220
    v_add_u32 v221, s55, v221
    ds_read_b128 v[128:131], v216 offset:0
    s_waitcnt lgkmcnt(7)
    v_mfma_f32_16x16x32_bf16 v[12:15], v[176:179], v[156:159], v[12:15]
    ds_read_b64_tr_b16 v[160:161], v218 offset:0
    s_waitcnt lgkmcnt(6)
    v_mfma_f32_16x16x32_bf16 v[16:19], v[180:183], v[144:147], v[16:19]
    ds_read_b64_tr_b16 v[162:163], v218 offset:2048
    v_mfma_f32_16x16x32_bf16 v[20:23], v[180:183], v[148:151], v[20:23]
    ds_read_b128 v[132:135], v216 offset:2048
    v_mfma_f32_16x16x32_bf16 v[24:27], v[180:183], v[152:155], v[24:27]
    ds_read_b128 v[136:139], v216 offset:4096
    v_mfma_f32_16x16x32_bf16 v[28:31], v[180:183], v[156:159], v[28:31]
    ds_read_b128 v[140:143], v216 offset:6144
    s_waitcnt lgkmcnt(8)
    v_mfma_f32_16x16x32_bf16 v[32:35], v[184:187], v[144:147], v[32:35]
    ds_read_b64_tr_b16 v[164:165], v219 offset:0
    v_mfma_f32_16x16x32_bf16 v[36:39], v[184:187], v[148:151], v[36:39]
    ds_read_b64_tr_b16 v[166:167], v219 offset:2048
    v_mfma_f32_16x16x32_bf16 v[40:43], v[184:187], v[152:155], v[40:43]
    ds_read_b64_tr_b16 v[168:169], v220 offset:0
    v_mfma_f32_16x16x32_bf16 v[44:47], v[184:187], v[156:159], v[44:47]
    ds_read_b64_tr_b16 v[170:171], v220 offset:2048
    s_waitcnt lgkmcnt(10)
    v_mfma_f32_16x16x32_bf16 v[48:51], v[188:191], v[144:147], v[48:51]
    ds_read_b64_tr_b16 v[172:173], v221 offset:0
    v_mfma_f32_16x16x32_bf16 v[52:55], v[188:191], v[148:151], v[52:55]
    ds_read_b64_tr_b16 v[174:175], v221 offset:2048
    v_mfma_f32_16x16x32_bf16 v[56:59], v[188:191], v[152:155], v[56:59]
    v_mfma_f32_16x16x32_bf16 v[60:63], v[188:191], v[156:159], v[60:63]
    s_waitcnt lgkmcnt(9)
    v_mfma_f32_16x16x32_bf16 v[0:3], v[160:163], v[128:131], v[0:3]
    s_waitcnt lgkmcnt(8)
    v_mfma_f32_16x16x32_bf16 v[4:7], v[160:163], v[132:135], v[4:7]
    s_waitcnt lgkmcnt(7)
    v_mfma_f32_16x16x32_bf16 v[8:11], v[160:163], v[136:139], v[8:11]
    s_barrier
    s_add_u32 s54, s4, 32768
    s_cmp_eq_u32 s54, 163840
    s_cselect_b32 s54, 0, s54
    s_sub_u32 s55, s54, s4
    s_mov_b32 s4, s54
    v_add_u32 v216, s55, v216
    v_add_u32 v218, s55, v218
    v_add_u32 v219, s55, v219
    v_add_u32 v220, s55, v220
    v_add_u32 v221, s55, v221
    ds_read_b128 v[144:147], v216 offset:0
    s_waitcnt lgkmcnt(7)
    v_mfma_f32_16x16x32_bf16 v[12:15], v[160:163], v[140:143], v[12:15]
    ds_read_b64_tr_b16 v[176:177], v218 offset:0
    s_waitcnt lgkmcnt(6)
    v_mfma_f32_16x16x32_bf16 v[16:19], v[164:167], v[128:131], v[16:19]
    ds_read_b64_tr_b16 v[178:179], v218 offset:2048
    v_mfma_f32_16x16x32_bf16 v[20:23], v[164:167], v[132:135], v[20:23]
    ds_read_b128 v[148:151], v216 offset:2048
    v_mfma_f32_16x16x32_bf16 v[24:27], v[164:167], v[136:139], v[24:27]
    ds_read_b128 v[152:155], v216 offset:4096
    v_mfma_f32_16x16x32_bf16 v[28:31], v[164:167], v[140:143], v[28:31]
    ds_read_b128 v[156:159], v216 offset:6144
    s_waitcnt lgkmcnt(8)
    v_mfma_f32_16x16x32_bf16 v[32:35], v[168:171], v[128:131], v[32:35]
    ds_read_b64_tr_b16 v[180:181], v219 offset:0
    v_mfma_f32_16x16x32_bf16 v[36:39], v[168:171], v[132:135], v[36:39]
    ds_read_b64_tr_b16 v[182:183], v219 offset:2048
    v_mfma_f32_16x16x32_bf16 v[40:43], v[168:171], v[136:139], v[40:43]
    ds_read_b64_tr_b16 v[184:185], v220 offset:0
    v_mfma_f32_16x16x32_bf16 v[44:47], v[168:171], v[140:143], v[44:47]
    ds_read_b64_tr_b16 v[186:187], v220 offset:2048
    s_waitcnt lgkmcnt(10)
    v_mfma_f32_16x16x32_bf16 v[48:51], v[172:175], v[128:131], v[48:51]
    ds_read_b64_tr_b16 v[188:189], v221 offset:0
    v_mfma_f32_16x16x32_bf16 v[52:55], v[172:175], v[132:135], v[52:55]
    ds_read_b64_tr_b16 v[190:191], v221 offset:2048
    v_mfma_f32_16x16x32_bf16 v[56:59], v[172:175], v[136:139], v[56:59]
    v_mfma_f32_16x16x32_bf16 v[60:63], v[172:175], v[140:143], v[60:63]
    s_waitcnt lgkmcnt(9)
    v_mfma_f32_16x16x32_bf16 v[0:3], v[176:179], v[144:147], v[0:3]
    s_waitcnt lgkmcnt(8)
    v_mfma_f32_16x16x32_bf16 v[4:7], v[176:179], v[148:151], v[4:7]
    s_waitcnt lgkmcnt(7)
    v_mfma_f32_16x16x32_bf16 v[8:11], v[176:179], v[152:155], v[8:11]
    s_waitcnt lgkmcnt(6)
    v_mfma_f32_16x16x32_bf16 v[12:15], v[176:179], v[156:159], v[12:15]
    s_waitcnt lgkmcnt(4)
    v_mfma_f32_16x16x32_bf16 v[16:19], v[180:183], v[144:147], v[16:19]
    v_mfma_f32_16x16x32_bf16 v[20:23], v[180:183], v[148:151], v[20:23]
    v_mfma_f32_16x16x32_bf16 v[24:27], v[180:183], v[152:155], v[24:27]
    v_mfma_f32_16x16x32_bf16 v[28:31], v[180:183], v[156:159], v[28:31]
    s_waitcnt lgkmcnt(2)
    v_mfma_f32_16x16x32_bf16 v[32:35], v[184:187], v[144:147], v[32:35]
    v_mfma_f32_16x16x32_bf16 v[36:39], v[184:187], v[148:151], v[36:39]
    v_mfma_f32_16x16x32_bf16 v[40:43], v[184:187], v[152:155], v[40:43]
    v_mfma_f32_16x16x32_bf16 v[44:47], v[184:187], v[156:159], v[44:47]
    s_waitcnt lgkmcnt(0)
    v_mfma_f32_16x16x32_bf16 v[48:51], v[188:191], v[144:147], v[48:51]
    v_mfma_f32_16x16x32_bf16 v[52:55], v[188:191], v[148:151], v[52:55]
    v_mfma_f32_16x16x32_bf16 v[56:59], v[188:191], v[152:155], v[56:59]
    v_mfma_f32_16x16x32_bf16 v[60:63], v[188:191], v[156:159], v[60:63]
    s_barrier
    s_lshl_b32 s54, s50, 13
    v_add_u32 v226, s54, v254
    s_xor_b32 s54, s54, 32768
    v_add_u32 v227, s54, v254
    ds_write_b128 v226, v[0:3] offset:0
    ds_write_b128 v226, v[4:7] offset:1024
    ds_write_b128 v226, v[8:11] offset:2048
    ds_write_b128 v226, v[12:15] offset:3072
    ds_write_b128 v226, v[16:19] offset:4096
    ds_write_b128 v226, v[20:23] offset:5120
    ds_write_b128 v226, v[24:27] offset:6144
    ds_write_b128 v226, v[28:31] offset:7168
    s_waitcnt lgkmcnt(0)
    s_barrier
    ds_read_b128 v[128:131], v227 offset:0
    ds_read_b128 v[132:135], v227 offset:1024
    ds_read_b128 v[136:139], v227 offset:2048
    ds_read_b128 v[140:143], v227 offset:3072
    ds_read_b128 v[144:147], v227 offset:4096
    ds_read_b128 v[148:151], v227 offset:5120
    ds_read_b128 v[152:155], v227 offset:6144
    ds_read_b128 v[156:159], v227 offset:7168
    s_lshl_b32 s54, s101, 18
    s_lshl_b32 s55, s15, 14
    s_add_u32 s54, s54, s59
    s_add_u32 s54, s54, 67108864
    s_lshl_b32 s56, s15, 16
    s_add_u32 s56, s56, s54
    s_add_u32 s54, s54, s55
    v_mov_b32 v228, 0xff
    v_and_b32 v229, 0xff, v251
    s_waitcnt lgkmcnt(7)
    v_add_f32 v128, v128, v32
    v_add_f32 v129, v129, v33
    v_add_f32 v130, v130, v34
    v_add_f32 v131, v131, v35
    s_waitcnt lgkmcnt(6)
    v_add_f32 v132, v132, v36
    v_add_f32 v133, v133, v37
    v_add_f32 v134, v134, v38
    v_add_f32 v135, v135, v39
    s_waitcnt lgkmcnt(5)
    v_add_f32 v136, v136, v40
    v_add_f32 v137, v137, v41
    v_add_f32 v138, v138, v42
    v_add_f32 v139, v139, v43
    s_waitcnt lgkmcnt(4)
    v_add_f32 v140, v140, v44
    v_add_f32 v141, v141, v45
    v_add_f32 v142, v142, v46
    v_add_f32 v143, v143, v47
    s_waitcnt lgkmcnt(3)
    v_add_f32 v144, v144, v48
    v_add_f32 v145, v145, v49
    v_add_f32 v146, v146, v50
    v_add_f32 v147, v147, v51
    s_waitcnt lgkmcnt(2)
    v_add_f32 v148, v148, v52
    v_add_f32 v149, v149, v53
    v_add_f32 v150, v150, v54
    v_add_f32 v151, v151, v55
    s_waitcnt lgkmcnt(1)
    v_add_f32 v152, v152, v56
    v_add_f32 v153, v153, v57
    v_add_f32 v154, v154, v58
    v_add_f32 v155, v155, v59
    s_waitcnt lgkmcnt(0)
    v_add_f32 v156, v156, v60
    v_add_f32 v157, v157, v61
    v_add_f32 v158, v158, v62
    v_add_f32 v159, v159, v63
    s_branch P4_fin
H_E2:
    ds_read_b128 v[184:187], v252 offset:16384
    ds_read_b128 v[188:191], v252 offset:17408
    ds_read_b128 v[160:163], v252 offset:18432
    ds_read_b128 v[164:167], v252 offset:19456
    ds_read_b128 v[168:171], v252 offset:20480
    ds_read_b128 v[172:175], v252 offset:21504
    s_waitcnt lgkmcnt(4)
    v_mfma_f32_32x32x16_bf16 v[64:79], v[184:187], v[48:51], v[64:79]
    ds_read_b128 v[176:179], v252 offset:22528
    v_mov_b32 v207, 0xff800000
    v_cmp_le_i32 vcc, 0, v212
    s_nop 1
    v_cndmask_b32 v16, v207, v16, vcc
    v_cmp_le_i32 vcc, 1, v212
    s_nop 1
    v_cndmask_b32 v17, v207, v17, vcc
    v_cmp_le_i32 vcc, 2, v212
    s_nop 1
    v_cndmask_b32 v18, v207, v18, vcc
    v_cmp_le_i32 vcc, 3, v212
    s_nop 1
    v_cndmask_b32 v19, v207, v19, vcc
    v_cmp_le_i32 vcc, 8, v212
    s_nop 1
    v_cndmask_b32 v20, v207, v20, vcc
    v_mfma_f32_32x32x16_bf16 v[80:95], v[188:191], v[48:51], v[80:95]
    ds_read_b128 v[180:183], v252 offset:23552
    v_cmp_le_i32 vcc, 9, v212
    s_nop 1
    v_cndmask_b32 v21, v207, v21, vcc
    v_cmp_le_i32 vcc, 10, v212
    s_nop 1
    v_cndmask_b32 v22, v207, v22, vcc
    v_cmp_le_i32 vcc, 11, v212
    s_nop 1
    v_cndmask_b32 v23, v207, v23, vcc
    v_cmp_le_i32 vcc, 16, v212
    s_nop 1
    v_cndmask_b32 v24, v207, v24, vcc
    v_cmp_le_i32 vcc, 17, v212
    s_nop 1
    v_cndmask_b32 v25, v207, v25, vcc
    v_cmp_le_i32 vcc, 18, v212
    s_waitcnt lgkmcnt(4)
    v_mfma_f32_32x32x16_bf16 v[96:111], v[160:163], v[48:51], v[96:111]
    ds_read_b128 v[184:187], v252 offset:24576
    v_cndmask_b32 v26, v207, v26, vcc
    v_cmp_le_i32 vcc, 19, v212
    s_nop 1
    v_cndmask_b32 v27, v207, v27, vcc
    v_cmp_le_i32 vcc, 24, v212
    s_nop 1
    v_cndmask_b32 v28, v207, v28, vcc
    v_cmp_le_i32 vcc, 25, v212
    s_nop 1
    v_cndmask_b32 v29, v207, v29, vcc
    v_cmp_le_i32 vcc, 26, v212
    s_nop 1
    v_cndmask_b32 v30, v207, v30, vcc
    v_cmp_le_i32 vcc, 27, v212
    s_nop 1
    v_cndmask_b32 v31, v207, v31, vcc
    v_mfma_f32_32x32x16_bf16 v[112:127], v[164:167], v[48:51], v[112:127]
    ds_read_b128 v[188:191], v252 offset:25600
    v_exp_f32 v192, v16
    v_exp_f32 v193, v17
    v_exp_f32 v194, v18
    v_exp_f32 v195, v19
    v_cvt_pk_bf16_f32 v56, v192, v193
    v_exp_f32 v196, v20
    v_add_f32 v242, v192, v194
    s_waitcnt lgkmcnt(4)
    v_mfma_f32_32x32x16_bf16 v[64:79], v[168:171], v[52:55], v[64:79]
    ds_read_b128 v[160:163], v252 offset:26624
    v_exp_f32 v197, v21
    v_add_f32 v243, v193, v195
    v_cvt_pk_bf16_f32 v57, v194, v195
    v_exp_f32 v198, v22
    v_add_f32 v242, v242, v196
    v_exp_f32 v199, v23
    v_add_f32 v243, v243, v197
    v_cvt_pk_bf16_f32 v60, v196, v197
    v_mfma_f32_32x32x16_bf16 v[80:95], v[172:175], v[52:55], v[80:95]
    ds_read_b128 v[164:167], v252 offset:27648
    v_exp_f32 v192, v24
    v_add_f32 v242, v242, v198
    v_exp_f32 v193, v25
    v_add_f32 v243, v243, v199
    v_cvt_pk_bf16_f32 v61, v198, v199
    v_exp_f32 v194, v26
    v_add_f32 v242, v242, v192
    s_waitcnt lgkmcnt(4)
    v_mfma_f32_32x32x16_bf16 v[96:111], v[176:179], v[52:55], v[96:111]
    ds_read_b128 v[168:171], v252 offset:28672
    v_exp_f32 v195, v27
    v_add_f32 v243, v243, v193
    v_cvt_pk_bf16_f32 v58, v192, v193
    v_exp_f32 v196, v28
    v_add_f32 v242, v242, v194
    v_exp_f32 v197, v29
    v_add_f32 v243, v243, v195
    v_cvt_pk_bf16_f32 v59, v194, v195
    v_mfma_f32_32x32x16_bf16 v[112:127], v[180:183], v[52:55], v[112:127]
    ds_read_b128 v[172:175], v252 offset:29696
    v_exp_f32 v198, v30
    v_add_f32 v242, v242, v196
    v_exp_f32 v199, v31
    v_add_f32 v243, v243, v197
    v_cvt_pk_bf16_f32 v62, v196, v197
    v_add_f32 v242, v242, v198
    v_add_f32 v243, v243, v199
    v_cvt_pk_bf16_f32 v63, v198, v199
    v_add_f32 v242, v242, v243
    v_cmp_lt_f32 vcc, s10, v242
    s_cbranch_vccnz H_E2_slow0
H_E2_ret0:
    v_add_f32 v240, v240, v242
    s_waitcnt lgkmcnt(4)
    v_mfma_f32_32x32x16_bf16 v[64:79], v[184:187], v[56:59], v[64:79]
    ds_read_b128 v[176:179], v252 offset:30720
    v_mfma_f32_32x32x16_bf16 v[80:95], v[188:191], v[56:59], v[80:95]
    ds_read_b128 v[180:183], v252 offset:31744
    s_waitcnt lgkmcnt(4)
    v_mfma_f32_32x32x16_bf16 v[96:111], v[160:163], v[56:59], v[96:111]
    v_mfma_f32_32x32x16_bf16 v[112:127], v[164:167], v[56:59], v[112:127]
    s_waitcnt lgkmcnt(2)
    v_mfma_f32_32x32x16_bf16 v[64:79], v[168:171], v[60:63], v[64:79]
    v_mfma_f32_32x32x16_bf16 v[80:95], v[172:175], v[60:63], v[80:95]
    s_waitcnt lgkmcnt(0)
    v_mfma_f32_32x32x16_bf16 v[96:111], v[176:179], v[60:63], v[96:111]
    v_mfma_f32_32x32x16_bf16 v[112:127], v[180:183], v[60:63], v[112:127]
    s_branch H_epi
H_F0d:
    s_waitcnt lgkmcnt(4)
    v_mfma_f32_32x32x16_bf16 v[0:15], v[160:163], v[128:131], v[32:47]
    ds_read_b128 v[184:187], v252 offset:6144
    v_mfma_f32_32x32x16_bf16 v[0:15], v[164:167], v[132:135], v[0:15]
    ds_read_b128 v[188:191], v252 offset:7168
    s_waitcnt lgkmcnt(4)
    v_mfma_f32_32x32x16_bf16 v[0:15], v[168:171], v[136:139], v[0:15]
    s_barrier
    s_add_u32 s4, s4, 32768
    s_cmp_eq_u32 s4, 163840
    s_cselect_b32 s4, 0, s4
    v_add_u32 v252, s4, v254
    ds_read_b128 v[160:163], v252 offset:0
    v_mfma_f32_32x32x16_bf16 v[0:15], v[172:175], v[140:143], v[0:15]
    ds_read_b128 v[164:167], v252 offset:16384
    s_waitcnt lgkmcnt(4)
    v_mfma_f32_32x32x16_bf16 v[0:15], v[176:179], v[144:147], v[0:15]
    ds_read_b128 v[168:171], v252 offset:1024
    v_mfma_f32_32x32x16_bf16 v[0:15], v[180:183], v[148:151], v[0:15]
    ds_read_b128 v[172:175], v252 offset:17408
    s_waitcnt lgkmcnt(4)
    v_mfma_f32_32x32x16_bf16 v[0:15], v[184:187], v[152:155], v[0:15]
    ds_read_b128 v[176:179], v252 offset:2048
    v_mfma_f32_32x32x16_bf16 v[0:15], v[188:191], v[156:159], v[0:15]
    ds_read_b128 v[180:183], v252 offset:18432
    s_nop 7
    s_nop 3
    v_mov_b32 v207, 0xff800000
    v_cmp_le_i32 vcc, 0, v212
    s_nop 1
    v_cndmask_b32 v0, v207, v0, vcc
    v_cmp_le_i32 vcc, 1, v212
    s_nop 1
    v_cndmask_b32 v1, v207, v1, vcc
    v_cmp_le_i32 vcc, 2, v212
    s_nop 1
    v_cndmask_b32 v2, v207, v2, vcc
    v_cmp_le_i32 vcc, 3, v212
    s_nop 1
    v_cndmask_b32 v3, v207, v3, vcc
    v_cmp_le_i32 vcc, 8, v212
    s_nop 1
    v_cndmask_b32 v4, v207, v4, vcc
    v_cmp_le_i32 vcc, 9, v212
    s_nop 1
    v_cndmask_b32 v5, v207, v5, vcc
    v_cmp_le_i32 vcc, 10, v212
    s_nop 1
    v_cndmask_b32 v6, v207, v6, vcc
    v_cmp_le_i32 vcc, 11, v212
    s_nop 1
    v_cndmask_b32 v7, v207, v7, vcc
    v_cmp_le_i32 vcc, 16, v212
    s_nop 1
    v_cndmask_b32 v8, v207, v8, vcc
    v_cmp_le_i32 vcc, 17, v212
    s_nop 1
    v_cndmask_b32 v9, v207, v9, vcc
    v_cmp_le_i32 vcc, 18, v212
    s_nop 1
    v_cndmask_b32 v10, v207, v10, vcc
    v_cmp_le_i32 vcc, 19, v212
    s_nop 1
    v_cndmask_b32 v11, v207, v11, vcc
    v_cmp_le_i32 vcc, 24, v212
    s_nop 1
    v_cndmask_b32 v12, v207, v12, vcc
    v_cmp_le_i32 vcc, 25, v212
    s_nop 1
    v_cndmask_b32 v13, v207, v13, vcc
    v_cmp_le_i32 vcc, 26, v212
    s_nop 1
    v_cndmask_b32 v14, v207, v14, vcc
    v_cmp_le_i32 vcc, 27, v212
    s_nop 1
    v_cndmask_b32 v15, v207, v15, vcc
    v_max3_f32 v200, v0, v1, v2
    v_max3_f32 v200, v200, v3, v4
    v_max3_f32 v200, v200, v5, v6
    v_max3_f32 v200, v200, v7, v8
    v_max3_f32 v200, v200, v9, v10
    v_max3_f32 v200, v200, v11, v12
    v_max3_f32 v200, v200, v13, v14
    v_max_f32 v200, v200, v15
    v_mov_b32 v201, v200
    s_nop 1
    v_permlane32_swap_b32 v200, v201
    v_max_f32 v200, v200, v201
    v_sub_f32 v32, 0, v200
    v_sub_f32 v33, 0, v200
    v_sub_f32 v34, 0, v200
    v_sub_f32 v35, 0, v200
    v_sub_f32 v36, 0, v200
    v_sub_f32 v37, 0, v200
    v_sub_f32 v38, 0, v200
    v_sub_f32 v39, 0, v200
    v_sub_f32 v40, 0, v200
    v_sub_f32 v41, 0, v200
    v_sub_f32 v42, 0, v200
    v_sub_f32 v43, 0, v200
    v_sub_f32 v44, 0, v200
    v_sub_f32 v45, 0, v200
    v_sub_f32 v46, 0, v200
    v_sub_f32 v47, 0, v200
    v_sub_f32 v0, v0, v200
    v_sub_f32 v1, v1, v200
    v_sub_f32 v2, v2, v200
    v_sub_f32 v3, v3, v200
    v_sub_f32 v4, v4, v200
    v_sub_f32 v5, v5, v200
    v_sub_f32 v6, v6, v200
    v_sub_f32 v7, v7, v200
    v_sub_f32 v8, v8, v200
    v_sub_f32 v9, v9, v200
    v_sub_f32 v10, v10, v200
    v_sub_f32 v11, v11, v200
    v_sub_f32 v12, v12, v200
    v_sub_f32 v13, v13, v200
    v_sub_f32 v14, v14, v200
    v_sub_f32 v15, v15, v200
    v_exp_f32 v192, v0
    v_exp_f32 v193, v1
    v_exp_f32 v194, v2
    v_exp_f32 v195, v3
    v_cvt_pk_bf16_f32 v48, v192, v193
    v_exp_f32 v196, v4
    v_add_f32 v242, v192, v194
    v_exp_f32 v197, v5
    v_add_f32 v243, v193, v195
    v_cvt_pk_bf16_f32 v49, v194, v195
    v_exp_f32 v198, v6
    v_add_f32 v242, v242, v196
    v_exp_f32 v199, v7
    v_add_f32 v243, v243, v197
    v_cvt_pk_bf16_f32 v52, v196, v197
    v_exp_f32 v192, v8
    v_add_f32 v242, v242, v198
    v_exp_f32 v193, v9
    v_add_f32 v243, v243, v199
    v_cvt_pk_bf16_f32 v53, v198, v199
    v_exp_f32 v194, v10
    v_add_f32 v242, v242, v192
    v_exp_f32 v195, v11
    v_add_f32 v243, v243, v193
    v_cvt_pk_bf16_f32 v50, v192, v193
    v_exp_f32 v196, v12
    v_add_f32 v242, v242, v194
    v_exp_f32 v197, v13
    v_add_f32 v243, v243, v195
    v_cvt_pk_bf16_f32 v51, v194, v195
    v_exp_f32 v198, v14
    v_add_f32 v242, v242, v196
    v_exp_f32 v199, v15
    v_add_f32 v243, v243, v197
    v_cvt_pk_bf16_f32 v54, v196, v197
    v_add_f32 v242, v242, v198
    v_add_f32 v243, v243, v199
    v_cvt_pk_bf16_f32 v55, v198, v199
    v_add_f32 v242, v242, v243
    v_mov_b32 v240, v242
    s_waitcnt vmcnt(0)
    s_lshl_b32 s54, s52, 5
    s_add_u32 s54, s54, s48
    s_lshl_b32 s54, s54, 2
    s_add_u32 s54, s54, 58753024
    s_mov_b64 exec, 1
    buffer_store_dword v251, off, s[16:19], s54 sc1
    s_mov_b64 exec, -1
    s_branch H_E3
L_FULL_slow0:
    s_nop 15
    v_max3_f32 v200, v16, v17, v18
    v_max3_f32 v200, v200, v19, v20
    v_max3_f32 v200, v200, v21, v22
    v_max3_f32 v200, v200, v23, v24
    v_max3_f32 v200, v200, v25, v26
    v_max3_f32 v200, v200, v27, v28
    v_max3_f32 v200, v200, v29, v30
    v_max_f32 v200, v200, v31
    v_mov_b32 v201, v200
    s_nop 1
    v_permlane32_swap_b32 v200, v201
    v_max_f32 v200, v200, v201
    v_max_f32 v200, 0, v200
    v_sub_f32 v202, 0, v200
    v_exp_f32 v202, v202
    v_sub_f32 v32, v32, v200
    v_sub_f32 v33, v33, v200
    v_sub_f32 v34, v34, v200
    v_sub_f32 v35, v35, v200
    v_sub_f32 v36, v36, v200
    v_sub_f32 v37, v37, v200
    v_sub_f32 v38, v38, v200
    v_sub_f32 v39, v39, v200
    v_sub_f32 v40, v40, v200
    v_sub_f32 v41, v41, v200
    v_sub_f32 v42, v42, v200
    v_sub_f32 v43, v43, v200
    v_sub_f32 v44, v44, v200
    v_sub_f32 v45, v45, v200
    v_sub_f32 v46, v46, v200
    v_sub_f32 v47, v47, v200
    v_sub_f32 v16, v16, v200
    v_sub_f32 v17, v17, v200
    v_sub_f32 v18, v18, v200
    v_sub_f32 v19, v19, v200
    v_sub_f32 v20, v20, v200
    v_sub_f32 v21, v21, v200
    v_sub_f32 v22, v22, v200
    v_sub_f32 v23, v23, v200
    v_sub_f32 v24, v24, v200
    v_sub_f32 v25, v25, v200
    v_sub_f32 v26, v26, v200
    v_sub_f32 v27, v27, v200
    v_sub_f32 v28, v28, v200
    v_sub_f32 v29, v29, v200
    v_sub_f32 v30, v30, v200
    v_sub_f32 v31, v31, v200
    v_sub_f32 v0, v0, v200
    v_sub_f32 v1, v1, v200
    v_sub_f32 v2, v2, v200
    v_sub_f32 v3, v3, v200
    v_sub_f32 v4, v4, v200
    v_sub_f32 v5, v5, v200
    v_sub_f32 v6, v6, v200
    v_sub_f32 v7, v7, v200
    v_sub_f32 v8, v8, v200
    v_sub_f32 v9, v9, v200
    v_sub_f32 v10, v10, v200
    v_sub_f32 v11, v11, v200
    v_sub_f32 v12, v12, v200
    v_sub_f32 v13, v13, v200
    v_sub_f32 v14, v14, v200
    v_sub_f32 v15, v15, v200
    v_mul_f32 v240, v240, v202
    v_mul_f32 v64, v64, v202
    v_mul_f32 v65, v65, v202
    v_mul_f32 v66, v66, v202
    v_mul_f32 v67, v67, v202
    v_mul_f32 v68, v68, v202
    v_mul_f32 v69, v69, v202
    v_mul_f32 v70, v70, v202
    v_mul_f32 v71, v71, v202
    v_mul_f32 v72, v72, v202
    v_mul_f32 v73, v73, v202
    v_mul_f32 v74, v74, v202
    v_mul_f32 v75, v75, v202
    v_mul_f32 v76, v76, v202
    v_mul_f32 v77, v77, v202
    v_mul_f32 v78, v78, v202
    v_mul_f32 v79, v79, v202
    v_mul_f32 v80, v80, v202
    v_mul_f32 v81, v81, v202
    v_mul_f32 v82, v82, v202
    v_mul_f32 v83, v83, v202
    v_mul_f32 v84, v84, v202
    v_mul_f32 v85, v85, v202
    v_mul_f32 v86, v86, v202
    v_mul_f32 v87, v87, v202
    v_mul_f32 v88, v88, v202
    v_mul_f32 v89, v89, v202
    v_mul_f32 v90, v90, v202
    v_mul_f32 v91, v91, v202
    v_mul_f32 v92, v92, v202
    v_mul_f32 v93, v93, v202
    v_mul_f32 v94, v94, v202
    v_mul_f32 v95, v95, v202
    v_mul_f32 v96, v96, v202
    v_mul_f32 v97, v97, v202
    v_mul_f32 v98, v98, v202
    v_mul_f32 v99, v99, v202
    v_mul_f32 v100, v100, v202
    v_mul_f32 v101, v101, v202
    v_mul_f32 v102, v102, v202
    v_mul_f32 v103, v103, v202
    v_mul_f32 v104, v104, v202
    v_mul_f32 v105, v105, v202
    v_mul_f32 v106, v106, v202
    v_mul_f32 v107, v107, v202
    v_mul_f32 v108, v108, v202
    v_mul_f32 v109, v109, v202
    v_mul_f32 v110, v110, v202
    v_mul_f32 v111, v111, v202
    v_mul_f32 v112, v112, v202
    v_mul_f32 v113, v113, v202
    v_mul_f32 v114, v114, v202
    v_mul_f32 v115, v115, v202
    v_mul_f32 v116, v116, v202
    v_mul_f32 v117, v117, v202
    v_mul_f32 v118, v118, v202
    v_mul_f32 v119, v119, v202
    v_mul_f32 v120, v120, v202
    v_mul_f32 v121, v121, v202
    v_mul_f32 v122, v122, v202
    v_mul_f32 v123, v123, v202
    v_mul_f32 v124, v124, v202
    v_mul_f32 v125, v125, v202
    v_mul_f32 v126, v126, v202
    v_mul_f32 v127, v127, v202
    v_exp_f32 v192, v16
    v_exp_f32 v193, v17
    v_exp_f32 v194, v18
    v_exp_f32 v195, v19
    v_cvt_pk_bf16_f32 v56, v192, v193
    v_exp_f32 v196, v20
    v_add_f32 v242, v192, v194
    v_exp_f32 v197, v21
    v_add_f32 v243, v193, v195
    v_cvt_pk_bf16_f32 v57, v194, v195
    v_exp_f32 v198, v22
    v_add_f32 v242, v242, v196
    v_exp_f32 v199, v23
    v_add_f32 v243, v243, v197
    v_cvt_pk_bf16_f32 v60, v196, v197
    v_exp_f32 v192, v24
    v_add_f32 v242, v242, v198
    v_exp_f32 v193, v25
    v_add_f32 v243, v243, v199
    v_cvt_pk_bf16_f32 v61, v198, v199
    v_exp_f32 v194, v26
    v_add_f32 v242, v242, v192
    v_exp_f32 v195, v27
    v_add_f32 v243, v243, v193
    v_cvt_pk_bf16_f32 v58, v192, v193
    v_exp_f32 v196, v28
    v_add_f32 v242, v242, v194
    v_exp_f32 v197, v29
    v_add_f32 v243, v243, v195
    v_cvt_pk_bf16_f32 v59, v194, v195
    v_exp_f32 v198, v30
    v_add_f32 v242, v242, v196
    v_exp_f32 v199, v31
    v_add_f32 v243, v243, v197
    v_cvt_pk_bf16_f32 v62, v196, v197
    v_add_f32 v242, v242, v198
    v_add_f32 v243, v243, v199
    v_cvt_pk_bf16_f32 v63, v198, v199
    v_add_f32 v242, v242, v243
    s_nop 3
    s_branch L_FULL_ret0
L_FULL_slow1:
    s_nop 15
    v_max3_f32 v200, v0, v1, v2
    v_max3_f32 v200, v200, v3, v4
    v_max3_f32 v200, v200, v5, v6
    v_max3_f32 v200, v200, v7, v8
    v_max3_f32 v200, v200, v9, v10
    v_max3_f32 v200, v200, v11, v12
    v_max3_f32 v200, v200, v13, v14
    v_max_f32 v200, v200, v15
    v_mov_b32 v201, v200
    s_nop 1
    v_permlane32_swap_b32 v200, v201
    v_max_f32 v200, v200, v201
    v_max_f32 v200, 0, v200
    v_sub_f32 v202, 0, v200
    v_exp_f32 v202, v202
    v_sub_f32 v32, v32, v200
    v_sub_f32 v33, v33, v200
    v_sub_f32 v34, v34, v200
    v_sub_f32 v35, v35, v200
    v_sub_f32 v36, v36, v200
    v_sub_f32 v37, v37, v200
    v_sub_f32 v38, v38, v200
    v_sub_f32 v39, v39, v200
    v_sub_f32 v40, v40, v200
    v_sub_f32 v41, v41, v200
    v_sub_f32 v42, v42, v200
    v_sub_f32 v43, v43, v200
    v_sub_f32 v44, v44, v200
    v_sub_f32 v45, v45, v200
    v_sub_f32 v46, v46, v200
    v_sub_f32 v47, v47, v200
    v_sub_f32 v0, v0, v200
    v_sub_f32 v1, v1, v200
    v_sub_f32 v2, v2, v200
    v_sub_f32 v3, v3, v200
    v_sub_f32 v4, v4, v200
    v_sub_f32 v5, v5, v200
    v_sub_f32 v6, v6, v200
    v_sub_f32 v7, v7, v200
    v_sub_f32 v8, v8, v200
    v_sub_f32 v9, v9, v200
    v_sub_f32 v10, v10, v200
    v_sub_f32 v11, v11, v200
    v_sub_f32 v12, v12, v200
    v_sub_f32 v13, v13, v200
    v_sub_f32 v14, v14, v200
    v_sub_f32 v15, v15, v200
    v_sub_f32 v16, v16, v200
    v_sub_f32 v17, v17, v200
    v_sub_f32 v18, v18, v200
    v_sub_f32 v19, v19, v200
    v_sub_f32 v20, v20, v200
    v_sub_f32 v21, v21, v200
    v_sub_f32 v22, v22, v200
    v_sub_f32 v23, v23, v200
    v_sub_f32 v24, v24, v200
    v_sub_f32 v25, v25, v200
    v_sub_f32 v26, v26, v200
    v_sub_f32 v27, v27, v200
    v_sub_f32 v28, v28, v200
    v_sub_f32 v29, v29, v200
    v_sub_f32 v30, v30, v200
    v_sub_f32 v31, v31, v200
    v_mul_f32 v240, v240, v202
    v_mul_f32 v64, v64, v202
    v_mul_f32 v65, v65, v202
    v_mul_f32 v66, v66, v202
    v_mul_f32 v67, v67, v202
    v_mul_f32 v68, v68, v202
    v_mul_f32 v69, v69, v202
    v_mul_f32 v70, v70, v202
    v_mul_f32 v71, v71, v202
    v_mul_f32 v72, v72, v202
    v_mul_f32 v73, v73, v202
    v_mul_f32 v74, v74, v202
    v_mul_f32 v75, v75, v202
    v_mul_f32 v76, v76, v202
    v_mul_f32 v77, v77, v202
    v_mul_f32 v78, v78, v202
    v_mul_f32 v79, v79, v202
    v_mul_f32 v80, v80, v202
    v_mul_f32 v81, v81, v202
    v_mul_f32 v82, v82, v202
    v_mul_f32 v83, v83, v202
    v_mul_f32 v84, v84, v202
    v_mul_f32 v85, v85, v202
    v_mul_f32 v86, v86, v202
    v_mul_f32 v87, v87, v202
    v_mul_f32 v88, v88, v202
    v_mul_f32 v89, v89, v202
    v_mul_f32 v90, v90, v202
    v_mul_f32 v91, v91, v202
    v_mul_f32 v92, v92, v202
    v_mul_f32 v93, v93, v202
    v_mul_f32 v94, v94, v202
    v_mul_f32 v95, v95, v202
    v_mul_f32 v96, v96, v202
    v_mul_f32 v97, v97, v202
    v_mul_f32 v98, v98, v202
    v_mul_f32 v99, v99, v202
    v_mul_f32 v100, v100, v202
    v_mul_f32 v101, v101, v202
    v_mul_f32 v102, v102, v202
    v_mul_f32 v103, v103, v202
    v_mul_f32 v104, v104, v202
    v_mul_f32 v105, v105, v202
    v_mul_f32 v106, v106, v202
    v_mul_f32 v107, v107, v202
    v_mul_f32 v108, v108, v202
    v_mul_f32 v109, v109, v202
    v_mul_f32 v110, v110, v202
    v_mul_f32 v111, v111, v202
    v_mul_f32 v112, v112, v202
    v_mul_f32 v113, v113, v202
    v_mul_f32 v114, v114, v202
    v_mul_f32 v115, v115, v202
    v_mul_f32 v116, v116, v202
    v_mul_f32 v117, v117, v202
    v_mul_f32 v118, v118, v202
    v_mul_f32 v119, v119, v202
    v_mul_f32 v120, v120, v202
    v_mul_f32 v121, v121, v202
    v_mul_f32 v122, v122, v202
    v_mul_f32 v123, v123, v202
    v_mul_f32 v124, v124, v202
    v_mul_f32 v125, v125, v202
    v_mul_f32 v126, v126, v202
    v_mul_f32 v127, v127, v202
    v_exp_f32 v192, v0
    v_exp_f32 v193, v1
    v_exp_f32 v194, v2
    v_exp_f32 v195, v3
    v_cvt_pk_bf16_f32 v48, v192, v193
    v_exp_f32 v196, v4
    v_add_f32 v242, v192, v194
    v_exp_f32 v197, v5
    v_add_f32 v243, v193, v195
    v_cvt_pk_bf16_f32 v49, v194, v195
    v_exp_f32 v198, v6
    v_add_f32 v242, v242, v196
    v_exp_f32 v199, v7
    v_add_f32 v243, v243, v197
    v_cvt_pk_bf16_f32 v52, v196, v197
    v_exp_f32 v192, v8
    v_add_f32 v242, v242, v198
    v_exp_f32 v193, v9
    v_add_f32 v243, v243, v199
    v_cvt_pk_bf16_f32 v53, v198, v199
    v_exp_f32 v194, v10
    v_add_f32 v242, v242, v192
    v_exp_f32 v195, v11
    v_add_f32 v243, v243, v193
    v_cvt_pk_bf16_f32 v50, v192, v193
    v_exp_f32 v196, v12
    v_add_f32 v242, v242, v194
    v_exp_f32 v197, v13
    v_add_f32 v243, v243, v195
    v_cvt_pk_bf16_f32 v51, v194, v195
    v_exp_f32 v198, v14
    v_add_f32 v242, v242, v196
    v_exp_f32 v199, v15
    v_add_f32 v243, v243, v197
    v_cvt_pk_bf16_f32 v54, v196, v197
    v_add_f32 v242, v242, v198
    v_add_f32 v243, v243, v199
    v_cvt_pk_bf16_f32 v55, v198, v199
    v_add_f32 v242, v242, v243
    s_nop 3
    s_branch L_FULL_ret1
L_E1_slow0:
    s_nop 15
    v_max3_f32 v200, v16, v17, v18
    v_max3_f32 v200, v200, v19, v20
    v_max3_f32 v200, v200, v21, v22
    v_max3_f32 v200, v200, v23, v24
    v_max3_f32 v200, v200, v25, v26
    v_max3_f32 v200, v200, v27, v28
    v_max3_f32 v200, v200, v29, v30
    v_max_f32 v200, v200, v31
    v_mov_b32 v201, v200
    s_nop 1
    v_permlane32_swap_b32 v200, v201
    v_max_f32 v200, v200, v201
    v_max_f32 v200, 0, v200
    v_sub_f32 v202, 0, v200
    v_exp_f32 v202, v202
    v_sub_f32 v32, v32, v200
    v_sub_f32 v33, v33, v200
    v_sub_f32 v34, v34, v200
    v_sub_f32 v35, v35, v200
    v_sub_f32 v36, v36, v200
    v_sub_f32 v37, v37, v200
    v_sub_f32 v38, v38, v200
    v_sub_f32 v39, v39, v200
    v_sub_f32 v40, v40, v200
    v_sub_f32 v41, v41, v200
    v_sub_f32 v42, v42, v200
    v_sub_f32 v43, v43, v200
    v_sub_f32 v44, v44, v200
    v_sub_f32 v45, v45, v200
    v_sub_f32 v46, v46, v200
    v_sub_f32 v47, v47, v200
    v_sub_f32 v16, v16, v200
    v_sub_f32 v17, v17, v200
    v_sub_f32 v18, v18, v200
    v_sub_f32 v19, v19, v200
    v_sub_f32 v20, v20, v200
    v_sub_f32 v21, v21, v200
    v_sub_f32 v22, v22, v200
    v_sub_f32 v23, v23, v200
    v_sub_f32 v24, v24, v200
    v_sub_f32 v25, v25, v200
    v_sub_f32 v26, v26, v200
    v_sub_f32 v27, v27, v200
    v_sub_f32 v28, v28, v200
    v_sub_f32 v29, v29, v200
    v_sub_f32 v30, v30, v200
    v_sub_f32 v31, v31, v200
    v_sub_f32 v0, v0, v200
    v_sub_f32 v1, v1, v200
    v_sub_f32 v2, v2, v200
    v_sub_f32 v3, v3, v200
    v_sub_f32 v4, v4, v200
    v_sub_f32 v5, v5, v200
    v_sub_f32 v6, v6, v200
    v_sub_f32 v7, v7, v200
    v_sub_f32 v8, v8, v200
    v_sub_f32 v9, v9, v200
    v_sub_f32 v10, v10, v200
    v_sub_f32 v11, v11, v200
    v_sub_f32 v12, v12, v200
    v_sub_f32 v13, v13, v200
    v_sub_f32 v14, v14, v200
    v_sub_f32 v15, v15, v200
    v_mul_f32 v240, v240, v202
    v_mul_f32 v64, v64, v202
    v_mul_f32 v65, v65, v202
    v_mul_f32 v66, v66, v202
    v_mul_f32 v67, v67, v202
    v_mul_f32 v68, v68, v202
    v_mul_f32 v69, v69, v202
    v_mul_f32 v70, v70, v202
    v_mul_f32 v71, v71, v202
    v_mul_f32 v72, v72, v202
    v_mul_f32 v73, v73, v202
    v_mul_f32 v74, v74, v202
    v_mul_f32 v75, v75, v202
    v_mul_f32 v76, v76, v202
    v_mul_f32 v77, v77, v202
    v_mul_f32 v78, v78, v202
    v_mul_f32 v79, v79, v202
    v_mul_f32 v80, v80, v202
    v_mul_f32 v81, v81, v202
    v_mul_f32 v82, v82, v202
    v_mul_f32 v83, v83, v202
    v_mul_f32 v84, v84, v202
    v_mul_f32 v85, v85, v202
    v_mul_f32 v86, v86, v202
    v_mul_f32 v87, v87, v202
    v_mul_f32 v88, v88, v202
    v_mul_f32 v89, v89, v202
    v_mul_f32 v90, v90, v202
    v_mul_f32 v91, v91, v202
    v_mul_f32 v92, v92, v202
    v_mul_f32 v93, v93, v202
    v_mul_f32 v94, v94, v202
    v_mul_f32 v95, v95, v202
    v_mul_f32 v96, v96, v202
    v_mul_f32 v97, v97, v202
    v_mul_f32 v98, v98, v202
    v_mul_f32 v99, v99, v202
    v_mul_f32 v100, v100, v202
    v_mul_f32 v101, v101, v202
    v_mul_f32 v102, v102, v202
    v_mul_f32 v103, v103, v202
    v_mul_f32 v104, v104, v202
    v_mul_f32 v105, v105, v202
    v_mul_f32 v106, v106, v202
    v_mul_f32 v107, v107, v202
    v_mul_f32 v108, v108, v202
    v_mul_f32 v109, v109, v202
    v_mul_f32 v110, v110, v202
    v_mul_f32 v111, v111, v202
    v_mul_f32 v112, v112, v202
    v_mul_f32 v113, v113, v202
    v_mul_f32 v114, v114, v202
    v_mul_f32 v115, v115, v202
    v_mul_f32 v116, v116, v202
    v_mul_f32 v117, v117, v202
    v_mul_f32 v118, v118, v202
    v_mul_f32 v119, v119, v202
    v_mul_f32 v120, v120, v202
    v_mul_f32 v121, v121, v202
    v_mul_f32 v122, v122, v202
    v_mul_f32 v123, v123, v202
    v_mul_f32 v124, v124, v202
    v_mul_f32 v125, v125, v202
    v_mul_f32 v126, v126, v202
    v_mul_f32 v127, v127, v202
    v_exp_f32 v192, v16
    v_exp_f32 v193, v17
    v_exp_f32 v194, v18
    v_exp_f32 v195, v19
    v_cvt_pk_bf16_f32 v56, v192, v193
    v_exp_f32 v196, v20
    v_add_f32 v242, v192, v194
    v_exp_f32 v197, v21
    v_add_f32 v243, v193, v195
    v_cvt_pk_bf16_f32 v57, v194, v195
    v_exp_f32 v198, v22
    v_add_f32 v242, v242, v196
    v_exp_f32 v199, v23
    v_add_f32 v243, v243, v197
    v_cvt_pk_bf16_f32 v60, v196, v197
    v_exp_f32 v192, v24
    v_add_f32 v242, v242, v198
    v_exp_f32 v193, v25
    v_add_f32 v243, v243, v199
    v_cvt_pk_bf16_f32 v61, v198, v199
    v_exp_f32 v194, v26
    v_add_f32 v242, v242, v192
    v_exp_f32 v195, v27
    v_add_f32 v243, v243, v193
    v_cvt_pk_bf16_f32 v58, v192, v193
    v_exp_f32 v196, v28
    v_add_f32 v242, v242, v194
    v_exp_f32 v197, v29
    v_add_f32 v243, v243, v195
    v_cvt_pk_bf16_f32 v59, v194, v195
    v_exp_f32 v198, v30
    v_add_f32 v242, v242, v196
    v_exp_f32 v199, v31
    v_add_f32 v243, v243, v197
    v_cvt_pk_bf16_f32 v62, v196, v197
    v_add_f32 v242, v242, v198
    v_add_f32 v243, v243, v199
    v_cvt_pk_bf16_f32 v63, v198, v199
    v_add_f32 v242, v242, v243
    s_nop 3
    s_branch L_E1_ret0
L_E1_slow1:
    s_nop 15
    v_max3_f32 v200, v0, v1, v2
    v_max3_f32 v200, v200, v3, v4
    v_max3_f32 v200, v200, v5, v6
    v_max3_f32 v200, v200, v7, v8
    v_max3_f32 v200, v200, v9, v10
    v_max3_f32 v200, v200, v11, v12
    v_max3_f32 v200, v200, v13, v14
    v_max_f32 v200, v200, v15
    v_mov_b32 v201, v200
    s_nop 1
    v_permlane32_swap_b32 v200, v201
    v_max_f32 v200, v200, v201
    v_max_f32 v200, 0, v200
    v_sub_f32 v202, 0, v200
    v_exp_f32 v202, v202
    v_sub_f32 v32, v32, v200
    v_sub_f32 v33, v33, v200
    v_sub_f32 v34, v34, v200
    v_sub_f32 v35, v35, v200
    v_sub_f32 v36, v36, v200
    v_sub_f32 v37, v37, v200
    v_sub_f32 v38, v38, v200
    v_sub_f32 v39, v39, v200
    v_sub_f32 v40, v40, v200
    v_sub_f32 v41, v41, v200
    v_sub_f32 v42, v42, v200
    v_sub_f32 v43, v43, v200
    v_sub_f32 v44, v44, v200
    v_sub_f32 v45, v45, v200
    v_sub_f32 v46, v46, v200
    v_sub_f32 v47, v47, v200
    v_sub_f32 v0, v0, v200
    v_sub_f32 v1, v1, v200
    v_sub_f32 v2, v2, v200
    v_sub_f32 v3, v3, v200
    v_sub_f32 v4, v4, v200
    v_sub_f32 v5, v5, v200
    v_sub_f32 v6, v6, v200
    v_sub_f32 v7, v7, v200
    v_sub_f32 v8, v8, v200
    v_sub_f32 v9, v9, v200
    v_sub_f32 v10, v10, v200
    v_sub_f32 v11, v11, v200
    v_sub_f32 v12, v12, v200
    v_sub_f32 v13, v13, v200
    v_sub_f32 v14, v14, v200
    v_sub_f32 v15, v15, v200
    v_mul_f32 v240, v240, v202
    v_mul_f32 v64, v64, v202
    v_mul_f32 v65, v65, v202
    v_mul_f32 v66, v66, v202
    v_mul_f32 v67, v67, v202
    v_mul_f32 v68, v68, v202
    v_mul_f32 v69, v69, v202
    v_mul_f32 v70, v70, v202
    v_mul_f32 v71, v71, v202
    v_mul_f32 v72, v72, v202
    v_mul_f32 v73, v73, v202
    v_mul_f32 v74, v74, v202
    v_mul_f32 v75, v75, v202
    v_mul_f32 v76, v76, v202
    v_mul_f32 v77, v77, v202
    v_mul_f32 v78, v78, v202
    v_mul_f32 v79, v79, v202
    v_mul_f32 v80, v80, v202
    v_mul_f32 v81, v81, v202
    v_mul_f32 v82, v82, v202
    v_mul_f32 v83, v83, v202
    v_mul_f32 v84, v84, v202
    v_mul_f32 v85, v85, v202
    v_mul_f32 v86, v86, v202
    v_mul_f32 v87, v87, v202
    v_mul_f32 v88, v88, v202
    v_mul_f32 v89, v89, v202
    v_mul_f32 v90, v90, v202
    v_mul_f32 v91, v91, v202
    v_mul_f32 v92, v92, v202
    v_mul_f32 v93, v93, v202
    v_mul_f32 v94, v94, v202
    v_mul_f32 v95, v95, v202
    v_mul_f32 v96, v96, v202
    v_mul_f32 v97, v97, v202
    v_mul_f32 v98, v98, v202
    v_mul_f32 v99, v99, v202
    v_mul_f32 v100, v100, v202
    v_mul_f32 v101, v101, v202
    v_mul_f32 v102, v102, v202
    v_mul_f32 v103, v103, v202
    v_mul_f32 v104, v104, v202
    v_mul_f32 v105, v105, v202
    v_mul_f32 v106, v106, v202
    v_mul_f32 v107, v107, v202
    v_mul_f32 v108, v108, v202
    v_mul_f32 v109, v109, v202
    v_mul_f32 v110, v110, v202
    v_mul_f32 v111, v111, v202
    v_mul_f32 v112, v112, v202
    v_mul_f32 v113, v113, v202
    v_mul_f32 v114, v114, v202
    v_mul_f32 v115, v115, v202
    v_mul_f32 v116, v116, v202
    v_mul_f32 v117, v117, v202
    v_mul_f32 v118, v118, v202
    v_mul_f32 v119, v119, v202
    v_mul_f32 v120, v120, v202
    v_mul_f32 v121, v121, v202
    v_mul_f32 v122, v122, v202
    v_mul_f32 v123, v123, v202
    v_mul_f32 v124, v124, v202
    v_mul_f32 v125, v125, v202
    v_mul_f32 v126, v126, v202
    v_mul_f32 v127, v127, v202
    v_exp_f32 v192, v0
    v_exp_f32 v193, v1
    v_exp_f32 v194, v2
    v_exp_f32 v195, v3
    v_cvt_pk_bf16_f32 v48, v192, v193
    v_exp_f32 v196, v4
    v_add_f32 v242, v192, v194
    v_exp_f32 v197, v5
    v_add_f32 v243, v193, v195
    v_cvt_pk_bf16_f32 v49, v194, v195
    v_exp_f32 v198, v6
    v_add_f32 v242, v242, v196
    v_exp_f32 v199, v7
    v_add_f32 v243, v243, v197
    v_cvt_pk_bf16_f32 v52, v196, v197
    v_exp_f32 v192, v8
    v_add_f32 v242, v242, v198
    v_exp_f32 v193, v9
    v_add_f32 v243, v243, v199
    v_cvt_pk_bf16_f32 v53, v198, v199
    v_exp_f32 v194, v10
    v_add_f32 v242, v242, v192
    v_exp_f32 v195, v11
    v_add_f32 v243, v243, v193
    v_cvt_pk_bf16_f32 v50, v192, v193
    v_exp_f32 v196, v12
    v_add_f32 v242, v242, v194
    v_exp_f32 v197, v13
    v_add_f32 v243, v243, v195
    v_cvt_pk_bf16_f32 v51, v194, v195
    v_exp_f32 v198, v14
    v_add_f32 v242, v242, v196
    v_exp_f32 v199, v15
    v_add_f32 v243, v243, v197
    v_cvt_pk_bf16_f32 v54, v196, v197
    v_add_f32 v242, v242, v198
    v_add_f32 v243, v243, v199
    v_cvt_pk_bf16_f32 v55, v198, v199
    v_add_f32 v242, v242, v243
    s_nop 3
    s_branch L_E1_ret1
L_E2_slow0:
    s_nop 15
    v_max3_f32 v200, v16, v17, v18
    v_max3_f32 v200, v200, v19, v20
    v_max3_f32 v200, v200, v21, v22
    v_max3_f32 v200, v200, v23, v24
    v_max3_f32 v200, v200, v25, v26
    v_max3_f32 v200, v200, v27, v28
    v_max3_f32 v200, v200, v29, v30
    v_max_f32 v200, v200, v31
    v_mov_b32 v201, v200
    s_nop 1
    v_permlane32_swap_b32 v200, v201
    v_max_f32 v200, v200, v201
    v_max_f32 v200, 0, v200
    v_sub_f32 v202, 0, v200
    v_exp_f32 v202, v202
    v_sub_f32 v32, v32, v200
    v_sub_f32 v33, v33, v200
    v_sub_f32 v34, v34, v200
    v_sub_f32 v35, v35, v200
    v_sub_f32 v36, v36, v200
    v_sub_f32 v37, v37, v200
    v_sub_f32 v38, v38, v200
    v_sub_f32 v39, v39, v200
    v_sub_f32 v40, v40, v200
    v_sub_f32 v41, v41, v200
    v_sub_f32 v42, v42, v200
    v_sub_f32 v43, v43, v200
    v_sub_f32 v44, v44, v200
    v_sub_f32 v45, v45, v200
    v_sub_f32 v46, v46, v200
    v_sub_f32 v47, v47, v200
    v_sub_f32 v16, v16, v200
    v_sub_f32 v17, v17, v200
    v_sub_f32 v18, v18, v200
    v_sub_f32 v19, v19, v200
    v_sub_f32 v20, v20, v200
    v_sub_f32 v21, v21, v200
    v_sub_f32 v22, v22, v200
    v_sub_f32 v23, v23, v200
    v_sub_f32 v24, v24, v200
    v_sub_f32 v25, v25, v200
    v_sub_f32 v26, v26, v200
    v_sub_f32 v27, v27, v200
    v_sub_f32 v28, v28, v200
    v_sub_f32 v29, v29, v200
    v_sub_f32 v30, v30, v200
    v_sub_f32 v31, v31, v200
    v_mul_f32 v240, v240, v202
    v_mul_f32 v64, v64, v202
    v_mul_f32 v65, v65, v202
    v_mul_f32 v66, v66, v202
    v_mul_f32 v67, v67, v202
    v_mul_f32 v68, v68, v202
    v_mul_f32 v69, v69, v202
    v_mul_f32 v70, v70, v202
    v_mul_f32 v71, v71, v202
    v_mul_f32 v72, v72, v202
    v_mul_f32 v73, v73, v202
    v_mul_f32 v74, v74, v202
    v_mul_f32 v75, v75, v202
    v_mul_f32 v76, v76, v202
    v_mul_f32 v77, v77, v202
    v_mul_f32 v78, v78, v202
    v_mul_f32 v79, v79, v202
    v_mul_f32 v80, v80, v202
    v_mul_f32 v81, v81, v202
    v_mul_f32 v82, v82, v202
    v_mul_f32 v83, v83, v202
    v_mul_f32 v84, v84, v202
    v_mul_f32 v85, v85, v202
    v_mul_f32 v86, v86, v202
    v_mul_f32 v87, v87, v202
    v_mul_f32 v88, v88, v202
    v_mul_f32 v89, v89, v202
    v_mul_f32 v90, v90, v202
    v_mul_f32 v91, v91, v202
    v_mul_f32 v92, v92, v202
    v_mul_f32 v93, v93, v202
    v_mul_f32 v94, v94, v202
    v_mul_f32 v95, v95, v202
    v_mul_f32 v96, v96, v202
    v_mul_f32 v97, v97, v202
    v_mul_f32 v98, v98, v202
    v_mul_f32 v99, v99, v202
    v_mul_f32 v100, v100, v202
    v_mul_f32 v101, v101, v202
    v_mul_f32 v102, v102, v202
    v_mul_f32 v103, v103, v202
    v_mul_f32 v104, v104, v202
    v_mul_f32 v105, v105, v202
    v_mul_f32 v106, v106, v202
    v_mul_f32 v107, v107, v202
    v_mul_f32 v108, v108, v202
    v_mul_f32 v109, v109, v202
    v_mul_f32 v110, v110, v202
    v_mul_f32 v111, v111, v202
    v_mul_f32 v112, v112, v202
    v_mul_f32 v113, v113, v202
    v_mul_f32 v114, v114, v202
    v_mul_f32 v115, v115, v202
    v_mul_f32 v116, v116, v202
    v_mul_f32 v117, v117, v202
    v_mul_f32 v118, v118, v202
    v_mul_f32 v119, v119, v202
    v_mul_f32 v120, v120, v202
    v_mul_f32 v121, v121, v202
    v_mul_f32 v122, v122, v202
    v_mul_f32 v123, v123, v202
    v_mul_f32 v124, v124, v202
    v_mul_f32 v125, v125, v202
    v_mul_f32 v126, v126, v202
    v_mul_f32 v127, v127, v202
    v_exp_f32 v192, v16
    v_exp_f32 v193, v17
    v_exp_f32 v194, v18
    v_exp_f32 v195, v19
    v_cvt_pk_bf16_f32 v56, v192, v193
    v_exp_f32 v196, v20
    v_add_f32 v242, v192, v194
    v_exp_f32 v197, v21
    v_add_f32 v243, v193, v195
    v_cvt_pk_bf16_f32 v57, v194, v195
    v_exp_f32 v198, v22
    v_add_f32 v242, v242, v196
    v_exp_f32 v199, v23
    v_add_f32 v243, v243, v197
    v_cvt_pk_bf16_f32 v60, v196, v197
    v_exp_f32 v192, v24
    v_add_f32 v242, v242, v198
    v_exp_f32 v193, v25
    v_add_f32 v243, v243, v199
    v_cvt_pk_bf16_f32 v61, v198, v199
    v_exp_f32 v194, v26
    v_add_f32 v242, v242, v192
    v_exp_f32 v195, v27
    v_add_f32 v243, v243, v193
    v_cvt_pk_bf16_f32 v58, v192, v193
    v_exp_f32 v196, v28
    v_add_f32 v242, v242, v194
    v_exp_f32 v197, v29
    v_add_f32 v243, v243, v195
    v_cvt_pk_bf16_f32 v59, v194, v195
    v_exp_f32 v198, v30
    v_add_f32 v242, v242, v196
    v_exp_f32 v199, v31
    v_add_f32 v243, v243, v197
    v_cvt_pk_bf16_f32 v62, v196, v197
    v_add_f32 v242, v242, v198
    v_add_f32 v243, v243, v199
    v_cvt_pk_bf16_f32 v63, v198, v199
    v_add_f32 v242, v242, v243
    s_nop 3
    s_branch L_E2_ret0
H_FULL_slow0:
    s_nop 15
    v_max3_f32 v200, v16, v17, v18
    v_max3_f32 v200, v200, v19, v20
    v_max3_f32 v200, v200, v21, v22
    v_max3_f32 v200, v200, v23, v24
    v_max3_f32 v200, v200, v25, v26
    v_max3_f32 v200, v200, v27, v28
    v_max3_f32 v200, v200, v29, v30
    v_max_f32 v200, v200, v31
    v_mov_b32 v201, v200
    s_nop 1
    v_permlane32_swap_b32 v200, v201
    v_max_f32 v200, v200, v201
    v_max_f32 v200, 0, v200
    v_sub_f32 v202, 0, v200
    v_exp_f32 v202, v202
    v_sub_f32 v32, v32, v200
    v_sub_f32 v33, v33, v200
    v_sub_f32 v34, v34, v200
    v_sub_f32 v35, v35, v200
    v_sub_f32 v36, v36, v200
    v_sub_f32 v37, v37, v200
    v_sub_f32 v38, v38, v200
    v_sub_f32 v39, v39, v200
    v_sub_f32 v40, v40, v200
    v_sub_f32 v41, v41, v200
    v_sub_f32 v42, v42, v200
    v_sub_f32 v43, v43, v200
    v_sub_f32 v44, v44, v200
    v_sub_f32 v45, v45, v200
    v_sub_f32 v46, v46, v200
    v_sub_f32 v47, v47, v200
    v_sub_f32 v16, v16, v200
    v_sub_f32 v17, v17, v200
    v_sub_f32 v18, v18, v200
    v_sub_f32 v19, v19, v200
    v_sub_f32 v20, v20, v200
    v_sub_f32 v21, v21, v200
    v_sub_f32 v22, v22, v200
    v_sub_f32 v23, v23, v200
    v_sub_f32 v24, v24, v200
    v_sub_f32 v25, v25, v200
    v_sub_f32 v26, v26, v200
    v_sub_f32 v27, v27, v200
    v_sub_f32 v28, v28, v200
    v_sub_f32 v29, v29, v200
    v_sub_f32 v30, v30, v200
    v_sub_f32 v31, v31, v200
    v_sub_f32 v0, v0, v200
    v_sub_f32 v1, v1, v200
    v_sub_f32 v2, v2, v200
    v_sub_f32 v3, v3, v200
    v_sub_f32 v4, v4, v200
    v_sub_f32 v5, v5, v200
    v_sub_f32 v6, v6, v200
    v_sub_f32 v7, v7, v200
    v_sub_f32 v8, v8, v200
    v_sub_f32 v9, v9, v200
    v_sub_f32 v10, v10, v200
    v_sub_f32 v11, v11, v200
    v_sub_f32 v12, v12, v200
    v_sub_f32 v13, v13, v200
    v_sub_f32 v14, v14, v200
    v_sub_f32 v15, v15, v200
    v_mul_f32 v240, v240, v202
    v_mul_f32 v64, v64, v202
    v_mul_f32 v65, v65, v202
    v_mul_f32 v66, v66, v202
    v_mul_f32 v67, v67, v202
    v_mul_f32 v68, v68, v202
    v_mul_f32 v69, v69, v202
    v_mul_f32 v70, v70, v202
    v_mul_f32 v71, v71, v202
    v_mul_f32 v72, v72, v202
    v_mul_f32 v73, v73, v202
    v_mul_f32 v74, v74, v202
    v_mul_f32 v75, v75, v202
    v_mul_f32 v76, v76, v202
    v_mul_f32 v77, v77, v202
    v_mul_f32 v78, v78, v202
    v_mul_f32 v79, v79, v202
    v_mul_f32 v80, v80, v202
    v_mul_f32 v81, v81, v202
    v_mul_f32 v82, v82, v202
    v_mul_f32 v83, v83, v202
    v_mul_f32 v84, v84, v202
    v_mul_f32 v85, v85, v202
    v_mul_f32 v86, v86, v202
    v_mul_f32 v87, v87, v202
    v_mul_f32 v88, v88, v202
    v_mul_f32 v89, v89, v202
    v_mul_f32 v90, v90, v202
    v_mul_f32 v91, v91, v202
    v_mul_f32 v92, v92, v202
    v_mul_f32 v93, v93, v202
    v_mul_f32 v94, v94, v202
    v_mul_f32 v95, v95, v202
    v_mul_f32 v96, v96, v202
    v_mul_f32 v97, v97, v202
    v_mul_f32 v98, v98, v202
    v_mul_f32 v99, v99, v202
    v_mul_f32 v100, v100, v202
    v_mul_f32 v101, v101, v202
    v_mul_f32 v102, v102, v202
    v_mul_f32 v103, v103, v202
    v_mul_f32 v104, v104, v202
    v_mul_f32 v105, v105, v202
    v_mul_f32 v106, v106, v202
    v_mul_f32 v107, v107, v202
    v_mul_f32 v108, v108, v202
    v_mul_f32 v109, v109, v202
    v_mul_f32 v110, v110, v202
    v_mul_f32 v111, v111, v202
    v_mul_f32 v112, v112, v202
    v_mul_f32 v113, v113, v202
    v_mul_f32 v114, v114, v202
    v_mul_f32 v115, v115, v202
    v_mul_f32 v116, v116, v202
    v_mul_f32 v117, v117, v202
    v_mul_f32 v118, v118, v202
    v_mul_f32 v119, v119, v202
    v_mul_f32 v120, v120, v202
    v_mul_f32 v121, v121, v202
    v_mul_f32 v122, v122, v202
    v_mul_f32 v123, v123, v202
    v_mul_f32 v124, v124, v202
    v_mul_f32 v125, v125, v202
    v_mul_f32 v126, v126, v202
    v_mul_f32 v127, v127, v202
    v_exp_f32 v192, v16
    v_exp_f32 v193, v17
    v_exp_f32 v194, v18
    v_exp_f32 v195, v19
    v_cvt_pk_bf16_f32 v56, v192, v193
    v_exp_f32 v196, v20
    v_add_f32 v242, v192, v194
    v_exp_f32 v197, v21
    v_add_f32 v243, v193, v195
    v_cvt_pk_bf16_f32 v57, v194, v195
    v_exp_f32 v198, v22
    v_add_f32 v242, v242, v196
    v_exp_f32 v199, v23
    v_add_f32 v243, v243, v197
    v_cvt_pk_bf16_f32 v60, v196, v197
    v_exp_f32 v192, v24
    v_add_f32 v242, v242, v198
    v_exp_f32 v193, v25
    v_add_f32 v243, v243, v199
    v_cvt_pk_bf16_f32 v61, v198, v199
    v_exp_f32 v194, v26
    v_add_f32 v242, v242, v192
    v_exp_f32 v195, v27
    v_add_f32 v243, v243, v193
    v_cvt_pk_bf16_f32 v58, v192, v193
    v_exp_f32 v196, v28
    v_add_f32 v242, v242, v194
    v_exp_f32 v197, v29
    v_add_f32 v243, v243, v195
    v_cvt_pk_bf16_f32 v59, v194, v195
    v_exp_f32 v198, v30
    v_add_f32 v242, v242, v196
    v_exp_f32 v199, v31
    v_add_f32 v243, v243, v197
    v_cvt_pk_bf16_f32 v62, v196, v197
    v_add_f32 v242, v242, v198
    v_add_f32 v243, v243, v199
    v_cvt_pk_bf16_f32 v63, v198, v199
    v_add_f32 v242, v242, v243
    s_nop 3
    s_branch H_FULL_ret0
H_FULL_slow1:
    s_nop 15
    v_max3_f32 v200, v0, v1, v2
    v_max3_f32 v200, v200, v3, v4
    v_max3_f32 v200, v200, v5, v6
    v_max3_f32 v200, v200, v7, v8
    v_max3_f32 v200, v200, v9, v10
    v_max3_f32 v200, v200, v11, v12
    v_max3_f32 v200, v200, v13, v14
    v_max_f32 v200, v200, v15
    v_mov_b32 v201, v200
    s_nop 1
    v_permlane32_swap_b32 v200, v201
    v_max_f32 v200, v200, v201
    v_max_f32 v200, 0, v200
    v_sub_f32 v202, 0, v200
    v_exp_f32 v202, v202
    v_sub_f32 v32, v32, v200
    v_sub_f32 v33, v33, v200
    v_sub_f32 v34, v34, v200
    v_sub_f32 v35, v35, v200
    v_sub_f32 v36, v36, v200
    v_sub_f32 v37, v37, v200
    v_sub_f32 v38, v38, v200
    v_sub_f32 v39, v39, v200
    v_sub_f32 v40, v40, v200
    v_sub_f32 v41, v41, v200
    v_sub_f32 v42, v42, v200
    v_sub_f32 v43, v43, v200
    v_sub_f32 v44, v44, v200
    v_sub_f32 v45, v45, v200
    v_sub_f32 v46, v46, v200
    v_sub_f32 v47, v47, v200
    v_sub_f32 v0, v0, v200
    v_sub_f32 v1, v1, v200
    v_sub_f32 v2, v2, v200
    v_sub_f32 v3, v3, v200
    v_sub_f32 v4, v4, v200
    v_sub_f32 v5, v5, v200
    v_sub_f32 v6, v6, v200
    v_sub_f32 v7, v7, v200
    v_sub_f32 v8, v8, v200
    v_sub_f32 v9, v9, v200
    v_sub_f32 v10, v10, v200
    v_sub_f32 v11, v11, v200
    v_sub_f32 v12, v12, v200
    v_sub_f32 v13, v13, v200
    v_sub_f32 v14, v14, v200
    v_sub_f32 v15, v15, v200
    v_sub_f32 v16, v16, v200
    v_sub_f32 v17, v17, v200
    v_sub_f32 v18, v18, v200
    v_sub_f32 v19, v19, v200
    v_sub_f32 v20, v20, v200
    v_sub_f32 v21, v21, v200
    v_sub_f32 v22, v22, v200
    v_sub_f32 v23, v23, v200
    v_sub_f32 v24, v24, v200
    v_sub_f32 v25, v25, v200
    v_sub_f32 v26, v26, v200
    v_sub_f32 v27, v27, v200
    v_sub_f32 v28, v28, v200
    v_sub_f32 v29, v29, v200
    v_sub_f32 v30, v30, v200
    v_sub_f32 v31, v31, v200
    v_mul_f32 v240, v240, v202
    v_mul_f32 v64, v64, v202
    v_mul_f32 v65, v65, v202
    v_mul_f32 v66, v66, v202
    v_mul_f32 v67, v67, v202
    v_mul_f32 v68, v68, v202
    v_mul_f32 v69, v69, v202
    v_mul_f32 v70, v70, v202
    v_mul_f32 v71, v71, v202
    v_mul_f32 v72, v72, v202
    v_mul_f32 v73, v73, v202
    v_mul_f32 v74, v74, v202
    v_mul_f32 v75, v75, v202
    v_mul_f32 v76, v76, v202
    v_mul_f32 v77, v77, v202
    v_mul_f32 v78, v78, v202
    v_mul_f32 v79, v79, v202
    v_mul_f32 v80, v80, v202
    v_mul_f32 v81, v81, v202
    v_mul_f32 v82, v82, v202
    v_mul_f32 v83, v83, v202
    v_mul_f32 v84, v84, v202
    v_mul_f32 v85, v85, v202
    v_mul_f32 v86, v86, v202
    v_mul_f32 v87, v87, v202
    v_mul_f32 v88, v88, v202
    v_mul_f32 v89, v89, v202
    v_mul_f32 v90, v90, v202
    v_mul_f32 v91, v91, v202
    v_mul_f32 v92, v92, v202
    v_mul_f32 v93, v93, v202
    v_mul_f32 v94, v94, v202
    v_mul_f32 v95, v95, v202
    v_mul_f32 v96, v96, v202
    v_mul_f32 v97, v97, v202
    v_mul_f32 v98, v98, v202
    v_mul_f32 v99, v99, v202
    v_mul_f32 v100, v100, v202
    v_mul_f32 v101, v101, v202
    v_mul_f32 v102, v102, v202
    v_mul_f32 v103, v103, v202
    v_mul_f32 v104, v104, v202
    v_mul_f32 v105, v105, v202
    v_mul_f32 v106, v106, v202
    v_mul_f32 v107, v107, v202
    v_mul_f32 v108, v108, v202
    v_mul_f32 v109, v109, v202
    v_mul_f32 v110, v110, v202
    v_mul_f32 v111, v111, v202
    v_mul_f32 v112, v112, v202
    v_mul_f32 v113, v113, v202
    v_mul_f32 v114, v114, v202
    v_mul_f32 v115, v115, v202
    v_mul_f32 v116, v116, v202
    v_mul_f32 v117, v117, v202
    v_mul_f32 v118, v118, v202
    v_mul_f32 v119, v119, v202
    v_mul_f32 v120, v120, v202
    v_mul_f32 v121, v121, v202
    v_mul_f32 v122, v122, v202
    v_mul_f32 v123, v123, v202
    v_mul_f32 v124, v124, v202
    v_mul_f32 v125, v125, v202
    v_mul_f32 v126, v126, v202
    v_mul_f32 v127, v127, v202
    v_exp_f32 v192, v0
    v_exp_f32 v193, v1
    v_exp_f32 v194, v2
    v_exp_f32 v195, v3
    v_cvt_pk_bf16_f32 v48, v192, v193
    v_exp_f32 v196, v4
    v_add_f32 v242, v192, v194
    v_exp_f32 v197, v5
    v_add_f32 v243, v193, v195
    v_cvt_pk_bf16_f32 v49, v194, v195
    v_exp_f32 v198, v6
    v_add_f32 v242, v242, v196
    v_exp_f32 v199, v7
    v_add_f32 v243, v243, v197
    v_cvt_pk_bf16_f32 v52, v196, v197
    v_exp_f32 v192, v8
    v_add_f32 v242, v242, v198
    v_exp_f32 v193, v9
    v_add_f32 v243, v243, v199
    v_cvt_pk_bf16_f32 v53, v198, v199
    v_exp_f32 v194, v10
    v_add_f32 v242, v242, v192
    v_exp_f32 v195, v11
    v_add_f32 v243, v243, v193
    v_cvt_pk_bf16_f32 v50, v192, v193
    v_exp_f32 v196, v12
    v_add_f32 v242, v242, v194
    v_exp_f32 v197, v13
    v_add_f32 v243, v243, v195
    v_cvt_pk_bf16_f32 v51, v194, v195
    v_exp_f32 v198, v14
    v_add_f32 v242, v242, v196
    v_exp_f32 v199, v15
    v_add_f32 v243, v243, v197
    v_cvt_pk_bf16_f32 v54, v196, v197
    v_add_f32 v242, v242, v198
    v_add_f32 v243, v243, v199
    v_cvt_pk_bf16_f32 v55, v198, v199
    v_add_f32 v242, v242, v243
    s_nop 3
    s_branch H_FULL_ret1
H_E1_slow0:
    s_nop 15
    v_max3_f32 v200, v16, v17, v18
    v_max3_f32 v200, v200, v19, v20
    v_max3_f32 v200, v200, v21, v22
    v_max3_f32 v200, v200, v23, v24
    v_max3_f32 v200, v200, v25, v26
    v_max3_f32 v200, v200, v27, v28
    v_max3_f32 v200, v200, v29, v30
    v_max_f32 v200, v200, v31
    v_mov_b32 v201, v200
    s_nop 1
    v_permlane32_swap_b32 v200, v201
    v_max_f32 v200, v200, v201
    v_max_f32 v200, 0, v200
    v_sub_f32 v202, 0, v200
    v_exp_f32 v202, v202
    v_sub_f32 v32, v32, v200
    v_sub_f32 v33, v33, v200
    v_sub_f32 v34, v34, v200
    v_sub_f32 v35, v35, v200
    v_sub_f32 v36, v36, v200
    v_sub_f32 v37, v37, v200
    v_sub_f32 v38, v38, v200
    v_sub_f32 v39, v39, v200
    v_sub_f32 v40, v40, v200
    v_sub_f32 v41, v41, v200
    v_sub_f32 v42, v42, v200
    v_sub_f32 v43, v43, v200
    v_sub_f32 v44, v44, v200
    v_sub_f32 v45, v45, v200
    v_sub_f32 v46, v46, v200
    v_sub_f32 v47, v47, v200
    v_sub_f32 v16, v16, v200
    v_sub_f32 v17, v17, v200
    v_sub_f32 v18, v18, v200
    v_sub_f32 v19, v19, v200
    v_sub_f32 v20, v20, v200
    v_sub_f32 v21, v21, v200
    v_sub_f32 v22, v22, v200
    v_sub_f32 v23, v23, v200
    v_sub_f32 v24, v24, v200
    v_sub_f32 v25, v25, v200
    v_sub_f32 v26, v26, v200
    v_sub_f32 v27, v27, v200
    v_sub_f32 v28, v28, v200
    v_sub_f32 v29, v29, v200
    v_sub_f32 v30, v30, v200
    v_sub_f32 v31, v31, v200
    v_sub_f32 v0, v0, v200
    v_sub_f32 v1, v1, v200
    v_sub_f32 v2, v2, v200
    v_sub_f32 v3, v3, v200
    v_sub_f32 v4, v4, v200
    v_sub_f32 v5, v5, v200
    v_sub_f32 v6, v6, v200
    v_sub_f32 v7, v7, v200
    v_sub_f32 v8, v8, v200
    v_sub_f32 v9, v9, v200
    v_sub_f32 v10, v10, v200
    v_sub_f32 v11, v11, v200
    v_sub_f32 v12, v12, v200
    v_sub_f32 v13, v13, v200
    v_sub_f32 v14, v14, v200
    v_sub_f32 v15, v15, v200
    v_mul_f32 v240, v240, v202
    v_mul_f32 v64, v64, v202
    v_mul_f32 v65, v65, v202
    v_mul_f32 v66, v66, v202
    v_mul_f32 v67, v67, v202
    v_mul_f32 v68, v68, v202
    v_mul_f32 v69, v69, v202
    v_mul_f32 v70, v70, v202
    v_mul_f32 v71, v71, v202
    v_mul_f32 v72, v72, v202
    v_mul_f32 v73, v73, v202
    v_mul_f32 v74, v74, v202
    v_mul_f32 v75, v75, v202
    v_mul_f32 v76, v76, v202
    v_mul_f32 v77, v77, v202
    v_mul_f32 v78, v78, v202
    v_mul_f32 v79, v79, v202
    v_mul_f32 v80, v80, v202
    v_mul_f32 v81, v81, v202
    v_mul_f32 v82, v82, v202
    v_mul_f32 v83, v83, v202
    v_mul_f32 v84, v84, v202
    v_mul_f32 v85, v85, v202
    v_mul_f32 v86, v86, v202
    v_mul_f32 v87, v87, v202
    v_mul_f32 v88, v88, v202
    v_mul_f32 v89, v89, v202
    v_mul_f32 v90, v90, v202
    v_mul_f32 v91, v91, v202
    v_mul_f32 v92, v92, v202
    v_mul_f32 v93, v93, v202
    v_mul_f32 v94, v94, v202
    v_mul_f32 v95, v95, v202
    v_mul_f32 v96, v96, v202
    v_mul_f32 v97, v97, v202
    v_mul_f32 v98, v98, v202
    v_mul_f32 v99, v99, v202
    v_mul_f32 v100, v100, v202
    v_mul_f32 v101, v101, v202
    v_mul_f32 v102, v102, v202
    v_mul_f32 v103, v103, v202
    v_mul_f32 v104, v104, v202
    v_mul_f32 v105, v105, v202
    v_mul_f32 v106, v106, v202
    v_mul_f32 v107, v107, v202
    v_mul_f32 v108, v108, v202
    v_mul_f32 v109, v109, v202
    v_mul_f32 v110, v110, v202
    v_mul_f32 v111, v111, v202
    v_mul_f32 v112, v112, v202
    v_mul_f32 v113, v113, v202
    v_mul_f32 v114, v114, v202
    v_mul_f32 v115, v115, v202
    v_mul_f32 v116, v116, v202
    v_mul_f32 v117, v117, v202
    v_mul_f32 v118, v118, v202
    v_mul_f32 v119, v119, v202
    v_mul_f32 v120, v120, v202
    v_mul_f32 v121, v121, v202
    v_mul_f32 v122, v122, v202
    v_mul_f32 v123, v123, v202
    v_mul_f32 v124, v124, v202
    v_mul_f32 v125, v125, v202
    v_mul_f32 v126, v126, v202
    v_mul_f32 v127, v127, v202
    v_exp_f32 v192, v16
    v_exp_f32 v193, v17
    v_exp_f32 v194, v18
    v_exp_f32 v195, v19
    v_cvt_pk_bf16_f32 v56, v192, v193
    v_exp_f32 v196, v20
    v_add_f32 v242, v192, v194
    v_exp_f32 v197, v21
    v_add_f32 v243, v193, v195
    v_cvt_pk_bf16_f32 v57, v194, v195
    v_exp_f32 v198, v22
    v_add_f32 v242, v242, v196
    v_exp_f32 v199, v23
    v_add_f32 v243, v243, v197
    v_cvt_pk_bf16_f32 v60, v196, v197
    v_exp_f32 v192, v24
    v_add_f32 v242, v242, v198
    v_exp_f32 v193, v25
    v_add_f32 v243, v243, v199
    v_cvt_pk_bf16_f32 v61, v198, v199
    v_exp_f32 v194, v26
    v_add_f32 v242, v242, v192
    v_exp_f32 v195, v27
    v_add_f32 v243, v243, v193
    v_cvt_pk_bf16_f32 v58, v192, v193
    v_exp_f32 v196, v28
    v_add_f32 v242, v242, v194
    v_exp_f32 v197, v29
    v_add_f32 v243, v243, v195
    v_cvt_pk_bf16_f32 v59, v194, v195
    v_exp_f32 v198, v30
    v_add_f32 v242, v242, v196
    v_exp_f32 v199, v31
    v_add_f32 v243, v243, v197
    v_cvt_pk_bf16_f32 v62, v196, v197
    v_add_f32 v242, v242, v198
    v_add_f32 v243, v243, v199
    v_cvt_pk_bf16_f32 v63, v198, v199
    v_add_f32 v242, v242, v243
    s_nop 3
    s_branch H_E1_ret0
H_E1_slow1:
    s_nop 15
    v_max3_f32 v200, v0, v1, v2
    v_max3_f32 v200, v200, v3, v4
    v_max3_f32 v200, v200, v5, v6
    v_max3_f32 v200, v200, v7, v8
    v_max3_f32 v200, v200, v9, v10
    v_max3_f32 v200, v200, v11, v12
    v_max3_f32 v200, v200, v13, v14
    v_max_f32 v200, v200, v15
    v_mov_b32 v201, v200
    s_nop 1
    v_permlane32_swap_b32 v200, v201
    v_max_f32 v200, v200, v201
    v_max_f32 v200, 0, v200
    v_sub_f32 v202, 0, v200
    v_exp_f32 v202, v202
    v_sub_f32 v32, v32, v200
    v_sub_f32 v33, v33, v200
    v_sub_f32 v34, v34, v200
    v_sub_f32 v35, v35, v200
    v_sub_f32 v36, v36, v200
    v_sub_f32 v37, v37, v200
    v_sub_f32 v38, v38, v200
    v_sub_f32 v39, v39, v200
    v_sub_f32 v40, v40, v200
    v_sub_f32 v41, v41, v200
    v_sub_f32 v42, v42, v200
    v_sub_f32 v43, v43, v200
    v_sub_f32 v44, v44, v200
    v_sub_f32 v45, v45, v200
    v_sub_f32 v46, v46, v200
    v_sub_f32 v47, v47, v200
    v_sub_f32 v0, v0, v200
    v_sub_f32 v1, v1, v200
    v_sub_f32 v2, v2, v200
    v_sub_f32 v3, v3, v200
    v_sub_f32 v4, v4, v200
    v_sub_f32 v5, v5, v200
    v_sub_f32 v6, v6, v200
    v_sub_f32 v7, v7, v200
    v_sub_f32 v8, v8, v200
    v_sub_f32 v9, v9, v200
    v_sub_f32 v10, v10, v200
    v_sub_f32 v11, v11, v200
    v_sub_f32 v12, v12, v200
    v_sub_f32 v13, v13, v200
    v_sub_f32 v14, v14, v200
    v_sub_f32 v15, v15, v200
    v_mul_f32 v240, v240, v202
    v_mul_f32 v64, v64, v202
    v_mul_f32 v65, v65, v202
    v_mul_f32 v66, v66, v202
    v_mul_f32 v67, v67, v202
    v_mul_f32 v68, v68, v202
    v_mul_f32 v69, v69, v202
    v_mul_f32 v70, v70, v202
    v_mul_f32 v71, v71, v202
    v_mul_f32 v72, v72, v202
    v_mul_f32 v73, v73, v202
    v_mul_f32 v74, v74, v202
    v_mul_f32 v75, v75, v202
    v_mul_f32 v76, v76, v202
    v_mul_f32 v77, v77, v202
    v_mul_f32 v78, v78, v202
    v_mul_f32 v79, v79, v202
    v_mul_f32 v80, v80, v202
    v_mul_f32 v81, v81, v202
    v_mul_f32 v82, v82, v202
    v_mul_f32 v83, v83, v202
    v_mul_f32 v84, v84, v202
    v_mul_f32 v85, v85, v202
    v_mul_f32 v86, v86, v202
    v_mul_f32 v87, v87, v202
    v_mul_f32 v88, v88, v202
    v_mul_f32 v89, v89, v202
    v_mul_f32 v90, v90, v202
    v_mul_f32 v91, v91, v202
    v_mul_f32 v92, v92, v202
    v_mul_f32 v93, v93, v202
    v_mul_f32 v94, v94, v202
    v_mul_f32 v95, v95, v202
    v_mul_f32 v96, v96, v202
    v_mul_f32 v97, v97, v202
    v_mul_f32 v98, v98, v202
    v_mul_f32 v99, v99, v202
    v_mul_f32 v100, v100, v202
    v_mul_f32 v101, v101, v202
    v_mul_f32 v102, v102, v202
    v_mul_f32 v103, v103, v202
    v_mul_f32 v104, v104, v202
    v_mul_f32 v105, v105, v202
    v_mul_f32 v106, v106, v202
    v_mul_f32 v107, v107, v202
    v_mul_f32 v108, v108, v202
    v_mul_f32 v109, v109, v202
    v_mul_f32 v110, v110, v202
    v_mul_f32 v111, v111, v202
    v_mul_f32 v112, v112, v202
    v_mul_f32 v113, v113, v202
    v_mul_f32 v114, v114, v202
    v_mul_f32 v115, v115, v202
    v_mul_f32 v116, v116, v202
    v_mul_f32 v117, v117, v202
    v_mul_f32 v118, v118, v202
    v_mul_f32 v119, v119, v202
    v_mul_f32 v120, v120, v202
    v_mul_f32 v121, v121, v202
    v_mul_f32 v122, v122, v202
    v_mul_f32 v123, v123, v202
    v_mul_f32 v124, v124, v202
    v_mul_f32 v125, v125, v202
    v_mul_f32 v126, v126, v202
    v_mul_f32 v127, v127, v202
    v_exp_f32 v192, v0
    v_exp_f32 v193, v1
    v_exp_f32 v194, v2
    v_exp_f32 v195, v3
    v_cvt_pk_bf16_f32 v48, v192, v193
    v_exp_f32 v196, v4
    v_add_f32 v242, v192, v194
    v_exp_f32 v197, v5
    v_add_f32 v243, v193, v195
    v_cvt_pk_bf16_f32 v49, v194, v195
    v_exp_f32 v198, v6
    v_add_f32 v242, v242, v196
    v_exp_f32 v199, v7
    v_add_f32 v243, v243, v197
    v_cvt_pk_bf16_f32 v52, v196, v197
    v_exp_f32 v192, v8
    v_add_f32 v242, v242, v198
    v_exp_f32 v193, v9
    v_add_f32 v243, v243, v199
    v_cvt_pk_bf16_f32 v53, v198, v199
    v_exp_f32 v194, v10
    v_add_f32 v242, v242, v192
    v_exp_f32 v195, v11
    v_add_f32 v243, v243, v193
    v_cvt_pk_bf16_f32 v50, v192, v193
    v_exp_f32 v196, v12
    v_add_f32 v242, v242, v194
    v_exp_f32 v197, v13
    v_add_f32 v243, v243, v195
    v_cvt_pk_bf16_f32 v51, v194, v195
    v_exp_f32 v198, v14
    v_add_f32 v242, v242, v196
    v_exp_f32 v199, v15
    v_add_f32 v243, v243, v197
    v_cvt_pk_bf16_f32 v54, v196, v197
    v_add_f32 v242, v242, v198
    v_add_f32 v243, v243, v199
    v_cvt_pk_bf16_f32 v55, v198, v199
    v_add_f32 v242, v242, v243
    s_nop 3
    s_branch H_E1_ret1
H_E2_slow0:
    s_nop 15
    v_max3_f32 v200, v16, v17, v18
    v_max3_f32 v200, v200, v19, v20
    v_max3_f32 v200, v200, v21, v22
    v_max3_f32 v200, v200, v23, v24
    v_max3_f32 v200, v200, v25, v26
    v_max3_f32 v200, v200, v27, v28
    v_max3_f32 v200, v200, v29, v30
    v_max_f32 v200, v200, v31
    v_mov_b32 v201, v200
    s_nop 1
    v_permlane32_swap_b32 v200, v201
    v_max_f32 v200, v200, v201
    v_max_f32 v200, 0, v200
    v_sub_f32 v202, 0, v200
    v_exp_f32 v202, v202
    v_sub_f32 v32, v32, v200
    v_sub_f32 v33, v33, v200
    v_sub_f32 v34, v34, v200
    v_sub_f32 v35, v35, v200
    v_sub_f32 v36, v36, v200
    v_sub_f32 v37, v37, v200
    v_sub_f32 v38, v38, v200
    v_sub_f32 v39, v39, v200
    v_sub_f32 v40, v40, v200
    v_sub_f32 v41, v41, v200
    v_sub_f32 v42, v42, v200
    v_sub_f32 v43, v43, v200
    v_sub_f32 v44, v44, v200
    v_sub_f32 v45, v45, v200
    v_sub_f32 v46, v46, v200
    v_sub_f32 v47, v47, v200
    v_sub_f32 v16, v16, v200
    v_sub_f32 v17, v17, v200
    v_sub_f32 v18, v18, v200
    v_sub_f32 v19, v19, v200
    v_sub_f32 v20, v20, v200
    v_sub_f32 v21, v21, v200
    v_sub_f32 v22, v22, v200
    v_sub_f32 v23, v23, v200
    v_sub_f32 v24, v24, v200
    v_sub_f32 v25, v25, v200
    v_sub_f32 v26, v26, v200
    v_sub_f32 v27, v27, v200
    v_sub_f32 v28, v28, v200
    v_sub_f32 v29, v29, v200
    v_sub_f32 v30, v30, v200
    v_sub_f32 v31, v31, v200
    v_mul_f32 v240, v240, v202
    v_mul_f32 v64, v64, v202
    v_mul_f32 v65, v65, v202
    v_mul_f32 v66, v66, v202
    v_mul_f32 v67, v67, v202
    v_mul_f32 v68, v68, v202
    v_mul_f32 v69, v69, v202
    v_mul_f32 v70, v70, v202
    v_mul_f32 v71, v71, v202
    v_mul_f32 v72, v72, v202
    v_mul_f32 v73, v73, v202
    v_mul_f32 v74, v74, v202
    v_mul_f32 v75, v75, v202
    v_mul_f32 v76, v76, v202
    v_mul_f32 v77, v77, v202
    v_mul_f32 v78, v78, v202
    v_mul_f32 v79, v79, v202
    v_mul_f32 v80, v80, v202
    v_mul_f32 v81, v81, v202
    v_mul_f32 v82, v82, v202
    v_mul_f32 v83, v83, v202
    v_mul_f32 v84, v84, v202
    v_mul_f32 v85, v85, v202
    v_mul_f32 v86, v86, v202
    v_mul_f32 v87, v87, v202
    v_mul_f32 v88, v88, v202
    v_mul_f32 v89, v89, v202
    v_mul_f32 v90, v90, v202
    v_mul_f32 v91, v91, v202
    v_mul_f32 v92, v92, v202
    v_mul_f32 v93, v93, v202
    v_mul_f32 v94, v94, v202
    v_mul_f32 v95, v95, v202
    v_mul_f32 v96, v96, v202
    v_mul_f32 v97, v97, v202
    v_mul_f32 v98, v98, v202
    v_mul_f32 v99, v99, v202
    v_mul_f32 v100, v100, v202
    v_mul_f32 v101, v101, v202
    v_mul_f32 v102, v102, v202
    v_mul_f32 v103, v103, v202
    v_mul_f32 v104, v104, v202
    v_mul_f32 v105, v105, v202
    v_mul_f32 v106, v106, v202
    v_mul_f32 v107, v107, v202
    v_mul_f32 v108, v108, v202
    v_mul_f32 v109, v109, v202
    v_mul_f32 v110, v110, v202
    v_mul_f32 v111, v111, v202
    v_mul_f32 v112, v112, v202
    v_mul_f32 v113, v113, v202
    v_mul_f32 v114, v114, v202
    v_mul_f32 v115, v115, v202
    v_mul_f32 v116, v116, v202
    v_mul_f32 v117, v117, v202
    v_mul_f32 v118, v118, v202
    v_mul_f32 v119, v119, v202
    v_mul_f32 v120, v120, v202
    v_mul_f32 v121, v121, v202
    v_mul_f32 v122, v122, v202
    v_mul_f32 v123, v123, v202
    v_mul_f32 v124, v124, v202
    v_mul_f32 v125, v125, v202
    v_mul_f32 v126, v126, v202
    v_mul_f32 v127, v127, v202
    v_exp_f32 v192, v16
    v_exp_f32 v193, v17
    v_exp_f32 v194, v18
    v_exp_f32 v195, v19
    v_cvt_pk_bf16_f32 v56, v192, v193
    v_exp_f32 v196, v20
    v_add_f32 v242, v192, v194
    v_exp_f32 v197, v21
    v_add_f32 v243, v193, v195
    v_cvt_pk_bf16_f32 v57, v194, v195
    v_exp_f32 v198, v22
    v_add_f32 v242, v242, v196
    v_exp_f32 v199, v23
    v_add_f32 v243, v243, v197
    v_cvt_pk_bf16_f32 v60, v196, v197
    v_exp_f32 v192, v24
    v_add_f32 v242, v242, v198
    v_exp_f32 v193, v25
    v_add_f32 v243, v243, v199
    v_cvt_pk_bf16_f32 v61, v198, v199
    v_exp_f32 v194, v26
    v_add_f32 v242, v242, v192
    v_exp_f32 v195, v27
    v_add_f32 v243, v243, v193
    v_cvt_pk_bf16_f32 v58, v192, v193
    v_exp_f32 v196, v28
    v_add_f32 v242, v242, v194
    v_exp_f32 v197, v29
    v_add_f32 v243, v243, v195
    v_cvt_pk_bf16_f32 v59, v194, v195
    v_exp_f32 v198, v30
    v_add_f32 v242, v242, v196
    v_exp_f32 v199, v31
    v_add_f32 v243, v243, v197
    v_cvt_pk_bf16_f32 v62, v196, v197
    v_add_f32 v242, v242, v198
    v_add_f32 v243, v243, v199
    v_cvt_pk_bf16_f32 v63, v198, v199
    v_add_f32 v242, v242, v243
    s_nop 3
    s_branch H_E2_ret0
P4_fin:
    s_cmp_eq_u32 s15, 0
    s_cbranch_scc1 P4_own0
    v_bfi_b32 v128, v228, v229, v128
    v_bfi_b32 v129, v228, v229, v129
    v_bfi_b32 v130, v228, v229, v130
    v_bfi_b32 v131, v228, v229, v131
    buffer_store_dwordx4 v[128:131], v254, s[16:19], s54 offen offset:0 sc1
    v_bfi_b32 v144, v228, v229, v144
    v_bfi_b32 v145, v228, v229, v145
    v_bfi_b32 v146, v228, v229, v146
    v_bfi_b32 v147, v228, v229, v147
    buffer_store_dwordx4 v[144:147], v254, s[16:19], s54 offen offset:1024 sc1
    s_branch P4_nx0
P4_own0:
    v_mov_b32 v0, v128
    v_mov_b32 v1, v129
    v_mov_b32 v2, v130
    v_mov_b32 v3, v131
    v_mov_b32 v4, v144
    v_mov_b32 v5, v145
    v_mov_b32 v6, v146
    v_mov_b32 v7, v147
P4_nx0:
    s_add_u32 s54, s54, 65536
    s_cmp_eq_u32 s15, 1
    s_cbranch_scc1 P4_own1
    v_bfi_b32 v132, v228, v229, v132
    v_bfi_b32 v133, v228, v229, v133
    v_bfi_b32 v134, v228, v229, v134
    v_bfi_b32 v135, v228, v229, v135
    buffer_store_dwordx4 v[132:135], v254, s[16:19], s54 offen offset:0 sc1
    v_bfi_b32 v148, v228, v229, v148
    v_bfi_b32 v149, v228, v229, v149
    v_bfi_b32 v150, v228, v229, v150
    v_bfi_b32 v151, v228, v229, v151
    buffer_store_dwordx4 v[148:151], v254, s[16:19], s54 offen offset:1024 sc1
    s_branch P4_nx1
P4_own1:
    v_mov_b32 v0, v132
    v_mov_b32 v1, v133
    v_mov_b32 v2, v134
    v_mov_b32 v3, v135
    v_mov_b32 v4, v148
    v_mov_b32 v5, v149
    v_mov_b32 v6, v150
    v_mov_b32 v7, v151
P4_nx1:
    s_add_u32 s54, s54, 65536
    s_cmp_eq_u32 s15, 2
    s_cbranch_scc1 P4_own2
    v_bfi_b32 v136, v228, v229, v136
    v_bfi_b32 v137, v228, v229, v137
    v_bfi_b32 v138, v228, v229, v138
    v_bfi_b32 v139, v228, v229, v139
    buffer_store_dwordx4 v[136:139], v254, s[16:19], s54 offen offset:0 sc1
    v_bfi_b32 v152, v228, v229, v152
    v_bfi_b32 v153, v228, v229, v153
    v_bfi_b32 v154, v228, v229, v154
    v_bfi_b32 v155, v228, v229, v155
    buffer_store_dwordx4 v[152:155], v254, s[16:19], s54 offen offset:1024 sc1
    s_branch P4_nx2
P4_own2:
    v_mov_b32 v0, v136
    v_mov_b32 v1, v137
    v_mov_b32 v2, v138
    v_mov_b32 v3, v139
    v_mov_b32 v4, v152
    v_mov_b32 v5, v153
    v_mov_b32 v6, v154
    v_mov_b32 v7, v155
P4_nx2:
    s_add_u32 s54, s54, 65536
    s_cmp_eq_u32 s15, 3
    s_cbranch_scc1 P4_own3
    v_bfi_b32 v140, v228, v229, v140
    v_bfi_b32 v141, v228, v229, v141
    v_bfi_b32 v142, v228, v229, v142
    v_bfi_b32 v143, v228, v229, v143
    buffer_store_dwordx4 v[140:143], v254, s[16:19], s54 offen offset:0 sc1
    v_bfi_b32 v156, v228, v229, v156
    v_bfi_b32 v157, v228, v229, v157
    v_bfi_b32 v158, v228, v229, v158
    v_bfi_b32 v159, v228, v229, v159
    buffer_store_dwordx4 v[156:159], v254, s[16:19], s54 offen offset:1024 sc1
    s_branch P4_nx3
P4_own3:
    v_mov_b32 v0, v140
    v_mov_b32 v1, v141
    v_mov_b32 v2, v142
    v_mov_b32 v3, v143
    v_mov_b32 v4, v156
    v_mov_b32 v5, v157
    v_mov_b32 v6, v158
    v_mov_b32 v7, v159
P4_nx3:
    s_add_u32 s54, s54, 65536
    v_lshlrev_b32 v8, 16, v222
    v_and_b32 v9, 0xffff0000, v222
    v_lshlrev_b32 v10, 16, v223
    v_and_b32 v11, 0xffff0000, v223
    v_lshlrev_b32 v12, 16, v224
    v_and_b32 v13, 0xffff0000, v224
    v_lshlrev_b32 v14, 16, v225
    v_and_b32 v15, 0xffff0000, v225
    v_add_f32 v0, v0, v8
    v_add_f32 v1, v1, v9
    v_add_f32 v2, v2, v10
    v_add_f32 v3, v3, v11
    v_add_f32 v4, v4, v12
    v_add_f32 v5, v5, v13
    v_add_f32 v6, v6, v14
    v_add_f32 v7, v7, v15
    s_mov_b32 s57, 0x40000
P4_poll:
    s_add_u32 s54, s15, 1
    s_and_b32 s54, s54, 3
    s_lshl_b32 s54, s54, 14
    s_add_u32 s54, s54, s56
    buffer_load_dwordx4 v[16:19], v254, s[16:19], s54 offen offset:0 sc1
    buffer_load_dwordx4 v[20:23], v254, s[16:19], s54 offen offset:1024 sc1
    s_add_u32 s54, s15, 2
    s_and_b32 s54, s54, 3
    s_lshl_b32 s54, s54, 14
    s_add_u32 s54, s54, s56
    buffer_load_dwordx4 v[24:27], v254, s[16:19], s54 offen offset:0 sc1
    buffer_load_dwordx4 v[28:31], v254, s[16:19], s54 offen offset:1024 sc1
    s_add_u32 s54, s15, 3
    s_and_b32 s54, s54, 3
    s_lshl_b32 s54, s54, 14
    s_add_u32 s54, s54, s56
    buffer_load_dwordx4 v[32:35], v254, s[16:19], s54 offen offset:0 sc1
    buffer_load_dwordx4 v[36:39], v254, s[16:19], s54 offen offset:1024 sc1
    s_waitcnt vmcnt(0)
    v_xor_b32 v16, v16, v229
    v_xor_b32 v17, v17, v229
    v_xor_b32 v18, v18, v229
    v_xor_b32 v19, v19, v229
    v_xor_b32 v20, v20, v229
    v_xor_b32 v21, v21, v229
    v_xor_b32 v22, v22, v229
    v_xor_b32 v23, v23, v229
    v_xor_b32 v24, v24, v229
    v_xor_b32 v25, v25, v229
    v_xor_b32 v26, v26, v229
    v_xor_b32 v27, v27, v229
    v_xor_b32 v28, v28, v229
    v_xor_b32 v29, v29, v229
    v_xor_b32 v30, v30, v229
    v_xor_b32 v31, v31, v229
    v_xor_b32 v32, v32, v229
    v_xor_b32 v33, v33, v229
    v_xor_b32 v34, v34, v229
    v_xor_b32 v35, v35, v229
    v_xor_b32 v36, v36, v229
    v_xor_b32 v37, v37, v229
    v_xor_b32 v38, v38, v229
    v_xor_b32 v39, v39, v229
    v_or_b32 v230, v16, v17
    v_or3_b32 v230, v230, v18, v19
    v_or3_b32 v230, v230, v20, v21
    v_or3_b32 v230, v230, v22, v23
    v_or3_b32 v230, v230, v24, v25
    v_or3_b32 v230, v230, v26, v27
    v_or3_b32 v230, v230, v28, v29
    v_or3_b32 v230, v230, v30, v31
    v_or3_b32 v230, v230, v32, v33
    v_or3_b32 v230, v230, v34, v35
    v_or3_b32 v230, v230, v36, v37
    v_or3_b32 v230, v230, v38, v39
    v_and_b32 v230, 0xff, v230
    v_cmp_ne_u32 vcc, 0, v230
    s_sub_u32 s57, s57, 1
    s_cbranch_scc1 P4_ok
    s_cbranch_vccnz P4_poll
P4_ok:
    v_add_f32 v0, v0, v16
    v_add_f32 v1, v1, v17
    v_add_f32 v2, v2, v18
    v_add_f32 v3, v3, v19
    v_add_f32 v4, v4, v20
    v_add_f32 v5, v5, v21
    v_add_f32 v6, v6, v22
    v_add_f32 v7, v7, v23
    v_add_f32 v0, v0, v24
    v_add_f32 v1, v1, v25
    v_add_f32 v2, v2, v26
    v_add_f32 v3, v3, v27
    v_add_f32 v4, v4, v28
    v_add_f32 v5, v5, v29
    v_add_f32 v6, v6, v30
    v_add_f32 v7, v7, v31
    v_add_f32 v0, v0, v32
    v_add_f32 v1, v1, v33
    v_add_f32 v2, v2, v34
    v_add_f32 v3, v3, v35
    v_add_f32 v4, v4, v36
    v_add_f32 v5, v5, v37
    v_add_f32 v6, v6, v38
    v_add_f32 v7, v7, v39
    v_cvt_pk_bf16_f32 v222, v0, v1
    v_cvt_pk_bf16_f32 v223, v2, v3
    v_cvt_pk_bf16_f32 v224, v4, v5
    v_cvt_pk_bf16_f32 v225, v6, v7
    buffer_store_dwordx2 v[222:223], v234, s[28:31], 0 offen
    buffer_store_dwordx2 v[224:225], v234, s[28:31], 0 offen offset:32
    s_or_b32 s54, s2, s50
    s_cmp_lg_u32 s54, 0
    s_cbranch_scc1 P4_noep
    s_mov_b32 s54, 58720256
    s_mov_b64 exec, 1
    buffer_store_dword v251, off, s[16:19], s54 sc1
    s_mov_b64 exec, -1
P4_noep:
F_end:
    s_endpgm
.section .rodata,"a"
.p2align 6
.amdhsa_kernel parallel_sum__compressed_kv_cla__glu_gated_reglu__prompt_kernel
  .amdhsa_next_free_vgpr 256
  .amdhsa_next_free_sgpr 102
  .amdhsa_accum_offset 256
  .amdhsa_group_segment_fixed_size 0
  .amdhsa_kernarg_size 104
  .amdhsa_user_sgpr_count 2
  .amdhsa_user_sgpr_kernarg_segment_ptr 1
  .amdhsa_system_sgpr_workgroup_id_x 1
.end_amdhsa_kernel
```
